```python
import torch

def _softmax(x, axis=-1):
    return torch.softmax(x, dim=axis)
def _gelu(x):
    return torch.nn.functional.gelu(x, approximate="tanh")
def _silu(x):
    return torch.nn.functional.silu(x)
def _sigmoid(x):
    return torch.sigmoid(x)
def _layernorm(x, axis=-1, eps=1e-5):
    m = x.mean(dim=axis, keepdim=True)
    v = x.var(dim=axis, keepdim=True, unbiased=False)
    return (x - m) / torch.sqrt(v + eps)
def _scatter_add(tgt, idx, src, axis=0):
    return tgt.clone().index_add_(axis, idx, src)
def _segment_sum(src, seg, n):
    out = torch.zeros((n,) + src.shape[1:], dtype=src.dtype)
    return out.index_add_(0, seg, src)
def _pad(x, pw):
    flat = tuple(v for pair in reversed(pw) for v in pair)
    return torch.nn.functional.pad(x, flat)

kernel_name = 'concat_heads__mha_block_cached__mha_block_cached__near_ridge'

def setup_inputs():

    _w = (lambda a: (lambda t: t.to(torch.bfloat16) if t.is_floating_point() else t)(torch.as_tensor(a)))
    def _A_setup():
        B, Sq, D = 8, 256, 448
        H, Sk, Dh = 16, 1024, 256
        return {
            "x": _w((lambda *s: torch.randn(*s, dtype=torch.bfloat16) * 0.8)(B, Sq, D)),
            "k_cache": _w((lambda *s: torch.randn(*s, dtype=torch.bfloat16) * 0.8)(B, H, Sk, Dh)),
            "v_cache": _w((lambda *s: torch.randn(*s, dtype=torch.bfloat16) * 0.05)(B, H, Sk, Dh)),
            "wq": _w((lambda *s: torch.randn(*s, dtype=torch.bfloat16) * 0.8)(D, H * Dh) * (D ** -0.5)),
            "wo": _w((lambda *s: torch.randn(*s, dtype=torch.bfloat16) * 0.05)(H * Dh, D) * ((H * Dh) ** -0.5)),
        }
    _A_in = _A_setup()

    def _B_setup():
        B, Sq, D = 8, 256, 448
        H, Sk, Dh = 16, 1024, 256
        return {
            "x": _w((lambda *s: torch.randn(*s, dtype=torch.bfloat16) * 0.8)(B, Sq, D)),
            "k_cache": _w((lambda *s: torch.randn(*s, dtype=torch.bfloat16) * 0.8)(B, H, Sk, Dh)),
            "v_cache": _w((lambda *s: torch.randn(*s, dtype=torch.bfloat16) * 0.05)(B, H, Sk, Dh)),
            "wq": _w((lambda *s: torch.randn(*s, dtype=torch.bfloat16) * 0.8)(D, H * Dh) * (D ** -0.5)),
            "wo": _w((lambda *s: torch.randn(*s, dtype=torch.bfloat16) * 0.05)(H * Dh, D) * ((H * Dh) ** -0.5)),
        }
    _B_in = _B_setup()

    return {
        "A_x": _A_in["x"],
        "A_k_cache": _A_in["k_cache"],
        "A_v_cache": _A_in["v_cache"],
        "A_wq": _A_in["wq"],
        "A_wo": _A_in["wo"],
        "B_x": _B_in["x"],
        "B_k_cache": _B_in["k_cache"],
        "B_v_cache": _B_in["v_cache"],
        "B_wq": _B_in["wq"],
        "B_wo": _B_in["wo"],
    }

def reference(A_x, A_k_cache, A_v_cache, A_wq, A_wo, B_x, B_k_cache, B_v_cache, B_wq, B_wo):
    def _A_ref(x, k_cache, v_cache, wq, wo):
        B, Sq, D = x.shape
        H, Dh = 16, 256
        q = (lambda x, *d: x.permute(*d))((x @ wq).reshape(B, Sq, H, Dh), 0, 2, 1, 3)
        scores = torch.einsum("bhqd,bhkd->bhqk", q, k_cache) * (Dh ** -0.5)
        p = _softmax(scores, axis=-1)
        o = torch.einsum("bhqk,bhkd->bhqd", p, v_cache)
        return (lambda x, *d: x.permute(*d))(o, 0, 2, 1, 3).reshape(B, Sq, H * Dh) @ wo

    def _B_ref(x, k_cache, v_cache, wq, wo):
        B, Sq, D = x.shape
        H, Dh = 16, 256
        q = (lambda x, *d: x.permute(*d))((x @ wq).reshape(B, Sq, H, Dh), 0, 2, 1, 3)
        scores = torch.einsum("bhqd,bhkd->bhqk", q, k_cache) * (Dh ** -0.5)
        p = _softmax(scores, axis=-1)
        o = torch.einsum("bhqk,bhkd->bhqd", p, v_cache)
        return (lambda x, *d: x.permute(*d))(o, 0, 2, 1, 3).reshape(B, Sq, H * Dh) @ wo

    a = _A_ref(A_x, A_k_cache, A_v_cache, A_wq, A_wo)
    b = _B_ref(B_x, B_k_cache, B_v_cache, B_wq, B_wo)
    return torch.concatenate([a, b], axis=-1)
```

```asm
; @launch grid=(256,1,1) block=(256,1,1) lds=152064
.amdgcn_target "amdgcn-amd-amdhsa--gfx950"
.text
.set CODE_BYTES, CODE_END - concat_heads__mha_block_cached__mha_block_cached__near_ridge_kernel
.globl concat_heads__mha_block_cached__mha_block_cached__near_ridge_kernel
.p2align 8
.type concat_heads__mha_block_cached__mha_block_cached__near_ridge_kernel,@function
concat_heads__mha_block_cached__mha_block_cached__near_ridge_kernel:
    s_cmp_ge_u32 s2, 0x100
    s_cbranch_scc1 L_end
    s_load_dwordx8 s[40:47], s[0:1], 0
    s_load_dwordx2 s[48:49], s[0:1], 32
    s_load_dwordx8 s[52:59], s[0:1], 40
    s_load_dwordx2 s[60:61], s[0:1], 72
    s_load_dwordx2 s[62:63], s[0:1], 96
    s_load_dwordx4 s[36:39], s[0:1], 80
    s_getpc_b64 s[8:9]
    s_and_b32 s8, s8, 0xffffff00
    s_and_b32 s9, s9, 0xffff
    s_mov_b32 s10, CODE_BYTES
    s_mov_b32 s11, 0x20000
    s_lshr_b32 s12, s2, 3
    s_lshl_b32 s12, s12, 12
    v_lshlrev_b32 v12, 4, v0
    buffer_load_dwordx4 v[16:19], v12, s[8:11], s12 offen
    v_and_b32 v250, 63, v0
    v_lshrrev_b32 v1, 6, v0
    s_and_b32 s4, s2, 7
    s_lshr_b32 s5, s2, 3
    v_readfirstlane_b32 s32, v1
    s_lshr_b32 s6, s4, 2
    s_and_b32 s4, s4, 3
    s_lshl_b32 s4, s4, 1
    s_lshr_b32 s7, s5, 4
    s_add_u32 s4, s4, s7
    s_and_b32 s5, s5, 15
    s_waitcnt lgkmcnt(0)
    s_cmp_eq_u32 s6, 0
    s_cselect_b64 s[40:41], s[40:41], s[52:53]
    s_cselect_b64 s[42:43], s[42:43], s[54:55]
    s_cselect_b64 s[44:45], s[44:45], s[56:57]
    s_cselect_b64 s[46:47], s[46:47], s[58:59]
    s_cselect_b64 s[48:49], s[48:49], s[60:61]
    s_lshl_b32 s7, s4, 4
    s_add_u32 s7, s7, s5
    s_lshl_b32 s50, s7, 19
    s_add_u32 s8, s42, s50
    s_addc_u32 s9, s43, 0
    s_and_b32 s9, s9, 0xffff
    s_mov_b32 s10, 0x80000
    s_mov_b32 s11, 0x20000
    s_add_u32 s12, s44, s50
    s_addc_u32 s13, s45, 0
    s_and_b32 s13, s13, 0xffff
    s_mov_b32 s14, 0x80000
    s_mov_b32 s15, 0x20000
    s_lshl_b32 s50, s5, 9
    s_add_u32 s16, s46, s50
    s_addc_u32 s17, s47, 0
    s_and_b32 s17, s17, 0xffff
    s_sub_u32 s18, 0x380000, s50
    s_mov_b32 s19, 0x20000
    s_mul_i32 s50, s4, 0x38000
    s_add_u32 s20, s40, s50
    s_addc_u32 s21, s41, 0
    s_and_b32 s21, s21, 0xffff
    s_mov_b32 s22, 0x38000
    s_mov_b32 s23, 0x20000
    s_mul_i32 s50, s5, 0x38000
    s_add_u32 s24, s48, s50
    s_addc_u32 s25, s49, 0
    s_and_b32 s25, s25, 0xffff
    s_mov_b32 s26, 0x38000
    s_mov_b32 s27, 0x20000
    s_lshl_b32 s7, s6, 3
    s_add_u32 s7, s7, s4
    s_mul_i32 s50, s7, 0x380000
    s_add_u32 s28, s62, s50
    s_addc_u32 s29, s63, 0
    s_and_b32 s29, s29, 0xffff
    s_mov_b32 s30, 0x380000
    s_mov_b32 s31, 0x20000
    s_lshl_b32 s60, s7, 4
    s_add_u32 s48, s38, s60
    s_addc_u32 s49, s39, 0
    s_and_b32 s49, s49, 0xffff
    s_mov_b32 s50, 0x10
    s_mov_b32 s51, 0x20000
    s_lshl_b32 s60, s7, 8
    s_add_u32 s60, s60, 0x3c00000
    s_add_u32 s52, s62, s60
    s_addc_u32 s53, s63, 0
    s_and_b32 s53, s53, 0xffff
    s_mov_b32 s54, 0x100
    s_mov_b32 s55, 0x20000
    s_lshl_b32 s60, s4, 8
    s_lshl_b32 s61, s5, 4
    s_add_u32 s60, s60, s61
    s_mul_i32 s60, s60, 1792
    s_mul_i32 s61, s6, 896
    s_add_u32 s60, s60, s61
    s_add_u32 s56, s36, s60
    s_addc_u32 s57, s37, 0
    s_and_b32 s57, s57, 0xffff
    s_sub_u32 s58, 0x380000, s60
    s_mov_b32 s59, 0x20000
    s_mov_b32 s46, s5
    s_lshl_b32 s60, s5, 2
    s_add_u32 s60, s60, s32
    s_lshl_b32 s47, s60, 2
    s_getreg_b32 s45, hwreg(HW_REG_XCC_ID, 0, 4)
    s_mov_b32 s64, s2
    s_lshr_b32 s7, s2, 3
    s_mul_i32 s60, s7, 43
    s_lshr_b32 s60, s60, 8
    s_mul_i32 s60, s60, 6
    s_sub_u32 s7, s7, s60
    s_add_u32 s7, s7, 2
    s_cmp_eq_u32 s32, 0
    s_cselect_b32 s3, s7, 0
    s_mul_i32 s33, s32, 4224
    s_mul_i32 s43, s32, 8448
    s_mov_b32 s34, 0x10000
    s_mov_b32 s35, 0xc000
    s_mov_b32 s37, 0x4e800000
    s_mov_b32 s39, 0x3db8aa3b
    v_and_b32 v1, 15, v250
    v_lshrrev_b32 v2, 4, v250
    v_lshrrev_b32 v3, 2, v1
    v_and_b32 v4, 3, v1
    v_lshrrev_b32 v5, 3, v250
    v_lshrrev_b32 v6, 2, v5
    v_and_b32 v5, 3, v5
    v_lshlrev_b32 v5, 4, v5
    v_lshl_add_u32 v5, v6, 3, v5
    s_lshl_b32 s7, s32, 6
    v_add_u32 v5, s7, v5
    v_mul_u32_u24 v5, 896, v5
    v_and_b32 v6, 7, v250
    v_lshl_add_u32 v132, v6, 4, v5
    s_and_b32 s7, s32, 1
    s_lshl_b32 s7, s7, 3
    s_lshr_b32 s6, s32, 1
    s_lshl_b32 s6, s6, 2
    s_add_u32 s7, s7, s6
    v_lshlrev_b32 v5, 4, v2
    v_add_u32 v5, s7, v5
    v_lshlrev_b32 v5, 13, v5
    v_lshl_add_u32 v131, v1, 4, v5
    s_mov_b32 s40, 0x0
    s_add_u32 m0, s43, 0
    s_nop 0
    buffer_load_dwordx4 v132, s[20:23], s40 offen  lds
    s_mov_b32 s40, 0x380
    s_add_u32 m0, s43, 1056
    s_nop 0
    buffer_load_dwordx4 v132, s[20:23], s40 offen  lds
    s_mov_b32 s40, 0x700
    s_add_u32 m0, s43, 2112
    s_nop 0
    buffer_load_dwordx4 v132, s[20:23], s40 offen  lds
    s_mov_b32 s40, 0xa80
    s_add_u32 m0, s43, 3168
    s_nop 0
    buffer_load_dwordx4 v132, s[20:23], s40 offen  lds
    s_mov_b32 s40, 0xe00
    s_add_u32 m0, s43, 4224
    s_nop 0
    buffer_load_dwordx4 v132, s[20:23], s40 offen  lds
    s_mov_b32 s40, 0x1180
    s_add_u32 m0, s43, 5280
    s_nop 0
    buffer_load_dwordx4 v132, s[20:23], s40 offen  lds
    s_mov_b32 s40, 0x1500
    s_add_u32 m0, s43, 6336
    s_nop 0
    buffer_load_dwordx4 v132, s[20:23], s40 offen  lds
    s_mov_b32 s40, 0x1880
    s_add_u32 m0, s43, 7392
    s_nop 0
    buffer_load_dwordx4 v132, s[20:23], s40 offen  lds
    s_mov_b32 s40, 0x0
    s_add_u32 m0, s33, 33792
    s_nop 0
    buffer_load_dwordx4 v131, s[16:19], s40 offen  lds
    s_mov_b32 s40, 0x2000
    s_add_u32 m0, s33, 34824
    s_nop 0
    buffer_load_dwordx4 v131, s[16:19], s40 offen  lds
    s_mov_b32 s40, 0x4000
    s_add_u32 m0, s33, 35904
    s_nop 0
    buffer_load_dwordx4 v131, s[16:19], s40 offen  lds
    s_mov_b32 s40, 0x6000
    s_add_u32 m0, s33, 36936
    s_nop 0
    buffer_load_dwordx4 v131, s[16:19], s40 offen  lds
    s_mov_b32 s40, 0x100
    s_add_u32 m0, s33, 50688
    s_nop 0
    buffer_load_dwordx4 v131, s[16:19], s40 offen  lds
    s_mov_b32 s40, 0x2100
    s_add_u32 m0, s33, 51720
    s_nop 0
    buffer_load_dwordx4 v131, s[16:19], s40 offen  lds
    s_mov_b32 s40, 0x4100
    s_add_u32 m0, s33, 52800
    s_nop 0
    buffer_load_dwordx4 v131, s[16:19], s40 offen  lds
    s_mov_b32 s40, 0x6100
    s_add_u32 m0, s33, 53832
    s_nop 0
    buffer_load_dwordx4 v131, s[16:19], s40 offen  lds
    s_mov_b32 s40, 0x80
    s_add_u32 m0, s43, 67584
    s_nop 0
    buffer_load_dwordx4 v132, s[20:23], s40 offen  lds
    s_mov_b32 s40, 0x400
    s_add_u32 m0, s43, 68640
    s_nop 0
    buffer_load_dwordx4 v132, s[20:23], s40 offen  lds
    s_mov_b32 s40, 0x780
    s_add_u32 m0, s43, 69696
    s_nop 0
    buffer_load_dwordx4 v132, s[20:23], s40 offen  lds
    s_mov_b32 s40, 0xb00
    s_add_u32 m0, s43, 70752
    s_nop 0
    buffer_load_dwordx4 v132, s[20:23], s40 offen  lds
    s_mov_b32 s40, 0xe80
    s_add_u32 m0, s43, 71808
    s_nop 0
    buffer_load_dwordx4 v132, s[20:23], s40 offen  lds
    s_mov_b32 s40, 0x1200
    s_add_u32 m0, s43, 72864
    s_nop 0
    buffer_load_dwordx4 v132, s[20:23], s40 offen  lds
    s_mov_b32 s40, 0x1580
    s_add_u32 m0, s43, 73920
    s_nop 0
    buffer_load_dwordx4 v132, s[20:23], s40 offen  lds
    s_mov_b32 s40, 0x1900
    s_add_u32 m0, s43, 74976
    s_nop 0
    buffer_load_dwordx4 v132, s[20:23], s40 offen  lds
    s_mov_b32 s40, 0x80000
    s_add_u32 m0, s33, 101376
    s_nop 0
    buffer_load_dwordx4 v131, s[16:19], s40 offen  lds
    s_mov_b32 s40, 0x82000
    s_add_u32 m0, s33, 102408
    s_nop 0
    buffer_load_dwordx4 v131, s[16:19], s40 offen  lds
    s_mov_b32 s40, 0x84000
    s_add_u32 m0, s33, 103488
    s_nop 0
    buffer_load_dwordx4 v131, s[16:19], s40 offen  lds
    s_mov_b32 s40, 0x86000
    s_add_u32 m0, s33, 104520
    s_nop 0
    buffer_load_dwordx4 v131, s[16:19], s40 offen  lds
    s_mov_b32 s40, 0x80100
    s_add_u32 m0, s33, 118272
    s_nop 0
    buffer_load_dwordx4 v131, s[16:19], s40 offen  lds
    s_mov_b32 s40, 0x82100
    s_add_u32 m0, s33, 119304
    s_nop 0
    buffer_load_dwordx4 v131, s[16:19], s40 offen  lds
    s_mov_b32 s40, 0x84100
    s_add_u32 m0, s33, 120384
    s_nop 0
    buffer_load_dwordx4 v131, s[16:19], s40 offen  lds
    s_mov_b32 s40, 0x86100
    s_add_u32 m0, s33, 121416
    s_nop 0
    buffer_load_dwordx4 v131, s[16:19], s40 offen  lds
    v_mov_b32 v9, 0
    s_mov_b64 exec, 1
    buffer_store_dword v9, off, s[52:55], s47 sc1
    s_add_u32 s4, s52, 0x10000
    s_addc_u32 s5, s53, 0
    s_mov_b32 s6, 256
    s_mov_b32 s7, 0x20000
    buffer_store_dword v9, off, s[4:7], s47 sc1
    s_mov_b64 exec, -1
    v_and_b32 v5, 7, v1
    v_mul_u32_u24 v5, 1056, v5
    v_lshrrev_b32 v6, 3, v1
    v_lshl_add_u32 v5, v6, 9, v5
    v_lshl_add_u32 v5, v2, 4, v5
    v_add_u32 v130, s43, v5
    v_add_u32 v246, 0x21000, v5
    v_and_b32 v5, 1, v2
    v_lshl_add_u32 v5, v5, 2, v3
    v_mov_b32 v7, v5
    v_mul_u32_u24 v5, 1056, v5
    v_lshrrev_b32 v6, 1, v2
    v_lshl_add_u32 v5, v6, 9, v5
    v_lshl_add_u32 v5, v4, 3, v5
    v_add_u32 v247, 0x18c00, v5
    v_lshlrev_b32 v5, 10, v7
    v_lshrrev_b32 v8, 1, v7
    v_lshl_add_u32 v5, v8, 6, v5
    v_and_b32 v8, 1, v7
    v_lshl_add_u32 v5, v8, 3, v5
    v_lshl_add_u32 v5, v6, 8, v5
    v_lshl_add_u32 v128, v4, 4, v5
    s_lshr_b32 s7, s32, 1
    s_lshl_b32 s7, s7, 13
    s_and_b32 s6, s32, 1
    s_lshl_b32 s6, s6, 11
    s_add_u32 s7, s7, s6
    v_lshrrev_b32 v5, 5, v250
    v_lshlrev_b32 v5, 12, v5
    v_and_b32 v6, 31, v250
    v_lshl_add_u32 v5, v6, 4, v5
    v_add_u32 v248, s7, v5
    v_and_b32 v238, 15, v250
    v_lshrrev_b32 v239, 4, v250
    v_lshrrev_b32 v240, 2, v238
    v_and_b32 v241, 3, v238
    v_and_b32 v242, 1, v239
    v_lshl_add_u32 v242, v242, 2, v240
    v_mul_u32_u24 v242, 1056, v242
    v_lshrrev_b32 v243, 1, v239
    v_lshl_add_u32 v242, v243, 7, v242
    v_lshl_add_u32 v251, v241, 3, v242
    s_lshr_b32 s7, s32, 1
    s_lshl_b32 s7, s7, 6
    s_and_b32 s6, s32, 1
    s_lshl_b32 s6, s6, 2
    s_add_u32 s7, s7, s6
    v_lshrrev_b32 v242, 3, v250
    v_lshlrev_b32 v242, 3, v242
    v_add_u32 v242, s7, v242
    v_mul_u32_u24 v242, 896, v242
    v_and_b32 v243, 7, v250
    v_lshl_add_u32 v252, v243, 4, v242
    s_lshl_b32 s7, s46, 14
    s_lshl_b32 s6, s32, 12
    s_add_u32 s7, s7, s6
    v_lshlrev_b32 v242, 4, v250
    v_add_u32 v253, s7, v242
    s_lshl_b32 s7, s46, 10
    s_lshl_b32 s6, s32, 8
    s_add_u32 s7, s7, s6
    v_lshlrev_b32 v242, 14, v239
    v_lshl_add_u32 v242, v238, 4, v242
    v_add_u32 v255, s7, v242
    s_waitcnt vmcnt(22)
    s_barrier
    v_add_u32 v254, 0x0, v130
    v_add_u32 v129, 0x8400, v128
    ds_read_b128 v[0:3], v254 offset:0
    ds_read_b128 v[4:7], v254 offset:128
    ds_read_b128 v[8:11], v254 offset:256
    ds_read_b128 v[12:15], v254 offset:384
    ds_read_b128 v[16:19], v254 offset:64
    ds_read_b128 v[20:23], v254 offset:192
    ds_read_b128 v[24:27], v254 offset:320
    ds_read_b128 v[28:31], v254 offset:448
    ds_read_b64_tr_b16 v[216:217], v129 offset:0
    ds_read_b64_tr_b16 v[218:219], v129 offset:8448
    ds_read_b64_tr_b16 v[220:221], v129 offset:512
    ds_read_b64_tr_b16 v[222:223], v129 offset:8960
    s_waitcnt lgkmcnt(0)
    v_mfma_f32_16x16x32_bf16 a[0:3], v[216:219], v[0:3], 0
    ds_read_b64_tr_b16 v[224:225], v129 offset:8
    v_mfma_f32_16x16x32_bf16 a[0:3], v[220:223], v[16:19], a[0:3]
    ds_read_b64_tr_b16 v[226:227], v129 offset:8456
    v_mfma_f32_16x16x32_bf16 a[4:7], v[216:219], v[4:7], 0
    ds_read_b64_tr_b16 v[228:229], v129 offset:520
    v_mfma_f32_16x16x32_bf16 a[4:7], v[220:223], v[20:23], a[4:7]
    ds_read_b64_tr_b16 v[230:231], v129 offset:8968
    v_mfma_f32_16x16x32_bf16 a[8:11], v[216:219], v[8:11], 0
    v_mfma_f32_16x16x32_bf16 a[8:11], v[220:223], v[24:27], a[8:11]
    v_mfma_f32_16x16x32_bf16 a[12:15], v[216:219], v[12:15], 0
    v_mfma_f32_16x16x32_bf16 a[12:15], v[220:223], v[28:31], a[12:15]
    s_waitcnt lgkmcnt(0)
    v_mfma_f32_16x16x32_bf16 a[16:19], v[224:227], v[0:3], 0
    ds_read_b64_tr_b16 v[216:217], v129 offset:64
    v_mfma_f32_16x16x32_bf16 a[16:19], v[228:231], v[16:19], a[16:19]
    ds_read_b64_tr_b16 v[218:219], v129 offset:8512
    v_mfma_f32_16x16x32_bf16 a[20:23], v[224:227], v[4:7], 0
    ds_read_b64_tr_b16 v[220:221], v129 offset:576
    v_mfma_f32_16x16x32_bf16 a[20:23], v[228:231], v[20:23], a[20:23]
    ds_read_b64_tr_b16 v[222:223], v129 offset:9024
    v_mfma_f32_16x16x32_bf16 a[24:27], v[224:227], v[8:11], 0
    v_mfma_f32_16x16x32_bf16 a[24:27], v[228:231], v[24:27], a[24:27]
    v_mfma_f32_16x16x32_bf16 a[28:31], v[224:227], v[12:15], 0
    v_mfma_f32_16x16x32_bf16 a[28:31], v[228:231], v[28:31], a[28:31]
    s_waitcnt lgkmcnt(0)
    v_mfma_f32_16x16x32_bf16 a[32:35], v[216:219], v[0:3], 0
    ds_read_b64_tr_b16 v[224:225], v129 offset:72
    v_mfma_f32_16x16x32_bf16 a[32:35], v[220:223], v[16:19], a[32:35]
    ds_read_b64_tr_b16 v[226:227], v129 offset:8520
    v_mfma_f32_16x16x32_bf16 a[36:39], v[216:219], v[4:7], 0
    ds_read_b64_tr_b16 v[228:229], v129 offset:584
    v_mfma_f32_16x16x32_bf16 a[36:39], v[220:223], v[20:23], a[36:39]
    ds_read_b64_tr_b16 v[230:231], v129 offset:9032
    v_mfma_f32_16x16x32_bf16 a[40:43], v[216:219], v[8:11], 0
    v_mfma_f32_16x16x32_bf16 a[40:43], v[220:223], v[24:27], a[40:43]
    v_mfma_f32_16x16x32_bf16 a[44:47], v[216:219], v[12:15], 0
    v_mfma_f32_16x16x32_bf16 a[44:47], v[220:223], v[28:31], a[44:47]
    s_waitcnt lgkmcnt(0)
    v_mfma_f32_16x16x32_bf16 a[48:51], v[224:227], v[0:3], 0
    ds_read_b64_tr_b16 v[216:217], v129 offset:128
    v_mfma_f32_16x16x32_bf16 a[48:51], v[228:231], v[16:19], a[48:51]
    ds_read_b64_tr_b16 v[218:219], v129 offset:8576
    v_mfma_f32_16x16x32_bf16 a[52:55], v[224:227], v[4:7], 0
    ds_read_b64_tr_b16 v[220:221], v129 offset:640
    v_mfma_f32_16x16x32_bf16 a[52:55], v[228:231], v[20:23], a[52:55]
    ds_read_b64_tr_b16 v[222:223], v129 offset:9088
    v_mfma_f32_16x16x32_bf16 a[56:59], v[224:227], v[8:11], 0
    v_mfma_f32_16x16x32_bf16 a[56:59], v[228:231], v[24:27], a[56:59]
    v_mfma_f32_16x16x32_bf16 a[60:63], v[224:227], v[12:15], 0
    v_mfma_f32_16x16x32_bf16 a[60:63], v[228:231], v[28:31], a[60:63]
    s_waitcnt lgkmcnt(0)
    v_mfma_f32_16x16x32_bf16 a[64:67], v[216:219], v[0:3], 0
    ds_read_b64_tr_b16 v[224:225], v129 offset:136
    v_mfma_f32_16x16x32_bf16 a[64:67], v[220:223], v[16:19], a[64:67]
    ds_read_b64_tr_b16 v[226:227], v129 offset:8584
    v_mfma_f32_16x16x32_bf16 a[68:71], v[216:219], v[4:7], 0
    ds_read_b64_tr_b16 v[228:229], v129 offset:648
    v_mfma_f32_16x16x32_bf16 a[68:71], v[220:223], v[20:23], a[68:71]
    ds_read_b64_tr_b16 v[230:231], v129 offset:9096
    v_mfma_f32_16x16x32_bf16 a[72:75], v[216:219], v[8:11], 0
    v_mfma_f32_16x16x32_bf16 a[72:75], v[220:223], v[24:27], a[72:75]
    v_mfma_f32_16x16x32_bf16 a[76:79], v[216:219], v[12:15], 0
    v_mfma_f32_16x16x32_bf16 a[76:79], v[220:223], v[28:31], a[76:79]
    s_waitcnt lgkmcnt(0)
    v_mfma_f32_16x16x32_bf16 a[80:83], v[224:227], v[0:3], 0
    ds_read_b64_tr_b16 v[216:217], v129 offset:192
    s_waitcnt vmcnt(18)
    s_barrier
    v_mfma_f32_16x16x32_bf16 a[80:83], v[228:231], v[16:19], a[80:83]
    ds_read_b64_tr_b16 v[218:219], v129 offset:8640
    v_mfma_f32_16x16x32_bf16 a[84:87], v[224:227], v[4:7], 0
    ds_read_b64_tr_b16 v[220:221], v129 offset:704
    v_mfma_f32_16x16x32_bf16 a[84:87], v[228:231], v[20:23], a[84:87]
    ds_read_b64_tr_b16 v[222:223], v129 offset:9152
    v_mfma_f32_16x16x32_bf16 a[88:91], v[224:227], v[8:11], 0
    v_mfma_f32_16x16x32_bf16 a[88:91], v[228:231], v[24:27], a[88:91]
    v_mfma_f32_16x16x32_bf16 a[92:95], v[224:227], v[12:15], 0
    v_mfma_f32_16x16x32_bf16 a[92:95], v[228:231], v[28:31], a[92:95]
    s_waitcnt lgkmcnt(0)
    v_mfma_f32_16x16x32_bf16 a[96:99], v[216:219], v[0:3], 0
    ds_read_b64_tr_b16 v[224:225], v129 offset:200
    v_mfma_f32_16x16x32_bf16 a[96:99], v[220:223], v[16:19], a[96:99]
    ds_read_b64_tr_b16 v[226:227], v129 offset:8648
    v_mfma_f32_16x16x32_bf16 a[100:103], v[216:219], v[4:7], 0
    ds_read_b64_tr_b16 v[228:229], v129 offset:712
    v_mfma_f32_16x16x32_bf16 a[100:103], v[220:223], v[20:23], a[100:103]
    ds_read_b64_tr_b16 v[230:231], v129 offset:9160
    v_mfma_f32_16x16x32_bf16 a[104:107], v[216:219], v[8:11], 0
    v_add_u32 v129, 0xc600, v128
    v_mfma_f32_16x16x32_bf16 a[104:107], v[220:223], v[24:27], a[104:107]
    v_mfma_f32_16x16x32_bf16 a[108:111], v[216:219], v[12:15], 0
    v_mfma_f32_16x16x32_bf16 a[108:111], v[220:223], v[28:31], a[108:111]
    s_waitcnt lgkmcnt(0)
    v_mfma_f32_16x16x32_bf16 a[112:115], v[224:227], v[0:3], 0
    ds_read_b64_tr_b16 v[216:217], v129 offset:0
    v_mfma_f32_16x16x32_bf16 a[112:115], v[228:231], v[16:19], a[112:115]
    ds_read_b64_tr_b16 v[218:219], v129 offset:8448
    v_mfma_f32_16x16x32_bf16 a[116:119], v[224:227], v[4:7], 0
    ds_read_b64_tr_b16 v[220:221], v129 offset:512
    v_mfma_f32_16x16x32_bf16 a[116:119], v[228:231], v[20:23], a[116:119]
    ds_read_b64_tr_b16 v[222:223], v129 offset:8960
    v_mfma_f32_16x16x32_bf16 a[120:123], v[224:227], v[8:11], 0
    v_mfma_f32_16x16x32_bf16 a[120:123], v[228:231], v[24:27], a[120:123]
    v_mfma_f32_16x16x32_bf16 a[124:127], v[224:227], v[12:15], 0
    v_mfma_f32_16x16x32_bf16 a[124:127], v[228:231], v[28:31], a[124:127]
    s_waitcnt lgkmcnt(0)
    v_mfma_f32_16x16x32_bf16 a[128:131], v[216:219], v[0:3], 0
    ds_read_b64_tr_b16 v[224:225], v129 offset:8
    v_mfma_f32_16x16x32_bf16 a[128:131], v[220:223], v[16:19], a[128:131]
    ds_read_b64_tr_b16 v[226:227], v129 offset:8456
    v_mfma_f32_16x16x32_bf16 a[132:135], v[216:219], v[4:7], 0
    ds_read_b64_tr_b16 v[228:229], v129 offset:520
    v_mfma_f32_16x16x32_bf16 a[132:135], v[220:223], v[20:23], a[132:135]
    s_mov_b32 s40, 0x100
    s_add_u32 m0, s43, 0
    ds_read_b64_tr_b16 v[230:231], v129 offset:8968
    v_mfma_f32_16x16x32_bf16 a[136:139], v[216:219], v[8:11], 0
    buffer_load_dwordx4 v132, s[20:23], s40 offen  lds
    v_mfma_f32_16x16x32_bf16 a[136:139], v[220:223], v[24:27], a[136:139]
    v_mfma_f32_16x16x32_bf16 a[140:143], v[216:219], v[12:15], 0
    v_mfma_f32_16x16x32_bf16 a[140:143], v[220:223], v[28:31], a[140:143]
    s_waitcnt lgkmcnt(0)
    s_mov_b32 s40, 0x480
    s_add_u32 m0, s43, 1056
    v_mfma_f32_16x16x32_bf16 a[144:147], v[224:227], v[0:3], 0
    ds_read_b64_tr_b16 v[216:217], v129 offset:64
    buffer_load_dwordx4 v132, s[20:23], s40 offen  lds
    v_mfma_f32_16x16x32_bf16 a[144:147], v[228:231], v[16:19], a[144:147]
    ds_read_b64_tr_b16 v[218:219], v129 offset:8512
    v_mfma_f32_16x16x32_bf16 a[148:151], v[224:227], v[4:7], 0
    ds_read_b64_tr_b16 v[220:221], v129 offset:576
    v_mfma_f32_16x16x32_bf16 a[148:151], v[228:231], v[20:23], a[148:151]
    s_mov_b32 s40, 0x800
    s_add_u32 m0, s43, 2112
    ds_read_b64_tr_b16 v[222:223], v129 offset:9024
    v_mfma_f32_16x16x32_bf16 a[152:155], v[224:227], v[8:11], 0
    buffer_load_dwordx4 v132, s[20:23], s40 offen  lds
    v_mfma_f32_16x16x32_bf16 a[152:155], v[228:231], v[24:27], a[152:155]
    v_mfma_f32_16x16x32_bf16 a[156:159], v[224:227], v[12:15], 0
    v_mfma_f32_16x16x32_bf16 a[156:159], v[228:231], v[28:31], a[156:159]
    s_waitcnt lgkmcnt(0)
    s_mov_b32 s40, 0xb80
    s_add_u32 m0, s43, 3168
    v_mfma_f32_16x16x32_bf16 a[160:163], v[216:219], v[0:3], 0
    ds_read_b64_tr_b16 v[224:225], v129 offset:72
    buffer_load_dwordx4 v132, s[20:23], s40 offen  lds
    v_mfma_f32_16x16x32_bf16 a[160:163], v[220:223], v[16:19], a[160:163]
    ds_read_b64_tr_b16 v[226:227], v129 offset:8520
    v_mfma_f32_16x16x32_bf16 a[164:167], v[216:219], v[4:7], 0
    ds_read_b64_tr_b16 v[228:229], v129 offset:584
    v_mfma_f32_16x16x32_bf16 a[164:167], v[220:223], v[20:23], a[164:167]
    s_mov_b32 s40, 0xf00
    s_add_u32 m0, s43, 4224
    ds_read_b64_tr_b16 v[230:231], v129 offset:9032
    v_mfma_f32_16x16x32_bf16 a[168:171], v[216:219], v[8:11], 0
    buffer_load_dwordx4 v132, s[20:23], s40 offen  lds
    v_mfma_f32_16x16x32_bf16 a[168:171], v[220:223], v[24:27], a[168:171]
    v_mfma_f32_16x16x32_bf16 a[172:175], v[216:219], v[12:15], 0
    v_mfma_f32_16x16x32_bf16 a[172:175], v[220:223], v[28:31], a[172:175]
    s_waitcnt lgkmcnt(0)
    s_mov_b32 s40, 0x1280
    s_add_u32 m0, s43, 5280
    v_mfma_f32_16x16x32_bf16 a[176:179], v[224:227], v[0:3], 0
    ds_read_b64_tr_b16 v[216:217], v129 offset:128
    buffer_load_dwordx4 v132, s[20:23], s40 offen  lds
    v_mfma_f32_16x16x32_bf16 a[176:179], v[228:231], v[16:19], a[176:179]
    ds_read_b64_tr_b16 v[218:219], v129 offset:8576
    v_mfma_f32_16x16x32_bf16 a[180:183], v[224:227], v[4:7], 0
    ds_read_b64_tr_b16 v[220:221], v129 offset:640
    v_mfma_f32_16x16x32_bf16 a[180:183], v[228:231], v[20:23], a[180:183]
    s_mov_b32 s40, 0x1600
    s_add_u32 m0, s43, 6336
    ds_read_b64_tr_b16 v[222:223], v129 offset:9088
    v_mfma_f32_16x16x32_bf16 a[184:187], v[224:227], v[8:11], 0
    buffer_load_dwordx4 v132, s[20:23], s40 offen  lds
    v_mfma_f32_16x16x32_bf16 a[184:187], v[228:231], v[24:27], a[184:187]
    v_mfma_f32_16x16x32_bf16 a[188:191], v[224:227], v[12:15], 0
    v_mfma_f32_16x16x32_bf16 a[188:191], v[228:231], v[28:31], a[188:191]
    s_waitcnt lgkmcnt(0)
    s_mov_b32 s40, 0x1980
    s_add_u32 m0, s43, 7392
    v_mfma_f32_16x16x32_bf16 a[192:195], v[216:219], v[0:3], 0
    ds_read_b64_tr_b16 v[224:225], v129 offset:136
    buffer_load_dwordx4 v132, s[20:23], s40 offen  lds
    v_mfma_f32_16x16x32_bf16 a[192:195], v[220:223], v[16:19], a[192:195]
    ds_read_b64_tr_b16 v[226:227], v129 offset:8584
    v_mfma_f32_16x16x32_bf16 a[196:199], v[216:219], v[4:7], 0
    ds_read_b64_tr_b16 v[228:229], v129 offset:648
    v_mfma_f32_16x16x32_bf16 a[196:199], v[220:223], v[20:23], a[196:199]
    ds_read_b64_tr_b16 v[230:231], v129 offset:9096
    v_mfma_f32_16x16x32_bf16 a[200:203], v[216:219], v[8:11], 0
    v_mfma_f32_16x16x32_bf16 a[200:203], v[220:223], v[24:27], a[200:203]
    v_mfma_f32_16x16x32_bf16 a[204:207], v[216:219], v[12:15], 0
    v_mfma_f32_16x16x32_bf16 a[204:207], v[220:223], v[28:31], a[204:207]
    s_waitcnt lgkmcnt(0)
    v_mfma_f32_16x16x32_bf16 a[208:211], v[224:227], v[0:3], 0
    ds_read_b64_tr_b16 v[216:217], v129 offset:192
    s_waitcnt vmcnt(14)
    s_barrier
    v_mfma_f32_16x16x32_bf16 a[208:211], v[228:231], v[16:19], a[208:211]
    ds_read_b64_tr_b16 v[218:219], v129 offset:8640
    v_add_u32 v254, 0x10800, v130
    v_mfma_f32_16x16x32_bf16 a[212:215], v[224:227], v[4:7], 0
    ds_read_b64_tr_b16 v[220:221], v129 offset:704
    ds_read_b128 v[32:35], v254 offset:0
    v_mfma_f32_16x16x32_bf16 a[212:215], v[228:231], v[20:23], a[212:215]
    s_add_u32 m0, s33, 33792
    ds_read_b64_tr_b16 v[222:223], v129 offset:9152
    ds_read_b128 v[36:39], v254 offset:128
    v_mfma_f32_16x16x32_bf16 a[216:219], v[224:227], v[8:11], 0
    s_mov_b32 s40, 0x100000
    ds_read_b128 v[40:43], v254 offset:256
    buffer_load_dwordx4 v131, s[16:19], s40 offen  lds
    v_mfma_f32_16x16x32_bf16 a[216:219], v[228:231], v[24:27], a[216:219]
    ds_read_b128 v[44:47], v254 offset:384
    v_mfma_f32_16x16x32_bf16 a[220:223], v[224:227], v[12:15], 0
    ds_read_b128 v[48:51], v254 offset:64
    v_mfma_f32_16x16x32_bf16 a[220:223], v[228:231], v[28:31], a[220:223]
    s_waitcnt lgkmcnt(4)
    ds_read_b128 v[52:55], v254 offset:192
    v_mfma_f32_16x16x32_bf16 a[224:227], v[216:219], v[0:3], 0
    ds_read_b64_tr_b16 v[224:225], v129 offset:200
    ds_read_b128 v[56:59], v254 offset:320
    v_mfma_f32_16x16x32_bf16 a[224:227], v[220:223], v[16:19], a[224:227]
    s_add_u32 m0, s33, 34824
    ds_read_b64_tr_b16 v[226:227], v129 offset:8648
    ds_read_b128 v[60:63], v254 offset:448
    v_mfma_f32_16x16x32_bf16 a[228:231], v[216:219], v[4:7], 0
    s_mov_b32 s40, 0x102000
    ds_read_b64_tr_b16 v[228:229], v129 offset:712
    buffer_load_dwordx4 v131, s[16:19], s40 offen  lds
    v_mfma_f32_16x16x32_bf16 a[228:231], v[220:223], v[20:23], a[228:231]
    ds_read_b64_tr_b16 v[230:231], v129 offset:9160
    v_mfma_f32_16x16x32_bf16 a[232:235], v[216:219], v[8:11], 0
    s_mov_b32 s40, 0x104000
    s_add_u32 m0, s33, 35904
    v_add_u32 v129, 0x18c00, v128
    v_mfma_f32_16x16x32_bf16 a[232:235], v[220:223], v[24:27], a[232:235]
    buffer_load_dwordx4 v131, s[16:19], s40 offen  lds
    v_mfma_f32_16x16x32_bf16 a[236:239], v[216:219], v[12:15], 0
    v_mfma_f32_16x16x32_bf16 a[236:239], v[220:223], v[28:31], a[236:239]
    s_waitcnt lgkmcnt(0)
    v_mfma_f32_16x16x32_bf16 a[240:243], v[224:227], v[0:3], 0
    ds_read_b64_tr_b16 v[216:217], v129 offset:0
    v_mfma_f32_16x16x32_bf16 a[240:243], v[228:231], v[16:19], a[240:243]
    s_mov_b32 s40, 0x106000
    s_add_u32 m0, s33, 36936
    ds_read_b64_tr_b16 v[218:219], v129 offset:8448
    v_mfma_f32_16x16x32_bf16 a[244:247], v[224:227], v[4:7], 0
    ds_read_b64_tr_b16 v[220:221], v129 offset:512
    buffer_load_dwordx4 v131, s[16:19], s40 offen  lds
    v_mfma_f32_16x16x32_bf16 a[244:247], v[228:231], v[20:23], a[244:247]
    ds_read_b64_tr_b16 v[222:223], v129 offset:8960
    v_mfma_f32_16x16x32_bf16 a[248:251], v[224:227], v[8:11], 0
    v_mfma_f32_16x16x32_bf16 a[248:251], v[228:231], v[24:27], a[248:251]
    v_mfma_f32_16x16x32_bf16 a[252:255], v[224:227], v[12:15], 0
    v_mfma_f32_16x16x32_bf16 a[252:255], v[228:231], v[28:31], a[252:255]
    s_waitcnt lgkmcnt(0)
    v_mfma_f32_16x16x32_bf16 a[0:3], v[216:219], v[32:35], a[0:3]
    ds_read_b64_tr_b16 v[224:225], v129 offset:8
    v_mfma_f32_16x16x32_bf16 a[0:3], v[220:223], v[48:51], a[0:3]
    ds_read_b64_tr_b16 v[226:227], v129 offset:8456
    v_mfma_f32_16x16x32_bf16 a[4:7], v[216:219], v[36:39], a[4:7]
    ds_read_b64_tr_b16 v[228:229], v129 offset:520
    v_mfma_f32_16x16x32_bf16 a[4:7], v[220:223], v[52:55], a[4:7]
    ds_read_b64_tr_b16 v[230:231], v129 offset:8968
    v_mfma_f32_16x16x32_bf16 a[8:11], v[216:219], v[40:43], a[8:11]
    v_mfma_f32_16x16x32_bf16 a[8:11], v[220:223], v[56:59], a[8:11]
    v_mfma_f32_16x16x32_bf16 a[12:15], v[216:219], v[44:47], a[12:15]
    v_mfma_f32_16x16x32_bf16 a[12:15], v[220:223], v[60:63], a[12:15]
    s_waitcnt lgkmcnt(0)
    v_mfma_f32_16x16x32_bf16 a[16:19], v[224:227], v[32:35], a[16:19]
    ds_read_b64_tr_b16 v[216:217], v129 offset:64
    v_mfma_f32_16x16x32_bf16 a[16:19], v[228:231], v[48:51], a[16:19]
    ds_read_b64_tr_b16 v[218:219], v129 offset:8512
    v_mfma_f32_16x16x32_bf16 a[20:23], v[224:227], v[36:39], a[20:23]
    ds_read_b64_tr_b16 v[220:221], v129 offset:576
    v_mfma_f32_16x16x32_bf16 a[20:23], v[228:231], v[52:55], a[20:23]
    ds_read_b64_tr_b16 v[222:223], v129 offset:9024
    v_mfma_f32_16x16x32_bf16 a[24:27], v[224:227], v[40:43], a[24:27]
    v_mfma_f32_16x16x32_bf16 a[24:27], v[228:231], v[56:59], a[24:27]
    v_mfma_f32_16x16x32_bf16 a[28:31], v[224:227], v[44:47], a[28:31]
    v_mfma_f32_16x16x32_bf16 a[28:31], v[228:231], v[60:63], a[28:31]
    s_waitcnt lgkmcnt(0)
    v_mfma_f32_16x16x32_bf16 a[32:35], v[216:219], v[32:35], a[32:35]
    ds_read_b64_tr_b16 v[224:225], v129 offset:72
    v_mfma_f32_16x16x32_bf16 a[32:35], v[220:223], v[48:51], a[32:35]
    ds_read_b64_tr_b16 v[226:227], v129 offset:8520
    v_mfma_f32_16x16x32_bf16 a[36:39], v[216:219], v[36:39], a[36:39]
    ds_read_b64_tr_b16 v[228:229], v129 offset:584
    v_mfma_f32_16x16x32_bf16 a[36:39], v[220:223], v[52:55], a[36:39]
    ds_read_b64_tr_b16 v[230:231], v129 offset:9032
    v_mfma_f32_16x16x32_bf16 a[40:43], v[216:219], v[40:43], a[40:43]
    v_mfma_f32_16x16x32_bf16 a[40:43], v[220:223], v[56:59], a[40:43]
    v_mfma_f32_16x16x32_bf16 a[44:47], v[216:219], v[44:47], a[44:47]
    v_mfma_f32_16x16x32_bf16 a[44:47], v[220:223], v[60:63], a[44:47]
    s_waitcnt lgkmcnt(0)
    v_mfma_f32_16x16x32_bf16 a[48:51], v[224:227], v[32:35], a[48:51]
    ds_read_b64_tr_b16 v[216:217], v129 offset:128
    v_mfma_f32_16x16x32_bf16 a[48:51], v[228:231], v[48:51], a[48:51]
    ds_read_b64_tr_b16 v[218:219], v129 offset:8576
    v_mfma_f32_16x16x32_bf16 a[52:55], v[224:227], v[36:39], a[52:55]
    ds_read_b64_tr_b16 v[220:221], v129 offset:640
    v_mfma_f32_16x16x32_bf16 a[52:55], v[228:231], v[52:55], a[52:55]
    ds_read_b64_tr_b16 v[222:223], v129 offset:9088
    v_mfma_f32_16x16x32_bf16 a[56:59], v[224:227], v[40:43], a[56:59]
    v_mfma_f32_16x16x32_bf16 a[56:59], v[228:231], v[56:59], a[56:59]
    v_mfma_f32_16x16x32_bf16 a[60:63], v[224:227], v[44:47], a[60:63]
    v_mfma_f32_16x16x32_bf16 a[60:63], v[228:231], v[60:63], a[60:63]
    s_waitcnt lgkmcnt(0)
    v_mfma_f32_16x16x32_bf16 a[64:67], v[216:219], v[32:35], a[64:67]
    ds_read_b64_tr_b16 v[224:225], v129 offset:136
    v_mfma_f32_16x16x32_bf16 a[64:67], v[220:223], v[48:51], a[64:67]
    ds_read_b64_tr_b16 v[226:227], v129 offset:8584
    v_mfma_f32_16x16x32_bf16 a[68:71], v[216:219], v[36:39], a[68:71]
    ds_read_b64_tr_b16 v[228:229], v129 offset:648
    v_mfma_f32_16x16x32_bf16 a[68:71], v[220:223], v[52:55], a[68:71]
    ds_read_b64_tr_b16 v[230:231], v129 offset:9096
    v_mfma_f32_16x16x32_bf16 a[72:75], v[216:219], v[40:43], a[72:75]
    v_mfma_f32_16x16x32_bf16 a[72:75], v[220:223], v[56:59], a[72:75]
    v_mfma_f32_16x16x32_bf16 a[76:79], v[216:219], v[44:47], a[76:79]
    v_mfma_f32_16x16x32_bf16 a[76:79], v[220:223], v[60:63], a[76:79]
    s_waitcnt lgkmcnt(0)
    v_mfma_f32_16x16x32_bf16 a[80:83], v[224:227], v[32:35], a[80:83]
    ds_read_b64_tr_b16 v[216:217], v129 offset:192
    s_waitcnt vmcnt(14)
    s_barrier
    v_mfma_f32_16x16x32_bf16 a[80:83], v[228:231], v[48:51], a[80:83]
    ds_read_b64_tr_b16 v[218:219], v129 offset:8640
    v_mfma_f32_16x16x32_bf16 a[84:87], v[224:227], v[36:39], a[84:87]
    s_mov_b32 s40, 0x100100
    s_add_u32 m0, s33, 50688
    ds_read_b64_tr_b16 v[220:221], v129 offset:704
    v_mfma_f32_16x16x32_bf16 a[84:87], v[228:231], v[52:55], a[84:87]
    ds_read_b64_tr_b16 v[222:223], v129 offset:9152
    buffer_load_dwordx4 v131, s[16:19], s40 offen  lds
    v_mfma_f32_16x16x32_bf16 a[88:91], v[224:227], v[40:43], a[88:91]
    v_mfma_f32_16x16x32_bf16 a[88:91], v[228:231], v[56:59], a[88:91]
    v_mfma_f32_16x16x32_bf16 a[92:95], v[224:227], v[44:47], a[92:95]
    v_mfma_f32_16x16x32_bf16 a[92:95], v[228:231], v[60:63], a[92:95]
    s_waitcnt lgkmcnt(0)
    s_mov_b32 s40, 0x102100
    s_add_u32 m0, s33, 51720
    v_mfma_f32_16x16x32_bf16 a[96:99], v[216:219], v[32:35], a[96:99]
    ds_read_b64_tr_b16 v[224:225], v129 offset:200
    buffer_load_dwordx4 v131, s[16:19], s40 offen  lds
    v_mfma_f32_16x16x32_bf16 a[96:99], v[220:223], v[48:51], a[96:99]
    ds_read_b64_tr_b16 v[226:227], v129 offset:8648
    v_mfma_f32_16x16x32_bf16 a[100:103], v[216:219], v[36:39], a[100:103]
    ds_read_b64_tr_b16 v[228:229], v129 offset:712
    v_mfma_f32_16x16x32_bf16 a[100:103], v[220:223], v[52:55], a[100:103]
    ds_read_b64_tr_b16 v[230:231], v129 offset:9160
    v_mfma_f32_16x16x32_bf16 a[104:107], v[216:219], v[40:43], a[104:107]
    s_mov_b32 s40, 0x104100
    s_add_u32 m0, s33, 52800
    v_add_u32 v129, 0x1ce00, v128
    v_mfma_f32_16x16x32_bf16 a[104:107], v[220:223], v[56:59], a[104:107]
    buffer_load_dwordx4 v131, s[16:19], s40 offen  lds
    v_mfma_f32_16x16x32_bf16 a[108:111], v[216:219], v[44:47], a[108:111]
    v_mfma_f32_16x16x32_bf16 a[108:111], v[220:223], v[60:63], a[108:111]
    s_waitcnt lgkmcnt(0)
    v_mfma_f32_16x16x32_bf16 a[112:115], v[224:227], v[32:35], a[112:115]
    ds_read_b64_tr_b16 v[216:217], v129 offset:0
    v_mfma_f32_16x16x32_bf16 a[112:115], v[228:231], v[48:51], a[112:115]
    s_mov_b32 s40, 0x106100
    s_add_u32 m0, s33, 53832
    ds_read_b64_tr_b16 v[218:219], v129 offset:8448
    v_mfma_f32_16x16x32_bf16 a[116:119], v[224:227], v[36:39], a[116:119]
    ds_read_b64_tr_b16 v[220:221], v129 offset:512
    buffer_load_dwordx4 v131, s[16:19], s40 offen  lds
    v_mfma_f32_16x16x32_bf16 a[116:119], v[228:231], v[52:55], a[116:119]
    ds_read_b64_tr_b16 v[222:223], v129 offset:8960
    v_mfma_f32_16x16x32_bf16 a[120:123], v[224:227], v[40:43], a[120:123]
    v_mfma_f32_16x16x32_bf16 a[120:123], v[228:231], v[56:59], a[120:123]
    v_mfma_f32_16x16x32_bf16 a[124:127], v[224:227], v[44:47], a[124:127]
    v_mfma_f32_16x16x32_bf16 a[124:127], v[228:231], v[60:63], a[124:127]
    s_waitcnt lgkmcnt(0)
    v_mfma_f32_16x16x32_bf16 a[128:131], v[216:219], v[32:35], a[128:131]
    ds_read_b64_tr_b16 v[224:225], v129 offset:8
    v_mfma_f32_16x16x32_bf16 a[128:131], v[220:223], v[48:51], a[128:131]
    ds_read_b64_tr_b16 v[226:227], v129 offset:8456
    v_mfma_f32_16x16x32_bf16 a[132:135], v[216:219], v[36:39], a[132:135]
    ds_read_b64_tr_b16 v[228:229], v129 offset:520
    v_mfma_f32_16x16x32_bf16 a[132:135], v[220:223], v[52:55], a[132:135]
    s_mov_b32 s40, 0x180
    s_add_u32 m0, s43, 67584
    ds_read_b64_tr_b16 v[230:231], v129 offset:8968
    v_mfma_f32_16x16x32_bf16 a[136:139], v[216:219], v[40:43], a[136:139]
    buffer_load_dwordx4 v132, s[20:23], s40 offen  lds
    v_mfma_f32_16x16x32_bf16 a[136:139], v[220:223], v[56:59], a[136:139]
    v_mfma_f32_16x16x32_bf16 a[140:143], v[216:219], v[44:47], a[140:143]
    v_mfma_f32_16x16x32_bf16 a[140:143], v[220:223], v[60:63], a[140:143]
    s_waitcnt lgkmcnt(0)
    s_mov_b32 s40, 0x500
    s_add_u32 m0, s43, 68640
    v_mfma_f32_16x16x32_bf16 a[144:147], v[224:227], v[32:35], a[144:147]
    ds_read_b64_tr_b16 v[216:217], v129 offset:64
    buffer_load_dwordx4 v132, s[20:23], s40 offen  lds
    v_mfma_f32_16x16x32_bf16 a[144:147], v[228:231], v[48:51], a[144:147]
    ds_read_b64_tr_b16 v[218:219], v129 offset:8512
    v_mfma_f32_16x16x32_bf16 a[148:151], v[224:227], v[36:39], a[148:151]
    ds_read_b64_tr_b16 v[220:221], v129 offset:576
    v_mfma_f32_16x16x32_bf16 a[148:151], v[228:231], v[52:55], a[148:151]
    s_mov_b32 s40, 0x880
    s_add_u32 m0, s43, 69696
    ds_read_b64_tr_b16 v[222:223], v129 offset:9024
    v_mfma_f32_16x16x32_bf16 a[152:155], v[224:227], v[40:43], a[152:155]
    buffer_load_dwordx4 v132, s[20:23], s40 offen  lds
    v_mfma_f32_16x16x32_bf16 a[152:155], v[228:231], v[56:59], a[152:155]
    v_mfma_f32_16x16x32_bf16 a[156:159], v[224:227], v[44:47], a[156:159]
    v_mfma_f32_16x16x32_bf16 a[156:159], v[228:231], v[60:63], a[156:159]
    s_waitcnt lgkmcnt(0)
    s_mov_b32 s40, 0xc00
    s_add_u32 m0, s43, 70752
    v_mfma_f32_16x16x32_bf16 a[160:163], v[216:219], v[32:35], a[160:163]
    ds_read_b64_tr_b16 v[224:225], v129 offset:72
    buffer_load_dwordx4 v132, s[20:23], s40 offen  lds
    v_mfma_f32_16x16x32_bf16 a[160:163], v[220:223], v[48:51], a[160:163]
    ds_read_b64_tr_b16 v[226:227], v129 offset:8520
    v_mfma_f32_16x16x32_bf16 a[164:167], v[216:219], v[36:39], a[164:167]
    ds_read_b64_tr_b16 v[228:229], v129 offset:584
    v_mfma_f32_16x16x32_bf16 a[164:167], v[220:223], v[52:55], a[164:167]
    s_mov_b32 s40, 0xf80
    s_add_u32 m0, s43, 71808
    ds_read_b64_tr_b16 v[230:231], v129 offset:9032
    v_mfma_f32_16x16x32_bf16 a[168:171], v[216:219], v[40:43], a[168:171]
    buffer_load_dwordx4 v132, s[20:23], s40 offen  lds
    v_mfma_f32_16x16x32_bf16 a[168:171], v[220:223], v[56:59], a[168:171]
    v_mfma_f32_16x16x32_bf16 a[172:175], v[216:219], v[44:47], a[172:175]
    v_mfma_f32_16x16x32_bf16 a[172:175], v[220:223], v[60:63], a[172:175]
    s_waitcnt lgkmcnt(0)
    s_mov_b32 s40, 0x1300
    s_add_u32 m0, s43, 72864
    v_mfma_f32_16x16x32_bf16 a[176:179], v[224:227], v[32:35], a[176:179]
    ds_read_b64_tr_b16 v[216:217], v129 offset:128
    buffer_load_dwordx4 v132, s[20:23], s40 offen  lds
    v_mfma_f32_16x16x32_bf16 a[176:179], v[228:231], v[48:51], a[176:179]
    ds_read_b64_tr_b16 v[218:219], v129 offset:8576
    v_mfma_f32_16x16x32_bf16 a[180:183], v[224:227], v[36:39], a[180:183]
    ds_read_b64_tr_b16 v[220:221], v129 offset:640
    v_mfma_f32_16x16x32_bf16 a[180:183], v[228:231], v[52:55], a[180:183]
    s_mov_b32 s40, 0x1680
    s_add_u32 m0, s43, 73920
    ds_read_b64_tr_b16 v[222:223], v129 offset:9088
    v_mfma_f32_16x16x32_bf16 a[184:187], v[224:227], v[40:43], a[184:187]
    buffer_load_dwordx4 v132, s[20:23], s40 offen  lds
    v_mfma_f32_16x16x32_bf16 a[184:187], v[228:231], v[56:59], a[184:187]
    v_mfma_f32_16x16x32_bf16 a[188:191], v[224:227], v[44:47], a[188:191]
    v_mfma_f32_16x16x32_bf16 a[188:191], v[228:231], v[60:63], a[188:191]
    s_waitcnt lgkmcnt(0)
    s_mov_b32 s40, 0x1a00
    s_add_u32 m0, s43, 74976
    v_mfma_f32_16x16x32_bf16 a[192:195], v[216:219], v[32:35], a[192:195]
    ds_read_b64_tr_b16 v[224:225], v129 offset:136
    buffer_load_dwordx4 v132, s[20:23], s40 offen  lds
    v_mfma_f32_16x16x32_bf16 a[192:195], v[220:223], v[48:51], a[192:195]
    ds_read_b64_tr_b16 v[226:227], v129 offset:8584
    v_mfma_f32_16x16x32_bf16 a[196:199], v[216:219], v[36:39], a[196:199]
    ds_read_b64_tr_b16 v[228:229], v129 offset:648
    v_mfma_f32_16x16x32_bf16 a[196:199], v[220:223], v[52:55], a[196:199]
    ds_read_b64_tr_b16 v[230:231], v129 offset:9096
    v_mfma_f32_16x16x32_bf16 a[200:203], v[216:219], v[40:43], a[200:203]
    v_mfma_f32_16x16x32_bf16 a[200:203], v[220:223], v[56:59], a[200:203]
    v_mfma_f32_16x16x32_bf16 a[204:207], v[216:219], v[44:47], a[204:207]
    v_mfma_f32_16x16x32_bf16 a[204:207], v[220:223], v[60:63], a[204:207]
    s_waitcnt lgkmcnt(0)
    v_mfma_f32_16x16x32_bf16 a[208:211], v[224:227], v[32:35], a[208:211]
    ds_read_b64_tr_b16 v[216:217], v129 offset:192
    s_waitcnt vmcnt(12)
    s_barrier
    v_mfma_f32_16x16x32_bf16 a[208:211], v[228:231], v[48:51], a[208:211]
    ds_read_b64_tr_b16 v[218:219], v129 offset:8640
    v_add_u32 v254, 0x0, v130
    v_mfma_f32_16x16x32_bf16 a[212:215], v[224:227], v[36:39], a[212:215]
    ds_read_b64_tr_b16 v[220:221], v129 offset:704
    ds_read_b128 v[0:3], v254 offset:0
    v_mfma_f32_16x16x32_bf16 a[212:215], v[228:231], v[52:55], a[212:215]
    s_add_u32 m0, s33, 101376
    ds_read_b64_tr_b16 v[222:223], v129 offset:9152
    ds_read_b128 v[4:7], v254 offset:128
    v_mfma_f32_16x16x32_bf16 a[216:219], v[224:227], v[40:43], a[216:219]
    s_mov_b32 s40, 0x180000
    ds_read_b128 v[8:11], v254 offset:256
    buffer_load_dwordx4 v131, s[16:19], s40 offen  lds
    v_mfma_f32_16x16x32_bf16 a[216:219], v[228:231], v[56:59], a[216:219]
    ds_read_b128 v[12:15], v254 offset:384
    v_mfma_f32_16x16x32_bf16 a[220:223], v[224:227], v[44:47], a[220:223]
    ds_read_b128 v[16:19], v254 offset:64
    v_mfma_f32_16x16x32_bf16 a[220:223], v[228:231], v[60:63], a[220:223]
    s_waitcnt lgkmcnt(4)
    ds_read_b128 v[20:23], v254 offset:192
    v_mfma_f32_16x16x32_bf16 a[224:227], v[216:219], v[32:35], a[224:227]
    ds_read_b64_tr_b16 v[224:225], v129 offset:200
    ds_read_b128 v[24:27], v254 offset:320
    v_mfma_f32_16x16x32_bf16 a[224:227], v[220:223], v[48:51], a[224:227]
    s_add_u32 m0, s33, 102408
    ds_read_b64_tr_b16 v[226:227], v129 offset:8648
    ds_read_b128 v[28:31], v254 offset:448
    v_mfma_f32_16x16x32_bf16 a[228:231], v[216:219], v[36:39], a[228:231]
    s_mov_b32 s40, 0x182000
    ds_read_b64_tr_b16 v[228:229], v129 offset:712
    buffer_load_dwordx4 v131, s[16:19], s40 offen  lds
    v_mfma_f32_16x16x32_bf16 a[228:231], v[220:223], v[52:55], a[228:231]
    ds_read_b64_tr_b16 v[230:231], v129 offset:9160
    v_mfma_f32_16x16x32_bf16 a[232:235], v[216:219], v[40:43], a[232:235]
    s_mov_b32 s40, 0x184000
    s_add_u32 m0, s33, 103488
    v_add_u32 v129, 0x8400, v128
    v_mfma_f32_16x16x32_bf16 a[232:235], v[220:223], v[56:59], a[232:235]
    buffer_load_dwordx4 v131, s[16:19], s40 offen  lds
    v_mfma_f32_16x16x32_bf16 a[236:239], v[216:219], v[44:47], a[236:239]
    v_mfma_f32_16x16x32_bf16 a[236:239], v[220:223], v[60:63], a[236:239]
    s_waitcnt lgkmcnt(0)
    v_mfma_f32_16x16x32_bf16 a[240:243], v[224:227], v[32:35], a[240:243]
    ds_read_b64_tr_b16 v[216:217], v129 offset:0
    v_mfma_f32_16x16x32_bf16 a[240:243], v[228:231], v[48:51], a[240:243]
    s_mov_b32 s40, 0x186000
    s_add_u32 m0, s33, 104520
    ds_read_b64_tr_b16 v[218:219], v129 offset:8448
    v_mfma_f32_16x16x32_bf16 a[244:247], v[224:227], v[36:39], a[244:247]
    ds_read_b64_tr_b16 v[220:221], v129 offset:512
    buffer_load_dwordx4 v131, s[16:19], s40 offen  lds
    v_mfma_f32_16x16x32_bf16 a[244:247], v[228:231], v[52:55], a[244:247]
    ds_read_b64_tr_b16 v[222:223], v129 offset:8960
    v_mfma_f32_16x16x32_bf16 a[248:251], v[224:227], v[40:43], a[248:251]
    v_mfma_f32_16x16x32_bf16 a[248:251], v[228:231], v[56:59], a[248:251]
    v_mfma_f32_16x16x32_bf16 a[252:255], v[224:227], v[44:47], a[252:255]
    v_mfma_f32_16x16x32_bf16 a[252:255], v[228:231], v[60:63], a[252:255]
    s_waitcnt lgkmcnt(0)
    v_mfma_f32_16x16x32_bf16 a[0:3], v[216:219], v[0:3], a[0:3]
    ds_read_b64_tr_b16 v[224:225], v129 offset:8
    v_mfma_f32_16x16x32_bf16 a[0:3], v[220:223], v[16:19], a[0:3]
    ds_read_b64_tr_b16 v[226:227], v129 offset:8456
    v_mfma_f32_16x16x32_bf16 a[4:7], v[216:219], v[4:7], a[4:7]
    ds_read_b64_tr_b16 v[228:229], v129 offset:520
    v_mfma_f32_16x16x32_bf16 a[4:7], v[220:223], v[20:23], a[4:7]
    ds_read_b64_tr_b16 v[230:231], v129 offset:8968
    v_mfma_f32_16x16x32_bf16 a[8:11], v[216:219], v[8:11], a[8:11]
    v_mfma_f32_16x16x32_bf16 a[8:11], v[220:223], v[24:27], a[8:11]
    v_mfma_f32_16x16x32_bf16 a[12:15], v[216:219], v[12:15], a[12:15]
    v_mfma_f32_16x16x32_bf16 a[12:15], v[220:223], v[28:31], a[12:15]
    s_waitcnt lgkmcnt(0)
    v_mfma_f32_16x16x32_bf16 a[16:19], v[224:227], v[0:3], a[16:19]
    ds_read_b64_tr_b16 v[216:217], v129 offset:64
    v_mfma_f32_16x16x32_bf16 a[16:19], v[228:231], v[16:19], a[16:19]
    ds_read_b64_tr_b16 v[218:219], v129 offset:8512
    v_mfma_f32_16x16x32_bf16 a[20:23], v[224:227], v[4:7], a[20:23]
    ds_read_b64_tr_b16 v[220:221], v129 offset:576
    v_mfma_f32_16x16x32_bf16 a[20:23], v[228:231], v[20:23], a[20:23]
    ds_read_b64_tr_b16 v[222:223], v129 offset:9024
    v_mfma_f32_16x16x32_bf16 a[24:27], v[224:227], v[8:11], a[24:27]
    v_mfma_f32_16x16x32_bf16 a[24:27], v[228:231], v[24:27], a[24:27]
    v_mfma_f32_16x16x32_bf16 a[28:31], v[224:227], v[12:15], a[28:31]
    v_mfma_f32_16x16x32_bf16 a[28:31], v[228:231], v[28:31], a[28:31]
    s_waitcnt lgkmcnt(0)
    v_mfma_f32_16x16x32_bf16 a[32:35], v[216:219], v[0:3], a[32:35]
    ds_read_b64_tr_b16 v[224:225], v129 offset:72
    v_mfma_f32_16x16x32_bf16 a[32:35], v[220:223], v[16:19], a[32:35]
    ds_read_b64_tr_b16 v[226:227], v129 offset:8520
    v_mfma_f32_16x16x32_bf16 a[36:39], v[216:219], v[4:7], a[36:39]
    ds_read_b64_tr_b16 v[228:229], v129 offset:584
    v_mfma_f32_16x16x32_bf16 a[36:39], v[220:223], v[20:23], a[36:39]
    ds_read_b64_tr_b16 v[230:231], v129 offset:9032
    v_mfma_f32_16x16x32_bf16 a[40:43], v[216:219], v[8:11], a[40:43]
    v_mfma_f32_16x16x32_bf16 a[40:43], v[220:223], v[24:27], a[40:43]
    v_mfma_f32_16x16x32_bf16 a[44:47], v[216:219], v[12:15], a[44:47]
    v_mfma_f32_16x16x32_bf16 a[44:47], v[220:223], v[28:31], a[44:47]
    s_waitcnt lgkmcnt(0)
    v_mfma_f32_16x16x32_bf16 a[48:51], v[224:227], v[0:3], a[48:51]
    ds_read_b64_tr_b16 v[216:217], v129 offset:128
    v_mfma_f32_16x16x32_bf16 a[48:51], v[228:231], v[16:19], a[48:51]
    ds_read_b64_tr_b16 v[218:219], v129 offset:8576
    v_mfma_f32_16x16x32_bf16 a[52:55], v[224:227], v[4:7], a[52:55]
    ds_read_b64_tr_b16 v[220:221], v129 offset:640
    v_mfma_f32_16x16x32_bf16 a[52:55], v[228:231], v[20:23], a[52:55]
    ds_read_b64_tr_b16 v[222:223], v129 offset:9088
    v_mfma_f32_16x16x32_bf16 a[56:59], v[224:227], v[8:11], a[56:59]
    v_mfma_f32_16x16x32_bf16 a[56:59], v[228:231], v[24:27], a[56:59]
    v_mfma_f32_16x16x32_bf16 a[60:63], v[224:227], v[12:15], a[60:63]
    v_mfma_f32_16x16x32_bf16 a[60:63], v[228:231], v[28:31], a[60:63]
    s_waitcnt lgkmcnt(0)
    v_mfma_f32_16x16x32_bf16 a[64:67], v[216:219], v[0:3], a[64:67]
    ds_read_b64_tr_b16 v[224:225], v129 offset:136
    v_mfma_f32_16x16x32_bf16 a[64:67], v[220:223], v[16:19], a[64:67]
    ds_read_b64_tr_b16 v[226:227], v129 offset:8584
    v_mfma_f32_16x16x32_bf16 a[68:71], v[216:219], v[4:7], a[68:71]
    ds_read_b64_tr_b16 v[228:229], v129 offset:648
    v_mfma_f32_16x16x32_bf16 a[68:71], v[220:223], v[20:23], a[68:71]
    ds_read_b64_tr_b16 v[230:231], v129 offset:9096
    v_mfma_f32_16x16x32_bf16 a[72:75], v[216:219], v[8:11], a[72:75]
    v_mfma_f32_16x16x32_bf16 a[72:75], v[220:223], v[24:27], a[72:75]
    v_mfma_f32_16x16x32_bf16 a[76:79], v[216:219], v[12:15], a[76:79]
    v_mfma_f32_16x16x32_bf16 a[76:79], v[220:223], v[28:31], a[76:79]
    s_waitcnt lgkmcnt(0)
    v_mfma_f32_16x16x32_bf16 a[80:83], v[224:227], v[0:3], a[80:83]
    ds_read_b64_tr_b16 v[216:217], v129 offset:192
    s_waitcnt vmcnt(12)
    s_barrier
    v_mfma_f32_16x16x32_bf16 a[80:83], v[228:231], v[16:19], a[80:83]
    ds_read_b64_tr_b16 v[218:219], v129 offset:8640
    v_mfma_f32_16x16x32_bf16 a[84:87], v[224:227], v[4:7], a[84:87]
    s_mov_b32 s40, 0x180100
    s_add_u32 m0, s33, 118272
    ds_read_b64_tr_b16 v[220:221], v129 offset:704
    v_mfma_f32_16x16x32_bf16 a[84:87], v[228:231], v[20:23], a[84:87]
    ds_read_b64_tr_b16 v[222:223], v129 offset:9152
    buffer_load_dwordx4 v131, s[16:19], s40 offen  lds
    v_mfma_f32_16x16x32_bf16 a[88:91], v[224:227], v[8:11], a[88:91]
    s_mov_b32 s40, 0x182100
    s_add_u32 m0, s33, 119304
    v_mfma_f32_16x16x32_bf16 a[88:91], v[228:231], v[24:27], a[88:91]
    buffer_load_dwordx4 v131, s[16:19], s40 offen  lds
    v_mfma_f32_16x16x32_bf16 a[92:95], v[224:227], v[12:15], a[92:95]
    s_mov_b32 s40, 0x184100
    s_add_u32 m0, s33, 120384
    v_mfma_f32_16x16x32_bf16 a[92:95], v[228:231], v[28:31], a[92:95]
    s_waitcnt lgkmcnt(0)
    buffer_load_dwordx4 v131, s[16:19], s40 offen  lds
    v_mfma_f32_16x16x32_bf16 a[96:99], v[216:219], v[0:3], a[96:99]
    s_mov_b32 s40, 0x186100
    s_add_u32 m0, s33, 121416
    ds_read_b64_tr_b16 v[224:225], v129 offset:200
    v_mfma_f32_16x16x32_bf16 a[96:99], v[220:223], v[16:19], a[96:99]
    ds_read_b64_tr_b16 v[226:227], v129 offset:8648
    buffer_load_dwordx4 v131, s[16:19], s40 offen  lds
    v_mfma_f32_16x16x32_bf16 a[100:103], v[216:219], v[4:7], a[100:103]
    s_mov_b32 s40, 0x0
    s_add_u32 m0, s33, 135168
    ds_read_b64_tr_b16 v[228:229], v129 offset:712
    v_mfma_f32_16x16x32_bf16 a[100:103], v[220:223], v[20:23], a[100:103]
    ds_read_b64_tr_b16 v[230:231], v129 offset:9160
    buffer_load_dwordx4 v248, s[8:11], s40 offen offset:0 nt lds
    v_mfma_f32_16x16x32_bf16 a[104:107], v[216:219], v[8:11], a[104:107]
    s_add_u32 m0, s33, 135712
    v_add_u32 v129, 0xc600, v128
    v_mfma_f32_16x16x32_bf16 a[104:107], v[220:223], v[24:27], a[104:107]
    buffer_load_dwordx4 v248, s[8:11], s40 offen offset:512 nt lds
    v_mfma_f32_16x16x32_bf16 a[108:111], v[216:219], v[12:15], a[108:111]
    s_add_u32 m0, s33, 136256
    v_mfma_f32_16x16x32_bf16 a[108:111], v[220:223], v[28:31], a[108:111]
    s_waitcnt lgkmcnt(0)
    buffer_load_dwordx4 v248, s[8:11], s40 offen offset:1024 nt lds
    v_mfma_f32_16x16x32_bf16 a[112:115], v[224:227], v[0:3], a[112:115]
    s_add_u32 m0, s33, 136800
    ds_read_b64_tr_b16 v[216:217], v129 offset:0
    v_mfma_f32_16x16x32_bf16 a[112:115], v[228:231], v[16:19], a[112:115]
    ds_read_b64_tr_b16 v[218:219], v129 offset:8448
    buffer_load_dwordx4 v248, s[8:11], s40 offen offset:1536 nt lds
    v_mfma_f32_16x16x32_bf16 a[116:119], v[224:227], v[4:7], a[116:119]
    ds_read_b64_tr_b16 v[220:221], v129 offset:512
    v_mfma_f32_16x16x32_bf16 a[116:119], v[228:231], v[20:23], a[116:119]
    ds_read_b64_tr_b16 v[222:223], v129 offset:8960
    v_mfma_f32_16x16x32_bf16 a[120:123], v[224:227], v[8:11], a[120:123]
    v_mfma_f32_16x16x32_bf16 a[120:123], v[228:231], v[24:27], a[120:123]
    v_mfma_f32_16x16x32_bf16 a[124:127], v[224:227], v[12:15], a[124:127]
    v_mfma_f32_16x16x32_bf16 a[124:127], v[228:231], v[28:31], a[124:127]
    s_waitcnt lgkmcnt(0)
    v_mfma_f32_16x16x32_bf16 a[128:131], v[216:219], v[0:3], a[128:131]
    ds_read_b64_tr_b16 v[224:225], v129 offset:8
    v_mfma_f32_16x16x32_bf16 a[128:131], v[220:223], v[16:19], a[128:131]
    ds_read_b64_tr_b16 v[226:227], v129 offset:8456
    v_mfma_f32_16x16x32_bf16 a[132:135], v[216:219], v[4:7], a[132:135]
    ds_read_b64_tr_b16 v[228:229], v129 offset:520
    v_mfma_f32_16x16x32_bf16 a[132:135], v[220:223], v[20:23], a[132:135]
    s_mov_b32 s40, 0x200
    s_add_u32 m0, s43, 0
    ds_read_b64_tr_b16 v[230:231], v129 offset:8968
    v_mfma_f32_16x16x32_bf16 a[136:139], v[216:219], v[8:11], a[136:139]
    buffer_load_dwordx4 v132, s[20:23], s40 offen  lds
    v_mfma_f32_16x16x32_bf16 a[136:139], v[220:223], v[24:27], a[136:139]
    v_mfma_f32_16x16x32_bf16 a[140:143], v[216:219], v[12:15], a[140:143]
    v_mfma_f32_16x16x32_bf16 a[140:143], v[220:223], v[28:31], a[140:143]
    s_waitcnt lgkmcnt(0)
    s_mov_b32 s40, 0x580
    s_add_u32 m0, s43, 1056
    v_mfma_f32_16x16x32_bf16 a[144:147], v[224:227], v[0:3], a[144:147]
    ds_read_b64_tr_b16 v[216:217], v129 offset:64
    buffer_load_dwordx4 v132, s[20:23], s40 offen  lds
    v_mfma_f32_16x16x32_bf16 a[144:147], v[228:231], v[16:19], a[144:147]
    ds_read_b64_tr_b16 v[218:219], v129 offset:8512
    v_mfma_f32_16x16x32_bf16 a[148:151], v[224:227], v[4:7], a[148:151]
    ds_read_b64_tr_b16 v[220:221], v129 offset:576
    v_mfma_f32_16x16x32_bf16 a[148:151], v[228:231], v[20:23], a[148:151]
    s_mov_b32 s40, 0x900
    s_add_u32 m0, s43, 2112
    ds_read_b64_tr_b16 v[222:223], v129 offset:9024
    v_mfma_f32_16x16x32_bf16 a[152:155], v[224:227], v[8:11], a[152:155]
    buffer_load_dwordx4 v132, s[20:23], s40 offen  lds
    v_mfma_f32_16x16x32_bf16 a[152:155], v[228:231], v[24:27], a[152:155]
    v_mfma_f32_16x16x32_bf16 a[156:159], v[224:227], v[12:15], a[156:159]
    v_mfma_f32_16x16x32_bf16 a[156:159], v[228:231], v[28:31], a[156:159]
    s_waitcnt lgkmcnt(0)
    s_mov_b32 s40, 0xc80
    s_add_u32 m0, s43, 3168
    v_mfma_f32_16x16x32_bf16 a[160:163], v[216:219], v[0:3], a[160:163]
    ds_read_b64_tr_b16 v[224:225], v129 offset:72
    buffer_load_dwordx4 v132, s[20:23], s40 offen  lds
    v_mfma_f32_16x16x32_bf16 a[160:163], v[220:223], v[16:19], a[160:163]
    ds_read_b64_tr_b16 v[226:227], v129 offset:8520
    v_mfma_f32_16x16x32_bf16 a[164:167], v[216:219], v[4:7], a[164:167]
    ds_read_b64_tr_b16 v[228:229], v129 offset:584
    v_mfma_f32_16x16x32_bf16 a[164:167], v[220:223], v[20:23], a[164:167]
    s_mov_b32 s40, 0x1000
    s_add_u32 m0, s43, 4224
    ds_read_b64_tr_b16 v[230:231], v129 offset:9032
    v_mfma_f32_16x16x32_bf16 a[168:171], v[216:219], v[8:11], a[168:171]
    buffer_load_dwordx4 v132, s[20:23], s40 offen  lds
    v_mfma_f32_16x16x32_bf16 a[168:171], v[220:223], v[24:27], a[168:171]
    v_mfma_f32_16x16x32_bf16 a[172:175], v[216:219], v[12:15], a[172:175]
    v_mfma_f32_16x16x32_bf16 a[172:175], v[220:223], v[28:31], a[172:175]
    s_waitcnt lgkmcnt(0)
    s_mov_b32 s40, 0x1380
    s_add_u32 m0, s43, 5280
    v_mfma_f32_16x16x32_bf16 a[176:179], v[224:227], v[0:3], a[176:179]
    ds_read_b64_tr_b16 v[216:217], v129 offset:128
    buffer_load_dwordx4 v132, s[20:23], s40 offen  lds
    v_mfma_f32_16x16x32_bf16 a[176:179], v[228:231], v[16:19], a[176:179]
    ds_read_b64_tr_b16 v[218:219], v129 offset:8576
    v_mfma_f32_16x16x32_bf16 a[180:183], v[224:227], v[4:7], a[180:183]
    ds_read_b64_tr_b16 v[220:221], v129 offset:640
    v_mfma_f32_16x16x32_bf16 a[180:183], v[228:231], v[20:23], a[180:183]
    s_mov_b32 s40, 0x1700
    s_add_u32 m0, s43, 6336
    ds_read_b64_tr_b16 v[222:223], v129 offset:9088
    v_mfma_f32_16x16x32_bf16 a[184:187], v[224:227], v[8:11], a[184:187]
    buffer_load_dwordx4 v132, s[20:23], s40 offen  lds
    v_mfma_f32_16x16x32_bf16 a[184:187], v[228:231], v[24:27], a[184:187]
    v_mfma_f32_16x16x32_bf16 a[188:191], v[224:227], v[12:15], a[188:191]
    v_mfma_f32_16x16x32_bf16 a[188:191], v[228:231], v[28:31], a[188:191]
    s_waitcnt lgkmcnt(0)
    s_mov_b32 s40, 0x1a80
    s_add_u32 m0, s43, 7392
    v_mfma_f32_16x16x32_bf16 a[192:195], v[216:219], v[0:3], a[192:195]
    ds_read_b64_tr_b16 v[224:225], v129 offset:136
    buffer_load_dwordx4 v132, s[20:23], s40 offen  lds
    v_mfma_f32_16x16x32_bf16 a[192:195], v[220:223], v[16:19], a[192:195]
    ds_read_b64_tr_b16 v[226:227], v129 offset:8584
    v_mfma_f32_16x16x32_bf16 a[196:199], v[216:219], v[4:7], a[196:199]
    ds_read_b64_tr_b16 v[228:229], v129 offset:648
    v_mfma_f32_16x16x32_bf16 a[196:199], v[220:223], v[20:23], a[196:199]
    ds_read_b64_tr_b16 v[230:231], v129 offset:9096
    v_mfma_f32_16x16x32_bf16 a[200:203], v[216:219], v[8:11], a[200:203]
    v_mfma_f32_16x16x32_bf16 a[200:203], v[220:223], v[24:27], a[200:203]
    v_mfma_f32_16x16x32_bf16 a[204:207], v[216:219], v[12:15], a[204:207]
    v_mfma_f32_16x16x32_bf16 a[204:207], v[220:223], v[28:31], a[204:207]
    s_waitcnt lgkmcnt(0)
    v_mfma_f32_16x16x32_bf16 a[208:211], v[224:227], v[0:3], a[208:211]
    ds_read_b64_tr_b16 v[216:217], v129 offset:192
    s_waitcnt vmcnt(16)
    s_barrier
    v_mfma_f32_16x16x32_bf16 a[208:211], v[228:231], v[16:19], a[208:211]
    ds_read_b64_tr_b16 v[218:219], v129 offset:8640
    v_add_u32 v254, 0x10800, v130
    v_mfma_f32_16x16x32_bf16 a[212:215], v[224:227], v[4:7], a[212:215]
    ds_read_b64_tr_b16 v[220:221], v129 offset:704
    ds_read_b128 v[32:35], v254 offset:0
    v_mfma_f32_16x16x32_bf16 a[212:215], v[228:231], v[20:23], a[212:215]
    s_add_u32 m0, s33, 33792
    ds_read_b64_tr_b16 v[222:223], v129 offset:9152
    ds_read_b128 v[36:39], v254 offset:128
    v_mfma_f32_16x16x32_bf16 a[216:219], v[224:227], v[8:11], a[216:219]
    s_mov_b32 s40, 0x200000
    ds_read_b128 v[40:43], v254 offset:256
    buffer_load_dwordx4 v131, s[16:19], s40 offen  lds
    v_mfma_f32_16x16x32_bf16 a[216:219], v[228:231], v[24:27], a[216:219]
    ds_read_b128 v[44:47], v254 offset:384
    v_mfma_f32_16x16x32_bf16 a[220:223], v[224:227], v[12:15], a[220:223]
    ds_read_b128 v[48:51], v254 offset:64
    v_mfma_f32_16x16x32_bf16 a[220:223], v[228:231], v[28:31], a[220:223]
    s_waitcnt lgkmcnt(4)
    ds_read_b128 v[52:55], v254 offset:192
    v_mfma_f32_16x16x32_bf16 a[224:227], v[216:219], v[0:3], a[224:227]
    ds_read_b64_tr_b16 v[224:225], v129 offset:200
    ds_read_b128 v[56:59], v254 offset:320
    v_mfma_f32_16x16x32_bf16 a[224:227], v[220:223], v[16:19], a[224:227]
    s_add_u32 m0, s33, 34824
    ds_read_b64_tr_b16 v[226:227], v129 offset:8648
    ds_read_b128 v[60:63], v254 offset:448
    v_mfma_f32_16x16x32_bf16 a[228:231], v[216:219], v[4:7], a[228:231]
    s_mov_b32 s40, 0x202000
    ds_read_b64_tr_b16 v[228:229], v129 offset:712
    buffer_load_dwordx4 v131, s[16:19], s40 offen  lds
    v_mfma_f32_16x16x32_bf16 a[228:231], v[220:223], v[20:23], a[228:231]
    ds_read_b64_tr_b16 v[230:231], v129 offset:9160
    v_mfma_f32_16x16x32_bf16 a[232:235], v[216:219], v[8:11], a[232:235]
    s_mov_b32 s40, 0x204000
    s_add_u32 m0, s33, 35904
    v_add_u32 v129, 0x18c00, v128
    v_mfma_f32_16x16x32_bf16 a[232:235], v[220:223], v[24:27], a[232:235]
    buffer_load_dwordx4 v131, s[16:19], s40 offen  lds
    v_mfma_f32_16x16x32_bf16 a[236:239], v[216:219], v[12:15], a[236:239]
    v_mfma_f32_16x16x32_bf16 a[236:239], v[220:223], v[28:31], a[236:239]
    s_waitcnt lgkmcnt(0)
    v_mfma_f32_16x16x32_bf16 a[240:243], v[224:227], v[0:3], a[240:243]
    ds_read_b64_tr_b16 v[216:217], v129 offset:0
    v_mfma_f32_16x16x32_bf16 a[240:243], v[228:231], v[16:19], a[240:243]
    s_mov_b32 s40, 0x206000
    s_add_u32 m0, s33, 36936
    ds_read_b64_tr_b16 v[218:219], v129 offset:8448
    v_mfma_f32_16x16x32_bf16 a[244:247], v[224:227], v[4:7], a[244:247]
    ds_read_b64_tr_b16 v[220:221], v129 offset:512
    buffer_load_dwordx4 v131, s[16:19], s40 offen  lds
    v_mfma_f32_16x16x32_bf16 a[244:247], v[228:231], v[20:23], a[244:247]
    ds_read_b64_tr_b16 v[222:223], v129 offset:8960
    v_mfma_f32_16x16x32_bf16 a[248:251], v[224:227], v[8:11], a[248:251]
    v_mfma_f32_16x16x32_bf16 a[248:251], v[228:231], v[24:27], a[248:251]
    v_mfma_f32_16x16x32_bf16 a[252:255], v[224:227], v[12:15], a[252:255]
    v_mfma_f32_16x16x32_bf16 a[252:255], v[228:231], v[28:31], a[252:255]
    s_waitcnt lgkmcnt(0)
    v_mfma_f32_16x16x32_bf16 a[0:3], v[216:219], v[32:35], a[0:3]
    ds_read_b64_tr_b16 v[224:225], v129 offset:8
    v_mfma_f32_16x16x32_bf16 a[0:3], v[220:223], v[48:51], a[0:3]
    ds_read_b64_tr_b16 v[226:227], v129 offset:8456
    v_mfma_f32_16x16x32_bf16 a[4:7], v[216:219], v[36:39], a[4:7]
    ds_read_b64_tr_b16 v[228:229], v129 offset:520
    v_mfma_f32_16x16x32_bf16 a[4:7], v[220:223], v[52:55], a[4:7]
    ds_read_b64_tr_b16 v[230:231], v129 offset:8968
    v_mfma_f32_16x16x32_bf16 a[8:11], v[216:219], v[40:43], a[8:11]
    v_mfma_f32_16x16x32_bf16 a[8:11], v[220:223], v[56:59], a[8:11]
    v_mfma_f32_16x16x32_bf16 a[12:15], v[216:219], v[44:47], a[12:15]
    v_mfma_f32_16x16x32_bf16 a[12:15], v[220:223], v[60:63], a[12:15]
    s_waitcnt lgkmcnt(0)
    v_mfma_f32_16x16x32_bf16 a[16:19], v[224:227], v[32:35], a[16:19]
    ds_read_b64_tr_b16 v[216:217], v129 offset:64
    v_mfma_f32_16x16x32_bf16 a[16:19], v[228:231], v[48:51], a[16:19]
    ds_read_b64_tr_b16 v[218:219], v129 offset:8512
    v_mfma_f32_16x16x32_bf16 a[20:23], v[224:227], v[36:39], a[20:23]
    ds_read_b64_tr_b16 v[220:221], v129 offset:576
    v_mfma_f32_16x16x32_bf16 a[20:23], v[228:231], v[52:55], a[20:23]
    ds_read_b64_tr_b16 v[222:223], v129 offset:9024
    v_mfma_f32_16x16x32_bf16 a[24:27], v[224:227], v[40:43], a[24:27]
    v_mfma_f32_16x16x32_bf16 a[24:27], v[228:231], v[56:59], a[24:27]
    v_mfma_f32_16x16x32_bf16 a[28:31], v[224:227], v[44:47], a[28:31]
    v_mfma_f32_16x16x32_bf16 a[28:31], v[228:231], v[60:63], a[28:31]
    s_waitcnt lgkmcnt(0)
    v_mfma_f32_16x16x32_bf16 a[32:35], v[216:219], v[32:35], a[32:35]
    ds_read_b64_tr_b16 v[224:225], v129 offset:72
    v_mfma_f32_16x16x32_bf16 a[32:35], v[220:223], v[48:51], a[32:35]
    ds_read_b64_tr_b16 v[226:227], v129 offset:8520
    v_mfma_f32_16x16x32_bf16 a[36:39], v[216:219], v[36:39], a[36:39]
    ds_read_b64_tr_b16 v[228:229], v129 offset:584
    v_mfma_f32_16x16x32_bf16 a[36:39], v[220:223], v[52:55], a[36:39]
    ds_read_b64_tr_b16 v[230:231], v129 offset:9032
    v_mfma_f32_16x16x32_bf16 a[40:43], v[216:219], v[40:43], a[40:43]
    v_mfma_f32_16x16x32_bf16 a[40:43], v[220:223], v[56:59], a[40:43]
    v_mfma_f32_16x16x32_bf16 a[44:47], v[216:219], v[44:47], a[44:47]
    v_mfma_f32_16x16x32_bf16 a[44:47], v[220:223], v[60:63], a[44:47]
    s_waitcnt lgkmcnt(0)
    v_mfma_f32_16x16x32_bf16 a[48:51], v[224:227], v[32:35], a[48:51]
    ds_read_b64_tr_b16 v[216:217], v129 offset:128
    v_mfma_f32_16x16x32_bf16 a[48:51], v[228:231], v[48:51], a[48:51]
    ds_read_b64_tr_b16 v[218:219], v129 offset:8576
    v_mfma_f32_16x16x32_bf16 a[52:55], v[224:227], v[36:39], a[52:55]
    ds_read_b64_tr_b16 v[220:221], v129 offset:640
    v_mfma_f32_16x16x32_bf16 a[52:55], v[228:231], v[52:55], a[52:55]
    ds_read_b64_tr_b16 v[222:223], v129 offset:9088
    v_mfma_f32_16x16x32_bf16 a[56:59], v[224:227], v[40:43], a[56:59]
    v_mfma_f32_16x16x32_bf16 a[56:59], v[228:231], v[56:59], a[56:59]
    v_mfma_f32_16x16x32_bf16 a[60:63], v[224:227], v[44:47], a[60:63]
    v_mfma_f32_16x16x32_bf16 a[60:63], v[228:231], v[60:63], a[60:63]
    s_waitcnt lgkmcnt(0)
    v_mfma_f32_16x16x32_bf16 a[64:67], v[216:219], v[32:35], a[64:67]
    ds_read_b64_tr_b16 v[224:225], v129 offset:136
    v_mfma_f32_16x16x32_bf16 a[64:67], v[220:223], v[48:51], a[64:67]
    ds_read_b64_tr_b16 v[226:227], v129 offset:8584
    v_mfma_f32_16x16x32_bf16 a[68:71], v[216:219], v[36:39], a[68:71]
    ds_read_b64_tr_b16 v[228:229], v129 offset:648
    v_mfma_f32_16x16x32_bf16 a[68:71], v[220:223], v[52:55], a[68:71]
    ds_read_b64_tr_b16 v[230:231], v129 offset:9096
    v_mfma_f32_16x16x32_bf16 a[72:75], v[216:219], v[40:43], a[72:75]
    v_mfma_f32_16x16x32_bf16 a[72:75], v[220:223], v[56:59], a[72:75]
    v_mfma_f32_16x16x32_bf16 a[76:79], v[216:219], v[44:47], a[76:79]
    v_mfma_f32_16x16x32_bf16 a[76:79], v[220:223], v[60:63], a[76:79]
    s_waitcnt lgkmcnt(0)
    v_mfma_f32_16x16x32_bf16 a[80:83], v[224:227], v[32:35], a[80:83]
    ds_read_b64_tr_b16 v[216:217], v129 offset:192
    s_waitcnt vmcnt(16)
    s_barrier
    v_mfma_f32_16x16x32_bf16 a[80:83], v[228:231], v[48:51], a[80:83]
    ds_read_b64_tr_b16 v[218:219], v129 offset:8640
    v_mfma_f32_16x16x32_bf16 a[84:87], v[224:227], v[36:39], a[84:87]
    s_mov_b32 s40, 0x200100
    s_add_u32 m0, s33, 50688
    ds_read_b64_tr_b16 v[220:221], v129 offset:704
    v_mfma_f32_16x16x32_bf16 a[84:87], v[228:231], v[52:55], a[84:87]
    ds_read_b64_tr_b16 v[222:223], v129 offset:9152
    buffer_load_dwordx4 v131, s[16:19], s40 offen  lds
    v_mfma_f32_16x16x32_bf16 a[88:91], v[224:227], v[40:43], a[88:91]
    v_mfma_f32_16x16x32_bf16 a[88:91], v[228:231], v[56:59], a[88:91]
    v_mfma_f32_16x16x32_bf16 a[92:95], v[224:227], v[44:47], a[92:95]
    v_mfma_f32_16x16x32_bf16 a[92:95], v[228:231], v[60:63], a[92:95]
    s_waitcnt lgkmcnt(0)
    s_mov_b32 s40, 0x202100
    s_add_u32 m0, s33, 51720
    v_mfma_f32_16x16x32_bf16 a[96:99], v[216:219], v[32:35], a[96:99]
    ds_read_b64_tr_b16 v[224:225], v129 offset:200
    buffer_load_dwordx4 v131, s[16:19], s40 offen  lds
    v_mfma_f32_16x16x32_bf16 a[96:99], v[220:223], v[48:51], a[96:99]
    ds_read_b64_tr_b16 v[226:227], v129 offset:8648
    v_mfma_f32_16x16x32_bf16 a[100:103], v[216:219], v[36:39], a[100:103]
    ds_read_b64_tr_b16 v[228:229], v129 offset:712
    v_mfma_f32_16x16x32_bf16 a[100:103], v[220:223], v[52:55], a[100:103]
    ds_read_b64_tr_b16 v[230:231], v129 offset:9160
    v_mfma_f32_16x16x32_bf16 a[104:107], v[216:219], v[40:43], a[104:107]
    s_mov_b32 s40, 0x204100
    s_add_u32 m0, s33, 52800
    v_add_u32 v129, 0x1ce00, v128
    v_mfma_f32_16x16x32_bf16 a[104:107], v[220:223], v[56:59], a[104:107]
    buffer_load_dwordx4 v131, s[16:19], s40 offen  lds
    v_mfma_f32_16x16x32_bf16 a[108:111], v[216:219], v[44:47], a[108:111]
    v_mfma_f32_16x16x32_bf16 a[108:111], v[220:223], v[60:63], a[108:111]
    s_waitcnt lgkmcnt(0)
    v_mfma_f32_16x16x32_bf16 a[112:115], v[224:227], v[32:35], a[112:115]
    ds_read_b64_tr_b16 v[216:217], v129 offset:0
    v_mfma_f32_16x16x32_bf16 a[112:115], v[228:231], v[48:51], a[112:115]
    s_mov_b32 s40, 0x206100
    s_add_u32 m0, s33, 53832
    ds_read_b64_tr_b16 v[218:219], v129 offset:8448
    v_mfma_f32_16x16x32_bf16 a[116:119], v[224:227], v[36:39], a[116:119]
    ds_read_b64_tr_b16 v[220:221], v129 offset:512
    buffer_load_dwordx4 v131, s[16:19], s40 offen  lds
    v_mfma_f32_16x16x32_bf16 a[116:119], v[228:231], v[52:55], a[116:119]
    ds_read_b64_tr_b16 v[222:223], v129 offset:8960
    v_mfma_f32_16x16x32_bf16 a[120:123], v[224:227], v[40:43], a[120:123]
    v_mfma_f32_16x16x32_bf16 a[120:123], v[228:231], v[56:59], a[120:123]
    v_mfma_f32_16x16x32_bf16 a[124:127], v[224:227], v[44:47], a[124:127]
    v_mfma_f32_16x16x32_bf16 a[124:127], v[228:231], v[60:63], a[124:127]
    s_waitcnt lgkmcnt(0)
    v_mfma_f32_16x16x32_bf16 a[128:131], v[216:219], v[32:35], a[128:131]
    ds_read_b64_tr_b16 v[224:225], v129 offset:8
    v_mfma_f32_16x16x32_bf16 a[128:131], v[220:223], v[48:51], a[128:131]
    ds_read_b64_tr_b16 v[226:227], v129 offset:8456
    v_mfma_f32_16x16x32_bf16 a[132:135], v[216:219], v[36:39], a[132:135]
    ds_read_b64_tr_b16 v[228:229], v129 offset:520
    v_mfma_f32_16x16x32_bf16 a[132:135], v[220:223], v[52:55], a[132:135]
    s_mov_b32 s40, 0x280
    s_add_u32 m0, s43, 67584
    ds_read_b64_tr_b16 v[230:231], v129 offset:8968
    v_mfma_f32_16x16x32_bf16 a[136:139], v[216:219], v[40:43], a[136:139]
    buffer_load_dwordx4 v132, s[20:23], s40 offen  lds
    v_mfma_f32_16x16x32_bf16 a[136:139], v[220:223], v[56:59], a[136:139]
    v_mfma_f32_16x16x32_bf16 a[140:143], v[216:219], v[44:47], a[140:143]
    v_mfma_f32_16x16x32_bf16 a[140:143], v[220:223], v[60:63], a[140:143]
    s_waitcnt lgkmcnt(0)
    s_mov_b32 s40, 0x600
    s_add_u32 m0, s43, 68640
    v_mfma_f32_16x16x32_bf16 a[144:147], v[224:227], v[32:35], a[144:147]
    ds_read_b64_tr_b16 v[216:217], v129 offset:64
    buffer_load_dwordx4 v132, s[20:23], s40 offen  lds
    v_mfma_f32_16x16x32_bf16 a[144:147], v[228:231], v[48:51], a[144:147]
    ds_read_b64_tr_b16 v[218:219], v129 offset:8512
    v_mfma_f32_16x16x32_bf16 a[148:151], v[224:227], v[36:39], a[148:151]
    ds_read_b64_tr_b16 v[220:221], v129 offset:576
    v_mfma_f32_16x16x32_bf16 a[148:151], v[228:231], v[52:55], a[148:151]
    s_mov_b32 s40, 0x980
    s_add_u32 m0, s43, 69696
    ds_read_b64_tr_b16 v[222:223], v129 offset:9024
    v_mfma_f32_16x16x32_bf16 a[152:155], v[224:227], v[40:43], a[152:155]
    buffer_load_dwordx4 v132, s[20:23], s40 offen  lds
    v_mfma_f32_16x16x32_bf16 a[152:155], v[228:231], v[56:59], a[152:155]
    v_mfma_f32_16x16x32_bf16 a[156:159], v[224:227], v[44:47], a[156:159]
    v_mfma_f32_16x16x32_bf16 a[156:159], v[228:231], v[60:63], a[156:159]
    s_waitcnt lgkmcnt(0)
    s_mov_b32 s40, 0xd00
    s_add_u32 m0, s43, 70752
    v_mfma_f32_16x16x32_bf16 a[160:163], v[216:219], v[32:35], a[160:163]
    ds_read_b64_tr_b16 v[224:225], v129 offset:72
    buffer_load_dwordx4 v132, s[20:23], s40 offen  lds
    v_mfma_f32_16x16x32_bf16 a[160:163], v[220:223], v[48:51], a[160:163]
    ds_read_b64_tr_b16 v[226:227], v129 offset:8520
    v_mfma_f32_16x16x32_bf16 a[164:167], v[216:219], v[36:39], a[164:167]
    ds_read_b64_tr_b16 v[228:229], v129 offset:584
    v_mfma_f32_16x16x32_bf16 a[164:167], v[220:223], v[52:55], a[164:167]
    s_mov_b32 s40, 0x1080
    s_add_u32 m0, s43, 71808
    ds_read_b64_tr_b16 v[230:231], v129 offset:9032
    v_mfma_f32_16x16x32_bf16 a[168:171], v[216:219], v[40:43], a[168:171]
    buffer_load_dwordx4 v132, s[20:23], s40 offen  lds
    v_mfma_f32_16x16x32_bf16 a[168:171], v[220:223], v[56:59], a[168:171]
    v_mfma_f32_16x16x32_bf16 a[172:175], v[216:219], v[44:47], a[172:175]
    v_mfma_f32_16x16x32_bf16 a[172:175], v[220:223], v[60:63], a[172:175]
    s_waitcnt lgkmcnt(0)
    s_mov_b32 s40, 0x1400
    s_add_u32 m0, s43, 72864
    v_mfma_f32_16x16x32_bf16 a[176:179], v[224:227], v[32:35], a[176:179]
    ds_read_b64_tr_b16 v[216:217], v129 offset:128
    buffer_load_dwordx4 v132, s[20:23], s40 offen  lds
    v_mfma_f32_16x16x32_bf16 a[176:179], v[228:231], v[48:51], a[176:179]
    ds_read_b64_tr_b16 v[218:219], v129 offset:8576
    v_mfma_f32_16x16x32_bf16 a[180:183], v[224:227], v[36:39], a[180:183]
    ds_read_b64_tr_b16 v[220:221], v129 offset:640
    v_mfma_f32_16x16x32_bf16 a[180:183], v[228:231], v[52:55], a[180:183]
    s_mov_b32 s40, 0x1780
    s_add_u32 m0, s43, 73920
    ds_read_b64_tr_b16 v[222:223], v129 offset:9088
    v_mfma_f32_16x16x32_bf16 a[184:187], v[224:227], v[40:43], a[184:187]
    buffer_load_dwordx4 v132, s[20:23], s40 offen  lds
    v_mfma_f32_16x16x32_bf16 a[184:187], v[228:231], v[56:59], a[184:187]
    v_mfma_f32_16x16x32_bf16 a[188:191], v[224:227], v[44:47], a[188:191]
    v_mfma_f32_16x16x32_bf16 a[188:191], v[228:231], v[60:63], a[188:191]
    s_waitcnt lgkmcnt(0)
    s_mov_b32 s40, 0x1b00
    s_add_u32 m0, s43, 74976
    v_mfma_f32_16x16x32_bf16 a[192:195], v[216:219], v[32:35], a[192:195]
    ds_read_b64_tr_b16 v[224:225], v129 offset:136
    buffer_load_dwordx4 v132, s[20:23], s40 offen  lds
    v_mfma_f32_16x16x32_bf16 a[192:195], v[220:223], v[48:51], a[192:195]
    ds_read_b64_tr_b16 v[226:227], v129 offset:8584
    v_mfma_f32_16x16x32_bf16 a[196:199], v[216:219], v[36:39], a[196:199]
    ds_read_b64_tr_b16 v[228:229], v129 offset:648
    v_mfma_f32_16x16x32_bf16 a[196:199], v[220:223], v[52:55], a[196:199]
    ds_read_b64_tr_b16 v[230:231], v129 offset:9096
    v_mfma_f32_16x16x32_bf16 a[200:203], v[216:219], v[40:43], a[200:203]
    v_mfma_f32_16x16x32_bf16 a[200:203], v[220:223], v[56:59], a[200:203]
    v_mfma_f32_16x16x32_bf16 a[204:207], v[216:219], v[44:47], a[204:207]
    v_mfma_f32_16x16x32_bf16 a[204:207], v[220:223], v[60:63], a[204:207]
    s_waitcnt lgkmcnt(0)
    v_mfma_f32_16x16x32_bf16 a[208:211], v[224:227], v[32:35], a[208:211]
    ds_read_b64_tr_b16 v[216:217], v129 offset:192
    s_waitcnt vmcnt(12)
    s_barrier
    v_mfma_f32_16x16x32_bf16 a[208:211], v[228:231], v[48:51], a[208:211]
    ds_read_b64_tr_b16 v[218:219], v129 offset:8640
    v_add_u32 v254, 0x0, v130
    v_mfma_f32_16x16x32_bf16 a[212:215], v[224:227], v[36:39], a[212:215]
    ds_read_b64_tr_b16 v[220:221], v129 offset:704
    ds_read_b128 v[0:3], v254 offset:0
    v_mfma_f32_16x16x32_bf16 a[212:215], v[228:231], v[52:55], a[212:215]
    s_add_u32 m0, s33, 101376
    ds_read_b64_tr_b16 v[222:223], v129 offset:9152
    ds_read_b128 v[4:7], v254 offset:128
    v_mfma_f32_16x16x32_bf16 a[216:219], v[224:227], v[40:43], a[216:219]
    s_mov_b32 s40, 0x280000
    ds_read_b128 v[8:11], v254 offset:256
    buffer_load_dwordx4 v131, s[16:19], s40 offen  lds
    v_mfma_f32_16x16x32_bf16 a[216:219], v[228:231], v[56:59], a[216:219]
    ds_read_b128 v[12:15], v254 offset:384
    v_mfma_f32_16x16x32_bf16 a[220:223], v[224:227], v[44:47], a[220:223]
    ds_read_b128 v[16:19], v254 offset:64
    v_mfma_f32_16x16x32_bf16 a[220:223], v[228:231], v[60:63], a[220:223]
    s_waitcnt lgkmcnt(4)
    ds_read_b128 v[20:23], v254 offset:192
    v_mfma_f32_16x16x32_bf16 a[224:227], v[216:219], v[32:35], a[224:227]
    ds_read_b64_tr_b16 v[224:225], v129 offset:200
    ds_read_b128 v[24:27], v254 offset:320
    v_mfma_f32_16x16x32_bf16 a[224:227], v[220:223], v[48:51], a[224:227]
    s_add_u32 m0, s33, 102408
    ds_read_b64_tr_b16 v[226:227], v129 offset:8648
    ds_read_b128 v[28:31], v254 offset:448
    v_mfma_f32_16x16x32_bf16 a[228:231], v[216:219], v[36:39], a[228:231]
    s_mov_b32 s40, 0x282000
    ds_read_b64_tr_b16 v[228:229], v129 offset:712
    buffer_load_dwordx4 v131, s[16:19], s40 offen  lds
    v_mfma_f32_16x16x32_bf16 a[228:231], v[220:223], v[52:55], a[228:231]
    ds_read_b64_tr_b16 v[230:231], v129 offset:9160
    v_mfma_f32_16x16x32_bf16 a[232:235], v[216:219], v[40:43], a[232:235]
    s_mov_b32 s40, 0x284000
    s_add_u32 m0, s33, 103488
    v_add_u32 v129, 0x8400, v128
    v_mfma_f32_16x16x32_bf16 a[232:235], v[220:223], v[56:59], a[232:235]
    buffer_load_dwordx4 v131, s[16:19], s40 offen  lds
    v_mfma_f32_16x16x32_bf16 a[236:239], v[216:219], v[44:47], a[236:239]
    v_mfma_f32_16x16x32_bf16 a[236:239], v[220:223], v[60:63], a[236:239]
    s_waitcnt lgkmcnt(0)
    v_mfma_f32_16x16x32_bf16 a[240:243], v[224:227], v[32:35], a[240:243]
    ds_read_b64_tr_b16 v[216:217], v129 offset:0
    v_mfma_f32_16x16x32_bf16 a[240:243], v[228:231], v[48:51], a[240:243]
    s_mov_b32 s40, 0x286000
    s_add_u32 m0, s33, 104520
    ds_read_b64_tr_b16 v[218:219], v129 offset:8448
    v_mfma_f32_16x16x32_bf16 a[244:247], v[224:227], v[36:39], a[244:247]
    ds_read_b64_tr_b16 v[220:221], v129 offset:512
    buffer_load_dwordx4 v131, s[16:19], s40 offen  lds
    v_mfma_f32_16x16x32_bf16 a[244:247], v[228:231], v[52:55], a[244:247]
    ds_read_b64_tr_b16 v[222:223], v129 offset:8960
    v_mfma_f32_16x16x32_bf16 a[248:251], v[224:227], v[40:43], a[248:251]
    v_mfma_f32_16x16x32_bf16 a[248:251], v[228:231], v[56:59], a[248:251]
    v_mfma_f32_16x16x32_bf16 a[252:255], v[224:227], v[44:47], a[252:255]
    v_mfma_f32_16x16x32_bf16 a[252:255], v[228:231], v[60:63], a[252:255]
    s_waitcnt lgkmcnt(0)
    v_mfma_f32_16x16x32_bf16 a[0:3], v[216:219], v[0:3], a[0:3]
    ds_read_b64_tr_b16 v[224:225], v129 offset:8
    v_mfma_f32_16x16x32_bf16 a[0:3], v[220:223], v[16:19], a[0:3]
    ds_read_b64_tr_b16 v[226:227], v129 offset:8456
    v_mfma_f32_16x16x32_bf16 a[4:7], v[216:219], v[4:7], a[4:7]
    ds_read_b64_tr_b16 v[228:229], v129 offset:520
    v_mfma_f32_16x16x32_bf16 a[4:7], v[220:223], v[20:23], a[4:7]
    ds_read_b64_tr_b16 v[230:231], v129 offset:8968
    v_mfma_f32_16x16x32_bf16 a[8:11], v[216:219], v[8:11], a[8:11]
    v_mfma_f32_16x16x32_bf16 a[8:11], v[220:223], v[24:27], a[8:11]
    v_mfma_f32_16x16x32_bf16 a[12:15], v[216:219], v[12:15], a[12:15]
    v_mfma_f32_16x16x32_bf16 a[12:15], v[220:223], v[28:31], a[12:15]
    s_waitcnt lgkmcnt(0)
    v_mfma_f32_16x16x32_bf16 a[16:19], v[224:227], v[0:3], a[16:19]
    ds_read_b64_tr_b16 v[216:217], v129 offset:64
    v_mfma_f32_16x16x32_bf16 a[16:19], v[228:231], v[16:19], a[16:19]
    ds_read_b64_tr_b16 v[218:219], v129 offset:8512
    v_mfma_f32_16x16x32_bf16 a[20:23], v[224:227], v[4:7], a[20:23]
    ds_read_b64_tr_b16 v[220:221], v129 offset:576
    v_mfma_f32_16x16x32_bf16 a[20:23], v[228:231], v[20:23], a[20:23]
    ds_read_b64_tr_b16 v[222:223], v129 offset:9024
    v_mfma_f32_16x16x32_bf16 a[24:27], v[224:227], v[8:11], a[24:27]
    v_mfma_f32_16x16x32_bf16 a[24:27], v[228:231], v[24:27], a[24:27]
    v_mfma_f32_16x16x32_bf16 a[28:31], v[224:227], v[12:15], a[28:31]
    v_mfma_f32_16x16x32_bf16 a[28:31], v[228:231], v[28:31], a[28:31]
    s_waitcnt lgkmcnt(0)
    v_mfma_f32_16x16x32_bf16 a[32:35], v[216:219], v[0:3], a[32:35]
    ds_read_b64_tr_b16 v[224:225], v129 offset:72
    v_mfma_f32_16x16x32_bf16 a[32:35], v[220:223], v[16:19], a[32:35]
    ds_read_b64_tr_b16 v[226:227], v129 offset:8520
    v_mfma_f32_16x16x32_bf16 a[36:39], v[216:219], v[4:7], a[36:39]
    ds_read_b64_tr_b16 v[228:229], v129 offset:584
    v_mfma_f32_16x16x32_bf16 a[36:39], v[220:223], v[20:23], a[36:39]
    ds_read_b64_tr_b16 v[230:231], v129 offset:9032
    v_mfma_f32_16x16x32_bf16 a[40:43], v[216:219], v[8:11], a[40:43]
    v_mfma_f32_16x16x32_bf16 a[40:43], v[220:223], v[24:27], a[40:43]
    v_mfma_f32_16x16x32_bf16 a[44:47], v[216:219], v[12:15], a[44:47]
    v_mfma_f32_16x16x32_bf16 a[44:47], v[220:223], v[28:31], a[44:47]
    s_waitcnt lgkmcnt(0)
    v_mfma_f32_16x16x32_bf16 a[48:51], v[224:227], v[0:3], a[48:51]
    ds_read_b64_tr_b16 v[216:217], v129 offset:128
    v_mfma_f32_16x16x32_bf16 a[48:51], v[228:231], v[16:19], a[48:51]
    ds_read_b64_tr_b16 v[218:219], v129 offset:8576
    v_mfma_f32_16x16x32_bf16 a[52:55], v[224:227], v[4:7], a[52:55]
    ds_read_b64_tr_b16 v[220:221], v129 offset:640
    v_mfma_f32_16x16x32_bf16 a[52:55], v[228:231], v[20:23], a[52:55]
    ds_read_b64_tr_b16 v[222:223], v129 offset:9088
    v_mfma_f32_16x16x32_bf16 a[56:59], v[224:227], v[8:11], a[56:59]
    v_mfma_f32_16x16x32_bf16 a[56:59], v[228:231], v[24:27], a[56:59]
    v_mfma_f32_16x16x32_bf16 a[60:63], v[224:227], v[12:15], a[60:63]
    v_mfma_f32_16x16x32_bf16 a[60:63], v[228:231], v[28:31], a[60:63]
    s_waitcnt lgkmcnt(0)
    v_mfma_f32_16x16x32_bf16 a[64:67], v[216:219], v[0:3], a[64:67]
    ds_read_b64_tr_b16 v[224:225], v129 offset:136
    v_mfma_f32_16x16x32_bf16 a[64:67], v[220:223], v[16:19], a[64:67]
    ds_read_b64_tr_b16 v[226:227], v129 offset:8584
    v_mfma_f32_16x16x32_bf16 a[68:71], v[216:219], v[4:7], a[68:71]
    ds_read_b64_tr_b16 v[228:229], v129 offset:648
    v_mfma_f32_16x16x32_bf16 a[68:71], v[220:223], v[20:23], a[68:71]
    ds_read_b64_tr_b16 v[230:231], v129 offset:9096
    v_mfma_f32_16x16x32_bf16 a[72:75], v[216:219], v[8:11], a[72:75]
    v_mfma_f32_16x16x32_bf16 a[72:75], v[220:223], v[24:27], a[72:75]
    v_mfma_f32_16x16x32_bf16 a[76:79], v[216:219], v[12:15], a[76:79]
    v_mfma_f32_16x16x32_bf16 a[76:79], v[220:223], v[28:31], a[76:79]
    s_waitcnt lgkmcnt(0)
    v_mfma_f32_16x16x32_bf16 a[80:83], v[224:227], v[0:3], a[80:83]
    ds_read_b64_tr_b16 v[216:217], v129 offset:192
    s_waitcnt vmcnt(12)
    s_barrier
    v_mfma_f32_16x16x32_bf16 a[80:83], v[228:231], v[16:19], a[80:83]
    ds_read_b64_tr_b16 v[218:219], v129 offset:8640
    v_mfma_f32_16x16x32_bf16 a[84:87], v[224:227], v[4:7], a[84:87]
    s_mov_b32 s40, 0x280100
    s_add_u32 m0, s33, 118272
    ds_read_b64_tr_b16 v[220:221], v129 offset:704
    v_mfma_f32_16x16x32_bf16 a[84:87], v[228:231], v[20:23], a[84:87]
    ds_read_b64_tr_b16 v[222:223], v129 offset:9152
    buffer_load_dwordx4 v131, s[16:19], s40 offen  lds
    v_mfma_f32_16x16x32_bf16 a[88:91], v[224:227], v[8:11], a[88:91]
    v_mfma_f32_16x16x32_bf16 a[88:91], v[228:231], v[24:27], a[88:91]
    v_mfma_f32_16x16x32_bf16 a[92:95], v[224:227], v[12:15], a[92:95]
    v_mfma_f32_16x16x32_bf16 a[92:95], v[228:231], v[28:31], a[92:95]
    s_waitcnt lgkmcnt(0)
    s_mov_b32 s40, 0x282100
    s_add_u32 m0, s33, 119304
    v_mfma_f32_16x16x32_bf16 a[96:99], v[216:219], v[0:3], a[96:99]
    ds_read_b64_tr_b16 v[224:225], v129 offset:200
    buffer_load_dwordx4 v131, s[16:19], s40 offen  lds
    v_mfma_f32_16x16x32_bf16 a[96:99], v[220:223], v[16:19], a[96:99]
    ds_read_b64_tr_b16 v[226:227], v129 offset:8648
    v_mfma_f32_16x16x32_bf16 a[100:103], v[216:219], v[4:7], a[100:103]
    ds_read_b64_tr_b16 v[228:229], v129 offset:712
    v_mfma_f32_16x16x32_bf16 a[100:103], v[220:223], v[20:23], a[100:103]
    ds_read_b64_tr_b16 v[230:231], v129 offset:9160
    v_mfma_f32_16x16x32_bf16 a[104:107], v[216:219], v[8:11], a[104:107]
    s_mov_b32 s40, 0x284100
    s_add_u32 m0, s33, 120384
    v_add_u32 v129, 0xc600, v128
    v_mfma_f32_16x16x32_bf16 a[104:107], v[220:223], v[24:27], a[104:107]
    buffer_load_dwordx4 v131, s[16:19], s40 offen  lds
    v_mfma_f32_16x16x32_bf16 a[108:111], v[216:219], v[12:15], a[108:111]
    v_mfma_f32_16x16x32_bf16 a[108:111], v[220:223], v[28:31], a[108:111]
    s_waitcnt lgkmcnt(0)
    v_mfma_f32_16x16x32_bf16 a[112:115], v[224:227], v[0:3], a[112:115]
    ds_read_b64_tr_b16 v[216:217], v129 offset:0
    v_mfma_f32_16x16x32_bf16 a[112:115], v[228:231], v[16:19], a[112:115]
    s_mov_b32 s40, 0x286100
    s_add_u32 m0, s33, 121416
    ds_read_b64_tr_b16 v[218:219], v129 offset:8448
    v_mfma_f32_16x16x32_bf16 a[116:119], v[224:227], v[4:7], a[116:119]
    ds_read_b64_tr_b16 v[220:221], v129 offset:512
    buffer_load_dwordx4 v131, s[16:19], s40 offen  lds
    v_mfma_f32_16x16x32_bf16 a[116:119], v[228:231], v[20:23], a[116:119]
    ds_read_b64_tr_b16 v[222:223], v129 offset:8960
    v_mfma_f32_16x16x32_bf16 a[120:123], v[224:227], v[8:11], a[120:123]
    v_mfma_f32_16x16x32_bf16 a[120:123], v[228:231], v[24:27], a[120:123]
    v_mfma_f32_16x16x32_bf16 a[124:127], v[224:227], v[12:15], a[124:127]
    v_mfma_f32_16x16x32_bf16 a[124:127], v[228:231], v[28:31], a[124:127]
    s_waitcnt lgkmcnt(0)
    v_mfma_f32_16x16x32_bf16 a[128:131], v[216:219], v[0:3], a[128:131]
    ds_read_b64_tr_b16 v[224:225], v129 offset:8
    v_mfma_f32_16x16x32_bf16 a[128:131], v[220:223], v[16:19], a[128:131]
    ds_read_b64_tr_b16 v[226:227], v129 offset:8456
    v_mfma_f32_16x16x32_bf16 a[132:135], v[216:219], v[4:7], a[132:135]
    ds_read_b64_tr_b16 v[228:229], v129 offset:520
    v_mfma_f32_16x16x32_bf16 a[132:135], v[220:223], v[20:23], a[132:135]
    s_mov_b32 s40, 0x300
    s_add_u32 m0, s43, 0
    ds_read_b64_tr_b16 v[230:231], v129 offset:8968
    v_mfma_f32_16x16x32_bf16 a[136:139], v[216:219], v[8:11], a[136:139]
    buffer_load_dwordx4 v132, s[20:23], s40 offen  lds
    v_mfma_f32_16x16x32_bf16 a[136:139], v[220:223], v[24:27], a[136:139]
    v_mfma_f32_16x16x32_bf16 a[140:143], v[216:219], v[12:15], a[140:143]
    v_mfma_f32_16x16x32_bf16 a[140:143], v[220:223], v[28:31], a[140:143]
    s_waitcnt lgkmcnt(0)
    s_mov_b32 s40, 0x680
    s_add_u32 m0, s43, 1056
    v_mfma_f32_16x16x32_bf16 a[144:147], v[224:227], v[0:3], a[144:147]
    ds_read_b64_tr_b16 v[216:217], v129 offset:64
    buffer_load_dwordx4 v132, s[20:23], s40 offen  lds
    v_mfma_f32_16x16x32_bf16 a[144:147], v[228:231], v[16:19], a[144:147]
    ds_read_b64_tr_b16 v[218:219], v129 offset:8512
    v_mfma_f32_16x16x32_bf16 a[148:151], v[224:227], v[4:7], a[148:151]
    ds_read_b64_tr_b16 v[220:221], v129 offset:576
    v_mfma_f32_16x16x32_bf16 a[148:151], v[228:231], v[20:23], a[148:151]
    s_mov_b32 s40, 0xa00
    s_add_u32 m0, s43, 2112
    ds_read_b64_tr_b16 v[222:223], v129 offset:9024
    v_mfma_f32_16x16x32_bf16 a[152:155], v[224:227], v[8:11], a[152:155]
    buffer_load_dwordx4 v132, s[20:23], s40 offen  lds
    v_mfma_f32_16x16x32_bf16 a[152:155], v[228:231], v[24:27], a[152:155]
    v_mfma_f32_16x16x32_bf16 a[156:159], v[224:227], v[12:15], a[156:159]
    v_mfma_f32_16x16x32_bf16 a[156:159], v[228:231], v[28:31], a[156:159]
    s_waitcnt lgkmcnt(0)
    s_mov_b32 s40, 0xd80
    s_add_u32 m0, s43, 3168
    v_mfma_f32_16x16x32_bf16 a[160:163], v[216:219], v[0:3], a[160:163]
    ds_read_b64_tr_b16 v[224:225], v129 offset:72
    buffer_load_dwordx4 v132, s[20:23], s40 offen  lds
    v_mfma_f32_16x16x32_bf16 a[160:163], v[220:223], v[16:19], a[160:163]
    ds_read_b64_tr_b16 v[226:227], v129 offset:8520
    v_mfma_f32_16x16x32_bf16 a[164:167], v[216:219], v[4:7], a[164:167]
    ds_read_b64_tr_b16 v[228:229], v129 offset:584
    v_mfma_f32_16x16x32_bf16 a[164:167], v[220:223], v[20:23], a[164:167]
    s_mov_b32 s40, 0x1100
    s_add_u32 m0, s43, 4224
    ds_read_b64_tr_b16 v[230:231], v129 offset:9032
    v_mfma_f32_16x16x32_bf16 a[168:171], v[216:219], v[8:11], a[168:171]
    buffer_load_dwordx4 v132, s[20:23], s40 offen  lds
    v_mfma_f32_16x16x32_bf16 a[168:171], v[220:223], v[24:27], a[168:171]
    v_mfma_f32_16x16x32_bf16 a[172:175], v[216:219], v[12:15], a[172:175]
    v_mfma_f32_16x16x32_bf16 a[172:175], v[220:223], v[28:31], a[172:175]
    s_waitcnt lgkmcnt(0)
    s_mov_b32 s40, 0x1480
    s_add_u32 m0, s43, 5280
    v_mfma_f32_16x16x32_bf16 a[176:179], v[224:227], v[0:3], a[176:179]
    ds_read_b64_tr_b16 v[216:217], v129 offset:128
    buffer_load_dwordx4 v132, s[20:23], s40 offen  lds
    v_mfma_f32_16x16x32_bf16 a[176:179], v[228:231], v[16:19], a[176:179]
    ds_read_b64_tr_b16 v[218:219], v129 offset:8576
    v_mfma_f32_16x16x32_bf16 a[180:183], v[224:227], v[4:7], a[180:183]
    ds_read_b64_tr_b16 v[220:221], v129 offset:640
    v_mfma_f32_16x16x32_bf16 a[180:183], v[228:231], v[20:23], a[180:183]
    s_mov_b32 s40, 0x1800
    s_add_u32 m0, s43, 6336
    ds_read_b64_tr_b16 v[222:223], v129 offset:9088
    v_mfma_f32_16x16x32_bf16 a[184:187], v[224:227], v[8:11], a[184:187]
    buffer_load_dwordx4 v132, s[20:23], s40 offen  lds
    v_mfma_f32_16x16x32_bf16 a[184:187], v[228:231], v[24:27], a[184:187]
    v_mfma_f32_16x16x32_bf16 a[188:191], v[224:227], v[12:15], a[188:191]
    v_mfma_f32_16x16x32_bf16 a[188:191], v[228:231], v[28:31], a[188:191]
    s_waitcnt lgkmcnt(0)
    s_mov_b32 s40, 0x1b80
    s_add_u32 m0, s43, 7392
    v_mfma_f32_16x16x32_bf16 a[192:195], v[216:219], v[0:3], a[192:195]
    ds_read_b64_tr_b16 v[224:225], v129 offset:136
    buffer_load_dwordx4 v132, s[20:23], s40 offen  lds
    v_mfma_f32_16x16x32_bf16 a[192:195], v[220:223], v[16:19], a[192:195]
    ds_read_b64_tr_b16 v[226:227], v129 offset:8584
    v_mfma_f32_16x16x32_bf16 a[196:199], v[216:219], v[4:7], a[196:199]
    ds_read_b64_tr_b16 v[228:229], v129 offset:648
    v_mfma_f32_16x16x32_bf16 a[196:199], v[220:223], v[20:23], a[196:199]
    ds_read_b64_tr_b16 v[230:231], v129 offset:9096
    v_mfma_f32_16x16x32_bf16 a[200:203], v[216:219], v[8:11], a[200:203]
    v_mfma_f32_16x16x32_bf16 a[200:203], v[220:223], v[24:27], a[200:203]
    v_mfma_f32_16x16x32_bf16 a[204:207], v[216:219], v[12:15], a[204:207]
    v_mfma_f32_16x16x32_bf16 a[204:207], v[220:223], v[28:31], a[204:207]
    s_waitcnt lgkmcnt(0)
    v_mfma_f32_16x16x32_bf16 a[208:211], v[224:227], v[0:3], a[208:211]
    ds_read_b64_tr_b16 v[216:217], v129 offset:192
    s_waitcnt vmcnt(12)
    s_barrier
    v_mfma_f32_16x16x32_bf16 a[208:211], v[228:231], v[16:19], a[208:211]
    ds_read_b64_tr_b16 v[218:219], v129 offset:8640
    v_add_u32 v254, 0x10800, v130
    v_mfma_f32_16x16x32_bf16 a[212:215], v[224:227], v[4:7], a[212:215]
    ds_read_b64_tr_b16 v[220:221], v129 offset:704
    ds_read_b128 v[32:35], v254 offset:0
    v_mfma_f32_16x16x32_bf16 a[212:215], v[228:231], v[20:23], a[212:215]
    s_add_u32 m0, s33, 33792
    ds_read_b64_tr_b16 v[222:223], v129 offset:9152
    ds_read_b128 v[36:39], v254 offset:128
    v_mfma_f32_16x16x32_bf16 a[216:219], v[224:227], v[8:11], a[216:219]
    s_mov_b32 s40, 0x300000
    ds_read_b128 v[40:43], v254 offset:256
    buffer_load_dwordx4 v131, s[16:19], s40 offen  lds
    v_mfma_f32_16x16x32_bf16 a[216:219], v[228:231], v[24:27], a[216:219]
    ds_read_b128 v[44:47], v254 offset:384
    v_mfma_f32_16x16x32_bf16 a[220:223], v[224:227], v[12:15], a[220:223]
    ds_read_b128 v[48:51], v254 offset:64
    v_mfma_f32_16x16x32_bf16 a[220:223], v[228:231], v[28:31], a[220:223]
    s_waitcnt lgkmcnt(4)
    ds_read_b128 v[52:55], v254 offset:192
    v_mfma_f32_16x16x32_bf16 a[224:227], v[216:219], v[0:3], a[224:227]
    ds_read_b64_tr_b16 v[224:225], v129 offset:200
    ds_read_b128 v[56:59], v254 offset:320
    v_mfma_f32_16x16x32_bf16 a[224:227], v[220:223], v[16:19], a[224:227]
    s_add_u32 m0, s33, 34824
    ds_read_b64_tr_b16 v[226:227], v129 offset:8648
    ds_read_b128 v[60:63], v254 offset:448
    v_mfma_f32_16x16x32_bf16 a[228:231], v[216:219], v[4:7], a[228:231]
    s_mov_b32 s40, 0x302000
    ds_read_b64_tr_b16 v[228:229], v129 offset:712
    buffer_load_dwordx4 v131, s[16:19], s40 offen  lds
    v_mfma_f32_16x16x32_bf16 a[228:231], v[220:223], v[20:23], a[228:231]
    ds_read_b64_tr_b16 v[230:231], v129 offset:9160
    v_mfma_f32_16x16x32_bf16 a[232:235], v[216:219], v[8:11], a[232:235]
    s_mov_b32 s40, 0x304000
    s_add_u32 m0, s33, 35904
    v_add_u32 v129, 0x18c00, v128
    v_mfma_f32_16x16x32_bf16 a[232:235], v[220:223], v[24:27], a[232:235]
    buffer_load_dwordx4 v131, s[16:19], s40 offen  lds
    v_mfma_f32_16x16x32_bf16 a[236:239], v[216:219], v[12:15], a[236:239]
    v_mfma_f32_16x16x32_bf16 a[236:239], v[220:223], v[28:31], a[236:239]
    s_waitcnt lgkmcnt(0)
    v_mfma_f32_16x16x32_bf16 a[240:243], v[224:227], v[0:3], a[240:243]
    ds_read_b64_tr_b16 v[216:217], v129 offset:0
    v_mfma_f32_16x16x32_bf16 a[240:243], v[228:231], v[16:19], a[240:243]
    s_mov_b32 s40, 0x306000
    s_add_u32 m0, s33, 36936
    ds_read_b64_tr_b16 v[218:219], v129 offset:8448
    v_mfma_f32_16x16x32_bf16 a[244:247], v[224:227], v[4:7], a[244:247]
    ds_read_b64_tr_b16 v[220:221], v129 offset:512
    buffer_load_dwordx4 v131, s[16:19], s40 offen  lds
    v_mfma_f32_16x16x32_bf16 a[244:247], v[228:231], v[20:23], a[244:247]
    ds_read_b64_tr_b16 v[222:223], v129 offset:8960
    v_mfma_f32_16x16x32_bf16 a[248:251], v[224:227], v[8:11], a[248:251]
    v_mfma_f32_16x16x32_bf16 a[248:251], v[228:231], v[24:27], a[248:251]
    v_mfma_f32_16x16x32_bf16 a[252:255], v[224:227], v[12:15], a[252:255]
    v_mfma_f32_16x16x32_bf16 a[252:255], v[228:231], v[28:31], a[252:255]
    s_waitcnt lgkmcnt(0)
    v_mfma_f32_16x16x32_bf16 a[0:3], v[216:219], v[32:35], a[0:3]
    ds_read_b64_tr_b16 v[224:225], v129 offset:8
    v_mfma_f32_16x16x32_bf16 a[0:3], v[220:223], v[48:51], a[0:3]
    ds_read_b64_tr_b16 v[226:227], v129 offset:8456
    v_mfma_f32_16x16x32_bf16 a[4:7], v[216:219], v[36:39], a[4:7]
    ds_read_b64_tr_b16 v[228:229], v129 offset:520
    v_mfma_f32_16x16x32_bf16 a[4:7], v[220:223], v[52:55], a[4:7]
    ds_read_b64_tr_b16 v[230:231], v129 offset:8968
    v_mfma_f32_16x16x32_bf16 a[8:11], v[216:219], v[40:43], a[8:11]
    v_mfma_f32_16x16x32_bf16 a[8:11], v[220:223], v[56:59], a[8:11]
    v_mfma_f32_16x16x32_bf16 a[12:15], v[216:219], v[44:47], a[12:15]
    v_mfma_f32_16x16x32_bf16 a[12:15], v[220:223], v[60:63], a[12:15]
    s_waitcnt lgkmcnt(0)
    v_mfma_f32_16x16x32_bf16 a[16:19], v[224:227], v[32:35], a[16:19]
    ds_read_b64_tr_b16 v[216:217], v129 offset:64
    v_mfma_f32_16x16x32_bf16 a[16:19], v[228:231], v[48:51], a[16:19]
    ds_read_b64_tr_b16 v[218:219], v129 offset:8512
    v_mfma_f32_16x16x32_bf16 a[20:23], v[224:227], v[36:39], a[20:23]
    ds_read_b64_tr_b16 v[220:221], v129 offset:576
    v_mfma_f32_16x16x32_bf16 a[20:23], v[228:231], v[52:55], a[20:23]
    ds_read_b64_tr_b16 v[222:223], v129 offset:9024
    v_mfma_f32_16x16x32_bf16 a[24:27], v[224:227], v[40:43], a[24:27]
    v_mfma_f32_16x16x32_bf16 a[24:27], v[228:231], v[56:59], a[24:27]
    v_mfma_f32_16x16x32_bf16 a[28:31], v[224:227], v[44:47], a[28:31]
    v_mfma_f32_16x16x32_bf16 a[28:31], v[228:231], v[60:63], a[28:31]
    s_waitcnt lgkmcnt(0)
    v_mfma_f32_16x16x32_bf16 a[32:35], v[216:219], v[32:35], a[32:35]
    ds_read_b64_tr_b16 v[224:225], v129 offset:72
    v_mfma_f32_16x16x32_bf16 a[32:35], v[220:223], v[48:51], a[32:35]
    ds_read_b64_tr_b16 v[226:227], v129 offset:8520
    v_mfma_f32_16x16x32_bf16 a[36:39], v[216:219], v[36:39], a[36:39]
    ds_read_b64_tr_b16 v[228:229], v129 offset:584
    v_mfma_f32_16x16x32_bf16 a[36:39], v[220:223], v[52:55], a[36:39]
    ds_read_b64_tr_b16 v[230:231], v129 offset:9032
    v_mfma_f32_16x16x32_bf16 a[40:43], v[216:219], v[40:43], a[40:43]
    v_mfma_f32_16x16x32_bf16 a[40:43], v[220:223], v[56:59], a[40:43]
    v_mfma_f32_16x16x32_bf16 a[44:47], v[216:219], v[44:47], a[44:47]
    v_mfma_f32_16x16x32_bf16 a[44:47], v[220:223], v[60:63], a[44:47]
    s_waitcnt lgkmcnt(0)
    v_mfma_f32_16x16x32_bf16 a[48:51], v[224:227], v[32:35], a[48:51]
    ds_read_b64_tr_b16 v[216:217], v129 offset:128
    v_mfma_f32_16x16x32_bf16 a[48:51], v[228:231], v[48:51], a[48:51]
    ds_read_b64_tr_b16 v[218:219], v129 offset:8576
    v_mfma_f32_16x16x32_bf16 a[52:55], v[224:227], v[36:39], a[52:55]
    ds_read_b64_tr_b16 v[220:221], v129 offset:640
    v_mfma_f32_16x16x32_bf16 a[52:55], v[228:231], v[52:55], a[52:55]
    ds_read_b64_tr_b16 v[222:223], v129 offset:9088
    v_mfma_f32_16x16x32_bf16 a[56:59], v[224:227], v[40:43], a[56:59]
    v_mfma_f32_16x16x32_bf16 a[56:59], v[228:231], v[56:59], a[56:59]
    v_mfma_f32_16x16x32_bf16 a[60:63], v[224:227], v[44:47], a[60:63]
    v_mfma_f32_16x16x32_bf16 a[60:63], v[228:231], v[60:63], a[60:63]
    s_waitcnt lgkmcnt(0)
    v_mfma_f32_16x16x32_bf16 a[64:67], v[216:219], v[32:35], a[64:67]
    ds_read_b64_tr_b16 v[224:225], v129 offset:136
    v_mfma_f32_16x16x32_bf16 a[64:67], v[220:223], v[48:51], a[64:67]
    ds_read_b64_tr_b16 v[226:227], v129 offset:8584
    v_mfma_f32_16x16x32_bf16 a[68:71], v[216:219], v[36:39], a[68:71]
    ds_read_b64_tr_b16 v[228:229], v129 offset:648
    v_mfma_f32_16x16x32_bf16 a[68:71], v[220:223], v[52:55], a[68:71]
    ds_read_b64_tr_b16 v[230:231], v129 offset:9096
    v_mfma_f32_16x16x32_bf16 a[72:75], v[216:219], v[40:43], a[72:75]
    v_mfma_f32_16x16x32_bf16 a[72:75], v[220:223], v[56:59], a[72:75]
    v_mfma_f32_16x16x32_bf16 a[76:79], v[216:219], v[44:47], a[76:79]
    v_mfma_f32_16x16x32_bf16 a[76:79], v[220:223], v[60:63], a[76:79]
    s_waitcnt lgkmcnt(0)
    v_mfma_f32_16x16x32_bf16 a[80:83], v[224:227], v[32:35], a[80:83]
    ds_read_b64_tr_b16 v[216:217], v129 offset:192
    s_waitcnt vmcnt(12)
    s_barrier
    v_mfma_f32_16x16x32_bf16 a[80:83], v[228:231], v[48:51], a[80:83]
    ds_read_b64_tr_b16 v[218:219], v129 offset:8640
    v_mfma_f32_16x16x32_bf16 a[84:87], v[224:227], v[36:39], a[84:87]
    s_mov_b32 s40, 0x300100
    s_add_u32 m0, s33, 50688
    ds_read_b64_tr_b16 v[220:221], v129 offset:704
    v_mfma_f32_16x16x32_bf16 a[84:87], v[228:231], v[52:55], a[84:87]
    ds_read_b64_tr_b16 v[222:223], v129 offset:9152
    buffer_load_dwordx4 v131, s[16:19], s40 offen  lds
    v_mfma_f32_16x16x32_bf16 a[88:91], v[224:227], v[40:43], a[88:91]
    s_mov_b32 s40, 0x302100
    s_add_u32 m0, s33, 51720
    v_mfma_f32_16x16x32_bf16 a[88:91], v[228:231], v[56:59], a[88:91]
    buffer_load_dwordx4 v131, s[16:19], s40 offen  lds
    v_mfma_f32_16x16x32_bf16 a[92:95], v[224:227], v[44:47], a[92:95]
    s_mov_b32 s40, 0x304100
    s_add_u32 m0, s33, 52800
    v_mfma_f32_16x16x32_bf16 a[92:95], v[228:231], v[60:63], a[92:95]
    s_waitcnt lgkmcnt(0)
    buffer_load_dwordx4 v131, s[16:19], s40 offen  lds
    v_mfma_f32_16x16x32_bf16 a[96:99], v[216:219], v[32:35], a[96:99]
    s_mov_b32 s40, 0x306100
    s_add_u32 m0, s33, 53832
    ds_read_b64_tr_b16 v[224:225], v129 offset:200
    v_mfma_f32_16x16x32_bf16 a[96:99], v[220:223], v[48:51], a[96:99]
    ds_read_b64_tr_b16 v[226:227], v129 offset:8648
    buffer_load_dwordx4 v131, s[16:19], s40 offen  lds
    v_mfma_f32_16x16x32_bf16 a[100:103], v[216:219], v[36:39], a[100:103]
    s_mov_b32 s40, 0x4000
    s_add_u32 m0, s33, 84480
    ds_read_b64_tr_b16 v[228:229], v129 offset:712
    v_mfma_f32_16x16x32_bf16 a[100:103], v[220:223], v[52:55], a[100:103]
    ds_read_b64_tr_b16 v[230:231], v129 offset:9160
    buffer_load_dwordx4 v248, s[8:11], s40 offen offset:0 nt lds
    v_mfma_f32_16x16x32_bf16 a[104:107], v[216:219], v[40:43], a[104:107]
    s_add_u32 m0, s33, 85024
    v_add_u32 v129, 0x1ce00, v128
    v_mfma_f32_16x16x32_bf16 a[104:107], v[220:223], v[56:59], a[104:107]
    buffer_load_dwordx4 v248, s[8:11], s40 offen offset:512 nt lds
    v_mfma_f32_16x16x32_bf16 a[108:111], v[216:219], v[44:47], a[108:111]
    s_add_u32 m0, s33, 85568
    v_mfma_f32_16x16x32_bf16 a[108:111], v[220:223], v[60:63], a[108:111]
    s_waitcnt lgkmcnt(0)
    buffer_load_dwordx4 v248, s[8:11], s40 offen offset:1024 nt lds
    v_mfma_f32_16x16x32_bf16 a[112:115], v[224:227], v[32:35], a[112:115]
    s_add_u32 m0, s33, 86112
    ds_read_b64_tr_b16 v[216:217], v129 offset:0
    v_mfma_f32_16x16x32_bf16 a[112:115], v[228:231], v[48:51], a[112:115]
    ds_read_b64_tr_b16 v[218:219], v129 offset:8448
    buffer_load_dwordx4 v248, s[8:11], s40 offen offset:1536 nt lds
    v_mfma_f32_16x16x32_bf16 a[116:119], v[224:227], v[36:39], a[116:119]
    ds_read_b64_tr_b16 v[220:221], v129 offset:512
    v_mfma_f32_16x16x32_bf16 a[116:119], v[228:231], v[52:55], a[116:119]
    ds_read_b64_tr_b16 v[222:223], v129 offset:8960
    v_mfma_f32_16x16x32_bf16 a[120:123], v[224:227], v[40:43], a[120:123]
    v_mfma_f32_16x16x32_bf16 a[120:123], v[228:231], v[56:59], a[120:123]
    v_mfma_f32_16x16x32_bf16 a[124:127], v[224:227], v[44:47], a[124:127]
    v_mfma_f32_16x16x32_bf16 a[124:127], v[228:231], v[60:63], a[124:127]
    s_waitcnt lgkmcnt(0)
    v_mfma_f32_16x16x32_bf16 a[128:131], v[216:219], v[32:35], a[128:131]
    ds_read_b64_tr_b16 v[224:225], v129 offset:8
    v_mfma_f32_16x16x32_bf16 a[128:131], v[220:223], v[48:51], a[128:131]
    ds_read_b64_tr_b16 v[226:227], v129 offset:8456
    v_mfma_f32_16x16x32_bf16 a[132:135], v[216:219], v[36:39], a[132:135]
    ds_read_b64_tr_b16 v[228:229], v129 offset:520
    v_mfma_f32_16x16x32_bf16 a[132:135], v[220:223], v[52:55], a[132:135]
    ds_read_b64_tr_b16 v[230:231], v129 offset:8968
    v_mfma_f32_16x16x32_bf16 a[136:139], v[216:219], v[40:43], a[136:139]
    v_mfma_f32_16x16x32_bf16 a[136:139], v[220:223], v[56:59], a[136:139]
    v_mfma_f32_16x16x32_bf16 a[140:143], v[216:219], v[44:47], a[140:143]
    v_mfma_f32_16x16x32_bf16 a[140:143], v[220:223], v[60:63], a[140:143]
    s_waitcnt lgkmcnt(0)
    v_mfma_f32_16x16x32_bf16 a[144:147], v[224:227], v[32:35], a[144:147]
    ds_read_b64_tr_b16 v[216:217], v129 offset:64
    v_mfma_f32_16x16x32_bf16 a[144:147], v[228:231], v[48:51], a[144:147]
    ds_read_b64_tr_b16 v[218:219], v129 offset:8512
    v_mfma_f32_16x16x32_bf16 a[148:151], v[224:227], v[36:39], a[148:151]
    ds_read_b64_tr_b16 v[220:221], v129 offset:576
    v_mfma_f32_16x16x32_bf16 a[148:151], v[228:231], v[52:55], a[148:151]
    ds_read_b64_tr_b16 v[222:223], v129 offset:9024
    v_mfma_f32_16x16x32_bf16 a[152:155], v[224:227], v[40:43], a[152:155]
    v_mfma_f32_16x16x32_bf16 a[152:155], v[228:231], v[56:59], a[152:155]
    v_mfma_f32_16x16x32_bf16 a[156:159], v[224:227], v[44:47], a[156:159]
    v_mfma_f32_16x16x32_bf16 a[156:159], v[228:231], v[60:63], a[156:159]
    s_waitcnt lgkmcnt(0)
    v_mfma_f32_16x16x32_bf16 a[160:163], v[216:219], v[32:35], a[160:163]
    ds_read_b64_tr_b16 v[224:225], v129 offset:72
    v_mfma_f32_16x16x32_bf16 a[160:163], v[220:223], v[48:51], a[160:163]
    ds_read_b64_tr_b16 v[226:227], v129 offset:8520
    v_mfma_f32_16x16x32_bf16 a[164:167], v[216:219], v[36:39], a[164:167]
    ds_read_b64_tr_b16 v[228:229], v129 offset:584
    v_mfma_f32_16x16x32_bf16 a[164:167], v[220:223], v[52:55], a[164:167]
    ds_read_b64_tr_b16 v[230:231], v129 offset:9032
    v_mfma_f32_16x16x32_bf16 a[168:171], v[216:219], v[40:43], a[168:171]
    v_mfma_f32_16x16x32_bf16 a[168:171], v[220:223], v[56:59], a[168:171]
    v_mfma_f32_16x16x32_bf16 a[172:175], v[216:219], v[44:47], a[172:175]
    v_mfma_f32_16x16x32_bf16 a[172:175], v[220:223], v[60:63], a[172:175]
    s_waitcnt lgkmcnt(0)
    v_mfma_f32_16x16x32_bf16 a[176:179], v[224:227], v[32:35], a[176:179]
    ds_read_b64_tr_b16 v[216:217], v129 offset:128
    v_mfma_f32_16x16x32_bf16 a[176:179], v[228:231], v[48:51], a[176:179]
    ds_read_b64_tr_b16 v[218:219], v129 offset:8576
    v_mfma_f32_16x16x32_bf16 a[180:183], v[224:227], v[36:39], a[180:183]
    ds_read_b64_tr_b16 v[220:221], v129 offset:640
    v_mfma_f32_16x16x32_bf16 a[180:183], v[228:231], v[52:55], a[180:183]
    ds_read_b64_tr_b16 v[222:223], v129 offset:9088
    v_mfma_f32_16x16x32_bf16 a[184:187], v[224:227], v[40:43], a[184:187]
    v_mfma_f32_16x16x32_bf16 a[184:187], v[228:231], v[56:59], a[184:187]
    v_mfma_f32_16x16x32_bf16 a[188:191], v[224:227], v[44:47], a[188:191]
    v_mfma_f32_16x16x32_bf16 a[188:191], v[228:231], v[60:63], a[188:191]
    s_waitcnt lgkmcnt(0)
    v_mfma_f32_16x16x32_bf16 a[192:195], v[216:219], v[32:35], a[192:195]
    ds_read_b64_tr_b16 v[224:225], v129 offset:136
    v_mfma_f32_16x16x32_bf16 a[192:195], v[220:223], v[48:51], a[192:195]
    ds_read_b64_tr_b16 v[226:227], v129 offset:8584
    v_mfma_f32_16x16x32_bf16 a[196:199], v[216:219], v[36:39], a[196:199]
    ds_read_b64_tr_b16 v[228:229], v129 offset:648
    v_mfma_f32_16x16x32_bf16 a[196:199], v[220:223], v[52:55], a[196:199]
    ds_read_b64_tr_b16 v[230:231], v129 offset:9096
    v_mfma_f32_16x16x32_bf16 a[200:203], v[216:219], v[40:43], a[200:203]
    v_mfma_f32_16x16x32_bf16 a[200:203], v[220:223], v[56:59], a[200:203]
    v_mfma_f32_16x16x32_bf16 a[204:207], v[216:219], v[44:47], a[204:207]
    v_mfma_f32_16x16x32_bf16 a[204:207], v[220:223], v[60:63], a[204:207]
    s_waitcnt lgkmcnt(0)
    v_mfma_f32_16x16x32_bf16 a[208:211], v[224:227], v[32:35], a[208:211]
    ds_read_b64_tr_b16 v[216:217], v129 offset:192
    s_waitcnt vmcnt(8)
    s_barrier
    v_mfma_f32_16x16x32_bf16 a[208:211], v[228:231], v[48:51], a[208:211]
    ds_read_b64_tr_b16 v[218:219], v129 offset:8640
    v_add_u32 v254, 0x0, v130
    v_mfma_f32_16x16x32_bf16 a[212:215], v[224:227], v[36:39], a[212:215]
    ds_read_b64_tr_b16 v[220:221], v129 offset:704
    ds_read_b128 v[0:3], v254 offset:0
    v_mfma_f32_16x16x32_bf16 a[212:215], v[228:231], v[52:55], a[212:215]
    s_add_u32 m0, s33, 101376
    ds_read_b64_tr_b16 v[222:223], v129 offset:9152
    ds_read_b128 v[4:7], v254 offset:128
    v_mfma_f32_16x16x32_bf16 a[216:219], v[224:227], v[40:43], a[216:219]
    s_mov_b32 s40, 0x0
    ds_read_b128 v[8:11], v254 offset:256
    buffer_load_dwordx4 v248, s[12:15], s40 offen offset:0 nt lds
    v_mfma_f32_16x16x32_bf16 a[216:219], v[228:231], v[56:59], a[216:219]
    ds_read_b128 v[12:15], v254 offset:384
    v_mfma_f32_16x16x32_bf16 a[220:223], v[224:227], v[44:47], a[220:223]
    ds_read_b128 v[16:19], v254 offset:64
    v_mfma_f32_16x16x32_bf16 a[220:223], v[228:231], v[60:63], a[220:223]
    s_waitcnt lgkmcnt(4)
    ds_read_b128 v[20:23], v254 offset:192
    v_mfma_f32_16x16x32_bf16 a[224:227], v[216:219], v[32:35], a[224:227]
    ds_read_b64_tr_b16 v[224:225], v129 offset:200
    ds_read_b128 v[24:27], v254 offset:320
    v_mfma_f32_16x16x32_bf16 a[224:227], v[220:223], v[48:51], a[224:227]
    s_add_u32 m0, s33, 101920
    ds_read_b64_tr_b16 v[226:227], v129 offset:8648
    ds_read_b128 v[28:31], v254 offset:448
    v_mfma_f32_16x16x32_bf16 a[228:231], v[216:219], v[36:39], a[228:231]
    ds_read_b64_tr_b16 v[228:229], v129 offset:712
    buffer_load_dwordx4 v248, s[12:15], s40 offen offset:512 nt lds
    v_mfma_f32_16x16x32_bf16 a[228:231], v[220:223], v[52:55], a[228:231]
    ds_read_b64_tr_b16 v[230:231], v129 offset:9160
    v_mfma_f32_16x16x32_bf16 a[232:235], v[216:219], v[40:43], a[232:235]
    s_add_u32 m0, s33, 102464
    v_add_u32 v129, 0x8400, v128
    v_mfma_f32_16x16x32_bf16 a[232:235], v[220:223], v[56:59], a[232:235]
    buffer_load_dwordx4 v248, s[12:15], s40 offen offset:1024 nt lds
    v_mfma_f32_16x16x32_bf16 a[236:239], v[216:219], v[44:47], a[236:239]
    v_mfma_f32_16x16x32_bf16 a[236:239], v[220:223], v[60:63], a[236:239]
    s_waitcnt lgkmcnt(0)
    v_mfma_f32_16x16x32_bf16 a[240:243], v[224:227], v[32:35], a[240:243]
    ds_read_b64_tr_b16 v[216:217], v129 offset:0
    v_mfma_f32_16x16x32_bf16 a[240:243], v[228:231], v[48:51], a[240:243]
    s_add_u32 m0, s33, 103008
    ds_read_b64_tr_b16 v[218:219], v129 offset:8448
    v_mfma_f32_16x16x32_bf16 a[244:247], v[224:227], v[36:39], a[244:247]
    ds_read_b64_tr_b16 v[220:221], v129 offset:512
    buffer_load_dwordx4 v248, s[12:15], s40 offen offset:1536 nt lds
    v_mfma_f32_16x16x32_bf16 a[244:247], v[228:231], v[52:55], a[244:247]
    ds_read_b64_tr_b16 v[222:223], v129 offset:8960
    v_mfma_f32_16x16x32_bf16 a[248:251], v[224:227], v[40:43], a[248:251]
    v_mfma_f32_16x16x32_bf16 a[248:251], v[228:231], v[56:59], a[248:251]
    v_mfma_f32_16x16x32_bf16 a[252:255], v[224:227], v[44:47], a[252:255]
    v_mfma_f32_16x16x32_bf16 a[252:255], v[228:231], v[60:63], a[252:255]
    s_waitcnt lgkmcnt(0)
    v_mfma_f32_16x16x32_bf16 a[0:3], v[216:219], v[0:3], a[0:3]
    ds_read_b64_tr_b16 v[224:225], v129 offset:8
    v_mfma_f32_16x16x32_bf16 a[0:3], v[220:223], v[16:19], a[0:3]
    ds_read_b64_tr_b16 v[226:227], v129 offset:8456
    v_mfma_f32_16x16x32_bf16 a[4:7], v[216:219], v[4:7], a[4:7]
    ds_read_b64_tr_b16 v[228:229], v129 offset:520
    v_mfma_f32_16x16x32_bf16 a[4:7], v[220:223], v[20:23], a[4:7]
    ds_read_b64_tr_b16 v[230:231], v129 offset:8968
    v_mfma_f32_16x16x32_bf16 a[8:11], v[216:219], v[8:11], a[8:11]
    v_mfma_f32_16x16x32_bf16 a[8:11], v[220:223], v[24:27], a[8:11]
    v_mfma_f32_16x16x32_bf16 a[12:15], v[216:219], v[12:15], a[12:15]
    v_mfma_f32_16x16x32_bf16 a[12:15], v[220:223], v[28:31], a[12:15]
    s_waitcnt lgkmcnt(0)
    v_mfma_f32_16x16x32_bf16 a[16:19], v[224:227], v[0:3], a[16:19]
    ds_read_b64_tr_b16 v[216:217], v129 offset:64
    v_mfma_f32_16x16x32_bf16 a[16:19], v[228:231], v[16:19], a[16:19]
    ds_read_b64_tr_b16 v[218:219], v129 offset:8512
    v_mfma_f32_16x16x32_bf16 a[20:23], v[224:227], v[4:7], a[20:23]
    ds_read_b64_tr_b16 v[220:221], v129 offset:576
    v_mfma_f32_16x16x32_bf16 a[20:23], v[228:231], v[20:23], a[20:23]
    ds_read_b64_tr_b16 v[222:223], v129 offset:9024
    v_mfma_f32_16x16x32_bf16 a[24:27], v[224:227], v[8:11], a[24:27]
    v_mfma_f32_16x16x32_bf16 a[24:27], v[228:231], v[24:27], a[24:27]
    v_mfma_f32_16x16x32_bf16 a[28:31], v[224:227], v[12:15], a[28:31]
    v_mfma_f32_16x16x32_bf16 a[28:31], v[228:231], v[28:31], a[28:31]
    s_waitcnt lgkmcnt(0)
    v_mfma_f32_16x16x32_bf16 a[32:35], v[216:219], v[0:3], a[32:35]
    ds_read_b64_tr_b16 v[224:225], v129 offset:72
    v_mfma_f32_16x16x32_bf16 a[32:35], v[220:223], v[16:19], a[32:35]
    ds_read_b64_tr_b16 v[226:227], v129 offset:8520
    v_mfma_f32_16x16x32_bf16 a[36:39], v[216:219], v[4:7], a[36:39]
    ds_read_b64_tr_b16 v[228:229], v129 offset:584
    v_mfma_f32_16x16x32_bf16 a[36:39], v[220:223], v[20:23], a[36:39]
    ds_read_b64_tr_b16 v[230:231], v129 offset:9032
    v_mfma_f32_16x16x32_bf16 a[40:43], v[216:219], v[8:11], a[40:43]
    v_mfma_f32_16x16x32_bf16 a[40:43], v[220:223], v[24:27], a[40:43]
    v_mfma_f32_16x16x32_bf16 a[44:47], v[216:219], v[12:15], a[44:47]
    v_mfma_f32_16x16x32_bf16 a[44:47], v[220:223], v[28:31], a[44:47]
    s_waitcnt lgkmcnt(0)
    v_mfma_f32_16x16x32_bf16 a[48:51], v[224:227], v[0:3], a[48:51]
    ds_read_b64_tr_b16 v[216:217], v129 offset:128
    v_mfma_f32_16x16x32_bf16 a[48:51], v[228:231], v[16:19], a[48:51]
    ds_read_b64_tr_b16 v[218:219], v129 offset:8576
    v_mfma_f32_16x16x32_bf16 a[52:55], v[224:227], v[4:7], a[52:55]
    ds_read_b64_tr_b16 v[220:221], v129 offset:640
    v_mfma_f32_16x16x32_bf16 a[52:55], v[228:231], v[20:23], a[52:55]
    ds_read_b64_tr_b16 v[222:223], v129 offset:9088
    v_mfma_f32_16x16x32_bf16 a[56:59], v[224:227], v[8:11], a[56:59]
    v_mfma_f32_16x16x32_bf16 a[56:59], v[228:231], v[24:27], a[56:59]
    v_mfma_f32_16x16x32_bf16 a[60:63], v[224:227], v[12:15], a[60:63]
    v_mfma_f32_16x16x32_bf16 a[60:63], v[228:231], v[28:31], a[60:63]
    s_waitcnt lgkmcnt(0)
    v_mfma_f32_16x16x32_bf16 a[64:67], v[216:219], v[0:3], a[64:67]
    ds_read_b64_tr_b16 v[224:225], v129 offset:136
    v_mfma_f32_16x16x32_bf16 a[64:67], v[220:223], v[16:19], a[64:67]
    ds_read_b64_tr_b16 v[226:227], v129 offset:8584
    v_mfma_f32_16x16x32_bf16 a[68:71], v[216:219], v[4:7], a[68:71]
    ds_read_b64_tr_b16 v[228:229], v129 offset:648
    v_mfma_f32_16x16x32_bf16 a[68:71], v[220:223], v[20:23], a[68:71]
    ds_read_b64_tr_b16 v[230:231], v129 offset:9096
    v_mfma_f32_16x16x32_bf16 a[72:75], v[216:219], v[8:11], a[72:75]
    v_mfma_f32_16x16x32_bf16 a[72:75], v[220:223], v[24:27], a[72:75]
    v_mfma_f32_16x16x32_bf16 a[76:79], v[216:219], v[12:15], a[76:79]
    v_mfma_f32_16x16x32_bf16 a[76:79], v[220:223], v[28:31], a[76:79]
    s_waitcnt lgkmcnt(0)
    v_mfma_f32_16x16x32_bf16 a[80:83], v[224:227], v[0:3], a[80:83]
    ds_read_b64_tr_b16 v[216:217], v129 offset:192
    s_waitcnt vmcnt(8)
    s_barrier
    v_mfma_f32_16x16x32_bf16 a[80:83], v[228:231], v[16:19], a[80:83]
    ds_read_b64_tr_b16 v[218:219], v129 offset:8640
    v_mfma_f32_16x16x32_bf16 a[84:87], v[224:227], v[4:7], a[84:87]
    s_mov_b32 s40, 0x8000
    s_add_u32 m0, s33, 118272
    ds_read_b64_tr_b16 v[220:221], v129 offset:704
    v_mfma_f32_16x16x32_bf16 a[84:87], v[228:231], v[20:23], a[84:87]
    ds_read_b64_tr_b16 v[222:223], v129 offset:9152
    buffer_load_dwordx4 v248, s[8:11], s40 offen offset:0 nt lds
    v_mfma_f32_16x16x32_bf16 a[88:91], v[224:227], v[8:11], a[88:91]
    v_mfma_f32_16x16x32_bf16 a[88:91], v[228:231], v[24:27], a[88:91]
    v_mfma_f32_16x16x32_bf16 a[92:95], v[224:227], v[12:15], a[92:95]
    v_mfma_f32_16x16x32_bf16 a[92:95], v[228:231], v[28:31], a[92:95]
    s_waitcnt lgkmcnt(0)
    s_add_u32 m0, s33, 118816
    v_mfma_f32_16x16x32_bf16 a[96:99], v[216:219], v[0:3], a[96:99]
    ds_read_b64_tr_b16 v[224:225], v129 offset:200
    buffer_load_dwordx4 v248, s[8:11], s40 offen offset:512 nt lds
    v_mfma_f32_16x16x32_bf16 a[96:99], v[220:223], v[16:19], a[96:99]
    ds_read_b64_tr_b16 v[226:227], v129 offset:8648
    v_mfma_f32_16x16x32_bf16 a[100:103], v[216:219], v[4:7], a[100:103]
    ds_read_b64_tr_b16 v[228:229], v129 offset:712
    v_mfma_f32_16x16x32_bf16 a[100:103], v[220:223], v[20:23], a[100:103]
    ds_read_b64_tr_b16 v[230:231], v129 offset:9160
    v_mfma_f32_16x16x32_bf16 a[104:107], v[216:219], v[8:11], a[104:107]
    s_add_u32 m0, s33, 119360
    v_add_u32 v129, 0xc600, v128
    v_mfma_f32_16x16x32_bf16 a[104:107], v[220:223], v[24:27], a[104:107]
    buffer_load_dwordx4 v248, s[8:11], s40 offen offset:1024 nt lds
    v_mfma_f32_16x16x32_bf16 a[108:111], v[216:219], v[12:15], a[108:111]
    v_mfma_f32_16x16x32_bf16 a[108:111], v[220:223], v[28:31], a[108:111]
    s_waitcnt lgkmcnt(0)
    v_mfma_f32_16x16x32_bf16 a[112:115], v[224:227], v[0:3], a[112:115]
    ds_read_b64_tr_b16 v[216:217], v129 offset:0
    v_mfma_f32_16x16x32_bf16 a[112:115], v[228:231], v[16:19], a[112:115]
    s_add_u32 m0, s33, 119904
    ds_read_b64_tr_b16 v[218:219], v129 offset:8448
    v_mfma_f32_16x16x32_bf16 a[116:119], v[224:227], v[4:7], a[116:119]
    ds_read_b64_tr_b16 v[220:221], v129 offset:512
    buffer_load_dwordx4 v248, s[8:11], s40 offen offset:1536 nt lds
    v_mfma_f32_16x16x32_bf16 a[116:119], v[228:231], v[20:23], a[116:119]
    ds_read_b64_tr_b16 v[222:223], v129 offset:8960
    v_mfma_f32_16x16x32_bf16 a[120:123], v[224:227], v[8:11], a[120:123]
    v_mfma_f32_16x16x32_bf16 a[120:123], v[228:231], v[24:27], a[120:123]
    v_mfma_f32_16x16x32_bf16 a[124:127], v[224:227], v[12:15], a[124:127]
    v_mfma_f32_16x16x32_bf16 a[124:127], v[228:231], v[28:31], a[124:127]
    s_waitcnt lgkmcnt(0)
    v_mfma_f32_16x16x32_bf16 a[128:131], v[216:219], v[0:3], a[128:131]
    ds_read_b64_tr_b16 v[224:225], v129 offset:8
    v_mfma_f32_16x16x32_bf16 a[128:131], v[220:223], v[16:19], a[128:131]
    ds_read_b64_tr_b16 v[226:227], v129 offset:8456
    v_mfma_f32_16x16x32_bf16 a[132:135], v[216:219], v[4:7], a[132:135]
    ds_read_b64_tr_b16 v[228:229], v129 offset:520
    v_mfma_f32_16x16x32_bf16 a[132:135], v[220:223], v[20:23], a[132:135]
    s_mov_b32 s40, 0x4000
    s_add_u32 m0, s33, 0
    ds_read_b64_tr_b16 v[230:231], v129 offset:8968
    v_mfma_f32_16x16x32_bf16 a[136:139], v[216:219], v[8:11], a[136:139]
    buffer_load_dwordx4 v248, s[12:15], s40 offen offset:0 nt lds
    v_mfma_f32_16x16x32_bf16 a[136:139], v[220:223], v[24:27], a[136:139]
    v_mfma_f32_16x16x32_bf16 a[140:143], v[216:219], v[12:15], a[140:143]
    v_mfma_f32_16x16x32_bf16 a[140:143], v[220:223], v[28:31], a[140:143]
    s_waitcnt lgkmcnt(0)
    v_mfma_f32_16x16x32_bf16 a[144:147], v[224:227], v[0:3], a[144:147]
    ds_read_b64_tr_b16 v[216:217], v129 offset:64
    v_mfma_f32_16x16x32_bf16 a[144:147], v[228:231], v[16:19], a[144:147]
    ds_read_b64_tr_b16 v[218:219], v129 offset:8512
    v_mfma_f32_16x16x32_bf16 a[148:151], v[224:227], v[4:7], a[148:151]
    ds_read_b64_tr_b16 v[220:221], v129 offset:576
    v_mfma_f32_16x16x32_bf16 a[148:151], v[228:231], v[20:23], a[148:151]
    s_add_u32 m0, s33, 544
    ds_read_b64_tr_b16 v[222:223], v129 offset:9024
    v_mfma_f32_16x16x32_bf16 a[152:155], v[224:227], v[8:11], a[152:155]
    buffer_load_dwordx4 v248, s[12:15], s40 offen offset:512 nt lds
    v_mfma_f32_16x16x32_bf16 a[152:155], v[228:231], v[24:27], a[152:155]
    v_mfma_f32_16x16x32_bf16 a[156:159], v[224:227], v[12:15], a[156:159]
    v_mfma_f32_16x16x32_bf16 a[156:159], v[228:231], v[28:31], a[156:159]
    s_waitcnt lgkmcnt(0)
    v_mfma_f32_16x16x32_bf16 a[160:163], v[216:219], v[0:3], a[160:163]
    ds_read_b64_tr_b16 v[224:225], v129 offset:72
    v_mfma_f32_16x16x32_bf16 a[160:163], v[220:223], v[16:19], a[160:163]
    ds_read_b64_tr_b16 v[226:227], v129 offset:8520
    v_mfma_f32_16x16x32_bf16 a[164:167], v[216:219], v[4:7], a[164:167]
    ds_read_b64_tr_b16 v[228:229], v129 offset:584
    v_mfma_f32_16x16x32_bf16 a[164:167], v[220:223], v[20:23], a[164:167]
    s_add_u32 m0, s33, 1088
    ds_read_b64_tr_b16 v[230:231], v129 offset:9032
    v_mfma_f32_16x16x32_bf16 a[168:171], v[216:219], v[8:11], a[168:171]
    buffer_load_dwordx4 v248, s[12:15], s40 offen offset:1024 nt lds
    v_mfma_f32_16x16x32_bf16 a[168:171], v[220:223], v[24:27], a[168:171]
    v_mfma_f32_16x16x32_bf16 a[172:175], v[216:219], v[12:15], a[172:175]
    v_mfma_f32_16x16x32_bf16 a[172:175], v[220:223], v[28:31], a[172:175]
    s_waitcnt lgkmcnt(0)
    v_mfma_f32_16x16x32_bf16 a[176:179], v[224:227], v[0:3], a[176:179]
    ds_read_b64_tr_b16 v[216:217], v129 offset:128
    v_mfma_f32_16x16x32_bf16 a[176:179], v[228:231], v[16:19], a[176:179]
    ds_read_b64_tr_b16 v[218:219], v129 offset:8576
    v_mfma_f32_16x16x32_bf16 a[180:183], v[224:227], v[4:7], a[180:183]
    ds_read_b64_tr_b16 v[220:221], v129 offset:640
    v_mfma_f32_16x16x32_bf16 a[180:183], v[228:231], v[20:23], a[180:183]
    s_add_u32 m0, s33, 1632
    ds_read_b64_tr_b16 v[222:223], v129 offset:9088
    v_mfma_f32_16x16x32_bf16 a[184:187], v[224:227], v[8:11], a[184:187]
    buffer_load_dwordx4 v248, s[12:15], s40 offen offset:1536 nt lds
    v_mfma_f32_16x16x32_bf16 a[184:187], v[228:231], v[24:27], a[184:187]
    v_mfma_f32_16x16x32_bf16 a[188:191], v[224:227], v[12:15], a[188:191]
    v_mfma_f32_16x16x32_bf16 a[188:191], v[228:231], v[28:31], a[188:191]
    s_waitcnt lgkmcnt(0)
    v_mfma_f32_16x16x32_bf16 a[192:195], v[216:219], v[0:3], a[192:195]
    ds_read_b64_tr_b16 v[224:225], v129 offset:136
    v_mfma_f32_16x16x32_bf16 a[192:195], v[220:223], v[16:19], a[192:195]
    ds_read_b64_tr_b16 v[226:227], v129 offset:8584
    v_mfma_f32_16x16x32_bf16 a[196:199], v[216:219], v[4:7], a[196:199]
    ds_read_b64_tr_b16 v[228:229], v129 offset:648
    v_mfma_f32_16x16x32_bf16 a[196:199], v[220:223], v[20:23], a[196:199]
    ds_read_b64_tr_b16 v[230:231], v129 offset:9096
    v_mfma_f32_16x16x32_bf16 a[200:203], v[216:219], v[8:11], a[200:203]
    v_mfma_f32_16x16x32_bf16 a[200:203], v[220:223], v[24:27], a[200:203]
    v_mfma_f32_16x16x32_bf16 a[204:207], v[216:219], v[12:15], a[204:207]
    v_mfma_f32_16x16x32_bf16 a[204:207], v[220:223], v[28:31], a[204:207]
    s_waitcnt lgkmcnt(0)
    v_mfma_f32_16x16x32_bf16 a[208:211], v[224:227], v[0:3], a[208:211]
    ds_read_b64_tr_b16 v[216:217], v129 offset:192
    s_waitcnt vmcnt(16)
    s_barrier
    v_mfma_f32_16x16x32_bf16 a[208:211], v[228:231], v[16:19], a[208:211]
    ds_read_b64_tr_b16 v[218:219], v129 offset:8640
    v_mfma_f32_16x16x32_bf16 a[212:215], v[224:227], v[4:7], a[212:215]
    ds_read_b64_tr_b16 v[220:221], v129 offset:704
    v_mfma_f32_16x16x32_bf16 a[212:215], v[228:231], v[20:23], a[212:215]
    ds_read_b64_tr_b16 v[222:223], v129 offset:9152
    v_mfma_f32_16x16x32_bf16 a[216:219], v[224:227], v[8:11], a[216:219]
    v_mfma_f32_16x16x32_bf16 a[216:219], v[228:231], v[24:27], a[216:219]
    v_mfma_f32_16x16x32_bf16 a[220:223], v[224:227], v[12:15], a[220:223]
    v_mfma_f32_16x16x32_bf16 a[220:223], v[228:231], v[28:31], a[220:223]
    s_waitcnt lgkmcnt(0)
    v_mfma_f32_16x16x32_bf16 a[224:227], v[216:219], v[0:3], a[224:227]
    ds_read_b64_tr_b16 v[224:225], v129 offset:200
    v_mfma_f32_16x16x32_bf16 a[224:227], v[220:223], v[16:19], a[224:227]
    ds_read_b64_tr_b16 v[226:227], v129 offset:8648
    v_mfma_f32_16x16x32_bf16 a[228:231], v[216:219], v[4:7], a[228:231]
    ds_read_b64_tr_b16 v[228:229], v129 offset:712
    v_mfma_f32_16x16x32_bf16 a[228:231], v[220:223], v[20:23], a[228:231]
    ds_read_b64_tr_b16 v[230:231], v129 offset:9160
    v_mfma_f32_16x16x32_bf16 a[232:235], v[216:219], v[8:11], a[232:235]
    v_mfma_f32_16x16x32_bf16 a[232:235], v[220:223], v[24:27], a[232:235]
    v_mfma_f32_16x16x32_bf16 a[236:239], v[216:219], v[12:15], a[236:239]
    v_mfma_f32_16x16x32_bf16 a[236:239], v[220:223], v[28:31], a[236:239]
    s_waitcnt lgkmcnt(0)
    v_mfma_f32_16x16x32_bf16 a[240:243], v[224:227], v[0:3], a[240:243]
    v_mfma_f32_16x16x32_bf16 a[240:243], v[228:231], v[16:19], a[240:243]
    v_mfma_f32_16x16x32_bf16 a[244:247], v[224:227], v[4:7], a[244:247]
    v_mfma_f32_16x16x32_bf16 a[244:247], v[228:231], v[20:23], a[244:247]
    v_mfma_f32_16x16x32_bf16 a[248:251], v[224:227], v[8:11], a[248:251]
    v_mfma_f32_16x16x32_bf16 a[248:251], v[228:231], v[24:27], a[248:251]
    v_mfma_f32_16x16x32_bf16 a[252:255], v[224:227], v[12:15], a[252:255]
    v_mfma_f32_16x16x32_bf16 a[252:255], v[228:231], v[28:31], a[252:255]
    s_nop 7
    ds_read_b128 v[216:219], v246 offset:0
    ds_read_b128 v[220:223], v246 offset:8448
    v_accvgpr_read_b32 v238, a0
    v_accvgpr_read_b32 v239, a1
    v_mul_f32 v238, s39, v238
    v_mul_f32 v239, s39, v239
    v_cvt_pk_bf16_f32 v0, v238, v239
    v_accvgpr_read_b32 v240, a2
    v_accvgpr_read_b32 v241, a3
    v_mul_f32 v240, s39, v240
    v_mul_f32 v241, s39, v241
    v_cvt_pk_bf16_f32 v1, v240, v241
    v_accvgpr_read_b32 v242, a16
    v_accvgpr_read_b32 v243, a17
    v_mul_f32 v242, s39, v242
    v_mul_f32 v243, s39, v243
    v_cvt_pk_bf16_f32 v2, v242, v243
    v_accvgpr_read_b32 v244, a18
    v_accvgpr_read_b32 v245, a19
    v_mul_f32 v244, s39, v244
    v_mul_f32 v245, s39, v245
    v_cvt_pk_bf16_f32 v3, v244, v245
    v_accvgpr_read_b32 v238, a4
    v_accvgpr_read_b32 v239, a5
    v_mul_f32 v238, s39, v238
    v_mul_f32 v239, s39, v239
    v_cvt_pk_bf16_f32 v4, v238, v239
    v_accvgpr_read_b32 v240, a6
    v_accvgpr_read_b32 v241, a7
    v_mul_f32 v240, s39, v240
    v_mul_f32 v241, s39, v241
    v_cvt_pk_bf16_f32 v5, v240, v241
    v_accvgpr_read_b32 v242, a20
    v_accvgpr_read_b32 v243, a21
    v_mul_f32 v242, s39, v242
    v_mul_f32 v243, s39, v243
    v_cvt_pk_bf16_f32 v6, v242, v243
    v_accvgpr_read_b32 v244, a22
    v_accvgpr_read_b32 v245, a23
    v_mul_f32 v244, s39, v244
    v_mul_f32 v245, s39, v245
    v_cvt_pk_bf16_f32 v7, v244, v245
    v_accvgpr_read_b32 v238, a8
    v_accvgpr_read_b32 v239, a9
    v_mul_f32 v238, s39, v238
    v_mul_f32 v239, s39, v239
    v_cvt_pk_bf16_f32 v8, v238, v239
    v_accvgpr_read_b32 v240, a10
    v_accvgpr_read_b32 v241, a11
    v_mul_f32 v240, s39, v240
    v_mul_f32 v241, s39, v241
    v_cvt_pk_bf16_f32 v9, v240, v241
    v_accvgpr_read_b32 v242, a24
    v_accvgpr_read_b32 v243, a25
    v_mul_f32 v242, s39, v242
    v_mul_f32 v243, s39, v243
    v_cvt_pk_bf16_f32 v10, v242, v243
    v_accvgpr_read_b32 v244, a26
    v_accvgpr_read_b32 v245, a27
    v_mul_f32 v244, s39, v244
    v_mul_f32 v245, s39, v245
    v_cvt_pk_bf16_f32 v11, v244, v245
    v_accvgpr_read_b32 v238, a12
    v_accvgpr_read_b32 v239, a13
    v_mul_f32 v238, s39, v238
    v_mul_f32 v239, s39, v239
    v_cvt_pk_bf16_f32 v12, v238, v239
    v_accvgpr_read_b32 v240, a14
    v_accvgpr_read_b32 v241, a15
    v_mul_f32 v240, s39, v240
    v_mul_f32 v241, s39, v241
    v_cvt_pk_bf16_f32 v13, v240, v241
    v_accvgpr_read_b32 v242, a28
    v_accvgpr_read_b32 v243, a29
    v_mul_f32 v242, s39, v242
    v_mul_f32 v243, s39, v243
    v_cvt_pk_bf16_f32 v14, v242, v243
    v_accvgpr_read_b32 v244, a30
    v_accvgpr_read_b32 v245, a31
    v_mul_f32 v244, s39, v244
    v_mul_f32 v245, s39, v245
    v_cvt_pk_bf16_f32 v15, v244, v245
    s_waitcnt lgkmcnt(0)
    v_mfma_f32_16x16x32_bf16 v[128:131], v[216:219], v[0:3], 0
    v_accvgpr_read_b32 v238, a32
    v_accvgpr_read_b32 v239, a33
    v_mul_f32 v238, s39, v238
    v_mul_f32 v239, s39, v239
    v_cvt_pk_bf16_f32 v16, v238, v239
    v_accvgpr_read_b32 v240, a34
    v_accvgpr_read_b32 v241, a35
    v_mul_f32 v240, s39, v240
    v_mul_f32 v241, s39, v241
    v_cvt_pk_bf16_f32 v17, v240, v241
    ds_read_b128 v[224:227], v246 offset:64
    ds_read_b128 v[228:231], v246 offset:8512
    v_mfma_f32_16x16x32_bf16 v[136:139], v[216:219], v[4:7], 0
    v_accvgpr_read_b32 v242, a48
    v_accvgpr_read_b32 v243, a49
    v_mul_f32 v242, s39, v242
    v_mul_f32 v243, s39, v243
    v_cvt_pk_bf16_f32 v18, v242, v243
    v_accvgpr_read_b32 v244, a50
    v_accvgpr_read_b32 v245, a51
    v_mul_f32 v244, s39, v244
    v_mul_f32 v245, s39, v245
    v_cvt_pk_bf16_f32 v19, v244, v245
    v_mfma_f32_16x16x32_bf16 v[144:147], v[216:219], v[8:11], 0
    v_accvgpr_read_b32 v238, a36
    v_accvgpr_read_b32 v239, a37
    v_mul_f32 v238, s39, v238
    v_mul_f32 v239, s39, v239
    v_cvt_pk_bf16_f32 v20, v238, v239
    v_accvgpr_read_b32 v240, a38
    v_accvgpr_read_b32 v241, a39
    v_mul_f32 v240, s39, v240
    v_mul_f32 v241, s39, v241
    v_cvt_pk_bf16_f32 v21, v240, v241
    v_mfma_f32_16x16x32_bf16 v[152:155], v[216:219], v[12:15], 0
    v_accvgpr_read_b32 v242, a52
    v_accvgpr_read_b32 v243, a53
    v_mul_f32 v242, s39, v242
    v_mul_f32 v243, s39, v243
    v_cvt_pk_bf16_f32 v22, v242, v243
    v_accvgpr_read_b32 v244, a54
    v_accvgpr_read_b32 v245, a55
    v_mul_f32 v244, s39, v244
    v_mul_f32 v245, s39, v245
    v_cvt_pk_bf16_f32 v23, v244, v245
    v_mfma_f32_16x16x32_bf16 v[132:135], v[220:223], v[0:3], 0
    v_accvgpr_read_b32 v238, a40
    v_accvgpr_read_b32 v239, a41
    v_mul_f32 v238, s39, v238
    v_mul_f32 v239, s39, v239
    v_cvt_pk_bf16_f32 v24, v238, v239
    v_accvgpr_read_b32 v240, a42
    v_accvgpr_read_b32 v241, a43
    v_mul_f32 v240, s39, v240
    v_mul_f32 v241, s39, v241
    v_cvt_pk_bf16_f32 v25, v240, v241
    v_mfma_f32_16x16x32_bf16 v[140:143], v[220:223], v[4:7], 0
    v_accvgpr_read_b32 v242, a56
    v_accvgpr_read_b32 v243, a57
    v_mul_f32 v242, s39, v242
    v_mul_f32 v243, s39, v243
    v_cvt_pk_bf16_f32 v26, v242, v243
    v_accvgpr_read_b32 v244, a58
    v_accvgpr_read_b32 v245, a59
    v_mul_f32 v244, s39, v244
    v_mul_f32 v245, s39, v245
    v_cvt_pk_bf16_f32 v27, v244, v245
    v_mfma_f32_16x16x32_bf16 v[148:151], v[220:223], v[8:11], 0
    v_accvgpr_read_b32 v238, a44
    v_accvgpr_read_b32 v239, a45
    v_mul_f32 v238, s39, v238
    v_mul_f32 v239, s39, v239
    v_cvt_pk_bf16_f32 v28, v238, v239
    v_accvgpr_read_b32 v240, a46
    v_accvgpr_read_b32 v241, a47
    v_mul_f32 v240, s39, v240
    v_mul_f32 v241, s39, v241
    v_cvt_pk_bf16_f32 v29, v240, v241
    v_mfma_f32_16x16x32_bf16 v[156:159], v[220:223], v[12:15], 0
    v_accvgpr_read_b32 v242, a60
    v_accvgpr_read_b32 v243, a61
    v_mul_f32 v242, s39, v242
    v_mul_f32 v243, s39, v243
    v_cvt_pk_bf16_f32 v30, v242, v243
    v_accvgpr_read_b32 v244, a62
    v_accvgpr_read_b32 v245, a63
    v_mul_f32 v244, s39, v244
    v_mul_f32 v245, s39, v245
    v_cvt_pk_bf16_f32 v31, v244, v245
    s_waitcnt lgkmcnt(0)
    v_mfma_f32_16x16x32_bf16 v[128:131], v[224:227], v[16:19], v[128:131]
    v_accvgpr_read_b32 v238, a64
    v_accvgpr_read_b32 v239, a65
    v_mul_f32 v238, s39, v238
    v_mul_f32 v239, s39, v239
    v_cvt_pk_bf16_f32 v32, v238, v239
    v_accvgpr_read_b32 v240, a66
    v_accvgpr_read_b32 v241, a67
    v_mul_f32 v240, s39, v240
    v_mul_f32 v241, s39, v241
    v_cvt_pk_bf16_f32 v33, v240, v241
    ds_read_b128 v[216:219], v246 offset:128
    ds_read_b128 v[220:223], v246 offset:8576
    v_mfma_f32_16x16x32_bf16 v[136:139], v[224:227], v[20:23], v[136:139]
    v_accvgpr_read_b32 v242, a80
    v_accvgpr_read_b32 v243, a81
    v_mul_f32 v242, s39, v242
    v_mul_f32 v243, s39, v243
    v_cvt_pk_bf16_f32 v34, v242, v243
    v_accvgpr_read_b32 v244, a82
    v_accvgpr_read_b32 v245, a83
    v_mul_f32 v244, s39, v244
    v_mul_f32 v245, s39, v245
    v_cvt_pk_bf16_f32 v35, v244, v245
    v_mfma_f32_16x16x32_bf16 v[144:147], v[224:227], v[24:27], v[144:147]
    v_accvgpr_read_b32 v238, a68
    v_accvgpr_read_b32 v239, a69
    v_mul_f32 v238, s39, v238
    v_mul_f32 v239, s39, v239
    v_cvt_pk_bf16_f32 v36, v238, v239
    v_accvgpr_read_b32 v240, a70
    v_accvgpr_read_b32 v241, a71
    v_mul_f32 v240, s39, v240
    v_mul_f32 v241, s39, v241
    v_cvt_pk_bf16_f32 v37, v240, v241
    v_mfma_f32_16x16x32_bf16 v[152:155], v[224:227], v[28:31], v[152:155]
    v_accvgpr_read_b32 v242, a84
    v_accvgpr_read_b32 v243, a85
    v_mul_f32 v242, s39, v242
    v_mul_f32 v243, s39, v243
    v_cvt_pk_bf16_f32 v38, v242, v243
    v_accvgpr_read_b32 v244, a86
    v_accvgpr_read_b32 v245, a87
    v_mul_f32 v244, s39, v244
    v_mul_f32 v245, s39, v245
    v_cvt_pk_bf16_f32 v39, v244, v245
    v_mfma_f32_16x16x32_bf16 v[132:135], v[228:231], v[16:19], v[132:135]
    v_accvgpr_read_b32 v238, a72
    v_accvgpr_read_b32 v239, a73
    v_mul_f32 v238, s39, v238
    v_mul_f32 v239, s39, v239
    v_cvt_pk_bf16_f32 v40, v238, v239
    v_accvgpr_read_b32 v240, a74
    v_accvgpr_read_b32 v241, a75
    v_mul_f32 v240, s39, v240
    v_mul_f32 v241, s39, v241
    v_cvt_pk_bf16_f32 v41, v240, v241
    v_mfma_f32_16x16x32_bf16 v[140:143], v[228:231], v[20:23], v[140:143]
    v_accvgpr_read_b32 v242, a88
    v_accvgpr_read_b32 v243, a89
    v_mul_f32 v242, s39, v242
    v_mul_f32 v243, s39, v243
    v_cvt_pk_bf16_f32 v42, v242, v243
    v_accvgpr_read_b32 v244, a90
    v_accvgpr_read_b32 v245, a91
    v_mul_f32 v244, s39, v244
    v_mul_f32 v245, s39, v245
    v_cvt_pk_bf16_f32 v43, v244, v245
    v_mfma_f32_16x16x32_bf16 v[148:151], v[228:231], v[24:27], v[148:151]
    v_accvgpr_read_b32 v238, a76
    v_accvgpr_read_b32 v239, a77
    v_mul_f32 v238, s39, v238
    v_mul_f32 v239, s39, v239
    v_cvt_pk_bf16_f32 v44, v238, v239
    v_accvgpr_read_b32 v240, a78
    v_accvgpr_read_b32 v241, a79
    v_mul_f32 v240, s39, v240
    v_mul_f32 v241, s39, v241
    v_cvt_pk_bf16_f32 v45, v240, v241
    v_mfma_f32_16x16x32_bf16 v[156:159], v[228:231], v[28:31], v[156:159]
    v_accvgpr_read_b32 v242, a92
    v_accvgpr_read_b32 v243, a93
    v_mul_f32 v242, s39, v242
    v_mul_f32 v243, s39, v243
    v_cvt_pk_bf16_f32 v46, v242, v243
    v_accvgpr_read_b32 v244, a94
    v_accvgpr_read_b32 v245, a95
    v_mul_f32 v244, s39, v244
    v_mul_f32 v245, s39, v245
    v_cvt_pk_bf16_f32 v47, v244, v245
    s_waitcnt lgkmcnt(0)
    v_mfma_f32_16x16x32_bf16 v[128:131], v[216:219], v[32:35], v[128:131]
    v_accvgpr_read_b32 v238, a96
    v_accvgpr_read_b32 v239, a97
    v_mul_f32 v238, s39, v238
    v_mul_f32 v239, s39, v239
    v_cvt_pk_bf16_f32 v48, v238, v239
    v_accvgpr_read_b32 v240, a98
    v_accvgpr_read_b32 v241, a99
    v_mul_f32 v240, s39, v240
    v_mul_f32 v241, s39, v241
    v_cvt_pk_bf16_f32 v49, v240, v241
    ds_read_b128 v[224:227], v246 offset:192
    ds_read_b128 v[228:231], v246 offset:8640
    v_mfma_f32_16x16x32_bf16 v[136:139], v[216:219], v[36:39], v[136:139]
    v_accvgpr_read_b32 v242, a112
    v_accvgpr_read_b32 v243, a113
    v_mul_f32 v242, s39, v242
    v_mul_f32 v243, s39, v243
    v_cvt_pk_bf16_f32 v50, v242, v243
    v_accvgpr_read_b32 v244, a114
    v_accvgpr_read_b32 v245, a115
    v_mul_f32 v244, s39, v244
    v_mul_f32 v245, s39, v245
    v_cvt_pk_bf16_f32 v51, v244, v245
    v_mfma_f32_16x16x32_bf16 v[144:147], v[216:219], v[40:43], v[144:147]
    v_accvgpr_read_b32 v238, a100
    v_accvgpr_read_b32 v239, a101
    v_mul_f32 v238, s39, v238
    v_mul_f32 v239, s39, v239
    v_cvt_pk_bf16_f32 v52, v238, v239
    v_accvgpr_read_b32 v240, a102
    v_accvgpr_read_b32 v241, a103
    v_mul_f32 v240, s39, v240
    v_mul_f32 v241, s39, v241
    v_cvt_pk_bf16_f32 v53, v240, v241
    v_mfma_f32_16x16x32_bf16 v[152:155], v[216:219], v[44:47], v[152:155]
    v_accvgpr_read_b32 v242, a116
    v_accvgpr_read_b32 v243, a117
    v_mul_f32 v242, s39, v242
    v_mul_f32 v243, s39, v243
    v_cvt_pk_bf16_f32 v54, v242, v243
    v_accvgpr_read_b32 v244, a118
    v_accvgpr_read_b32 v245, a119
    v_mul_f32 v244, s39, v244
    v_mul_f32 v245, s39, v245
    v_cvt_pk_bf16_f32 v55, v244, v245
    v_mfma_f32_16x16x32_bf16 v[132:135], v[220:223], v[32:35], v[132:135]
    v_accvgpr_read_b32 v238, a104
    v_accvgpr_read_b32 v239, a105
    v_mul_f32 v238, s39, v238
    v_mul_f32 v239, s39, v239
    v_cvt_pk_bf16_f32 v56, v238, v239
    v_accvgpr_read_b32 v240, a106
    v_accvgpr_read_b32 v241, a107
    v_mul_f32 v240, s39, v240
    v_mul_f32 v241, s39, v241
    v_cvt_pk_bf16_f32 v57, v240, v241
    v_mfma_f32_16x16x32_bf16 v[140:143], v[220:223], v[36:39], v[140:143]
    v_accvgpr_read_b32 v242, a120
    v_accvgpr_read_b32 v243, a121
    v_mul_f32 v242, s39, v242
    v_mul_f32 v243, s39, v243
    v_cvt_pk_bf16_f32 v58, v242, v243
    v_accvgpr_read_b32 v244, a122
    v_accvgpr_read_b32 v245, a123
    v_mul_f32 v244, s39, v244
    v_mul_f32 v245, s39, v245
    v_cvt_pk_bf16_f32 v59, v244, v245
    v_mfma_f32_16x16x32_bf16 v[148:151], v[220:223], v[40:43], v[148:151]
    v_accvgpr_read_b32 v238, a108
    v_accvgpr_read_b32 v239, a109
    v_mul_f32 v238, s39, v238
    v_mul_f32 v239, s39, v239
    v_cvt_pk_bf16_f32 v60, v238, v239
    v_accvgpr_read_b32 v240, a110
    v_accvgpr_read_b32 v241, a111
    v_mul_f32 v240, s39, v240
    v_mul_f32 v241, s39, v241
    v_cvt_pk_bf16_f32 v61, v240, v241
    v_mfma_f32_16x16x32_bf16 v[156:159], v[220:223], v[44:47], v[156:159]
    v_accvgpr_read_b32 v242, a124
    v_accvgpr_read_b32 v243, a125
    v_mul_f32 v242, s39, v242
    v_mul_f32 v243, s39, v243
    v_cvt_pk_bf16_f32 v62, v242, v243
    v_accvgpr_read_b32 v244, a126
    v_accvgpr_read_b32 v245, a127
    v_mul_f32 v244, s39, v244
    v_mul_f32 v245, s39, v245
    v_cvt_pk_bf16_f32 v63, v244, v245
    s_mov_b32 s40, 0xc000
    s_add_u32 m0, s33, 16896
    s_nop 0
    buffer_load_dwordx4 v248, s[8:11], s40 offen offset:0 nt lds
    s_add_u32 m0, s33, 17440
    s_nop 0
    buffer_load_dwordx4 v248, s[8:11], s40 offen offset:512 nt lds
    s_add_u32 m0, s33, 17984
    s_nop 0
    buffer_load_dwordx4 v248, s[8:11], s40 offen offset:1024 nt lds
    s_add_u32 m0, s33, 18528
    s_nop 0
    buffer_load_dwordx4 v248, s[8:11], s40 offen offset:1536 nt lds
    s_waitcnt lgkmcnt(0)
    v_mfma_f32_16x16x32_bf16 v[128:131], v[224:227], v[48:51], v[128:131]
    v_accvgpr_read_b32 v238, a128
    v_accvgpr_read_b32 v239, a129
    v_mul_f32 v238, s39, v238
    v_mul_f32 v239, s39, v239
    v_cvt_pk_bf16_f32 v64, v238, v239
    v_accvgpr_read_b32 v240, a130
    v_accvgpr_read_b32 v241, a131
    v_mul_f32 v240, s39, v240
    v_mul_f32 v241, s39, v241
    v_cvt_pk_bf16_f32 v65, v240, v241
    ds_read_b128 v[216:219], v246 offset:256
    ds_read_b128 v[220:223], v246 offset:8704
    v_mfma_f32_16x16x32_bf16 v[136:139], v[224:227], v[52:55], v[136:139]
    v_accvgpr_read_b32 v242, a144
    v_accvgpr_read_b32 v243, a145
    v_mul_f32 v242, s39, v242
    v_mul_f32 v243, s39, v243
    v_cvt_pk_bf16_f32 v66, v242, v243
    v_accvgpr_read_b32 v244, a146
    v_accvgpr_read_b32 v245, a147
    v_mul_f32 v244, s39, v244
    v_mul_f32 v245, s39, v245
    v_cvt_pk_bf16_f32 v67, v244, v245
    v_mfma_f32_16x16x32_bf16 v[144:147], v[224:227], v[56:59], v[144:147]
    v_accvgpr_read_b32 v238, a132
    v_accvgpr_read_b32 v239, a133
    v_mul_f32 v238, s39, v238
    v_mul_f32 v239, s39, v239
    v_cvt_pk_bf16_f32 v68, v238, v239
    v_accvgpr_read_b32 v240, a134
    v_accvgpr_read_b32 v241, a135
    v_mul_f32 v240, s39, v240
    v_mul_f32 v241, s39, v241
    v_cvt_pk_bf16_f32 v69, v240, v241
    v_mfma_f32_16x16x32_bf16 v[152:155], v[224:227], v[60:63], v[152:155]
    v_accvgpr_read_b32 v242, a148
    v_accvgpr_read_b32 v243, a149
    v_mul_f32 v242, s39, v242
    v_mul_f32 v243, s39, v243
    v_cvt_pk_bf16_f32 v70, v242, v243
    v_accvgpr_read_b32 v244, a150
    v_accvgpr_read_b32 v245, a151
    v_mul_f32 v244, s39, v244
    v_mul_f32 v245, s39, v245
    v_cvt_pk_bf16_f32 v71, v244, v245
    v_mfma_f32_16x16x32_bf16 v[132:135], v[228:231], v[48:51], v[132:135]
    v_accvgpr_read_b32 v238, a136
    v_accvgpr_read_b32 v239, a137
    v_mul_f32 v238, s39, v238
    v_mul_f32 v239, s39, v239
    v_cvt_pk_bf16_f32 v72, v238, v239
    v_accvgpr_read_b32 v240, a138
    v_accvgpr_read_b32 v241, a139
    v_mul_f32 v240, s39, v240
    v_mul_f32 v241, s39, v241
    v_cvt_pk_bf16_f32 v73, v240, v241
    v_mfma_f32_16x16x32_bf16 v[140:143], v[228:231], v[52:55], v[140:143]
    v_accvgpr_read_b32 v242, a152
    v_accvgpr_read_b32 v243, a153
    v_mul_f32 v242, s39, v242
    v_mul_f32 v243, s39, v243
    v_cvt_pk_bf16_f32 v74, v242, v243
    v_accvgpr_read_b32 v244, a154
    v_accvgpr_read_b32 v245, a155
    v_mul_f32 v244, s39, v244
    v_mul_f32 v245, s39, v245
    v_cvt_pk_bf16_f32 v75, v244, v245
    v_mfma_f32_16x16x32_bf16 v[148:151], v[228:231], v[56:59], v[148:151]
    v_accvgpr_read_b32 v238, a140
    v_accvgpr_read_b32 v239, a141
    v_mul_f32 v238, s39, v238
    v_mul_f32 v239, s39, v239
    v_cvt_pk_bf16_f32 v76, v238, v239
    v_accvgpr_read_b32 v240, a142
    v_accvgpr_read_b32 v241, a143
    v_mul_f32 v240, s39, v240
    v_mul_f32 v241, s39, v241
    v_cvt_pk_bf16_f32 v77, v240, v241
    v_mfma_f32_16x16x32_bf16 v[156:159], v[228:231], v[60:63], v[156:159]
    v_accvgpr_read_b32 v242, a156
    v_accvgpr_read_b32 v243, a157
    v_mul_f32 v242, s39, v242
    v_mul_f32 v243, s39, v243
    v_cvt_pk_bf16_f32 v78, v242, v243
    v_accvgpr_read_b32 v244, a158
    v_accvgpr_read_b32 v245, a159
    v_mul_f32 v244, s39, v244
    v_mul_f32 v245, s39, v245
    v_cvt_pk_bf16_f32 v79, v244, v245
    s_waitcnt lgkmcnt(0)
    v_mfma_f32_16x16x32_bf16 v[128:131], v[216:219], v[64:67], v[128:131]
    v_accvgpr_read_b32 v238, a160
    v_accvgpr_read_b32 v239, a161
    v_mul_f32 v238, s39, v238
    v_mul_f32 v239, s39, v239
    v_cvt_pk_bf16_f32 v80, v238, v239
    v_accvgpr_read_b32 v240, a162
    v_accvgpr_read_b32 v241, a163
    v_mul_f32 v240, s39, v240
    v_mul_f32 v241, s39, v241
    v_cvt_pk_bf16_f32 v81, v240, v241
    ds_read_b128 v[224:227], v246 offset:320
    ds_read_b128 v[228:231], v246 offset:8768
    v_mfma_f32_16x16x32_bf16 v[136:139], v[216:219], v[68:71], v[136:139]
    v_accvgpr_read_b32 v242, a176
    v_accvgpr_read_b32 v243, a177
    v_mul_f32 v242, s39, v242
    v_mul_f32 v243, s39, v243
    v_cvt_pk_bf16_f32 v82, v242, v243
    v_accvgpr_read_b32 v244, a178
    v_accvgpr_read_b32 v245, a179
    v_mul_f32 v244, s39, v244
    v_mul_f32 v245, s39, v245
    v_cvt_pk_bf16_f32 v83, v244, v245
    v_mfma_f32_16x16x32_bf16 v[144:147], v[216:219], v[72:75], v[144:147]
    v_accvgpr_read_b32 v238, a164
    v_accvgpr_read_b32 v239, a165
    v_mul_f32 v238, s39, v238
    v_mul_f32 v239, s39, v239
    v_cvt_pk_bf16_f32 v84, v238, v239
    v_accvgpr_read_b32 v240, a166
    v_accvgpr_read_b32 v241, a167
    v_mul_f32 v240, s39, v240
    v_mul_f32 v241, s39, v241
    v_cvt_pk_bf16_f32 v85, v240, v241
    v_mfma_f32_16x16x32_bf16 v[152:155], v[216:219], v[76:79], v[152:155]
    v_accvgpr_read_b32 v242, a180
    v_accvgpr_read_b32 v243, a181
    v_mul_f32 v242, s39, v242
    v_mul_f32 v243, s39, v243
    v_cvt_pk_bf16_f32 v86, v242, v243
    v_accvgpr_read_b32 v244, a182
    v_accvgpr_read_b32 v245, a183
    v_mul_f32 v244, s39, v244
    v_mul_f32 v245, s39, v245
    v_cvt_pk_bf16_f32 v87, v244, v245
    v_mfma_f32_16x16x32_bf16 v[132:135], v[220:223], v[64:67], v[132:135]
    v_accvgpr_read_b32 v238, a168
    v_accvgpr_read_b32 v239, a169
    v_mul_f32 v238, s39, v238
    v_mul_f32 v239, s39, v239
    v_cvt_pk_bf16_f32 v88, v238, v239
    v_accvgpr_read_b32 v240, a170
    v_accvgpr_read_b32 v241, a171
    v_mul_f32 v240, s39, v240
    v_mul_f32 v241, s39, v241
    v_cvt_pk_bf16_f32 v89, v240, v241
    v_mfma_f32_16x16x32_bf16 v[140:143], v[220:223], v[68:71], v[140:143]
    v_accvgpr_read_b32 v242, a184
    v_accvgpr_read_b32 v243, a185
    v_mul_f32 v242, s39, v242
    v_mul_f32 v243, s39, v243
    v_cvt_pk_bf16_f32 v90, v242, v243
    v_accvgpr_read_b32 v244, a186
    v_accvgpr_read_b32 v245, a187
    v_mul_f32 v244, s39, v244
    v_mul_f32 v245, s39, v245
    v_cvt_pk_bf16_f32 v91, v244, v245
    v_mfma_f32_16x16x32_bf16 v[148:151], v[220:223], v[72:75], v[148:151]
    v_accvgpr_read_b32 v238, a172
    v_accvgpr_read_b32 v239, a173
    v_mul_f32 v238, s39, v238
    v_mul_f32 v239, s39, v239
    v_cvt_pk_bf16_f32 v92, v238, v239
    v_accvgpr_read_b32 v240, a174
    v_accvgpr_read_b32 v241, a175
    v_mul_f32 v240, s39, v240
    v_mul_f32 v241, s39, v241
    v_cvt_pk_bf16_f32 v93, v240, v241
    v_mfma_f32_16x16x32_bf16 v[156:159], v[220:223], v[76:79], v[156:159]
    v_accvgpr_read_b32 v242, a188
    v_accvgpr_read_b32 v243, a189
    v_mul_f32 v242, s39, v242
    v_mul_f32 v243, s39, v243
    v_cvt_pk_bf16_f32 v94, v242, v243
    v_accvgpr_read_b32 v244, a190
    v_accvgpr_read_b32 v245, a191
    v_mul_f32 v244, s39, v244
    v_mul_f32 v245, s39, v245
    v_cvt_pk_bf16_f32 v95, v244, v245
    s_waitcnt lgkmcnt(0)
    v_mfma_f32_16x16x32_bf16 v[128:131], v[224:227], v[80:83], v[128:131]
    v_accvgpr_read_b32 v238, a192
    v_accvgpr_read_b32 v239, a193
    v_mul_f32 v238, s39, v238
    v_mul_f32 v239, s39, v239
    v_cvt_pk_bf16_f32 v96, v238, v239
    v_accvgpr_read_b32 v240, a194
    v_accvgpr_read_b32 v241, a195
    v_mul_f32 v240, s39, v240
    v_mul_f32 v241, s39, v241
    v_cvt_pk_bf16_f32 v97, v240, v241
    ds_read_b128 v[216:219], v246 offset:384
    ds_read_b128 v[220:223], v246 offset:8832
    v_mfma_f32_16x16x32_bf16 v[136:139], v[224:227], v[84:87], v[136:139]
    v_accvgpr_read_b32 v242, a208
    v_accvgpr_read_b32 v243, a209
    v_mul_f32 v242, s39, v242
    v_mul_f32 v243, s39, v243
    v_cvt_pk_bf16_f32 v98, v242, v243
    v_accvgpr_read_b32 v244, a210
    v_accvgpr_read_b32 v245, a211
    v_mul_f32 v244, s39, v244
    v_mul_f32 v245, s39, v245
    v_cvt_pk_bf16_f32 v99, v244, v245
    v_mfma_f32_16x16x32_bf16 v[144:147], v[224:227], v[88:91], v[144:147]
    v_accvgpr_read_b32 v238, a196
    v_accvgpr_read_b32 v239, a197
    v_mul_f32 v238, s39, v238
    v_mul_f32 v239, s39, v239
    v_cvt_pk_bf16_f32 v100, v238, v239
    v_accvgpr_read_b32 v240, a198
    v_accvgpr_read_b32 v241, a199
    v_mul_f32 v240, s39, v240
    v_mul_f32 v241, s39, v241
    v_cvt_pk_bf16_f32 v101, v240, v241
    v_mfma_f32_16x16x32_bf16 v[152:155], v[224:227], v[92:95], v[152:155]
    v_accvgpr_read_b32 v242, a212
    v_accvgpr_read_b32 v243, a213
    v_mul_f32 v242, s39, v242
    v_mul_f32 v243, s39, v243
    v_cvt_pk_bf16_f32 v102, v242, v243
    v_accvgpr_read_b32 v244, a214
    v_accvgpr_read_b32 v245, a215
    v_mul_f32 v244, s39, v244
    v_mul_f32 v245, s39, v245
    v_cvt_pk_bf16_f32 v103, v244, v245
    v_mfma_f32_16x16x32_bf16 v[132:135], v[228:231], v[80:83], v[132:135]
    v_accvgpr_read_b32 v238, a200
    v_accvgpr_read_b32 v239, a201
    v_mul_f32 v238, s39, v238
    v_mul_f32 v239, s39, v239
    v_cvt_pk_bf16_f32 v104, v238, v239
    v_accvgpr_read_b32 v240, a202
    v_accvgpr_read_b32 v241, a203
    v_mul_f32 v240, s39, v240
    v_mul_f32 v241, s39, v241
    v_cvt_pk_bf16_f32 v105, v240, v241
    v_mfma_f32_16x16x32_bf16 v[140:143], v[228:231], v[84:87], v[140:143]
    v_accvgpr_read_b32 v242, a216
    v_accvgpr_read_b32 v243, a217
    v_mul_f32 v242, s39, v242
    v_mul_f32 v243, s39, v243
    v_cvt_pk_bf16_f32 v106, v242, v243
    v_accvgpr_read_b32 v244, a218
    v_accvgpr_read_b32 v245, a219
    v_mul_f32 v244, s39, v244
    v_mul_f32 v245, s39, v245
    v_cvt_pk_bf16_f32 v107, v244, v245
    v_mfma_f32_16x16x32_bf16 v[148:151], v[228:231], v[88:91], v[148:151]
    v_accvgpr_read_b32 v238, a204
    v_accvgpr_read_b32 v239, a205
    v_mul_f32 v238, s39, v238
    v_mul_f32 v239, s39, v239
    v_cvt_pk_bf16_f32 v108, v238, v239
    v_accvgpr_read_b32 v240, a206
    v_accvgpr_read_b32 v241, a207
    v_mul_f32 v240, s39, v240
    v_mul_f32 v241, s39, v241
    v_cvt_pk_bf16_f32 v109, v240, v241
    v_mfma_f32_16x16x32_bf16 v[156:159], v[228:231], v[92:95], v[156:159]
    v_accvgpr_read_b32 v242, a220
    v_accvgpr_read_b32 v243, a221
    v_mul_f32 v242, s39, v242
    v_mul_f32 v243, s39, v243
    v_cvt_pk_bf16_f32 v110, v242, v243
    v_accvgpr_read_b32 v244, a222
    v_accvgpr_read_b32 v245, a223
    v_mul_f32 v244, s39, v244
    v_mul_f32 v245, s39, v245
    v_cvt_pk_bf16_f32 v111, v244, v245
    s_waitcnt lgkmcnt(0)
    v_mfma_f32_16x16x32_bf16 v[128:131], v[216:219], v[96:99], v[128:131]
    v_accvgpr_read_b32 v238, a224
    v_accvgpr_read_b32 v239, a225
    v_mul_f32 v238, s39, v238
    v_mul_f32 v239, s39, v239
    v_cvt_pk_bf16_f32 v112, v238, v239
    v_accvgpr_read_b32 v240, a226
    v_accvgpr_read_b32 v241, a227
    v_mul_f32 v240, s39, v240
    v_mul_f32 v241, s39, v241
    v_cvt_pk_bf16_f32 v113, v240, v241
    ds_read_b128 v[224:227], v246 offset:448
    ds_read_b128 v[228:231], v246 offset:8896
    v_mfma_f32_16x16x32_bf16 v[136:139], v[216:219], v[100:103], v[136:139]
    v_accvgpr_read_b32 v242, a240
    v_accvgpr_read_b32 v243, a241
    v_mul_f32 v242, s39, v242
    v_mul_f32 v243, s39, v243
    v_cvt_pk_bf16_f32 v114, v242, v243
    v_accvgpr_read_b32 v244, a242
    v_accvgpr_read_b32 v245, a243
    v_mul_f32 v244, s39, v244
    v_mul_f32 v245, s39, v245
    v_cvt_pk_bf16_f32 v115, v244, v245
    v_mfma_f32_16x16x32_bf16 v[144:147], v[216:219], v[104:107], v[144:147]
    v_accvgpr_read_b32 v238, a228
    v_accvgpr_read_b32 v239, a229
    v_mul_f32 v238, s39, v238
    v_mul_f32 v239, s39, v239
    v_cvt_pk_bf16_f32 v116, v238, v239
    v_accvgpr_read_b32 v240, a230
    v_accvgpr_read_b32 v241, a231
    v_mul_f32 v240, s39, v240
    v_mul_f32 v241, s39, v241
    v_cvt_pk_bf16_f32 v117, v240, v241
    v_mfma_f32_16x16x32_bf16 v[152:155], v[216:219], v[108:111], v[152:155]
    v_accvgpr_read_b32 v242, a244
    v_accvgpr_read_b32 v243, a245
    v_mul_f32 v242, s39, v242
    v_mul_f32 v243, s39, v243
    v_cvt_pk_bf16_f32 v118, v242, v243
    v_accvgpr_read_b32 v244, a246
    v_accvgpr_read_b32 v245, a247
    v_mul_f32 v244, s39, v244
    v_mul_f32 v245, s39, v245
    v_cvt_pk_bf16_f32 v119, v244, v245
    v_mfma_f32_16x16x32_bf16 v[132:135], v[220:223], v[96:99], v[132:135]
    v_accvgpr_read_b32 v238, a232
    v_accvgpr_read_b32 v239, a233
    v_mul_f32 v238, s39, v238
    v_mul_f32 v239, s39, v239
    v_cvt_pk_bf16_f32 v120, v238, v239
    v_accvgpr_read_b32 v240, a234
    v_accvgpr_read_b32 v241, a235
    v_mul_f32 v240, s39, v240
    v_mul_f32 v241, s39, v241
    v_cvt_pk_bf16_f32 v121, v240, v241
    v_mfma_f32_16x16x32_bf16 v[140:143], v[220:223], v[100:103], v[140:143]
    v_accvgpr_read_b32 v242, a248
    v_accvgpr_read_b32 v243, a249
    v_mul_f32 v242, s39, v242
    v_mul_f32 v243, s39, v243
    v_cvt_pk_bf16_f32 v122, v242, v243
    v_accvgpr_read_b32 v244, a250
    v_accvgpr_read_b32 v245, a251
    v_mul_f32 v244, s39, v244
    v_mul_f32 v245, s39, v245
    v_cvt_pk_bf16_f32 v123, v244, v245
    v_mfma_f32_16x16x32_bf16 v[148:151], v[220:223], v[104:107], v[148:151]
    v_accvgpr_read_b32 v238, a236
    v_accvgpr_read_b32 v239, a237
    v_mul_f32 v238, s39, v238
    v_mul_f32 v239, s39, v239
    v_cvt_pk_bf16_f32 v124, v238, v239
    v_accvgpr_read_b32 v240, a238
    v_accvgpr_read_b32 v241, a239
    v_mul_f32 v240, s39, v240
    v_mul_f32 v241, s39, v241
    v_cvt_pk_bf16_f32 v125, v240, v241
    v_mfma_f32_16x16x32_bf16 v[156:159], v[220:223], v[108:111], v[156:159]
    v_accvgpr_read_b32 v242, a252
    v_accvgpr_read_b32 v243, a253
    v_mul_f32 v242, s39, v242
    v_mul_f32 v243, s39, v243
    v_cvt_pk_bf16_f32 v126, v242, v243
    v_accvgpr_read_b32 v244, a254
    v_accvgpr_read_b32 v245, a255
    v_mul_f32 v244, s39, v244
    v_mul_f32 v245, s39, v245
    v_cvt_pk_bf16_f32 v127, v244, v245
    s_waitcnt lgkmcnt(0)
    s_nop 1
    v_mfma_f32_16x16x32_bf16 v[128:131], v[224:227], v[112:115], v[128:131]
    v_mfma_f32_16x16x32_bf16 v[136:139], v[224:227], v[116:119], v[136:139]
    v_mfma_f32_16x16x32_bf16 v[144:147], v[224:227], v[120:123], v[144:147]
    v_mfma_f32_16x16x32_bf16 v[152:155], v[224:227], v[124:127], v[152:155]
    v_mfma_f32_16x16x32_bf16 v[132:135], v[228:231], v[112:115], v[132:135]
    v_mfma_f32_16x16x32_bf16 v[140:143], v[228:231], v[116:119], v[140:143]
    v_mfma_f32_16x16x32_bf16 v[148:151], v[228:231], v[120:123], v[148:151]
    v_mfma_f32_16x16x32_bf16 v[156:159], v[228:231], v[124:127], v[156:159]
    s_mov_b32 s40, 0x8000
    s_add_u32 m0, s33, 33792
    s_nop 0
    buffer_load_dwordx4 v248, s[12:15], s40 offen offset:0 nt lds
    s_add_u32 m0, s33, 34336
    s_nop 0
    buffer_load_dwordx4 v248, s[12:15], s40 offen offset:512 nt lds
    s_add_u32 m0, s33, 34880
    s_nop 0
    buffer_load_dwordx4 v248, s[12:15], s40 offen offset:1024 nt lds
    s_add_u32 m0, s33, 35424
    s_nop 0
    buffer_load_dwordx4 v248, s[12:15], s40 offen offset:1536 nt lds
    s_waitcnt vmcnt(16)
    s_barrier
    v_add_u32 v246, 0xffff3a00, v246
    ds_read_b128 v[216:219], v246 offset:0
    ds_read_b128 v[220:223], v246 offset:64
    s_nop 7
    v_max3_f32 v238, v128, v129, v130
    v_max3_f32 v238, v238, v131, v132
    v_max3_f32 v238, v238, v133, v134
    v_max_f32 v238, v238, v135
    v_max3_f32 v239, v136, v137, v138
    v_max3_f32 v239, v239, v139, v140
    v_max3_f32 v239, v239, v141, v142
    v_max_f32 v239, v239, v143
    v_max3_f32 v240, v144, v145, v146
    v_max3_f32 v240, v240, v147, v148
    v_max3_f32 v240, v240, v149, v150
    v_max_f32 v240, v240, v151
    v_max3_f32 v241, v152, v153, v154
    v_max3_f32 v241, v241, v155, v156
    v_max3_f32 v241, v241, v157, v158
    v_max_f32 v241, v241, v159
    v_mov_b32 v242, v238
    v_mov_b32 v243, v239
    v_mov_b32 v244, v240
    v_mov_b32 v245, v241
    v_permlane16_swap_b32 v238, v242
    v_permlane16_swap_b32 v239, v243
    v_permlane16_swap_b32 v240, v244
    v_permlane16_swap_b32 v241, v245
    v_max_f32 v238, v238, v242
    v_max_f32 v239, v239, v243
    v_max_f32 v240, v240, v244
    v_max_f32 v241, v241, v245
    v_mov_b32 v242, v238
    v_mov_b32 v243, v239
    v_mov_b32 v244, v240
    v_mov_b32 v245, v241
    v_permlane32_swap_b32 v238, v242
    v_permlane32_swap_b32 v239, v243
    v_permlane32_swap_b32 v240, v244
    v_permlane32_swap_b32 v241, v245
    v_max_f32 v238, v238, v242
    v_max_f32 v239, v239, v243
    v_max_f32 v240, v240, v244
    v_max_f32 v241, v241, v245
    v_sub_f32 v200, 0, v238
    v_sub_f32 v201, 0, v238
    v_sub_f32 v202, 0, v238
    v_sub_f32 v203, 0, v238
    v_sub_f32 v128, v128, v238
    v_sub_f32 v129, v129, v238
    v_sub_f32 v130, v130, v238
    v_sub_f32 v131, v131, v238
    v_sub_f32 v132, v132, v238
    v_sub_f32 v133, v133, v238
    v_sub_f32 v134, v134, v238
    v_sub_f32 v135, v135, v238
    v_mov_b32 v232, 0
    v_sub_f32 v204, 0, v239
    v_sub_f32 v205, 0, v239
    v_sub_f32 v206, 0, v239
    v_sub_f32 v207, 0, v239
    v_sub_f32 v136, v136, v239
    v_sub_f32 v137, v137, v239
    v_sub_f32 v138, v138, v239
    v_sub_f32 v139, v139, v239
    v_sub_f32 v140, v140, v239
    v_sub_f32 v141, v141, v239
    v_sub_f32 v142, v142, v239
    v_sub_f32 v143, v143, v239
    v_mov_b32 v233, 0
    v_sub_f32 v208, 0, v240
    v_sub_f32 v209, 0, v240
    v_sub_f32 v210, 0, v240
    v_sub_f32 v211, 0, v240
    v_sub_f32 v144, v144, v240
    v_sub_f32 v145, v145, v240
    v_sub_f32 v146, v146, v240
    v_sub_f32 v147, v147, v240
    v_sub_f32 v148, v148, v240
    v_sub_f32 v149, v149, v240
    v_sub_f32 v150, v150, v240
    v_sub_f32 v151, v151, v240
    v_mov_b32 v234, 0
    v_sub_f32 v212, 0, v241
    v_sub_f32 v213, 0, v241
    v_sub_f32 v214, 0, v241
    v_sub_f32 v215, 0, v241
    v_sub_f32 v152, v152, v241
    v_sub_f32 v153, v153, v241
    v_sub_f32 v154, v154, v241
    v_sub_f32 v155, v155, v241
    v_sub_f32 v156, v156, v241
    v_sub_f32 v157, v157, v241
    v_sub_f32 v158, v158, v241
    v_sub_f32 v159, v159, v241
    v_mov_b32 v235, 0
    v_exp_f32 v238, v128
    v_exp_f32 v239, v129
    s_nop 0
    v_add_f32 v236, v238, v239
    v_cvt_pk_bf16_f32 v176, v238, v239
    v_exp_f32 v240, v130
    v_exp_f32 v241, v131
    s_nop 0
    v_add_f32 v236, v236, v240
    v_add_f32 v236, v236, v241
    v_cvt_pk_bf16_f32 v177, v240, v241
    v_exp_f32 v242, v136
    v_exp_f32 v243, v137
    s_nop 0
    v_add_f32 v237, v242, v243
    v_cvt_pk_bf16_f32 v180, v242, v243
    v_exp_f32 v244, v138
    v_exp_f32 v245, v139
    s_nop 0
    v_add_f32 v237, v237, v244
    v_add_f32 v237, v237, v245
    v_cvt_pk_bf16_f32 v181, v244, v245
    v_exp_f32 v238, v132
    v_exp_f32 v239, v133
    s_nop 0
    v_add_f32 v236, v236, v238
    v_add_f32 v236, v236, v239
    v_cvt_pk_bf16_f32 v178, v238, v239
    v_exp_f32 v240, v134
    v_exp_f32 v241, v135
    s_nop 0
    v_add_f32 v236, v236, v240
    v_add_f32 v236, v236, v241
    v_cvt_pk_bf16_f32 v179, v240, v241
    v_exp_f32 v242, v140
    v_exp_f32 v243, v141
    s_nop 0
    v_add_f32 v237, v237, v242
    v_add_f32 v237, v237, v243
    v_cvt_pk_bf16_f32 v182, v242, v243
    v_exp_f32 v244, v142
    v_exp_f32 v245, v143
    s_nop 0
    v_add_f32 v237, v237, v244
    v_add_f32 v237, v237, v245
    v_cvt_pk_bf16_f32 v183, v244, v245
    s_waitcnt lgkmcnt(0)
    s_nop 1
    v_mfma_f32_16x16x32_bf16 v[128:131], v[216:219], v[0:3], v[200:203]
    ds_read_b128 v[224:227], v246 offset:128
    v_add_f32 v232, v232, v236
    v_mfma_f32_16x16x32_bf16 v[128:131], v[220:223], v[16:19], v[128:131]
    ds_read_b128 v[228:231], v246 offset:192
    v_add_f32 v233, v233, v237
    v_mfma_f32_16x16x32_bf16 v[136:139], v[216:219], v[4:7], v[204:207]
    v_exp_f32 v238, v144
    v_mfma_f32_16x16x32_bf16 v[136:139], v[220:223], v[20:23], v[136:139]
    v_exp_f32 v239, v145
    v_mfma_f32_16x16x32_bf16 v[160:163], v[216:219], v[8:11], v[208:211]
    v_add_f32 v236, v238, v239
    v_cvt_pk_bf16_f32 v192, v238, v239
    v_mfma_f32_16x16x32_bf16 v[160:163], v[220:223], v[24:27], v[160:163]
    v_mfma_f32_16x16x32_bf16 v[168:171], v[216:219], v[12:15], v[212:215]
    v_mfma_f32_16x16x32_bf16 v[168:171], v[220:223], v[28:31], v[168:171]
    s_waitcnt lgkmcnt(0)
    v_mfma_f32_16x16x32_bf16 v[128:131], v[224:227], v[32:35], v[128:131]
    ds_read_b128 v[216:219], v246 offset:256
    v_mfma_f32_16x16x32_bf16 v[128:131], v[228:231], v[48:51], v[128:131]
    s_add_u32 m0, s33, 50688
    ds_read_b128 v[220:223], v246 offset:320
    v_mfma_f32_16x16x32_bf16 v[136:139], v[224:227], v[36:39], v[136:139]
    buffer_load_dwordx4 v248, s[8:11], s34 offen offset:0 nt lds
    v_mfma_f32_16x16x32_bf16 v[136:139], v[228:231], v[52:55], v[136:139]
    v_exp_f32 v240, v146
    v_mfma_f32_16x16x32_bf16 v[160:163], v[224:227], v[40:43], v[160:163]
    v_exp_f32 v241, v147
    v_mfma_f32_16x16x32_bf16 v[160:163], v[228:231], v[56:59], v[160:163]
    v_add_f32 v236, v236, v240
    v_add_f32 v236, v236, v241
    v_mfma_f32_16x16x32_bf16 v[168:171], v[224:227], v[44:47], v[168:171]
    v_cvt_pk_bf16_f32 v193, v240, v241
    v_mfma_f32_16x16x32_bf16 v[168:171], v[228:231], v[60:63], v[168:171]
    s_waitcnt lgkmcnt(0)
    v_exp_f32 v242, v152
    v_mfma_f32_16x16x32_bf16 v[128:131], v[216:219], v[64:67], v[128:131]
    ds_read_b128 v[224:227], v246 offset:384
    v_mfma_f32_16x16x32_bf16 v[128:131], v[220:223], v[80:83], v[128:131]
    ds_read_b128 v[228:231], v246 offset:448
    v_mfma_f32_16x16x32_bf16 v[136:139], v[216:219], v[68:71], v[136:139]
    v_exp_f32 v243, v153
    v_mfma_f32_16x16x32_bf16 v[136:139], v[220:223], v[84:87], v[136:139]
    v_add_f32 v237, v242, v243
    v_cvt_pk_bf16_f32 v196, v242, v243
    v_mfma_f32_16x16x32_bf16 v[160:163], v[216:219], v[72:75], v[160:163]
    s_add_u32 m0, s33, 51232
    v_mfma_f32_16x16x32_bf16 v[160:163], v[220:223], v[88:91], v[160:163]
    buffer_load_dwordx4 v248, s[8:11], s34 offen offset:512 nt lds
    v_mfma_f32_16x16x32_bf16 v[168:171], v[216:219], v[76:79], v[168:171]
    v_exp_f32 v244, v154
    v_mfma_f32_16x16x32_bf16 v[168:171], v[220:223], v[92:95], v[168:171]
    s_waitcnt lgkmcnt(0)
    v_exp_f32 v245, v155
    v_mfma_f32_16x16x32_bf16 v[128:131], v[224:227], v[96:99], v[128:131]
    ds_read_b128 v[216:219], v246 offset:8448
    v_add_f32 v237, v237, v244
    v_mfma_f32_16x16x32_bf16 v[128:131], v[228:231], v[112:115], v[128:131]
    ds_read_b128 v[220:223], v246 offset:8512
    v_add_f32 v237, v237, v245
    v_mfma_f32_16x16x32_bf16 v[136:139], v[224:227], v[100:103], v[136:139]
    v_cvt_pk_bf16_f32 v197, v244, v245
    v_mfma_f32_16x16x32_bf16 v[136:139], v[228:231], v[116:119], v[136:139]
    v_mfma_f32_16x16x32_bf16 v[160:163], v[224:227], v[104:107], v[160:163]
    v_exp_f32 v238, v148
    v_mfma_f32_16x16x32_bf16 v[160:163], v[228:231], v[120:123], v[160:163]
    v_exp_f32 v239, v149
    v_mfma_f32_16x16x32_bf16 v[168:171], v[224:227], v[108:111], v[168:171]
    v_add_f32 v236, v236, v238
    v_add_f32 v236, v236, v239
    v_mfma_f32_16x16x32_bf16 v[168:171], v[228:231], v[124:127], v[168:171]
    s_waitcnt lgkmcnt(0)
    v_cvt_pk_bf16_f32 v194, v238, v239
    v_mfma_f32_16x16x32_bf16 v[132:135], v[216:219], v[0:3], v[200:203]
    ds_read_b128 v[224:227], v246 offset:8576
    v_mfma_f32_16x16x32_bf16 v[132:135], v[220:223], v[16:19], v[132:135]
    s_add_u32 m0, s33, 51776
    ds_read_b128 v[228:231], v246 offset:8640
    v_mfma_f32_16x16x32_bf16 v[140:143], v[216:219], v[4:7], v[204:207]
    buffer_load_dwordx4 v248, s[8:11], s34 offen offset:1024 nt lds
    v_mfma_f32_16x16x32_bf16 v[140:143], v[220:223], v[20:23], v[140:143]
    v_exp_f32 v240, v150
    v_mfma_f32_16x16x32_bf16 v[164:167], v[216:219], v[8:11], v[208:211]
    v_exp_f32 v241, v151
    v_mfma_f32_16x16x32_bf16 v[164:167], v[220:223], v[24:27], v[164:167]
    v_add_f32 v236, v236, v240
    v_add_f32 v236, v236, v241
    v_mfma_f32_16x16x32_bf16 v[172:175], v[216:219], v[12:15], v[212:215]
    v_cvt_pk_bf16_f32 v195, v240, v241
    v_mfma_f32_16x16x32_bf16 v[172:175], v[220:223], v[28:31], v[172:175]
    s_waitcnt lgkmcnt(0)
    v_mfma_f32_16x16x32_bf16 v[132:135], v[224:227], v[32:35], v[132:135]
    ds_read_b128 v[216:219], v246 offset:8704
    v_mfma_f32_16x16x32_bf16 v[132:135], v[228:231], v[48:51], v[132:135]
    ds_read_b128 v[220:223], v246 offset:8768
    v_mfma_f32_16x16x32_bf16 v[140:143], v[224:227], v[36:39], v[140:143]
    v_exp_f32 v242, v156
    v_mfma_f32_16x16x32_bf16 v[140:143], v[228:231], v[52:55], v[140:143]
    v_exp_f32 v243, v157
    v_mfma_f32_16x16x32_bf16 v[164:167], v[224:227], v[40:43], v[164:167]
    s_add_u32 m0, s33, 52320
    v_add_f32 v237, v237, v242
    v_add_f32 v237, v237, v243
    v_mfma_f32_16x16x32_bf16 v[164:167], v[228:231], v[56:59], v[164:167]
    buffer_load_dwordx4 v248, s[8:11], s34 offen offset:1536 nt lds
    v_mfma_f32_16x16x32_bf16 v[172:175], v[224:227], v[44:47], v[172:175]
    s_add_u32 s34, s34, 0x4000
    v_cvt_pk_bf16_f32 v198, v242, v243
    v_mfma_f32_16x16x32_bf16 v[172:175], v[228:231], v[60:63], v[172:175]
    s_waitcnt lgkmcnt(0)
    v_exp_f32 v244, v158
    v_mfma_f32_16x16x32_bf16 v[132:135], v[216:219], v[64:67], v[132:135]
    ds_read_b128 v[224:227], v246 offset:8832
    v_mfma_f32_16x16x32_bf16 v[132:135], v[220:223], v[80:83], v[132:135]
    ds_read_b128 v[228:231], v246 offset:8896
    v_mfma_f32_16x16x32_bf16 v[140:143], v[216:219], v[68:71], v[140:143]
    v_exp_f32 v245, v159
    v_mfma_f32_16x16x32_bf16 v[140:143], v[220:223], v[84:87], v[140:143]
    v_add_f32 v237, v237, v244
    v_add_f32 v237, v237, v245
    v_mfma_f32_16x16x32_bf16 v[164:167], v[216:219], v[72:75], v[164:167]
    v_cvt_pk_bf16_f32 v199, v244, v245
    v_mfma_f32_16x16x32_bf16 v[164:167], v[220:223], v[88:91], v[164:167]
    v_mfma_f32_16x16x32_bf16 v[172:175], v[216:219], v[76:79], v[172:175]
    v_mfma_f32_16x16x32_bf16 v[172:175], v[220:223], v[92:95], v[172:175]
    s_waitcnt lgkmcnt(0)
    v_mfma_f32_16x16x32_bf16 v[132:135], v[224:227], v[96:99], v[132:135]
    ds_read_b64_tr_b16 v[216:217], v247 offset:0
    v_mfma_f32_16x16x32_bf16 v[132:135], v[228:231], v[112:115], v[132:135]
    ds_read_b64_tr_b16 v[218:219], v247 offset:8448
    v_mfma_f32_16x16x32_bf16 v[140:143], v[224:227], v[100:103], v[140:143]
    ds_read_b64_tr_b16 v[220:221], v247 offset:32
    v_max_f32 v249, v236, v237
    v_mfma_f32_16x16x32_bf16 v[140:143], v[228:231], v[116:119], v[140:143]
    ds_read_b64_tr_b16 v[222:223], v247 offset:8480
    v_cmp_lt_f32 vcc, s37, v249
    v_mfma_f32_16x16x32_bf16 v[164:167], v[224:227], v[104:107], v[164:167]
    v_mfma_f32_16x16x32_bf16 v[164:167], v[228:231], v[120:123], v[164:167]
    v_mfma_f32_16x16x32_bf16 v[172:175], v[224:227], v[108:111], v[172:175]
    v_mfma_f32_16x16x32_bf16 v[172:175], v[228:231], v[124:127], v[172:175]
    s_waitcnt lgkmcnt(2)
    s_cbranch_vccnz S_R1_P0
R1_P0:
    s_waitcnt vmcnt(12)
    s_barrier
    v_mfma_f32_16x16x32_bf16 a[0:3], v[216:219], v[176:179], 0
    ds_read_b64_tr_b16 v[224:225], v247 offset:64
    v_add_f32 v234, v234, v236
    v_mfma_f32_16x16x32_bf16 a[4:7], v[216:219], v[180:183], 0
    ds_read_b64_tr_b16 v[226:227], v247 offset:8512
    v_add_f32 v235, v235, v237
    v_mfma_f32_16x16x32_bf16 a[8:11], v[216:219], v[192:195], 0
    ds_read_b64_tr_b16 v[228:229], v247 offset:96
    v_mfma_f32_16x16x32_bf16 a[12:15], v[216:219], v[196:199], 0
    s_waitcnt lgkmcnt(3)
    ds_read_b64_tr_b16 v[230:231], v247 offset:8544
    v_mfma_f32_16x16x32_bf16 a[16:19], v[220:223], v[176:179], 0
    ds_read_b64_tr_b16 v[216:217], v247 offset:128
    v_add_u32 v246, 0x8400, v246
    v_mfma_f32_16x16x32_bf16 a[20:23], v[220:223], v[180:183], 0
    s_add_u32 m0, s33, 67584
    ds_read_b64_tr_b16 v[218:219], v247 offset:8576
    v_mfma_f32_16x16x32_bf16 a[24:27], v[220:223], v[192:195], 0
    buffer_load_dwordx4 v248, s[12:15], s35 offen offset:0 nt lds
    v_mfma_f32_16x16x32_bf16 a[28:31], v[220:223], v[196:199], 0
    s_waitcnt lgkmcnt(4)
    v_exp_f32 v238, v128
    v_mfma_f32_16x16x32_bf16 a[32:35], v[224:227], v[176:179], 0
    ds_read_b64_tr_b16 v[220:221], v247 offset:160
    v_mfma_f32_16x16x32_bf16 a[36:39], v[224:227], v[180:183], 0
    ds_read_b64_tr_b16 v[222:223], v247 offset:8608
    v_mfma_f32_16x16x32_bf16 a[40:43], v[224:227], v[192:195], 0
    v_exp_f32 v239, v129
    v_mfma_f32_16x16x32_bf16 a[44:47], v[224:227], v[196:199], 0
    s_waitcnt lgkmcnt(4)
    v_add_f32 v236, v238, v239
    v_cvt_pk_bf16_f32 v184, v238, v239
    v_mfma_f32_16x16x32_bf16 a[48:51], v[228:231], v[176:179], 0
    ds_read_b64_tr_b16 v[224:225], v247 offset:192
    v_mfma_f32_16x16x32_bf16 a[52:55], v[228:231], v[180:183], 0
    ds_read_b64_tr_b16 v[226:227], v247 offset:8640
    v_mfma_f32_16x16x32_bf16 a[56:59], v[228:231], v[192:195], 0
    v_exp_f32 v240, v130
    v_mfma_f32_16x16x32_bf16 a[60:63], v[228:231], v[196:199], 0
    s_waitcnt lgkmcnt(4)
    v_exp_f32 v241, v131
    v_mfma_f32_16x16x32_bf16 a[64:67], v[216:219], v[176:179], 0
    ds_read_b64_tr_b16 v[228:229], v247 offset:224
    v_add_f32 v236, v236, v240
    v_mfma_f32_16x16x32_bf16 a[68:71], v[216:219], v[180:183], 0
    s_add_u32 m0, s33, 68128
    ds_read_b64_tr_b16 v[230:231], v247 offset:8672
    v_add_f32 v236, v236, v241
    v_mfma_f32_16x16x32_bf16 a[72:75], v[216:219], v[192:195], 0
    buffer_load_dwordx4 v248, s[12:15], s35 offen offset:512 nt lds
    v_mfma_f32_16x16x32_bf16 a[76:79], v[216:219], v[196:199], 0
    s_waitcnt lgkmcnt(4)
    v_cvt_pk_bf16_f32 v185, v240, v241
    v_mfma_f32_16x16x32_bf16 a[80:83], v[220:223], v[176:179], 0
    ds_read_b64_tr_b16 v[216:217], v247 offset:256
    v_mfma_f32_16x16x32_bf16 a[84:87], v[220:223], v[180:183], 0
    ds_read_b64_tr_b16 v[218:219], v247 offset:8704
    v_mfma_f32_16x16x32_bf16 a[88:91], v[220:223], v[192:195], 0
    v_exp_f32 v242, v136
    v_mfma_f32_16x16x32_bf16 a[92:95], v[220:223], v[196:199], 0
    s_waitcnt lgkmcnt(4)
    v_exp_f32 v243, v137
    v_mfma_f32_16x16x32_bf16 a[96:99], v[224:227], v[176:179], 0
    ds_read_b64_tr_b16 v[220:221], v247 offset:288
    v_add_f32 v237, v242, v243
    v_mfma_f32_16x16x32_bf16 a[100:103], v[224:227], v[180:183], 0
    ds_read_b64_tr_b16 v[222:223], v247 offset:8736
    v_cvt_pk_bf16_f32 v188, v242, v243
    v_mfma_f32_16x16x32_bf16 a[104:107], v[224:227], v[192:195], 0
    v_exp_f32 v244, v138
    v_mfma_f32_16x16x32_bf16 a[108:111], v[224:227], v[196:199], 0
    s_waitcnt lgkmcnt(4)
    v_exp_f32 v245, v139
    v_mfma_f32_16x16x32_bf16 a[112:115], v[228:231], v[176:179], 0
    ds_read_b64_tr_b16 v[224:225], v247 offset:320
    v_add_f32 v237, v237, v244
    v_mfma_f32_16x16x32_bf16 a[116:119], v[228:231], v[180:183], 0
    s_add_u32 m0, s33, 68672
    ds_read_b64_tr_b16 v[226:227], v247 offset:8768
    v_add_f32 v237, v237, v245
    v_mfma_f32_16x16x32_bf16 a[120:123], v[228:231], v[192:195], 0
    buffer_load_dwordx4 v248, s[12:15], s35 offen offset:1024 nt lds
    v_mfma_f32_16x16x32_bf16 a[124:127], v[228:231], v[196:199], 0
    s_waitcnt lgkmcnt(4)
    v_cvt_pk_bf16_f32 v189, v244, v245
    v_mfma_f32_16x16x32_bf16 a[128:131], v[216:219], v[176:179], 0
    ds_read_b64_tr_b16 v[228:229], v247 offset:352
    v_mfma_f32_16x16x32_bf16 a[132:135], v[216:219], v[180:183], 0
    ds_read_b64_tr_b16 v[230:231], v247 offset:8800
    v_mfma_f32_16x16x32_bf16 a[136:139], v[216:219], v[192:195], 0
    v_exp_f32 v238, v132
    v_mfma_f32_16x16x32_bf16 a[140:143], v[216:219], v[196:199], 0
    s_waitcnt lgkmcnt(4)
    v_exp_f32 v239, v133
    v_mfma_f32_16x16x32_bf16 a[144:147], v[220:223], v[176:179], 0
    ds_read_b64_tr_b16 v[216:217], v247 offset:384
    v_add_f32 v236, v236, v238
    v_mfma_f32_16x16x32_bf16 a[148:151], v[220:223], v[180:183], 0
    ds_read_b64_tr_b16 v[218:219], v247 offset:8832
    v_add_f32 v236, v236, v239
    v_mfma_f32_16x16x32_bf16 a[152:155], v[220:223], v[192:195], 0
    v_cvt_pk_bf16_f32 v186, v238, v239
    v_mfma_f32_16x16x32_bf16 a[156:159], v[220:223], v[196:199], 0
    s_waitcnt lgkmcnt(4)
    v_exp_f32 v240, v134
    v_mfma_f32_16x16x32_bf16 a[160:163], v[224:227], v[176:179], 0
    ds_read_b64_tr_b16 v[220:221], v247 offset:416
    v_mfma_f32_16x16x32_bf16 a[164:167], v[224:227], v[180:183], 0
    s_add_u32 m0, s33, 69216
    ds_read_b64_tr_b16 v[222:223], v247 offset:8864
    v_mfma_f32_16x16x32_bf16 a[168:171], v[224:227], v[192:195], 0
    buffer_load_dwordx4 v248, s[12:15], s35 offen offset:1536 nt lds
    v_mfma_f32_16x16x32_bf16 a[172:175], v[224:227], v[196:199], 0
    s_waitcnt lgkmcnt(4)
    s_add_u32 s35, s35, 0x4000
    v_mfma_f32_16x16x32_bf16 a[176:179], v[228:231], v[176:179], 0
    ds_read_b64_tr_b16 v[224:225], v247 offset:448
    v_mfma_f32_16x16x32_bf16 a[180:183], v[228:231], v[180:183], 0
    ds_read_b64_tr_b16 v[226:227], v247 offset:8896
    v_mfma_f32_16x16x32_bf16 a[184:187], v[228:231], v[192:195], 0
    v_exp_f32 v241, v135
    v_mfma_f32_16x16x32_bf16 a[188:191], v[228:231], v[196:199], 0
    s_waitcnt lgkmcnt(4)
    v_add_f32 v236, v236, v240
    v_add_f32 v236, v236, v241
    v_mfma_f32_16x16x32_bf16 a[192:195], v[216:219], v[176:179], 0
    ds_read_b64_tr_b16 v[228:229], v247 offset:480
    v_cvt_pk_bf16_f32 v187, v240, v241
    v_mfma_f32_16x16x32_bf16 a[196:199], v[216:219], v[180:183], 0
    ds_read_b64_tr_b16 v[230:231], v247 offset:8928
    v_mfma_f32_16x16x32_bf16 a[200:203], v[216:219], v[192:195], 0
    v_exp_f32 v242, v140
    v_mfma_f32_16x16x32_bf16 a[204:207], v[216:219], v[196:199], 0
    s_waitcnt lgkmcnt(4)
    v_exp_f32 v243, v141
    v_mfma_f32_16x16x32_bf16 a[208:211], v[220:223], v[176:179], 0
    v_add_u32 v247, 0xfffe7400, v247
    v_add_f32 v237, v237, v242
    v_mfma_f32_16x16x32_bf16 a[212:215], v[220:223], v[180:183], 0
    v_add_f32 v237, v237, v243
    v_cvt_pk_bf16_f32 v190, v242, v243
    v_mfma_f32_16x16x32_bf16 a[216:219], v[220:223], v[192:195], 0
    v_exp_f32 v244, v142
    v_mfma_f32_16x16x32_bf16 a[220:223], v[220:223], v[196:199], 0
    s_waitcnt lgkmcnt(2)
    v_exp_f32 v245, v143
    v_mfma_f32_16x16x32_bf16 a[224:227], v[224:227], v[176:179], 0
    ds_read_b128 v[216:219], v246 offset:0
    v_add_f32 v237, v237, v244
    v_mfma_f32_16x16x32_bf16 a[228:231], v[224:227], v[180:183], 0
    ds_read_b128 v[220:223], v246 offset:64
    v_add_f32 v237, v237, v245
    v_mfma_f32_16x16x32_bf16 a[232:235], v[224:227], v[192:195], 0
    v_cvt_pk_bf16_f32 v191, v244, v245
    v_mfma_f32_16x16x32_bf16 a[236:239], v[224:227], v[196:199], 0
    s_waitcnt lgkmcnt(2)
    v_max_f32 v249, v236, v237
    v_mfma_f32_16x16x32_bf16 a[240:243], v[228:231], v[176:179], 0
    v_cmp_lt_f32 vcc, s37, v249
    v_mfma_f32_16x16x32_bf16 a[244:247], v[228:231], v[180:183], 0
    v_mfma_f32_16x16x32_bf16 a[248:251], v[228:231], v[192:195], 0
    v_mfma_f32_16x16x32_bf16 a[252:255], v[228:231], v[196:199], 0
    s_waitcnt lgkmcnt(0)
    s_cbranch_vccnz S_R2_P0
R2_P0:
    s_mov_b32 s36, 7
L_loop:
    v_mfma_f32_16x16x32_bf16 v[128:131], v[216:219], v[0:3], v[200:203]
    ds_read_b128 v[224:227], v246 offset:128
    v_add_f32 v232, v232, v236
    v_mfma_f32_16x16x32_bf16 v[128:131], v[220:223], v[16:19], v[128:131]
    ds_read_b128 v[228:231], v246 offset:192
    v_add_f32 v233, v233, v237
    v_mfma_f32_16x16x32_bf16 v[136:139], v[216:219], v[4:7], v[204:207]
    v_exp_f32 v238, v160
    v_mfma_f32_16x16x32_bf16 v[136:139], v[220:223], v[20:23], v[136:139]
    v_exp_f32 v239, v161
    v_mfma_f32_16x16x32_bf16 v[144:147], v[216:219], v[8:11], v[208:211]
    v_add_f32 v236, v238, v239
    v_cvt_pk_bf16_f32 v192, v238, v239
    v_mfma_f32_16x16x32_bf16 v[144:147], v[220:223], v[24:27], v[144:147]
    v_mfma_f32_16x16x32_bf16 v[152:155], v[216:219], v[12:15], v[212:215]
    v_mfma_f32_16x16x32_bf16 v[152:155], v[220:223], v[28:31], v[152:155]
    s_waitcnt lgkmcnt(0)
    v_mfma_f32_16x16x32_bf16 v[128:131], v[224:227], v[32:35], v[128:131]
    ds_read_b128 v[216:219], v246 offset:256
    v_mfma_f32_16x16x32_bf16 v[128:131], v[228:231], v[48:51], v[128:131]
    s_add_u32 m0, s33, 84480
    ds_read_b128 v[220:223], v246 offset:320
    v_mfma_f32_16x16x32_bf16 v[136:139], v[224:227], v[36:39], v[136:139]
    buffer_load_dwordx4 v248, s[8:11], s34 offen offset:0 nt lds
    v_mfma_f32_16x16x32_bf16 v[136:139], v[228:231], v[52:55], v[136:139]
    v_exp_f32 v240, v162
    v_mfma_f32_16x16x32_bf16 v[144:147], v[224:227], v[40:43], v[144:147]
    v_exp_f32 v241, v163
    v_mfma_f32_16x16x32_bf16 v[144:147], v[228:231], v[56:59], v[144:147]
    v_add_f32 v236, v236, v240
    v_add_f32 v236, v236, v241
    v_mfma_f32_16x16x32_bf16 v[152:155], v[224:227], v[44:47], v[152:155]
    v_cvt_pk_bf16_f32 v193, v240, v241
    v_mfma_f32_16x16x32_bf16 v[152:155], v[228:231], v[60:63], v[152:155]
    s_waitcnt lgkmcnt(0)
    v_exp_f32 v242, v168
    v_mfma_f32_16x16x32_bf16 v[128:131], v[216:219], v[64:67], v[128:131]
    ds_read_b128 v[224:227], v246 offset:384
    v_mfma_f32_16x16x32_bf16 v[128:131], v[220:223], v[80:83], v[128:131]
    ds_read_b128 v[228:231], v246 offset:448
    v_mfma_f32_16x16x32_bf16 v[136:139], v[216:219], v[68:71], v[136:139]
    v_exp_f32 v243, v169
    v_mfma_f32_16x16x32_bf16 v[136:139], v[220:223], v[84:87], v[136:139]
    v_add_f32 v237, v242, v243
    v_cvt_pk_bf16_f32 v196, v242, v243
    v_mfma_f32_16x16x32_bf16 v[144:147], v[216:219], v[72:75], v[144:147]
    s_add_u32 m0, s33, 85024
    v_mfma_f32_16x16x32_bf16 v[144:147], v[220:223], v[88:91], v[144:147]
    buffer_load_dwordx4 v248, s[8:11], s34 offen offset:512 nt lds
    v_mfma_f32_16x16x32_bf16 v[152:155], v[216:219], v[76:79], v[152:155]
    v_exp_f32 v244, v170
    v_mfma_f32_16x16x32_bf16 v[152:155], v[220:223], v[92:95], v[152:155]
    s_waitcnt lgkmcnt(0)
    v_exp_f32 v245, v171
    v_mfma_f32_16x16x32_bf16 v[128:131], v[224:227], v[96:99], v[128:131]
    ds_read_b128 v[216:219], v246 offset:8448
    v_add_f32 v237, v237, v244
    v_mfma_f32_16x16x32_bf16 v[128:131], v[228:231], v[112:115], v[128:131]
    ds_read_b128 v[220:223], v246 offset:8512
    v_add_f32 v237, v237, v245
    v_mfma_f32_16x16x32_bf16 v[136:139], v[224:227], v[100:103], v[136:139]
    v_cvt_pk_bf16_f32 v197, v244, v245
    v_mfma_f32_16x16x32_bf16 v[136:139], v[228:231], v[116:119], v[136:139]
    v_mfma_f32_16x16x32_bf16 v[144:147], v[224:227], v[104:107], v[144:147]
    v_exp_f32 v238, v164
    v_mfma_f32_16x16x32_bf16 v[144:147], v[228:231], v[120:123], v[144:147]
    v_exp_f32 v239, v165
    v_mfma_f32_16x16x32_bf16 v[152:155], v[224:227], v[108:111], v[152:155]
    v_add_f32 v236, v236, v238
    v_add_f32 v236, v236, v239
    v_mfma_f32_16x16x32_bf16 v[152:155], v[228:231], v[124:127], v[152:155]
    s_waitcnt lgkmcnt(0)
    v_cvt_pk_bf16_f32 v194, v238, v239
    v_mfma_f32_16x16x32_bf16 v[132:135], v[216:219], v[0:3], v[200:203]
    ds_read_b128 v[224:227], v246 offset:8576
    v_mfma_f32_16x16x32_bf16 v[132:135], v[220:223], v[16:19], v[132:135]
    s_add_u32 m0, s33, 85568
    ds_read_b128 v[228:231], v246 offset:8640
    v_mfma_f32_16x16x32_bf16 v[140:143], v[216:219], v[4:7], v[204:207]
    buffer_load_dwordx4 v248, s[8:11], s34 offen offset:1024 nt lds
    v_mfma_f32_16x16x32_bf16 v[140:143], v[220:223], v[20:23], v[140:143]
    v_exp_f32 v240, v166
    v_mfma_f32_16x16x32_bf16 v[148:151], v[216:219], v[8:11], v[208:211]
    v_exp_f32 v241, v167
    v_mfma_f32_16x16x32_bf16 v[148:151], v[220:223], v[24:27], v[148:151]
    v_add_f32 v236, v236, v240
    v_add_f32 v236, v236, v241
    v_mfma_f32_16x16x32_bf16 v[156:159], v[216:219], v[12:15], v[212:215]
    v_cvt_pk_bf16_f32 v195, v240, v241
    v_mfma_f32_16x16x32_bf16 v[156:159], v[220:223], v[28:31], v[156:159]
    s_waitcnt lgkmcnt(0)
    v_mfma_f32_16x16x32_bf16 v[132:135], v[224:227], v[32:35], v[132:135]
    ds_read_b128 v[216:219], v246 offset:8704
    v_mfma_f32_16x16x32_bf16 v[132:135], v[228:231], v[48:51], v[132:135]
    ds_read_b128 v[220:223], v246 offset:8768
    v_mfma_f32_16x16x32_bf16 v[140:143], v[224:227], v[36:39], v[140:143]
    v_exp_f32 v242, v172
    v_mfma_f32_16x16x32_bf16 v[140:143], v[228:231], v[52:55], v[140:143]
    v_exp_f32 v243, v173
    v_mfma_f32_16x16x32_bf16 v[148:151], v[224:227], v[40:43], v[148:151]
    s_add_u32 m0, s33, 86112
    v_add_f32 v237, v237, v242
    v_add_f32 v237, v237, v243
    v_mfma_f32_16x16x32_bf16 v[148:151], v[228:231], v[56:59], v[148:151]
    buffer_load_dwordx4 v248, s[8:11], s34 offen offset:1536 nt lds
    v_mfma_f32_16x16x32_bf16 v[156:159], v[224:227], v[44:47], v[156:159]
    s_add_u32 s34, s34, 0x4000
    v_cvt_pk_bf16_f32 v198, v242, v243
    v_mfma_f32_16x16x32_bf16 v[156:159], v[228:231], v[60:63], v[156:159]
    s_waitcnt lgkmcnt(0)
    v_exp_f32 v244, v174
    v_mfma_f32_16x16x32_bf16 v[132:135], v[216:219], v[64:67], v[132:135]
    ds_read_b128 v[224:227], v246 offset:8832
    v_mfma_f32_16x16x32_bf16 v[132:135], v[220:223], v[80:83], v[132:135]
    ds_read_b128 v[228:231], v246 offset:8896
    v_mfma_f32_16x16x32_bf16 v[140:143], v[216:219], v[68:71], v[140:143]
    v_exp_f32 v245, v175
    v_mfma_f32_16x16x32_bf16 v[140:143], v[220:223], v[84:87], v[140:143]
    v_add_f32 v237, v237, v244
    v_add_f32 v237, v237, v245
    v_mfma_f32_16x16x32_bf16 v[148:151], v[216:219], v[72:75], v[148:151]
    v_cvt_pk_bf16_f32 v199, v244, v245
    v_mfma_f32_16x16x32_bf16 v[148:151], v[220:223], v[88:91], v[148:151]
    v_mfma_f32_16x16x32_bf16 v[156:159], v[216:219], v[76:79], v[156:159]
    v_mfma_f32_16x16x32_bf16 v[156:159], v[220:223], v[92:95], v[156:159]
    s_waitcnt lgkmcnt(0)
    v_mfma_f32_16x16x32_bf16 v[132:135], v[224:227], v[96:99], v[132:135]
    ds_read_b64_tr_b16 v[216:217], v247 offset:0
    v_mfma_f32_16x16x32_bf16 v[132:135], v[228:231], v[112:115], v[132:135]
    ds_read_b64_tr_b16 v[218:219], v247 offset:8448
    v_mfma_f32_16x16x32_bf16 v[140:143], v[224:227], v[100:103], v[140:143]
    ds_read_b64_tr_b16 v[220:221], v247 offset:32
    v_max_f32 v249, v236, v237
    v_mfma_f32_16x16x32_bf16 v[140:143], v[228:231], v[116:119], v[140:143]
    ds_read_b64_tr_b16 v[222:223], v247 offset:8480
    v_cmp_lt_f32 vcc, s37, v249
    v_mfma_f32_16x16x32_bf16 v[148:151], v[224:227], v[104:107], v[148:151]
    v_mfma_f32_16x16x32_bf16 v[148:151], v[228:231], v[120:123], v[148:151]
    v_mfma_f32_16x16x32_bf16 v[156:159], v[224:227], v[108:111], v[156:159]
    v_mfma_f32_16x16x32_bf16 v[156:159], v[228:231], v[124:127], v[156:159]
    s_waitcnt lgkmcnt(2)
    s_cbranch_vccnz S_R1_L1
R1_L1:
    s_waitcnt vmcnt(3)
    s_barrier
    v_mfma_f32_16x16x32_bf16 a[0:3], v[216:219], v[184:187], a[0:3]
    ds_read_b64_tr_b16 v[224:225], v247 offset:64
    v_add_f32 v234, v234, v236
    v_mfma_f32_16x16x32_bf16 a[4:7], v[216:219], v[188:191], a[4:7]
    ds_read_b64_tr_b16 v[226:227], v247 offset:8512
    v_add_f32 v235, v235, v237
    v_mfma_f32_16x16x32_bf16 a[8:11], v[216:219], v[192:195], a[8:11]
    ds_read_b64_tr_b16 v[228:229], v247 offset:96
    v_mfma_f32_16x16x32_bf16 a[12:15], v[216:219], v[196:199], a[12:15]
    s_waitcnt lgkmcnt(3)
    ds_read_b64_tr_b16 v[230:231], v247 offset:8544
    v_mfma_f32_16x16x32_bf16 a[16:19], v[220:223], v[184:187], a[16:19]
    ds_read_b64_tr_b16 v[216:217], v247 offset:128
    v_add_u32 v246, 0xfffe7400, v246
    v_mfma_f32_16x16x32_bf16 a[20:23], v[220:223], v[188:191], a[20:23]
    s_add_u32 m0, s33, 101376
    ds_read_b64_tr_b16 v[218:219], v247 offset:8576
    v_mfma_f32_16x16x32_bf16 a[24:27], v[220:223], v[192:195], a[24:27]
    buffer_load_dwordx4 v248, s[12:15], s35 offen offset:0 nt lds
    v_mfma_f32_16x16x32_bf16 a[28:31], v[220:223], v[196:199], a[28:31]
    s_waitcnt lgkmcnt(4)
    v_exp_f32 v238, v128
    v_mfma_f32_16x16x32_bf16 a[32:35], v[224:227], v[184:187], a[32:35]
    ds_read_b64_tr_b16 v[220:221], v247 offset:160
    v_mfma_f32_16x16x32_bf16 a[36:39], v[224:227], v[188:191], a[36:39]
    ds_read_b64_tr_b16 v[222:223], v247 offset:8608
    v_mfma_f32_16x16x32_bf16 a[40:43], v[224:227], v[192:195], a[40:43]
    v_exp_f32 v239, v129
    v_mfma_f32_16x16x32_bf16 a[44:47], v[224:227], v[196:199], a[44:47]
    s_waitcnt lgkmcnt(4)
    v_add_f32 v236, v238, v239
    v_cvt_pk_bf16_f32 v176, v238, v239
    v_mfma_f32_16x16x32_bf16 a[48:51], v[228:231], v[184:187], a[48:51]
    ds_read_b64_tr_b16 v[224:225], v247 offset:192
    v_mfma_f32_16x16x32_bf16 a[52:55], v[228:231], v[188:191], a[52:55]
    ds_read_b64_tr_b16 v[226:227], v247 offset:8640
    v_mfma_f32_16x16x32_bf16 a[56:59], v[228:231], v[192:195], a[56:59]
    v_exp_f32 v240, v130
    v_mfma_f32_16x16x32_bf16 a[60:63], v[228:231], v[196:199], a[60:63]
    s_waitcnt lgkmcnt(4)
    v_exp_f32 v241, v131
    v_mfma_f32_16x16x32_bf16 a[64:67], v[216:219], v[184:187], a[64:67]
    ds_read_b64_tr_b16 v[228:229], v247 offset:224
    v_add_f32 v236, v236, v240
    v_mfma_f32_16x16x32_bf16 a[68:71], v[216:219], v[188:191], a[68:71]
    s_add_u32 m0, s33, 101920
    ds_read_b64_tr_b16 v[230:231], v247 offset:8672
    v_add_f32 v236, v236, v241
    v_mfma_f32_16x16x32_bf16 a[72:75], v[216:219], v[192:195], a[72:75]
    buffer_load_dwordx4 v248, s[12:15], s35 offen offset:512 nt lds
    v_mfma_f32_16x16x32_bf16 a[76:79], v[216:219], v[196:199], a[76:79]
    s_waitcnt lgkmcnt(4)
    v_cvt_pk_bf16_f32 v177, v240, v241
    v_mfma_f32_16x16x32_bf16 a[80:83], v[220:223], v[184:187], a[80:83]
    ds_read_b64_tr_b16 v[216:217], v247 offset:256
    v_mfma_f32_16x16x32_bf16 a[84:87], v[220:223], v[188:191], a[84:87]
    ds_read_b64_tr_b16 v[218:219], v247 offset:8704
    v_mfma_f32_16x16x32_bf16 a[88:91], v[220:223], v[192:195], a[88:91]
    v_exp_f32 v242, v136
    v_mfma_f32_16x16x32_bf16 a[92:95], v[220:223], v[196:199], a[92:95]
    s_waitcnt lgkmcnt(4)
    v_exp_f32 v243, v137
    v_mfma_f32_16x16x32_bf16 a[96:99], v[224:227], v[184:187], a[96:99]
    ds_read_b64_tr_b16 v[220:221], v247 offset:288
    v_add_f32 v237, v242, v243
    v_mfma_f32_16x16x32_bf16 a[100:103], v[224:227], v[188:191], a[100:103]
    ds_read_b64_tr_b16 v[222:223], v247 offset:8736
    v_cvt_pk_bf16_f32 v180, v242, v243
    v_mfma_f32_16x16x32_bf16 a[104:107], v[224:227], v[192:195], a[104:107]
    v_exp_f32 v244, v138
    v_mfma_f32_16x16x32_bf16 a[108:111], v[224:227], v[196:199], a[108:111]
    s_waitcnt lgkmcnt(4)
    v_exp_f32 v245, v139
    v_mfma_f32_16x16x32_bf16 a[112:115], v[228:231], v[184:187], a[112:115]
    ds_read_b64_tr_b16 v[224:225], v247 offset:320
    v_add_f32 v237, v237, v244
    v_mfma_f32_16x16x32_bf16 a[116:119], v[228:231], v[188:191], a[116:119]
    s_add_u32 m0, s33, 102464
    ds_read_b64_tr_b16 v[226:227], v247 offset:8768
    v_add_f32 v237, v237, v245
    v_mfma_f32_16x16x32_bf16 a[120:123], v[228:231], v[192:195], a[120:123]
    buffer_load_dwordx4 v248, s[12:15], s35 offen offset:1024 nt lds
    v_mfma_f32_16x16x32_bf16 a[124:127], v[228:231], v[196:199], a[124:127]
    s_waitcnt lgkmcnt(4)
    v_cvt_pk_bf16_f32 v181, v244, v245
    v_mfma_f32_16x16x32_bf16 a[128:131], v[216:219], v[184:187], a[128:131]
    ds_read_b64_tr_b16 v[228:229], v247 offset:352
    v_mfma_f32_16x16x32_bf16 a[132:135], v[216:219], v[188:191], a[132:135]
    ds_read_b64_tr_b16 v[230:231], v247 offset:8800
    v_mfma_f32_16x16x32_bf16 a[136:139], v[216:219], v[192:195], a[136:139]
    v_exp_f32 v238, v132
    v_mfma_f32_16x16x32_bf16 a[140:143], v[216:219], v[196:199], a[140:143]
    s_waitcnt lgkmcnt(4)
    v_exp_f32 v239, v133
    v_mfma_f32_16x16x32_bf16 a[144:147], v[220:223], v[184:187], a[144:147]
    ds_read_b64_tr_b16 v[216:217], v247 offset:384
    v_add_f32 v236, v236, v238
    v_mfma_f32_16x16x32_bf16 a[148:151], v[220:223], v[188:191], a[148:151]
    ds_read_b64_tr_b16 v[218:219], v247 offset:8832
    v_add_f32 v236, v236, v239
    v_mfma_f32_16x16x32_bf16 a[152:155], v[220:223], v[192:195], a[152:155]
    v_cvt_pk_bf16_f32 v178, v238, v239
    v_mfma_f32_16x16x32_bf16 a[156:159], v[220:223], v[196:199], a[156:159]
    s_waitcnt lgkmcnt(4)
    v_exp_f32 v240, v134
    v_mfma_f32_16x16x32_bf16 a[160:163], v[224:227], v[184:187], a[160:163]
    ds_read_b64_tr_b16 v[220:221], v247 offset:416
    v_mfma_f32_16x16x32_bf16 a[164:167], v[224:227], v[188:191], a[164:167]
    s_add_u32 m0, s33, 103008
    ds_read_b64_tr_b16 v[222:223], v247 offset:8864
    v_mfma_f32_16x16x32_bf16 a[168:171], v[224:227], v[192:195], a[168:171]
    buffer_load_dwordx4 v248, s[12:15], s35 offen offset:1536 nt lds
    v_mfma_f32_16x16x32_bf16 a[172:175], v[224:227], v[196:199], a[172:175]
    s_waitcnt lgkmcnt(4)
    s_add_u32 s35, s35, 0x4000
    v_mfma_f32_16x16x32_bf16 a[176:179], v[228:231], v[184:187], a[176:179]
    ds_read_b64_tr_b16 v[224:225], v247 offset:448
    v_mfma_f32_16x16x32_bf16 a[180:183], v[228:231], v[188:191], a[180:183]
    ds_read_b64_tr_b16 v[226:227], v247 offset:8896
    v_mfma_f32_16x16x32_bf16 a[184:187], v[228:231], v[192:195], a[184:187]
    v_exp_f32 v241, v135
    v_mfma_f32_16x16x32_bf16 a[188:191], v[228:231], v[196:199], a[188:191]
    s_waitcnt lgkmcnt(4)
    v_add_f32 v236, v236, v240
    v_add_f32 v236, v236, v241
    v_mfma_f32_16x16x32_bf16 a[192:195], v[216:219], v[184:187], a[192:195]
    ds_read_b64_tr_b16 v[228:229], v247 offset:480
    v_cvt_pk_bf16_f32 v179, v240, v241
    v_mfma_f32_16x16x32_bf16 a[196:199], v[216:219], v[188:191], a[196:199]
    ds_read_b64_tr_b16 v[230:231], v247 offset:8928
    v_mfma_f32_16x16x32_bf16 a[200:203], v[216:219], v[192:195], a[200:203]
    v_exp_f32 v242, v140
    v_mfma_f32_16x16x32_bf16 a[204:207], v[216:219], v[196:199], a[204:207]
    s_waitcnt lgkmcnt(4)
    v_exp_f32 v243, v141
    v_mfma_f32_16x16x32_bf16 a[208:211], v[220:223], v[184:187], a[208:211]
    v_add_u32 v247, 0x8400, v247
    v_add_f32 v237, v237, v242
    v_mfma_f32_16x16x32_bf16 a[212:215], v[220:223], v[188:191], a[212:215]
    v_add_f32 v237, v237, v243
    v_cvt_pk_bf16_f32 v182, v242, v243
    v_mfma_f32_16x16x32_bf16 a[216:219], v[220:223], v[192:195], a[216:219]
    v_exp_f32 v244, v142
    v_mfma_f32_16x16x32_bf16 a[220:223], v[220:223], v[196:199], a[220:223]
    s_waitcnt lgkmcnt(2)
    v_exp_f32 v245, v143
    v_mfma_f32_16x16x32_bf16 a[224:227], v[224:227], v[184:187], a[224:227]
    ds_read_b128 v[216:219], v246 offset:0
    v_add_f32 v237, v237, v244
    v_mfma_f32_16x16x32_bf16 a[228:231], v[224:227], v[188:191], a[228:231]
    ds_read_b128 v[220:223], v246 offset:64
    v_add_f32 v237, v237, v245
    v_mfma_f32_16x16x32_bf16 a[232:235], v[224:227], v[192:195], a[232:235]
    v_cvt_pk_bf16_f32 v183, v244, v245
    v_mfma_f32_16x16x32_bf16 a[236:239], v[224:227], v[196:199], a[236:239]
    s_waitcnt lgkmcnt(2)
    v_max_f32 v249, v236, v237
    v_mfma_f32_16x16x32_bf16 a[240:243], v[228:231], v[184:187], a[240:243]
    v_cmp_lt_f32 vcc, s37, v249
    v_mfma_f32_16x16x32_bf16 a[244:247], v[228:231], v[188:191], a[244:247]
    v_mfma_f32_16x16x32_bf16 a[248:251], v[228:231], v[192:195], a[248:251]
    v_mfma_f32_16x16x32_bf16 a[252:255], v[228:231], v[196:199], a[252:255]
    s_waitcnt lgkmcnt(0)
    s_cbranch_vccnz S_R2_L1
R2_L1:
    v_mfma_f32_16x16x32_bf16 v[128:131], v[216:219], v[0:3], v[200:203]
    ds_read_b128 v[224:227], v246 offset:128
    v_add_f32 v232, v232, v236
    v_mfma_f32_16x16x32_bf16 v[128:131], v[220:223], v[16:19], v[128:131]
    ds_read_b128 v[228:231], v246 offset:192
    v_add_f32 v233, v233, v237
    v_mfma_f32_16x16x32_bf16 v[136:139], v[216:219], v[4:7], v[204:207]
    v_exp_f32 v238, v144
    v_mfma_f32_16x16x32_bf16 v[136:139], v[220:223], v[20:23], v[136:139]
    v_exp_f32 v239, v145
    v_mfma_f32_16x16x32_bf16 v[160:163], v[216:219], v[8:11], v[208:211]
    v_add_f32 v236, v238, v239
    v_cvt_pk_bf16_f32 v192, v238, v239
    v_mfma_f32_16x16x32_bf16 v[160:163], v[220:223], v[24:27], v[160:163]
    v_mfma_f32_16x16x32_bf16 v[168:171], v[216:219], v[12:15], v[212:215]
    v_mfma_f32_16x16x32_bf16 v[168:171], v[220:223], v[28:31], v[168:171]
    s_waitcnt lgkmcnt(0)
    v_mfma_f32_16x16x32_bf16 v[128:131], v[224:227], v[32:35], v[128:131]
    ds_read_b128 v[216:219], v246 offset:256
    v_mfma_f32_16x16x32_bf16 v[128:131], v[228:231], v[48:51], v[128:131]
    s_add_u32 m0, s33, 118272
    ds_read_b128 v[220:223], v246 offset:320
    v_mfma_f32_16x16x32_bf16 v[136:139], v[224:227], v[36:39], v[136:139]
    buffer_load_dwordx4 v248, s[8:11], s34 offen offset:0 nt lds
    v_mfma_f32_16x16x32_bf16 v[136:139], v[228:231], v[52:55], v[136:139]
    v_exp_f32 v240, v146
    v_mfma_f32_16x16x32_bf16 v[160:163], v[224:227], v[40:43], v[160:163]
    v_exp_f32 v241, v147
    v_mfma_f32_16x16x32_bf16 v[160:163], v[228:231], v[56:59], v[160:163]
    v_add_f32 v236, v236, v240
    v_add_f32 v236, v236, v241
    v_mfma_f32_16x16x32_bf16 v[168:171], v[224:227], v[44:47], v[168:171]
    v_cvt_pk_bf16_f32 v193, v240, v241
    v_mfma_f32_16x16x32_bf16 v[168:171], v[228:231], v[60:63], v[168:171]
    s_waitcnt lgkmcnt(0)
    v_exp_f32 v242, v152
    v_mfma_f32_16x16x32_bf16 v[128:131], v[216:219], v[64:67], v[128:131]
    ds_read_b128 v[224:227], v246 offset:384
    v_mfma_f32_16x16x32_bf16 v[128:131], v[220:223], v[80:83], v[128:131]
    ds_read_b128 v[228:231], v246 offset:448
    v_mfma_f32_16x16x32_bf16 v[136:139], v[216:219], v[68:71], v[136:139]
    v_exp_f32 v243, v153
    v_mfma_f32_16x16x32_bf16 v[136:139], v[220:223], v[84:87], v[136:139]
    v_add_f32 v237, v242, v243
    v_cvt_pk_bf16_f32 v196, v242, v243
    v_mfma_f32_16x16x32_bf16 v[160:163], v[216:219], v[72:75], v[160:163]
    s_add_u32 m0, s33, 118816
    v_mfma_f32_16x16x32_bf16 v[160:163], v[220:223], v[88:91], v[160:163]
    buffer_load_dwordx4 v248, s[8:11], s34 offen offset:512 nt lds
    v_mfma_f32_16x16x32_bf16 v[168:171], v[216:219], v[76:79], v[168:171]
    v_exp_f32 v244, v154
    v_mfma_f32_16x16x32_bf16 v[168:171], v[220:223], v[92:95], v[168:171]
    s_waitcnt lgkmcnt(0)
    v_exp_f32 v245, v155
    v_mfma_f32_16x16x32_bf16 v[128:131], v[224:227], v[96:99], v[128:131]
    ds_read_b128 v[216:219], v246 offset:8448
    v_add_f32 v237, v237, v244
    v_mfma_f32_16x16x32_bf16 v[128:131], v[228:231], v[112:115], v[128:131]
    ds_read_b128 v[220:223], v246 offset:8512
    v_add_f32 v237, v237, v245
    v_mfma_f32_16x16x32_bf16 v[136:139], v[224:227], v[100:103], v[136:139]
    v_cvt_pk_bf16_f32 v197, v244, v245
    v_mfma_f32_16x16x32_bf16 v[136:139], v[228:231], v[116:119], v[136:139]
    v_mfma_f32_16x16x32_bf16 v[160:163], v[224:227], v[104:107], v[160:163]
    v_exp_f32 v238, v148
    v_mfma_f32_16x16x32_bf16 v[160:163], v[228:231], v[120:123], v[160:163]
    v_exp_f32 v239, v149
    v_mfma_f32_16x16x32_bf16 v[168:171], v[224:227], v[108:111], v[168:171]
    v_add_f32 v236, v236, v238
    v_add_f32 v236, v236, v239
    v_mfma_f32_16x16x32_bf16 v[168:171], v[228:231], v[124:127], v[168:171]
    s_waitcnt lgkmcnt(0)
    v_cvt_pk_bf16_f32 v194, v238, v239
    v_mfma_f32_16x16x32_bf16 v[132:135], v[216:219], v[0:3], v[200:203]
    ds_read_b128 v[224:227], v246 offset:8576
    v_mfma_f32_16x16x32_bf16 v[132:135], v[220:223], v[16:19], v[132:135]
    s_add_u32 m0, s33, 119360
    ds_read_b128 v[228:231], v246 offset:8640
    v_mfma_f32_16x16x32_bf16 v[140:143], v[216:219], v[4:7], v[204:207]
    buffer_load_dwordx4 v248, s[8:11], s34 offen offset:1024 nt lds
    v_mfma_f32_16x16x32_bf16 v[140:143], v[220:223], v[20:23], v[140:143]
    v_exp_f32 v240, v150
    v_mfma_f32_16x16x32_bf16 v[164:167], v[216:219], v[8:11], v[208:211]
    v_exp_f32 v241, v151
    v_mfma_f32_16x16x32_bf16 v[164:167], v[220:223], v[24:27], v[164:167]
    v_add_f32 v236, v236, v240
    v_add_f32 v236, v236, v241
    v_mfma_f32_16x16x32_bf16 v[172:175], v[216:219], v[12:15], v[212:215]
    v_cvt_pk_bf16_f32 v195, v240, v241
    v_mfma_f32_16x16x32_bf16 v[172:175], v[220:223], v[28:31], v[172:175]
    s_waitcnt lgkmcnt(0)
    v_mfma_f32_16x16x32_bf16 v[132:135], v[224:227], v[32:35], v[132:135]
    ds_read_b128 v[216:219], v246 offset:8704
    v_mfma_f32_16x16x32_bf16 v[132:135], v[228:231], v[48:51], v[132:135]
    ds_read_b128 v[220:223], v246 offset:8768
    v_mfma_f32_16x16x32_bf16 v[140:143], v[224:227], v[36:39], v[140:143]
    v_exp_f32 v242, v156
    v_mfma_f32_16x16x32_bf16 v[140:143], v[228:231], v[52:55], v[140:143]
    v_exp_f32 v243, v157
    v_mfma_f32_16x16x32_bf16 v[164:167], v[224:227], v[40:43], v[164:167]
    s_add_u32 m0, s33, 119904
    v_add_f32 v237, v237, v242
    v_add_f32 v237, v237, v243
    v_mfma_f32_16x16x32_bf16 v[164:167], v[228:231], v[56:59], v[164:167]
    buffer_load_dwordx4 v248, s[8:11], s34 offen offset:1536 nt lds
    v_mfma_f32_16x16x32_bf16 v[172:175], v[224:227], v[44:47], v[172:175]
    s_add_u32 s34, s34, 0x4000
    v_cvt_pk_bf16_f32 v198, v242, v243
    v_mfma_f32_16x16x32_bf16 v[172:175], v[228:231], v[60:63], v[172:175]
    s_waitcnt lgkmcnt(0)
    v_exp_f32 v244, v158
    v_mfma_f32_16x16x32_bf16 v[132:135], v[216:219], v[64:67], v[132:135]
    ds_read_b128 v[224:227], v246 offset:8832
    v_mfma_f32_16x16x32_bf16 v[132:135], v[220:223], v[80:83], v[132:135]
    ds_read_b128 v[228:231], v246 offset:8896
    v_mfma_f32_16x16x32_bf16 v[140:143], v[216:219], v[68:71], v[140:143]
    v_exp_f32 v245, v159
    v_mfma_f32_16x16x32_bf16 v[140:143], v[220:223], v[84:87], v[140:143]
    v_add_f32 v237, v237, v244
    v_add_f32 v237, v237, v245
    v_mfma_f32_16x16x32_bf16 v[164:167], v[216:219], v[72:75], v[164:167]
    v_cvt_pk_bf16_f32 v199, v244, v245
    v_mfma_f32_16x16x32_bf16 v[164:167], v[220:223], v[88:91], v[164:167]
    v_mfma_f32_16x16x32_bf16 v[172:175], v[216:219], v[76:79], v[172:175]
    v_mfma_f32_16x16x32_bf16 v[172:175], v[220:223], v[92:95], v[172:175]
    s_waitcnt lgkmcnt(0)
    v_mfma_f32_16x16x32_bf16 v[132:135], v[224:227], v[96:99], v[132:135]
    ds_read_b64_tr_b16 v[216:217], v247 offset:0
    v_mfma_f32_16x16x32_bf16 v[132:135], v[228:231], v[112:115], v[132:135]
    ds_read_b64_tr_b16 v[218:219], v247 offset:8448
    v_mfma_f32_16x16x32_bf16 v[140:143], v[224:227], v[100:103], v[140:143]
    ds_read_b64_tr_b16 v[220:221], v247 offset:32
    v_max_f32 v249, v236, v237
    v_mfma_f32_16x16x32_bf16 v[140:143], v[228:231], v[116:119], v[140:143]
    ds_read_b64_tr_b16 v[222:223], v247 offset:8480
    v_cmp_lt_f32 vcc, s37, v249
    v_mfma_f32_16x16x32_bf16 v[164:167], v[224:227], v[104:107], v[164:167]
    v_mfma_f32_16x16x32_bf16 v[164:167], v[228:231], v[120:123], v[164:167]
    v_mfma_f32_16x16x32_bf16 v[172:175], v[224:227], v[108:111], v[172:175]
    v_mfma_f32_16x16x32_bf16 v[172:175], v[228:231], v[124:127], v[172:175]
    s_waitcnt lgkmcnt(2)
    s_cbranch_vccnz S_R1_L2
R1_L2:
    s_waitcnt vmcnt(3)
    s_barrier
    v_mfma_f32_16x16x32_bf16 a[0:3], v[216:219], v[176:179], a[0:3]
    ds_read_b64_tr_b16 v[224:225], v247 offset:64
    v_add_f32 v234, v234, v236
    v_mfma_f32_16x16x32_bf16 a[4:7], v[216:219], v[180:183], a[4:7]
    ds_read_b64_tr_b16 v[226:227], v247 offset:8512
    v_add_f32 v235, v235, v237
    v_mfma_f32_16x16x32_bf16 a[8:11], v[216:219], v[192:195], a[8:11]
    ds_read_b64_tr_b16 v[228:229], v247 offset:96
    v_mfma_f32_16x16x32_bf16 a[12:15], v[216:219], v[196:199], a[12:15]
    s_waitcnt lgkmcnt(3)
    ds_read_b64_tr_b16 v[230:231], v247 offset:8544
    v_mfma_f32_16x16x32_bf16 a[16:19], v[220:223], v[176:179], a[16:19]
    ds_read_b64_tr_b16 v[216:217], v247 offset:128
    v_add_u32 v246, 0x8400, v246
    v_mfma_f32_16x16x32_bf16 a[20:23], v[220:223], v[180:183], a[20:23]
    s_add_u32 m0, s33, 0
    ds_read_b64_tr_b16 v[218:219], v247 offset:8576
    v_mfma_f32_16x16x32_bf16 a[24:27], v[220:223], v[192:195], a[24:27]
    buffer_load_dwordx4 v248, s[12:15], s35 offen offset:0 nt lds
    v_mfma_f32_16x16x32_bf16 a[28:31], v[220:223], v[196:199], a[28:31]
    s_waitcnt lgkmcnt(4)
    v_exp_f32 v238, v128
    v_mfma_f32_16x16x32_bf16 a[32:35], v[224:227], v[176:179], a[32:35]
    ds_read_b64_tr_b16 v[220:221], v247 offset:160
    v_mfma_f32_16x16x32_bf16 a[36:39], v[224:227], v[180:183], a[36:39]
    ds_read_b64_tr_b16 v[222:223], v247 offset:8608
    v_mfma_f32_16x16x32_bf16 a[40:43], v[224:227], v[192:195], a[40:43]
    v_exp_f32 v239, v129
    v_mfma_f32_16x16x32_bf16 a[44:47], v[224:227], v[196:199], a[44:47]
    s_waitcnt lgkmcnt(4)
    v_add_f32 v236, v238, v239
    v_cvt_pk_bf16_f32 v184, v238, v239
    v_mfma_f32_16x16x32_bf16 a[48:51], v[228:231], v[176:179], a[48:51]
    ds_read_b64_tr_b16 v[224:225], v247 offset:192
    v_mfma_f32_16x16x32_bf16 a[52:55], v[228:231], v[180:183], a[52:55]
    ds_read_b64_tr_b16 v[226:227], v247 offset:8640
    v_mfma_f32_16x16x32_bf16 a[56:59], v[228:231], v[192:195], a[56:59]
    v_exp_f32 v240, v130
    v_mfma_f32_16x16x32_bf16 a[60:63], v[228:231], v[196:199], a[60:63]
    s_waitcnt lgkmcnt(4)
    v_exp_f32 v241, v131
    v_mfma_f32_16x16x32_bf16 a[64:67], v[216:219], v[176:179], a[64:67]
    ds_read_b64_tr_b16 v[228:229], v247 offset:224
    v_add_f32 v236, v236, v240
    v_mfma_f32_16x16x32_bf16 a[68:71], v[216:219], v[180:183], a[68:71]
    s_add_u32 m0, s33, 544
    ds_read_b64_tr_b16 v[230:231], v247 offset:8672
    v_add_f32 v236, v236, v241
    v_mfma_f32_16x16x32_bf16 a[72:75], v[216:219], v[192:195], a[72:75]
    buffer_load_dwordx4 v248, s[12:15], s35 offen offset:512 nt lds
    v_mfma_f32_16x16x32_bf16 a[76:79], v[216:219], v[196:199], a[76:79]
    s_waitcnt lgkmcnt(4)
    v_cvt_pk_bf16_f32 v185, v240, v241
    v_mfma_f32_16x16x32_bf16 a[80:83], v[220:223], v[176:179], a[80:83]
    ds_read_b64_tr_b16 v[216:217], v247 offset:256
    v_mfma_f32_16x16x32_bf16 a[84:87], v[220:223], v[180:183], a[84:87]
    ds_read_b64_tr_b16 v[218:219], v247 offset:8704
    v_mfma_f32_16x16x32_bf16 a[88:91], v[220:223], v[192:195], a[88:91]
    v_exp_f32 v242, v136
    v_mfma_f32_16x16x32_bf16 a[92:95], v[220:223], v[196:199], a[92:95]
    s_waitcnt lgkmcnt(4)
    v_exp_f32 v243, v137
    v_mfma_f32_16x16x32_bf16 a[96:99], v[224:227], v[176:179], a[96:99]
    ds_read_b64_tr_b16 v[220:221], v247 offset:288
    v_add_f32 v237, v242, v243
    v_mfma_f32_16x16x32_bf16 a[100:103], v[224:227], v[180:183], a[100:103]
    ds_read_b64_tr_b16 v[222:223], v247 offset:8736
    v_cvt_pk_bf16_f32 v188, v242, v243
    v_mfma_f32_16x16x32_bf16 a[104:107], v[224:227], v[192:195], a[104:107]
    v_exp_f32 v244, v138
    v_mfma_f32_16x16x32_bf16 a[108:111], v[224:227], v[196:199], a[108:111]
    s_waitcnt lgkmcnt(4)
    v_exp_f32 v245, v139
    v_mfma_f32_16x16x32_bf16 a[112:115], v[228:231], v[176:179], a[112:115]
    ds_read_b64_tr_b16 v[224:225], v247 offset:320
    v_add_f32 v237, v237, v244
    v_mfma_f32_16x16x32_bf16 a[116:119], v[228:231], v[180:183], a[116:119]
    s_add_u32 m0, s33, 1088
    ds_read_b64_tr_b16 v[226:227], v247 offset:8768
    v_add_f32 v237, v237, v245
    v_mfma_f32_16x16x32_bf16 a[120:123], v[228:231], v[192:195], a[120:123]
    buffer_load_dwordx4 v248, s[12:15], s35 offen offset:1024 nt lds
    v_mfma_f32_16x16x32_bf16 a[124:127], v[228:231], v[196:199], a[124:127]
    s_waitcnt lgkmcnt(4)
    v_cvt_pk_bf16_f32 v189, v244, v245
    v_mfma_f32_16x16x32_bf16 a[128:131], v[216:219], v[176:179], a[128:131]
    ds_read_b64_tr_b16 v[228:229], v247 offset:352
    v_mfma_f32_16x16x32_bf16 a[132:135], v[216:219], v[180:183], a[132:135]
    ds_read_b64_tr_b16 v[230:231], v247 offset:8800
    v_mfma_f32_16x16x32_bf16 a[136:139], v[216:219], v[192:195], a[136:139]
    v_exp_f32 v238, v132
    v_mfma_f32_16x16x32_bf16 a[140:143], v[216:219], v[196:199], a[140:143]
    s_waitcnt lgkmcnt(4)
    v_exp_f32 v239, v133
    v_mfma_f32_16x16x32_bf16 a[144:147], v[220:223], v[176:179], a[144:147]
    ds_read_b64_tr_b16 v[216:217], v247 offset:384
    v_add_f32 v236, v236, v238
    v_mfma_f32_16x16x32_bf16 a[148:151], v[220:223], v[180:183], a[148:151]
    ds_read_b64_tr_b16 v[218:219], v247 offset:8832
    v_add_f32 v236, v236, v239
    v_mfma_f32_16x16x32_bf16 a[152:155], v[220:223], v[192:195], a[152:155]
    v_cvt_pk_bf16_f32 v186, v238, v239
    v_mfma_f32_16x16x32_bf16 a[156:159], v[220:223], v[196:199], a[156:159]
    s_waitcnt lgkmcnt(4)
    v_exp_f32 v240, v134
    v_mfma_f32_16x16x32_bf16 a[160:163], v[224:227], v[176:179], a[160:163]
    ds_read_b64_tr_b16 v[220:221], v247 offset:416
    v_mfma_f32_16x16x32_bf16 a[164:167], v[224:227], v[180:183], a[164:167]
    s_add_u32 m0, s33, 1632
    ds_read_b64_tr_b16 v[222:223], v247 offset:8864
    v_mfma_f32_16x16x32_bf16 a[168:171], v[224:227], v[192:195], a[168:171]
    buffer_load_dwordx4 v248, s[12:15], s35 offen offset:1536 nt lds
    v_mfma_f32_16x16x32_bf16 a[172:175], v[224:227], v[196:199], a[172:175]
    s_waitcnt lgkmcnt(4)
    s_add_u32 s35, s35, 0x4000
    v_mfma_f32_16x16x32_bf16 a[176:179], v[228:231], v[176:179], a[176:179]
    ds_read_b64_tr_b16 v[224:225], v247 offset:448
    v_mfma_f32_16x16x32_bf16 a[180:183], v[228:231], v[180:183], a[180:183]
    ds_read_b64_tr_b16 v[226:227], v247 offset:8896
    v_mfma_f32_16x16x32_bf16 a[184:187], v[228:231], v[192:195], a[184:187]
    v_exp_f32 v241, v135
    v_mfma_f32_16x16x32_bf16 a[188:191], v[228:231], v[196:199], a[188:191]
    s_waitcnt lgkmcnt(4)
    v_add_f32 v236, v236, v240
    v_add_f32 v236, v236, v241
    v_mfma_f32_16x16x32_bf16 a[192:195], v[216:219], v[176:179], a[192:195]
    ds_read_b64_tr_b16 v[228:229], v247 offset:480
    v_cvt_pk_bf16_f32 v187, v240, v241
    v_mfma_f32_16x16x32_bf16 a[196:199], v[216:219], v[180:183], a[196:199]
    ds_read_b64_tr_b16 v[230:231], v247 offset:8928
    v_mfma_f32_16x16x32_bf16 a[200:203], v[216:219], v[192:195], a[200:203]
    v_exp_f32 v242, v140
    v_mfma_f32_16x16x32_bf16 a[204:207], v[216:219], v[196:199], a[204:207]
    s_waitcnt lgkmcnt(4)
    v_exp_f32 v243, v141
    v_mfma_f32_16x16x32_bf16 a[208:211], v[220:223], v[176:179], a[208:211]
    v_add_u32 v247, 0x8400, v247
    v_add_f32 v237, v237, v242
    v_mfma_f32_16x16x32_bf16 a[212:215], v[220:223], v[180:183], a[212:215]
    v_add_f32 v237, v237, v243
    v_cvt_pk_bf16_f32 v190, v242, v243
    v_mfma_f32_16x16x32_bf16 a[216:219], v[220:223], v[192:195], a[216:219]
    v_exp_f32 v244, v142
    v_mfma_f32_16x16x32_bf16 a[220:223], v[220:223], v[196:199], a[220:223]
    s_waitcnt lgkmcnt(2)
    v_exp_f32 v245, v143
    v_mfma_f32_16x16x32_bf16 a[224:227], v[224:227], v[176:179], a[224:227]
    ds_read_b128 v[216:219], v246 offset:0
    v_add_f32 v237, v237, v244
    v_mfma_f32_16x16x32_bf16 a[228:231], v[224:227], v[180:183], a[228:231]
    ds_read_b128 v[220:223], v246 offset:64
    v_add_f32 v237, v237, v245
    v_mfma_f32_16x16x32_bf16 a[232:235], v[224:227], v[192:195], a[232:235]
    v_cvt_pk_bf16_f32 v191, v244, v245
    v_mfma_f32_16x16x32_bf16 a[236:239], v[224:227], v[196:199], a[236:239]
    s_waitcnt lgkmcnt(2)
    v_max_f32 v249, v236, v237
    v_mfma_f32_16x16x32_bf16 a[240:243], v[228:231], v[176:179], a[240:243]
    v_cmp_lt_f32 vcc, s37, v249
    v_mfma_f32_16x16x32_bf16 a[244:247], v[228:231], v[180:183], a[244:247]
    v_mfma_f32_16x16x32_bf16 a[248:251], v[228:231], v[192:195], a[248:251]
    v_mfma_f32_16x16x32_bf16 a[252:255], v[228:231], v[196:199], a[252:255]
    s_waitcnt lgkmcnt(0)
    s_cbranch_vccnz S_R2_L2
R2_L2:
    v_mfma_f32_16x16x32_bf16 v[128:131], v[216:219], v[0:3], v[200:203]
    ds_read_b128 v[224:227], v246 offset:128
    v_add_f32 v232, v232, v236
    v_mfma_f32_16x16x32_bf16 v[128:131], v[220:223], v[16:19], v[128:131]
    ds_read_b128 v[228:231], v246 offset:192
    v_add_f32 v233, v233, v237
    v_mfma_f32_16x16x32_bf16 v[136:139], v[216:219], v[4:7], v[204:207]
    v_exp_f32 v238, v160
    v_mfma_f32_16x16x32_bf16 v[136:139], v[220:223], v[20:23], v[136:139]
    v_exp_f32 v239, v161
    v_mfma_f32_16x16x32_bf16 v[144:147], v[216:219], v[8:11], v[208:211]
    v_add_f32 v236, v238, v239
    v_cvt_pk_bf16_f32 v192, v238, v239
    v_mfma_f32_16x16x32_bf16 v[144:147], v[220:223], v[24:27], v[144:147]
    v_mfma_f32_16x16x32_bf16 v[152:155], v[216:219], v[12:15], v[212:215]
    v_mfma_f32_16x16x32_bf16 v[152:155], v[220:223], v[28:31], v[152:155]
    s_waitcnt lgkmcnt(0)
    v_mfma_f32_16x16x32_bf16 v[128:131], v[224:227], v[32:35], v[128:131]
    ds_read_b128 v[216:219], v246 offset:256
    v_mfma_f32_16x16x32_bf16 v[128:131], v[228:231], v[48:51], v[128:131]
    s_add_u32 m0, s33, 16896
    ds_read_b128 v[220:223], v246 offset:320
    v_mfma_f32_16x16x32_bf16 v[136:139], v[224:227], v[36:39], v[136:139]
    buffer_load_dwordx4 v248, s[8:11], s34 offen offset:0 nt lds
    v_mfma_f32_16x16x32_bf16 v[136:139], v[228:231], v[52:55], v[136:139]
    v_exp_f32 v240, v162
    v_mfma_f32_16x16x32_bf16 v[144:147], v[224:227], v[40:43], v[144:147]
    v_exp_f32 v241, v163
    v_mfma_f32_16x16x32_bf16 v[144:147], v[228:231], v[56:59], v[144:147]
    v_add_f32 v236, v236, v240
    v_add_f32 v236, v236, v241
    v_mfma_f32_16x16x32_bf16 v[152:155], v[224:227], v[44:47], v[152:155]
    v_cvt_pk_bf16_f32 v193, v240, v241
    v_mfma_f32_16x16x32_bf16 v[152:155], v[228:231], v[60:63], v[152:155]
    s_waitcnt lgkmcnt(0)
    v_exp_f32 v242, v168
    v_mfma_f32_16x16x32_bf16 v[128:131], v[216:219], v[64:67], v[128:131]
    ds_read_b128 v[224:227], v246 offset:384
    v_mfma_f32_16x16x32_bf16 v[128:131], v[220:223], v[80:83], v[128:131]
    ds_read_b128 v[228:231], v246 offset:448
    v_mfma_f32_16x16x32_bf16 v[136:139], v[216:219], v[68:71], v[136:139]
    v_exp_f32 v243, v169
    v_mfma_f32_16x16x32_bf16 v[136:139], v[220:223], v[84:87], v[136:139]
    v_add_f32 v237, v242, v243
    v_cvt_pk_bf16_f32 v196, v242, v243
    v_mfma_f32_16x16x32_bf16 v[144:147], v[216:219], v[72:75], v[144:147]
    s_add_u32 m0, s33, 17440
    v_mfma_f32_16x16x32_bf16 v[144:147], v[220:223], v[88:91], v[144:147]
    buffer_load_dwordx4 v248, s[8:11], s34 offen offset:512 nt lds
    v_mfma_f32_16x16x32_bf16 v[152:155], v[216:219], v[76:79], v[152:155]
    v_exp_f32 v244, v170
    v_mfma_f32_16x16x32_bf16 v[152:155], v[220:223], v[92:95], v[152:155]
    s_waitcnt lgkmcnt(0)
    v_exp_f32 v245, v171
    v_mfma_f32_16x16x32_bf16 v[128:131], v[224:227], v[96:99], v[128:131]
    ds_read_b128 v[216:219], v246 offset:8448
    v_add_f32 v237, v237, v244
    v_mfma_f32_16x16x32_bf16 v[128:131], v[228:231], v[112:115], v[128:131]
    ds_read_b128 v[220:223], v246 offset:8512
    v_add_f32 v237, v237, v245
    v_mfma_f32_16x16x32_bf16 v[136:139], v[224:227], v[100:103], v[136:139]
    v_cvt_pk_bf16_f32 v197, v244, v245
    v_mfma_f32_16x16x32_bf16 v[136:139], v[228:231], v[116:119], v[136:139]
    v_mfma_f32_16x16x32_bf16 v[144:147], v[224:227], v[104:107], v[144:147]
    v_exp_f32 v238, v164
    v_mfma_f32_16x16x32_bf16 v[144:147], v[228:231], v[120:123], v[144:147]
    v_exp_f32 v239, v165
    v_mfma_f32_16x16x32_bf16 v[152:155], v[224:227], v[108:111], v[152:155]
    v_add_f32 v236, v236, v238
    v_add_f32 v236, v236, v239
    v_mfma_f32_16x16x32_bf16 v[152:155], v[228:231], v[124:127], v[152:155]
    s_waitcnt lgkmcnt(0)
    v_cvt_pk_bf16_f32 v194, v238, v239
    v_mfma_f32_16x16x32_bf16 v[132:135], v[216:219], v[0:3], v[200:203]
    ds_read_b128 v[224:227], v246 offset:8576
    v_mfma_f32_16x16x32_bf16 v[132:135], v[220:223], v[16:19], v[132:135]
    s_add_u32 m0, s33, 17984
    ds_read_b128 v[228:231], v246 offset:8640
    v_mfma_f32_16x16x32_bf16 v[140:143], v[216:219], v[4:7], v[204:207]
    buffer_load_dwordx4 v248, s[8:11], s34 offen offset:1024 nt lds
    v_mfma_f32_16x16x32_bf16 v[140:143], v[220:223], v[20:23], v[140:143]
    v_exp_f32 v240, v166
    v_mfma_f32_16x16x32_bf16 v[148:151], v[216:219], v[8:11], v[208:211]
    v_exp_f32 v241, v167
    v_mfma_f32_16x16x32_bf16 v[148:151], v[220:223], v[24:27], v[148:151]
    v_add_f32 v236, v236, v240
    v_add_f32 v236, v236, v241
    v_mfma_f32_16x16x32_bf16 v[156:159], v[216:219], v[12:15], v[212:215]
    v_cvt_pk_bf16_f32 v195, v240, v241
    v_mfma_f32_16x16x32_bf16 v[156:159], v[220:223], v[28:31], v[156:159]
    s_waitcnt lgkmcnt(0)
    v_mfma_f32_16x16x32_bf16 v[132:135], v[224:227], v[32:35], v[132:135]
    ds_read_b128 v[216:219], v246 offset:8704
    v_mfma_f32_16x16x32_bf16 v[132:135], v[228:231], v[48:51], v[132:135]
    ds_read_b128 v[220:223], v246 offset:8768
    v_mfma_f32_16x16x32_bf16 v[140:143], v[224:227], v[36:39], v[140:143]
    v_exp_f32 v242, v172
    v_mfma_f32_16x16x32_bf16 v[140:143], v[228:231], v[52:55], v[140:143]
    v_exp_f32 v243, v173
    v_mfma_f32_16x16x32_bf16 v[148:151], v[224:227], v[40:43], v[148:151]
    s_add_u32 m0, s33, 18528
    v_add_f32 v237, v237, v242
    v_add_f32 v237, v237, v243
    v_mfma_f32_16x16x32_bf16 v[148:151], v[228:231], v[56:59], v[148:151]
    buffer_load_dwordx4 v248, s[8:11], s34 offen offset:1536 nt lds
    v_mfma_f32_16x16x32_bf16 v[156:159], v[224:227], v[44:47], v[156:159]
    s_add_u32 s34, s34, 0x4000
    v_cvt_pk_bf16_f32 v198, v242, v243
    v_mfma_f32_16x16x32_bf16 v[156:159], v[228:231], v[60:63], v[156:159]
    s_waitcnt lgkmcnt(0)
    v_exp_f32 v244, v174
    v_mfma_f32_16x16x32_bf16 v[132:135], v[216:219], v[64:67], v[132:135]
    ds_read_b128 v[224:227], v246 offset:8832
    v_mfma_f32_16x16x32_bf16 v[132:135], v[220:223], v[80:83], v[132:135]
    ds_read_b128 v[228:231], v246 offset:8896
    v_mfma_f32_16x16x32_bf16 v[140:143], v[216:219], v[68:71], v[140:143]
    v_exp_f32 v245, v175
    v_mfma_f32_16x16x32_bf16 v[140:143], v[220:223], v[84:87], v[140:143]
    v_add_f32 v237, v237, v244
    v_add_f32 v237, v237, v245
    v_mfma_f32_16x16x32_bf16 v[148:151], v[216:219], v[72:75], v[148:151]
    v_cvt_pk_bf16_f32 v199, v244, v245
    v_mfma_f32_16x16x32_bf16 v[148:151], v[220:223], v[88:91], v[148:151]
    v_mfma_f32_16x16x32_bf16 v[156:159], v[216:219], v[76:79], v[156:159]
    v_mfma_f32_16x16x32_bf16 v[156:159], v[220:223], v[92:95], v[156:159]
    s_waitcnt lgkmcnt(0)
    v_mfma_f32_16x16x32_bf16 v[132:135], v[224:227], v[96:99], v[132:135]
    ds_read_b64_tr_b16 v[216:217], v247 offset:0
    v_mfma_f32_16x16x32_bf16 v[132:135], v[228:231], v[112:115], v[132:135]
    ds_read_b64_tr_b16 v[218:219], v247 offset:8448
    v_mfma_f32_16x16x32_bf16 v[140:143], v[224:227], v[100:103], v[140:143]
    ds_read_b64_tr_b16 v[220:221], v247 offset:32
    v_max_f32 v249, v236, v237
    v_mfma_f32_16x16x32_bf16 v[140:143], v[228:231], v[116:119], v[140:143]
    ds_read_b64_tr_b16 v[222:223], v247 offset:8480
    v_cmp_lt_f32 vcc, s37, v249
    v_mfma_f32_16x16x32_bf16 v[148:151], v[224:227], v[104:107], v[148:151]
    v_mfma_f32_16x16x32_bf16 v[148:151], v[228:231], v[120:123], v[148:151]
    v_mfma_f32_16x16x32_bf16 v[156:159], v[224:227], v[108:111], v[156:159]
    v_mfma_f32_16x16x32_bf16 v[156:159], v[228:231], v[124:127], v[156:159]
    s_waitcnt lgkmcnt(2)
    s_cbranch_vccnz S_R1_L3
R1_L3:
    s_waitcnt vmcnt(3)
    s_barrier
    v_mfma_f32_16x16x32_bf16 a[0:3], v[216:219], v[184:187], a[0:3]
    ds_read_b64_tr_b16 v[224:225], v247 offset:64
    v_add_f32 v234, v234, v236
    v_mfma_f32_16x16x32_bf16 a[4:7], v[216:219], v[188:191], a[4:7]
    ds_read_b64_tr_b16 v[226:227], v247 offset:8512
    v_add_f32 v235, v235, v237
    v_mfma_f32_16x16x32_bf16 a[8:11], v[216:219], v[192:195], a[8:11]
    ds_read_b64_tr_b16 v[228:229], v247 offset:96
    v_mfma_f32_16x16x32_bf16 a[12:15], v[216:219], v[196:199], a[12:15]
    s_waitcnt lgkmcnt(3)
    ds_read_b64_tr_b16 v[230:231], v247 offset:8544
    v_mfma_f32_16x16x32_bf16 a[16:19], v[220:223], v[184:187], a[16:19]
    ds_read_b64_tr_b16 v[216:217], v247 offset:128
    v_add_u32 v246, 0x8400, v246
    v_mfma_f32_16x16x32_bf16 a[20:23], v[220:223], v[188:191], a[20:23]
    s_add_u32 m0, s33, 33792
    ds_read_b64_tr_b16 v[218:219], v247 offset:8576
    v_mfma_f32_16x16x32_bf16 a[24:27], v[220:223], v[192:195], a[24:27]
    buffer_load_dwordx4 v248, s[12:15], s35 offen offset:0 nt lds
    v_mfma_f32_16x16x32_bf16 a[28:31], v[220:223], v[196:199], a[28:31]
    s_waitcnt lgkmcnt(4)
    v_exp_f32 v238, v128
    v_mfma_f32_16x16x32_bf16 a[32:35], v[224:227], v[184:187], a[32:35]
    ds_read_b64_tr_b16 v[220:221], v247 offset:160
    v_mfma_f32_16x16x32_bf16 a[36:39], v[224:227], v[188:191], a[36:39]
    ds_read_b64_tr_b16 v[222:223], v247 offset:8608
    v_mfma_f32_16x16x32_bf16 a[40:43], v[224:227], v[192:195], a[40:43]
    v_exp_f32 v239, v129
    v_mfma_f32_16x16x32_bf16 a[44:47], v[224:227], v[196:199], a[44:47]
    s_waitcnt lgkmcnt(4)
    v_add_f32 v236, v238, v239
    v_cvt_pk_bf16_f32 v176, v238, v239
    v_mfma_f32_16x16x32_bf16 a[48:51], v[228:231], v[184:187], a[48:51]
    ds_read_b64_tr_b16 v[224:225], v247 offset:192
    v_mfma_f32_16x16x32_bf16 a[52:55], v[228:231], v[188:191], a[52:55]
    ds_read_b64_tr_b16 v[226:227], v247 offset:8640
    v_mfma_f32_16x16x32_bf16 a[56:59], v[228:231], v[192:195], a[56:59]
    v_exp_f32 v240, v130
    v_mfma_f32_16x16x32_bf16 a[60:63], v[228:231], v[196:199], a[60:63]
    s_waitcnt lgkmcnt(4)
    v_exp_f32 v241, v131
    v_mfma_f32_16x16x32_bf16 a[64:67], v[216:219], v[184:187], a[64:67]
    ds_read_b64_tr_b16 v[228:229], v247 offset:224
    v_add_f32 v236, v236, v240
    v_mfma_f32_16x16x32_bf16 a[68:71], v[216:219], v[188:191], a[68:71]
    s_add_u32 m0, s33, 34336
    ds_read_b64_tr_b16 v[230:231], v247 offset:8672
    v_add_f32 v236, v236, v241
    v_mfma_f32_16x16x32_bf16 a[72:75], v[216:219], v[192:195], a[72:75]
    buffer_load_dwordx4 v248, s[12:15], s35 offen offset:512 nt lds
    v_mfma_f32_16x16x32_bf16 a[76:79], v[216:219], v[196:199], a[76:79]
    s_waitcnt lgkmcnt(4)
    v_cvt_pk_bf16_f32 v177, v240, v241
    v_mfma_f32_16x16x32_bf16 a[80:83], v[220:223], v[184:187], a[80:83]
    ds_read_b64_tr_b16 v[216:217], v247 offset:256
    v_mfma_f32_16x16x32_bf16 a[84:87], v[220:223], v[188:191], a[84:87]
    ds_read_b64_tr_b16 v[218:219], v247 offset:8704
    v_mfma_f32_16x16x32_bf16 a[88:91], v[220:223], v[192:195], a[88:91]
    v_exp_f32 v242, v136
    v_mfma_f32_16x16x32_bf16 a[92:95], v[220:223], v[196:199], a[92:95]
    s_waitcnt lgkmcnt(4)
    v_exp_f32 v243, v137
    v_mfma_f32_16x16x32_bf16 a[96:99], v[224:227], v[184:187], a[96:99]
    ds_read_b64_tr_b16 v[220:221], v247 offset:288
    v_add_f32 v237, v242, v243
    v_mfma_f32_16x16x32_bf16 a[100:103], v[224:227], v[188:191], a[100:103]
    ds_read_b64_tr_b16 v[222:223], v247 offset:8736
    v_cvt_pk_bf16_f32 v180, v242, v243
    v_mfma_f32_16x16x32_bf16 a[104:107], v[224:227], v[192:195], a[104:107]
    v_exp_f32 v244, v138
    v_mfma_f32_16x16x32_bf16 a[108:111], v[224:227], v[196:199], a[108:111]
    s_waitcnt lgkmcnt(4)
    v_exp_f32 v245, v139
    v_mfma_f32_16x16x32_bf16 a[112:115], v[228:231], v[184:187], a[112:115]
    ds_read_b64_tr_b16 v[224:225], v247 offset:320
    v_add_f32 v237, v237, v244
    v_mfma_f32_16x16x32_bf16 a[116:119], v[228:231], v[188:191], a[116:119]
    s_add_u32 m0, s33, 34880
    ds_read_b64_tr_b16 v[226:227], v247 offset:8768
    v_add_f32 v237, v237, v245
    v_mfma_f32_16x16x32_bf16 a[120:123], v[228:231], v[192:195], a[120:123]
    buffer_load_dwordx4 v248, s[12:15], s35 offen offset:1024 nt lds
    v_mfma_f32_16x16x32_bf16 a[124:127], v[228:231], v[196:199], a[124:127]
    s_waitcnt lgkmcnt(4)
    v_cvt_pk_bf16_f32 v181, v244, v245
    v_mfma_f32_16x16x32_bf16 a[128:131], v[216:219], v[184:187], a[128:131]
    ds_read_b64_tr_b16 v[228:229], v247 offset:352
    v_mfma_f32_16x16x32_bf16 a[132:135], v[216:219], v[188:191], a[132:135]
    ds_read_b64_tr_b16 v[230:231], v247 offset:8800
    v_mfma_f32_16x16x32_bf16 a[136:139], v[216:219], v[192:195], a[136:139]
    v_exp_f32 v238, v132
    v_mfma_f32_16x16x32_bf16 a[140:143], v[216:219], v[196:199], a[140:143]
    s_waitcnt lgkmcnt(4)
    v_exp_f32 v239, v133
    v_mfma_f32_16x16x32_bf16 a[144:147], v[220:223], v[184:187], a[144:147]
    ds_read_b64_tr_b16 v[216:217], v247 offset:384
    v_add_f32 v236, v236, v238
    v_mfma_f32_16x16x32_bf16 a[148:151], v[220:223], v[188:191], a[148:151]
    ds_read_b64_tr_b16 v[218:219], v247 offset:8832
    v_add_f32 v236, v236, v239
    v_mfma_f32_16x16x32_bf16 a[152:155], v[220:223], v[192:195], a[152:155]
    v_cvt_pk_bf16_f32 v178, v238, v239
    v_mfma_f32_16x16x32_bf16 a[156:159], v[220:223], v[196:199], a[156:159]
    s_waitcnt lgkmcnt(4)
    v_exp_f32 v240, v134
    v_mfma_f32_16x16x32_bf16 a[160:163], v[224:227], v[184:187], a[160:163]
    ds_read_b64_tr_b16 v[220:221], v247 offset:416
    v_mfma_f32_16x16x32_bf16 a[164:167], v[224:227], v[188:191], a[164:167]
    s_add_u32 m0, s33, 35424
    ds_read_b64_tr_b16 v[222:223], v247 offset:8864
    v_mfma_f32_16x16x32_bf16 a[168:171], v[224:227], v[192:195], a[168:171]
    buffer_load_dwordx4 v248, s[12:15], s35 offen offset:1536 nt lds
    v_mfma_f32_16x16x32_bf16 a[172:175], v[224:227], v[196:199], a[172:175]
    s_waitcnt lgkmcnt(4)
    s_add_u32 s35, s35, 0x4000
    v_mfma_f32_16x16x32_bf16 a[176:179], v[228:231], v[184:187], a[176:179]
    ds_read_b64_tr_b16 v[224:225], v247 offset:448
    v_mfma_f32_16x16x32_bf16 a[180:183], v[228:231], v[188:191], a[180:183]
    ds_read_b64_tr_b16 v[226:227], v247 offset:8896
    v_mfma_f32_16x16x32_bf16 a[184:187], v[228:231], v[192:195], a[184:187]
    v_exp_f32 v241, v135
    v_mfma_f32_16x16x32_bf16 a[188:191], v[228:231], v[196:199], a[188:191]
    s_waitcnt lgkmcnt(4)
    v_add_f32 v236, v236, v240
    v_add_f32 v236, v236, v241
    v_mfma_f32_16x16x32_bf16 a[192:195], v[216:219], v[184:187], a[192:195]
    ds_read_b64_tr_b16 v[228:229], v247 offset:480
    v_cvt_pk_bf16_f32 v179, v240, v241
    v_mfma_f32_16x16x32_bf16 a[196:199], v[216:219], v[188:191], a[196:199]
    ds_read_b64_tr_b16 v[230:231], v247 offset:8928
    v_mfma_f32_16x16x32_bf16 a[200:203], v[216:219], v[192:195], a[200:203]
    v_exp_f32 v242, v140
    v_mfma_f32_16x16x32_bf16 a[204:207], v[216:219], v[196:199], a[204:207]
    s_waitcnt lgkmcnt(4)
    v_exp_f32 v243, v141
    v_mfma_f32_16x16x32_bf16 a[208:211], v[220:223], v[184:187], a[208:211]
    v_add_u32 v247, 0x8400, v247
    v_add_f32 v237, v237, v242
    v_mfma_f32_16x16x32_bf16 a[212:215], v[220:223], v[188:191], a[212:215]
    v_add_f32 v237, v237, v243
    v_cvt_pk_bf16_f32 v182, v242, v243
    v_mfma_f32_16x16x32_bf16 a[216:219], v[220:223], v[192:195], a[216:219]
    v_exp_f32 v244, v142
    v_mfma_f32_16x16x32_bf16 a[220:223], v[220:223], v[196:199], a[220:223]
    s_waitcnt lgkmcnt(2)
    v_exp_f32 v245, v143
    v_mfma_f32_16x16x32_bf16 a[224:227], v[224:227], v[184:187], a[224:227]
    ds_read_b128 v[216:219], v246 offset:0
    v_add_f32 v237, v237, v244
    v_mfma_f32_16x16x32_bf16 a[228:231], v[224:227], v[188:191], a[228:231]
    ds_read_b128 v[220:223], v246 offset:64
    v_add_f32 v237, v237, v245
    v_mfma_f32_16x16x32_bf16 a[232:235], v[224:227], v[192:195], a[232:235]
    v_cvt_pk_bf16_f32 v183, v244, v245
    v_mfma_f32_16x16x32_bf16 a[236:239], v[224:227], v[196:199], a[236:239]
    s_waitcnt lgkmcnt(2)
    v_max_f32 v249, v236, v237
    v_mfma_f32_16x16x32_bf16 a[240:243], v[228:231], v[184:187], a[240:243]
    v_cmp_lt_f32 vcc, s37, v249
    v_mfma_f32_16x16x32_bf16 a[244:247], v[228:231], v[188:191], a[244:247]
    v_mfma_f32_16x16x32_bf16 a[248:251], v[228:231], v[192:195], a[248:251]
    v_mfma_f32_16x16x32_bf16 a[252:255], v[228:231], v[196:199], a[252:255]
    s_waitcnt lgkmcnt(0)
    s_cbranch_vccnz S_R2_L3
R2_L3:
    v_mfma_f32_16x16x32_bf16 v[128:131], v[216:219], v[0:3], v[200:203]
    ds_read_b128 v[224:227], v246 offset:128
    v_add_f32 v232, v232, v236
    v_mfma_f32_16x16x32_bf16 v[128:131], v[220:223], v[16:19], v[128:131]
    ds_read_b128 v[228:231], v246 offset:192
    v_add_f32 v233, v233, v237
    v_mfma_f32_16x16x32_bf16 v[136:139], v[216:219], v[4:7], v[204:207]
    v_exp_f32 v238, v144
    v_mfma_f32_16x16x32_bf16 v[136:139], v[220:223], v[20:23], v[136:139]
    v_exp_f32 v239, v145
    v_mfma_f32_16x16x32_bf16 v[160:163], v[216:219], v[8:11], v[208:211]
    v_add_f32 v236, v238, v239
    v_cvt_pk_bf16_f32 v192, v238, v239
    v_mfma_f32_16x16x32_bf16 v[160:163], v[220:223], v[24:27], v[160:163]
    v_mfma_f32_16x16x32_bf16 v[168:171], v[216:219], v[12:15], v[212:215]
    v_mfma_f32_16x16x32_bf16 v[168:171], v[220:223], v[28:31], v[168:171]
    s_waitcnt lgkmcnt(0)
    v_mfma_f32_16x16x32_bf16 v[128:131], v[224:227], v[32:35], v[128:131]
    ds_read_b128 v[216:219], v246 offset:256
    v_mfma_f32_16x16x32_bf16 v[128:131], v[228:231], v[48:51], v[128:131]
    s_add_u32 m0, s33, 50688
    ds_read_b128 v[220:223], v246 offset:320
    v_mfma_f32_16x16x32_bf16 v[136:139], v[224:227], v[36:39], v[136:139]
    buffer_load_dwordx4 v248, s[8:11], s34 offen offset:0 nt lds
    v_mfma_f32_16x16x32_bf16 v[136:139], v[228:231], v[52:55], v[136:139]
    v_exp_f32 v240, v146
    v_mfma_f32_16x16x32_bf16 v[160:163], v[224:227], v[40:43], v[160:163]
    v_exp_f32 v241, v147
    v_mfma_f32_16x16x32_bf16 v[160:163], v[228:231], v[56:59], v[160:163]
    v_add_f32 v236, v236, v240
    v_add_f32 v236, v236, v241
    v_mfma_f32_16x16x32_bf16 v[168:171], v[224:227], v[44:47], v[168:171]
    v_cvt_pk_bf16_f32 v193, v240, v241
    v_mfma_f32_16x16x32_bf16 v[168:171], v[228:231], v[60:63], v[168:171]
    s_waitcnt lgkmcnt(0)
    v_exp_f32 v242, v152
    v_mfma_f32_16x16x32_bf16 v[128:131], v[216:219], v[64:67], v[128:131]
    ds_read_b128 v[224:227], v246 offset:384
    v_mfma_f32_16x16x32_bf16 v[128:131], v[220:223], v[80:83], v[128:131]
    ds_read_b128 v[228:231], v246 offset:448
    v_mfma_f32_16x16x32_bf16 v[136:139], v[216:219], v[68:71], v[136:139]
    v_exp_f32 v243, v153
    v_mfma_f32_16x16x32_bf16 v[136:139], v[220:223], v[84:87], v[136:139]
    v_add_f32 v237, v242, v243
    v_cvt_pk_bf16_f32 v196, v242, v243
    v_mfma_f32_16x16x32_bf16 v[160:163], v[216:219], v[72:75], v[160:163]
    s_add_u32 m0, s33, 51232
    v_mfma_f32_16x16x32_bf16 v[160:163], v[220:223], v[88:91], v[160:163]
    buffer_load_dwordx4 v248, s[8:11], s34 offen offset:512 nt lds
    v_mfma_f32_16x16x32_bf16 v[168:171], v[216:219], v[76:79], v[168:171]
    v_exp_f32 v244, v154
    v_mfma_f32_16x16x32_bf16 v[168:171], v[220:223], v[92:95], v[168:171]
    s_waitcnt lgkmcnt(0)
    v_exp_f32 v245, v155
    v_mfma_f32_16x16x32_bf16 v[128:131], v[224:227], v[96:99], v[128:131]
    ds_read_b128 v[216:219], v246 offset:8448
    v_add_f32 v237, v237, v244
    v_mfma_f32_16x16x32_bf16 v[128:131], v[228:231], v[112:115], v[128:131]
    ds_read_b128 v[220:223], v246 offset:8512
    v_add_f32 v237, v237, v245
    v_mfma_f32_16x16x32_bf16 v[136:139], v[224:227], v[100:103], v[136:139]
    v_cvt_pk_bf16_f32 v197, v244, v245
    v_mfma_f32_16x16x32_bf16 v[136:139], v[228:231], v[116:119], v[136:139]
    v_mfma_f32_16x16x32_bf16 v[160:163], v[224:227], v[104:107], v[160:163]
    v_exp_f32 v238, v148
    v_mfma_f32_16x16x32_bf16 v[160:163], v[228:231], v[120:123], v[160:163]
    v_exp_f32 v239, v149
    v_mfma_f32_16x16x32_bf16 v[168:171], v[224:227], v[108:111], v[168:171]
    v_add_f32 v236, v236, v238
    v_add_f32 v236, v236, v239
    v_mfma_f32_16x16x32_bf16 v[168:171], v[228:231], v[124:127], v[168:171]
    s_waitcnt lgkmcnt(0)
    v_cvt_pk_bf16_f32 v194, v238, v239
    v_mfma_f32_16x16x32_bf16 v[132:135], v[216:219], v[0:3], v[200:203]
    ds_read_b128 v[224:227], v246 offset:8576
    v_mfma_f32_16x16x32_bf16 v[132:135], v[220:223], v[16:19], v[132:135]
    s_add_u32 m0, s33, 51776
    ds_read_b128 v[228:231], v246 offset:8640
    v_mfma_f32_16x16x32_bf16 v[140:143], v[216:219], v[4:7], v[204:207]
    buffer_load_dwordx4 v248, s[8:11], s34 offen offset:1024 nt lds
    v_mfma_f32_16x16x32_bf16 v[140:143], v[220:223], v[20:23], v[140:143]
    v_exp_f32 v240, v150
    v_mfma_f32_16x16x32_bf16 v[164:167], v[216:219], v[8:11], v[208:211]
    v_exp_f32 v241, v151
    v_mfma_f32_16x16x32_bf16 v[164:167], v[220:223], v[24:27], v[164:167]
    v_add_f32 v236, v236, v240
    v_add_f32 v236, v236, v241
    v_mfma_f32_16x16x32_bf16 v[172:175], v[216:219], v[12:15], v[212:215]
    v_cvt_pk_bf16_f32 v195, v240, v241
    v_mfma_f32_16x16x32_bf16 v[172:175], v[220:223], v[28:31], v[172:175]
    s_waitcnt lgkmcnt(0)
    v_mfma_f32_16x16x32_bf16 v[132:135], v[224:227], v[32:35], v[132:135]
    ds_read_b128 v[216:219], v246 offset:8704
    v_mfma_f32_16x16x32_bf16 v[132:135], v[228:231], v[48:51], v[132:135]
    ds_read_b128 v[220:223], v246 offset:8768
    v_mfma_f32_16x16x32_bf16 v[140:143], v[224:227], v[36:39], v[140:143]
    v_exp_f32 v242, v156
    v_mfma_f32_16x16x32_bf16 v[140:143], v[228:231], v[52:55], v[140:143]
    v_exp_f32 v243, v157
    v_mfma_f32_16x16x32_bf16 v[164:167], v[224:227], v[40:43], v[164:167]
    s_add_u32 m0, s33, 52320
    v_add_f32 v237, v237, v242
    v_add_f32 v237, v237, v243
    v_mfma_f32_16x16x32_bf16 v[164:167], v[228:231], v[56:59], v[164:167]
    buffer_load_dwordx4 v248, s[8:11], s34 offen offset:1536 nt lds
    v_mfma_f32_16x16x32_bf16 v[172:175], v[224:227], v[44:47], v[172:175]
    s_add_u32 s34, s34, 0x4000
    v_cvt_pk_bf16_f32 v198, v242, v243
    v_mfma_f32_16x16x32_bf16 v[172:175], v[228:231], v[60:63], v[172:175]
    s_waitcnt lgkmcnt(0)
    v_exp_f32 v244, v158
    v_mfma_f32_16x16x32_bf16 v[132:135], v[216:219], v[64:67], v[132:135]
    ds_read_b128 v[224:227], v246 offset:8832
    v_mfma_f32_16x16x32_bf16 v[132:135], v[220:223], v[80:83], v[132:135]
    ds_read_b128 v[228:231], v246 offset:8896
    v_mfma_f32_16x16x32_bf16 v[140:143], v[216:219], v[68:71], v[140:143]
    v_exp_f32 v245, v159
    v_mfma_f32_16x16x32_bf16 v[140:143], v[220:223], v[84:87], v[140:143]
    v_add_f32 v237, v237, v244
    v_add_f32 v237, v237, v245
    v_mfma_f32_16x16x32_bf16 v[164:167], v[216:219], v[72:75], v[164:167]
    v_cvt_pk_bf16_f32 v199, v244, v245
    v_mfma_f32_16x16x32_bf16 v[164:167], v[220:223], v[88:91], v[164:167]
    v_mfma_f32_16x16x32_bf16 v[172:175], v[216:219], v[76:79], v[172:175]
    v_mfma_f32_16x16x32_bf16 v[172:175], v[220:223], v[92:95], v[172:175]
    s_waitcnt lgkmcnt(0)
    v_mfma_f32_16x16x32_bf16 v[132:135], v[224:227], v[96:99], v[132:135]
    ds_read_b64_tr_b16 v[216:217], v247 offset:0
    v_mfma_f32_16x16x32_bf16 v[132:135], v[228:231], v[112:115], v[132:135]
    ds_read_b64_tr_b16 v[218:219], v247 offset:8448
    v_mfma_f32_16x16x32_bf16 v[140:143], v[224:227], v[100:103], v[140:143]
    ds_read_b64_tr_b16 v[220:221], v247 offset:32
    v_max_f32 v249, v236, v237
    v_mfma_f32_16x16x32_bf16 v[140:143], v[228:231], v[116:119], v[140:143]
    ds_read_b64_tr_b16 v[222:223], v247 offset:8480
    v_cmp_lt_f32 vcc, s37, v249
    v_mfma_f32_16x16x32_bf16 v[164:167], v[224:227], v[104:107], v[164:167]
    v_mfma_f32_16x16x32_bf16 v[164:167], v[228:231], v[120:123], v[164:167]
    v_mfma_f32_16x16x32_bf16 v[172:175], v[224:227], v[108:111], v[172:175]
    v_mfma_f32_16x16x32_bf16 v[172:175], v[228:231], v[124:127], v[172:175]
    s_waitcnt lgkmcnt(2)
    s_cbranch_vccnz S_R1_L0
R1_L0:
    s_waitcnt vmcnt(3)
    s_barrier
    v_mfma_f32_16x16x32_bf16 a[0:3], v[216:219], v[176:179], a[0:3]
    ds_read_b64_tr_b16 v[224:225], v247 offset:64
    v_add_f32 v234, v234, v236
    v_mfma_f32_16x16x32_bf16 a[4:7], v[216:219], v[180:183], a[4:7]
    ds_read_b64_tr_b16 v[226:227], v247 offset:8512
    v_add_f32 v235, v235, v237
    v_mfma_f32_16x16x32_bf16 a[8:11], v[216:219], v[192:195], a[8:11]
    ds_read_b64_tr_b16 v[228:229], v247 offset:96
    v_mfma_f32_16x16x32_bf16 a[12:15], v[216:219], v[196:199], a[12:15]
    s_waitcnt lgkmcnt(3)
    ds_read_b64_tr_b16 v[230:231], v247 offset:8544
    v_mfma_f32_16x16x32_bf16 a[16:19], v[220:223], v[176:179], a[16:19]
    ds_read_b64_tr_b16 v[216:217], v247 offset:128
    v_add_u32 v246, 0x8400, v246
    v_mfma_f32_16x16x32_bf16 a[20:23], v[220:223], v[180:183], a[20:23]
    s_add_u32 m0, s33, 67584
    ds_read_b64_tr_b16 v[218:219], v247 offset:8576
    v_mfma_f32_16x16x32_bf16 a[24:27], v[220:223], v[192:195], a[24:27]
    buffer_load_dwordx4 v248, s[12:15], s35 offen offset:0 nt lds
    v_mfma_f32_16x16x32_bf16 a[28:31], v[220:223], v[196:199], a[28:31]
    s_waitcnt lgkmcnt(4)
    v_exp_f32 v238, v128
    v_mfma_f32_16x16x32_bf16 a[32:35], v[224:227], v[176:179], a[32:35]
    ds_read_b64_tr_b16 v[220:221], v247 offset:160
    v_mfma_f32_16x16x32_bf16 a[36:39], v[224:227], v[180:183], a[36:39]
    ds_read_b64_tr_b16 v[222:223], v247 offset:8608
    v_mfma_f32_16x16x32_bf16 a[40:43], v[224:227], v[192:195], a[40:43]
    v_exp_f32 v239, v129
    v_mfma_f32_16x16x32_bf16 a[44:47], v[224:227], v[196:199], a[44:47]
    s_waitcnt lgkmcnt(4)
    v_add_f32 v236, v238, v239
    v_cvt_pk_bf16_f32 v184, v238, v239
    v_mfma_f32_16x16x32_bf16 a[48:51], v[228:231], v[176:179], a[48:51]
    ds_read_b64_tr_b16 v[224:225], v247 offset:192
    v_mfma_f32_16x16x32_bf16 a[52:55], v[228:231], v[180:183], a[52:55]
    ds_read_b64_tr_b16 v[226:227], v247 offset:8640
    v_mfma_f32_16x16x32_bf16 a[56:59], v[228:231], v[192:195], a[56:59]
    v_exp_f32 v240, v130
    v_mfma_f32_16x16x32_bf16 a[60:63], v[228:231], v[196:199], a[60:63]
    s_waitcnt lgkmcnt(4)
    v_exp_f32 v241, v131
    v_mfma_f32_16x16x32_bf16 a[64:67], v[216:219], v[176:179], a[64:67]
    ds_read_b64_tr_b16 v[228:229], v247 offset:224
    v_add_f32 v236, v236, v240
    v_mfma_f32_16x16x32_bf16 a[68:71], v[216:219], v[180:183], a[68:71]
    s_add_u32 m0, s33, 68128
    ds_read_b64_tr_b16 v[230:231], v247 offset:8672
    v_add_f32 v236, v236, v241
    v_mfma_f32_16x16x32_bf16 a[72:75], v[216:219], v[192:195], a[72:75]
    buffer_load_dwordx4 v248, s[12:15], s35 offen offset:512 nt lds
    v_mfma_f32_16x16x32_bf16 a[76:79], v[216:219], v[196:199], a[76:79]
    s_waitcnt lgkmcnt(4)
    v_cvt_pk_bf16_f32 v185, v240, v241
    v_mfma_f32_16x16x32_bf16 a[80:83], v[220:223], v[176:179], a[80:83]
    ds_read_b64_tr_b16 v[216:217], v247 offset:256
    v_mfma_f32_16x16x32_bf16 a[84:87], v[220:223], v[180:183], a[84:87]
    ds_read_b64_tr_b16 v[218:219], v247 offset:8704
    v_mfma_f32_16x16x32_bf16 a[88:91], v[220:223], v[192:195], a[88:91]
    v_exp_f32 v242, v136
    v_mfma_f32_16x16x32_bf16 a[92:95], v[220:223], v[196:199], a[92:95]
    s_waitcnt lgkmcnt(4)
    v_exp_f32 v243, v137
    v_mfma_f32_16x16x32_bf16 a[96:99], v[224:227], v[176:179], a[96:99]
    ds_read_b64_tr_b16 v[220:221], v247 offset:288
    v_add_f32 v237, v242, v243
    v_mfma_f32_16x16x32_bf16 a[100:103], v[224:227], v[180:183], a[100:103]
    ds_read_b64_tr_b16 v[222:223], v247 offset:8736
    v_cvt_pk_bf16_f32 v188, v242, v243
    v_mfma_f32_16x16x32_bf16 a[104:107], v[224:227], v[192:195], a[104:107]
    v_exp_f32 v244, v138
    v_mfma_f32_16x16x32_bf16 a[108:111], v[224:227], v[196:199], a[108:111]
    s_waitcnt lgkmcnt(4)
    v_exp_f32 v245, v139
    v_mfma_f32_16x16x32_bf16 a[112:115], v[228:231], v[176:179], a[112:115]
    ds_read_b64_tr_b16 v[224:225], v247 offset:320
    v_add_f32 v237, v237, v244
    v_mfma_f32_16x16x32_bf16 a[116:119], v[228:231], v[180:183], a[116:119]
    s_add_u32 m0, s33, 68672
    ds_read_b64_tr_b16 v[226:227], v247 offset:8768
    v_add_f32 v237, v237, v245
    v_mfma_f32_16x16x32_bf16 a[120:123], v[228:231], v[192:195], a[120:123]
    buffer_load_dwordx4 v248, s[12:15], s35 offen offset:1024 nt lds
    v_mfma_f32_16x16x32_bf16 a[124:127], v[228:231], v[196:199], a[124:127]
    s_waitcnt lgkmcnt(4)
    v_cvt_pk_bf16_f32 v189, v244, v245
    v_mfma_f32_16x16x32_bf16 a[128:131], v[216:219], v[176:179], a[128:131]
    ds_read_b64_tr_b16 v[228:229], v247 offset:352
    v_mfma_f32_16x16x32_bf16 a[132:135], v[216:219], v[180:183], a[132:135]
    ds_read_b64_tr_b16 v[230:231], v247 offset:8800
    v_mfma_f32_16x16x32_bf16 a[136:139], v[216:219], v[192:195], a[136:139]
    v_exp_f32 v238, v132
    v_mfma_f32_16x16x32_bf16 a[140:143], v[216:219], v[196:199], a[140:143]
    s_waitcnt lgkmcnt(4)
    v_exp_f32 v239, v133
    v_mfma_f32_16x16x32_bf16 a[144:147], v[220:223], v[176:179], a[144:147]
    ds_read_b64_tr_b16 v[216:217], v247 offset:384
    v_add_f32 v236, v236, v238
    v_mfma_f32_16x16x32_bf16 a[148:151], v[220:223], v[180:183], a[148:151]
    ds_read_b64_tr_b16 v[218:219], v247 offset:8832
    v_add_f32 v236, v236, v239
    v_mfma_f32_16x16x32_bf16 a[152:155], v[220:223], v[192:195], a[152:155]
    v_cvt_pk_bf16_f32 v186, v238, v239
    v_mfma_f32_16x16x32_bf16 a[156:159], v[220:223], v[196:199], a[156:159]
    s_waitcnt lgkmcnt(4)
    v_exp_f32 v240, v134
    v_mfma_f32_16x16x32_bf16 a[160:163], v[224:227], v[176:179], a[160:163]
    ds_read_b64_tr_b16 v[220:221], v247 offset:416
    v_mfma_f32_16x16x32_bf16 a[164:167], v[224:227], v[180:183], a[164:167]
    s_add_u32 m0, s33, 69216
    ds_read_b64_tr_b16 v[222:223], v247 offset:8864
    v_mfma_f32_16x16x32_bf16 a[168:171], v[224:227], v[192:195], a[168:171]
    buffer_load_dwordx4 v248, s[12:15], s35 offen offset:1536 nt lds
    v_mfma_f32_16x16x32_bf16 a[172:175], v[224:227], v[196:199], a[172:175]
    s_waitcnt lgkmcnt(4)
    s_add_u32 s35, s35, 0x4000
    v_mfma_f32_16x16x32_bf16 a[176:179], v[228:231], v[176:179], a[176:179]
    ds_read_b64_tr_b16 v[224:225], v247 offset:448
    v_mfma_f32_16x16x32_bf16 a[180:183], v[228:231], v[180:183], a[180:183]
    ds_read_b64_tr_b16 v[226:227], v247 offset:8896
    v_mfma_f32_16x16x32_bf16 a[184:187], v[228:231], v[192:195], a[184:187]
    v_exp_f32 v241, v135
    v_mfma_f32_16x16x32_bf16 a[188:191], v[228:231], v[196:199], a[188:191]
    s_waitcnt lgkmcnt(4)
    v_add_f32 v236, v236, v240
    v_add_f32 v236, v236, v241
    v_mfma_f32_16x16x32_bf16 a[192:195], v[216:219], v[176:179], a[192:195]
    ds_read_b64_tr_b16 v[228:229], v247 offset:480
    v_cvt_pk_bf16_f32 v187, v240, v241
    v_mfma_f32_16x16x32_bf16 a[196:199], v[216:219], v[180:183], a[196:199]
    ds_read_b64_tr_b16 v[230:231], v247 offset:8928
    v_mfma_f32_16x16x32_bf16 a[200:203], v[216:219], v[192:195], a[200:203]
    v_exp_f32 v242, v140
    v_mfma_f32_16x16x32_bf16 a[204:207], v[216:219], v[196:199], a[204:207]
    s_waitcnt lgkmcnt(4)
    v_exp_f32 v243, v141
    v_mfma_f32_16x16x32_bf16 a[208:211], v[220:223], v[176:179], a[208:211]
    v_add_u32 v247, 0xfffe7400, v247
    v_add_f32 v237, v237, v242
    v_mfma_f32_16x16x32_bf16 a[212:215], v[220:223], v[180:183], a[212:215]
    v_add_f32 v237, v237, v243
    v_cvt_pk_bf16_f32 v190, v242, v243
    v_mfma_f32_16x16x32_bf16 a[216:219], v[220:223], v[192:195], a[216:219]
    v_exp_f32 v244, v142
    v_mfma_f32_16x16x32_bf16 a[220:223], v[220:223], v[196:199], a[220:223]
    s_waitcnt lgkmcnt(2)
    v_exp_f32 v245, v143
    v_mfma_f32_16x16x32_bf16 a[224:227], v[224:227], v[176:179], a[224:227]
    ds_read_b128 v[216:219], v246 offset:0
    v_add_f32 v237, v237, v244
    v_mfma_f32_16x16x32_bf16 a[228:231], v[224:227], v[180:183], a[228:231]
    ds_read_b128 v[220:223], v246 offset:64
    v_add_f32 v237, v237, v245
    v_mfma_f32_16x16x32_bf16 a[232:235], v[224:227], v[192:195], a[232:235]
    v_cvt_pk_bf16_f32 v191, v244, v245
    v_mfma_f32_16x16x32_bf16 a[236:239], v[224:227], v[196:199], a[236:239]
    s_waitcnt lgkmcnt(2)
    v_max_f32 v249, v236, v237
    v_mfma_f32_16x16x32_bf16 a[240:243], v[228:231], v[176:179], a[240:243]
    v_cmp_lt_f32 vcc, s37, v249
    v_mfma_f32_16x16x32_bf16 a[244:247], v[228:231], v[180:183], a[244:247]
    v_mfma_f32_16x16x32_bf16 a[248:251], v[228:231], v[192:195], a[248:251]
    v_mfma_f32_16x16x32_bf16 a[252:255], v[228:231], v[196:199], a[252:255]
    s_waitcnt lgkmcnt(0)
    s_cbranch_vccnz S_R2_L0
R2_L0:
    s_cmp_lg_u32 s36, s3
    s_cbranch_scc1 D_skip
    s_lshl_b32 s42, s45, 4
    s_or_b32 s42, s42, 0x80
    v_mov_b32 v249, s42
    s_mov_b64 exec, 1
    buffer_store_byte v249, off, s[48:51], s46 sc1
    s_mov_b64 exec, -1
    s_nop 3
D_skip:
    s_sub_u32 s36, s36, 1
    s_cmp_lg_u32 s36, 0
    s_cbranch_scc1 L_loop
    v_mfma_f32_16x16x32_bf16 v[128:131], v[216:219], v[0:3], v[200:203]
    ds_read_b128 v[224:227], v246 offset:128
    v_add_f32 v232, v232, v236
    v_mfma_f32_16x16x32_bf16 v[128:131], v[220:223], v[16:19], v[128:131]
    ds_read_b128 v[228:231], v246 offset:192
    v_add_f32 v233, v233, v237
    v_mfma_f32_16x16x32_bf16 v[136:139], v[216:219], v[4:7], v[204:207]
    v_exp_f32 v238, v160
    v_mfma_f32_16x16x32_bf16 v[136:139], v[220:223], v[20:23], v[136:139]
    v_exp_f32 v239, v161
    v_mfma_f32_16x16x32_bf16 v[144:147], v[216:219], v[8:11], v[208:211]
    v_add_f32 v236, v238, v239
    v_cvt_pk_bf16_f32 v192, v238, v239
    v_mfma_f32_16x16x32_bf16 v[144:147], v[220:223], v[24:27], v[144:147]
    v_mfma_f32_16x16x32_bf16 v[152:155], v[216:219], v[12:15], v[212:215]
    v_mfma_f32_16x16x32_bf16 v[152:155], v[220:223], v[28:31], v[152:155]
    s_waitcnt lgkmcnt(0)
    v_mfma_f32_16x16x32_bf16 v[128:131], v[224:227], v[32:35], v[128:131]
    ds_read_b128 v[216:219], v246 offset:256
    v_mfma_f32_16x16x32_bf16 v[128:131], v[228:231], v[48:51], v[128:131]
    ds_read_b128 v[220:223], v246 offset:320
    v_mfma_f32_16x16x32_bf16 v[136:139], v[224:227], v[36:39], v[136:139]
    v_exp_f32 v240, v162
    v_mfma_f32_16x16x32_bf16 v[136:139], v[228:231], v[52:55], v[136:139]
    v_exp_f32 v241, v163
    v_mfma_f32_16x16x32_bf16 v[144:147], v[224:227], v[40:43], v[144:147]
    v_add_f32 v236, v236, v240
    v_add_f32 v236, v236, v241
    v_mfma_f32_16x16x32_bf16 v[144:147], v[228:231], v[56:59], v[144:147]
    v_cvt_pk_bf16_f32 v193, v240, v241
    v_mfma_f32_16x16x32_bf16 v[152:155], v[224:227], v[44:47], v[152:155]
    v_mfma_f32_16x16x32_bf16 v[152:155], v[228:231], v[60:63], v[152:155]
    s_waitcnt lgkmcnt(0)
    v_exp_f32 v242, v168
    v_mfma_f32_16x16x32_bf16 v[128:131], v[216:219], v[64:67], v[128:131]
    ds_read_b128 v[224:227], v246 offset:384
    v_mfma_f32_16x16x32_bf16 v[128:131], v[220:223], v[80:83], v[128:131]
    ds_read_b128 v[228:231], v246 offset:448
    v_mfma_f32_16x16x32_bf16 v[136:139], v[216:219], v[68:71], v[136:139]
    v_exp_f32 v243, v169
    v_mfma_f32_16x16x32_bf16 v[136:139], v[220:223], v[84:87], v[136:139]
    v_add_f32 v237, v242, v243
    v_cvt_pk_bf16_f32 v196, v242, v243
    v_mfma_f32_16x16x32_bf16 v[144:147], v[216:219], v[72:75], v[144:147]
    v_mfma_f32_16x16x32_bf16 v[144:147], v[220:223], v[88:91], v[144:147]
    v_exp_f32 v244, v170
    v_mfma_f32_16x16x32_bf16 v[152:155], v[216:219], v[76:79], v[152:155]
    v_exp_f32 v245, v171
    v_mfma_f32_16x16x32_bf16 v[152:155], v[220:223], v[92:95], v[152:155]
    s_waitcnt lgkmcnt(0)
    v_add_f32 v237, v237, v244
    v_add_f32 v237, v237, v245
    v_mfma_f32_16x16x32_bf16 v[128:131], v[224:227], v[96:99], v[128:131]
    ds_read_b128 v[216:219], v246 offset:8448
    v_cvt_pk_bf16_f32 v197, v244, v245
    v_mfma_f32_16x16x32_bf16 v[128:131], v[228:231], v[112:115], v[128:131]
    ds_read_b128 v[220:223], v246 offset:8512
    v_mfma_f32_16x16x32_bf16 v[136:139], v[224:227], v[100:103], v[136:139]
    v_mfma_f32_16x16x32_bf16 v[136:139], v[228:231], v[116:119], v[136:139]
    v_mfma_f32_16x16x32_bf16 v[144:147], v[224:227], v[104:107], v[144:147]
    v_exp_f32 v238, v164
    v_mfma_f32_16x16x32_bf16 v[144:147], v[228:231], v[120:123], v[144:147]
    v_exp_f32 v239, v165
    v_mfma_f32_16x16x32_bf16 v[152:155], v[224:227], v[108:111], v[152:155]
    v_add_f32 v236, v236, v238
    v_add_f32 v236, v236, v239
    v_mfma_f32_16x16x32_bf16 v[152:155], v[228:231], v[124:127], v[152:155]
    s_waitcnt lgkmcnt(0)
    v_cvt_pk_bf16_f32 v194, v238, v239
    v_mfma_f32_16x16x32_bf16 v[132:135], v[216:219], v[0:3], v[200:203]
    ds_read_b128 v[224:227], v246 offset:8576
    v_mfma_f32_16x16x32_bf16 v[132:135], v[220:223], v[16:19], v[132:135]
    ds_read_b128 v[228:231], v246 offset:8640
    v_mfma_f32_16x16x32_bf16 v[140:143], v[216:219], v[4:7], v[204:207]
    v_exp_f32 v240, v166
    v_mfma_f32_16x16x32_bf16 v[140:143], v[220:223], v[20:23], v[140:143]
    v_exp_f32 v241, v167
    v_mfma_f32_16x16x32_bf16 v[148:151], v[216:219], v[8:11], v[208:211]
    v_add_f32 v236, v236, v240
    v_add_f32 v236, v236, v241
    v_mfma_f32_16x16x32_bf16 v[148:151], v[220:223], v[24:27], v[148:151]
    v_cvt_pk_bf16_f32 v195, v240, v241
    v_mfma_f32_16x16x32_bf16 v[156:159], v[216:219], v[12:15], v[212:215]
    v_mfma_f32_16x16x32_bf16 v[156:159], v[220:223], v[28:31], v[156:159]
    s_waitcnt lgkmcnt(0)
    v_mfma_f32_16x16x32_bf16 v[132:135], v[224:227], v[32:35], v[132:135]
    ds_read_b128 v[216:219], v246 offset:8704
    v_mfma_f32_16x16x32_bf16 v[132:135], v[228:231], v[48:51], v[132:135]
    ds_read_b128 v[220:223], v246 offset:8768
    v_mfma_f32_16x16x32_bf16 v[140:143], v[224:227], v[36:39], v[140:143]
    v_exp_f32 v242, v172
    v_mfma_f32_16x16x32_bf16 v[140:143], v[228:231], v[52:55], v[140:143]
    v_exp_f32 v243, v173
    v_mfma_f32_16x16x32_bf16 v[148:151], v[224:227], v[40:43], v[148:151]
    v_add_f32 v237, v237, v242
    v_add_f32 v237, v237, v243
    v_mfma_f32_16x16x32_bf16 v[148:151], v[228:231], v[56:59], v[148:151]
    v_cvt_pk_bf16_f32 v198, v242, v243
    v_mfma_f32_16x16x32_bf16 v[156:159], v[224:227], v[44:47], v[156:159]
    v_mfma_f32_16x16x32_bf16 v[156:159], v[228:231], v[60:63], v[156:159]
    s_waitcnt lgkmcnt(0)
    v_exp_f32 v244, v174
    v_mfma_f32_16x16x32_bf16 v[132:135], v[216:219], v[64:67], v[132:135]
    ds_read_b128 v[224:227], v246 offset:8832
    v_mfma_f32_16x16x32_bf16 v[132:135], v[220:223], v[80:83], v[132:135]
    ds_read_b128 v[228:231], v246 offset:8896
    v_mfma_f32_16x16x32_bf16 v[140:143], v[216:219], v[68:71], v[140:143]
    v_exp_f32 v245, v175
    v_mfma_f32_16x16x32_bf16 v[140:143], v[220:223], v[84:87], v[140:143]
    v_add_f32 v237, v237, v244
    v_add_f32 v237, v237, v245
    v_mfma_f32_16x16x32_bf16 v[148:151], v[216:219], v[72:75], v[148:151]
    v_cvt_pk_bf16_f32 v199, v244, v245
    v_mfma_f32_16x16x32_bf16 v[148:151], v[220:223], v[88:91], v[148:151]
    v_mfma_f32_16x16x32_bf16 v[156:159], v[216:219], v[76:79], v[156:159]
    v_mfma_f32_16x16x32_bf16 v[156:159], v[220:223], v[92:95], v[156:159]
    s_waitcnt lgkmcnt(0)
    v_mfma_f32_16x16x32_bf16 v[132:135], v[224:227], v[96:99], v[132:135]
    ds_read_b64_tr_b16 v[216:217], v247 offset:0
    v_mfma_f32_16x16x32_bf16 v[132:135], v[228:231], v[112:115], v[132:135]
    ds_read_b64_tr_b16 v[218:219], v247 offset:8448
    v_mfma_f32_16x16x32_bf16 v[140:143], v[224:227], v[100:103], v[140:143]
    ds_read_b64_tr_b16 v[220:221], v247 offset:32
    v_max_f32 v249, v236, v237
    v_mfma_f32_16x16x32_bf16 v[140:143], v[228:231], v[116:119], v[140:143]
    ds_read_b64_tr_b16 v[222:223], v247 offset:8480
    v_cmp_lt_f32 vcc, s37, v249
    v_mfma_f32_16x16x32_bf16 v[148:151], v[224:227], v[104:107], v[148:151]
    v_mfma_f32_16x16x32_bf16 v[148:151], v[228:231], v[120:123], v[148:151]
    v_mfma_f32_16x16x32_bf16 v[156:159], v[224:227], v[108:111], v[156:159]
    v_mfma_f32_16x16x32_bf16 v[156:159], v[228:231], v[124:127], v[156:159]
    s_waitcnt lgkmcnt(2)
    s_cbranch_vccnz S_R1_P29
R1_P29:
    s_waitcnt vmcnt(7)
    s_barrier
    v_mfma_f32_16x16x32_bf16 a[0:3], v[216:219], v[184:187], a[0:3]
    ds_read_b64_tr_b16 v[224:225], v247 offset:64
    v_add_f32 v234, v234, v236
    v_mfma_f32_16x16x32_bf16 a[4:7], v[216:219], v[188:191], a[4:7]
    ds_read_b64_tr_b16 v[226:227], v247 offset:8512
    v_add_f32 v235, v235, v237
    v_mfma_f32_16x16x32_bf16 a[8:11], v[216:219], v[192:195], a[8:11]
    ds_read_b64_tr_b16 v[228:229], v247 offset:96
    v_mfma_f32_16x16x32_bf16 a[12:15], v[216:219], v[196:199], a[12:15]
    s_waitcnt lgkmcnt(3)
    ds_read_b64_tr_b16 v[230:231], v247 offset:8544
    v_mfma_f32_16x16x32_bf16 a[16:19], v[220:223], v[184:187], a[16:19]
    ds_read_b64_tr_b16 v[216:217], v247 offset:128
    v_add_u32 v246, 0xfffe7400, v246
    v_mfma_f32_16x16x32_bf16 a[20:23], v[220:223], v[188:191], a[20:23]
    s_mov_b32 s41, 0x0
    s_add_u32 m0, s33, 101376
    ds_read_b64_tr_b16 v[218:219], v247 offset:8576
    v_mfma_f32_16x16x32_bf16 a[24:27], v[220:223], v[192:195], a[24:27]
    buffer_load_dwordx4 v252, s[24:27], s41 offen offset:0  lds
    v_mfma_f32_16x16x32_bf16 a[28:31], v[220:223], v[196:199], a[28:31]
    s_waitcnt lgkmcnt(4)
    v_exp_f32 v238, v128
    v_mfma_f32_16x16x32_bf16 a[32:35], v[224:227], v[184:187], a[32:35]
    ds_read_b64_tr_b16 v[220:221], v247 offset:160
    v_mfma_f32_16x16x32_bf16 a[36:39], v[224:227], v[188:191], a[36:39]
    ds_read_b64_tr_b16 v[222:223], v247 offset:8608
    v_mfma_f32_16x16x32_bf16 a[40:43], v[224:227], v[192:195], a[40:43]
    v_exp_f32 v239, v129
    v_mfma_f32_16x16x32_bf16 a[44:47], v[224:227], v[196:199], a[44:47]
    s_waitcnt lgkmcnt(4)
    v_add_f32 v236, v238, v239
    v_cvt_pk_bf16_f32 v176, v238, v239
    v_mfma_f32_16x16x32_bf16 a[48:51], v[228:231], v[184:187], a[48:51]
    ds_read_b64_tr_b16 v[224:225], v247 offset:192
    v_mfma_f32_16x16x32_bf16 a[52:55], v[228:231], v[188:191], a[52:55]
    ds_read_b64_tr_b16 v[226:227], v247 offset:8640
    v_mfma_f32_16x16x32_bf16 a[56:59], v[228:231], v[192:195], a[56:59]
    v_exp_f32 v240, v130
    v_mfma_f32_16x16x32_bf16 a[60:63], v[228:231], v[196:199], a[60:63]
    s_waitcnt lgkmcnt(4)
    v_exp_f32 v241, v131
    v_mfma_f32_16x16x32_bf16 a[64:67], v[216:219], v[184:187], a[64:67]
    ds_read_b64_tr_b16 v[228:229], v247 offset:224
    v_add_f32 v236, v236, v240
    v_mfma_f32_16x16x32_bf16 a[68:71], v[216:219], v[188:191], a[68:71]
    s_add_u32 m0, s33, 101536
    ds_read_b64_tr_b16 v[230:231], v247 offset:8672
    v_add_f32 v236, v236, v241
    v_mfma_f32_16x16x32_bf16 a[72:75], v[216:219], v[192:195], a[72:75]
    buffer_load_dwordx4 v252, s[24:27], s41 offen offset:896  lds
    v_mfma_f32_16x16x32_bf16 a[76:79], v[216:219], v[196:199], a[76:79]
    s_waitcnt lgkmcnt(4)
    v_cvt_pk_bf16_f32 v177, v240, v241
    v_mfma_f32_16x16x32_bf16 a[80:83], v[220:223], v[184:187], a[80:83]
    ds_read_b64_tr_b16 v[216:217], v247 offset:256
    v_mfma_f32_16x16x32_bf16 a[84:87], v[220:223], v[188:191], a[84:87]
    ds_read_b64_tr_b16 v[218:219], v247 offset:8704
    v_mfma_f32_16x16x32_bf16 a[88:91], v[220:223], v[192:195], a[88:91]
    v_exp_f32 v242, v136
    v_mfma_f32_16x16x32_bf16 a[92:95], v[220:223], v[196:199], a[92:95]
    s_waitcnt lgkmcnt(4)
    v_exp_f32 v243, v137
    v_mfma_f32_16x16x32_bf16 a[96:99], v[224:227], v[184:187], a[96:99]
    ds_read_b64_tr_b16 v[220:221], v247 offset:288
    v_add_f32 v237, v242, v243
    v_mfma_f32_16x16x32_bf16 a[100:103], v[224:227], v[188:191], a[100:103]
    ds_read_b64_tr_b16 v[222:223], v247 offset:8736
    v_cvt_pk_bf16_f32 v180, v242, v243
    v_mfma_f32_16x16x32_bf16 a[104:107], v[224:227], v[192:195], a[104:107]
    v_exp_f32 v244, v138
    v_mfma_f32_16x16x32_bf16 a[108:111], v[224:227], v[196:199], a[108:111]
    s_waitcnt lgkmcnt(4)
    v_exp_f32 v245, v139
    v_mfma_f32_16x16x32_bf16 a[112:115], v[228:231], v[184:187], a[112:115]
    ds_read_b64_tr_b16 v[224:225], v247 offset:320
    v_add_f32 v237, v237, v244
    v_mfma_f32_16x16x32_bf16 a[116:119], v[228:231], v[188:191], a[116:119]
    s_add_u32 m0, s33, 101696
    ds_read_b64_tr_b16 v[226:227], v247 offset:8768
    v_add_f32 v237, v237, v245
    v_mfma_f32_16x16x32_bf16 a[120:123], v[228:231], v[192:195], a[120:123]
    buffer_load_dwordx4 v252, s[24:27], s41 offen offset:1792  lds
    v_mfma_f32_16x16x32_bf16 a[124:127], v[228:231], v[196:199], a[124:127]
    s_waitcnt lgkmcnt(4)
    v_cvt_pk_bf16_f32 v181, v244, v245
    v_mfma_f32_16x16x32_bf16 a[128:131], v[216:219], v[184:187], a[128:131]
    ds_read_b64_tr_b16 v[228:229], v247 offset:352
    v_mfma_f32_16x16x32_bf16 a[132:135], v[216:219], v[188:191], a[132:135]
    ds_read_b64_tr_b16 v[230:231], v247 offset:8800
    v_mfma_f32_16x16x32_bf16 a[136:139], v[216:219], v[192:195], a[136:139]
    v_exp_f32 v238, v132
    v_mfma_f32_16x16x32_bf16 a[140:143], v[216:219], v[196:199], a[140:143]
    s_waitcnt lgkmcnt(4)
    v_exp_f32 v239, v133
    v_mfma_f32_16x16x32_bf16 a[144:147], v[220:223], v[184:187], a[144:147]
    ds_read_b64_tr_b16 v[216:217], v247 offset:384
    v_add_f32 v236, v236, v238
    v_mfma_f32_16x16x32_bf16 a[148:151], v[220:223], v[188:191], a[148:151]
    ds_read_b64_tr_b16 v[218:219], v247 offset:8832
    v_add_f32 v236, v236, v239
    v_mfma_f32_16x16x32_bf16 a[152:155], v[220:223], v[192:195], a[152:155]
    v_cvt_pk_bf16_f32 v178, v238, v239
    v_mfma_f32_16x16x32_bf16 a[156:159], v[220:223], v[196:199], a[156:159]
    s_waitcnt lgkmcnt(4)
    v_exp_f32 v240, v134
    v_mfma_f32_16x16x32_bf16 a[160:163], v[224:227], v[184:187], a[160:163]
    ds_read_b64_tr_b16 v[220:221], v247 offset:416
    v_mfma_f32_16x16x32_bf16 a[164:167], v[224:227], v[188:191], a[164:167]
    s_add_u32 m0, s33, 101856
    ds_read_b64_tr_b16 v[222:223], v247 offset:8864
    v_mfma_f32_16x16x32_bf16 a[168:171], v[224:227], v[192:195], a[168:171]
    buffer_load_dwordx4 v252, s[24:27], s41 offen offset:2688  lds
    v_mfma_f32_16x16x32_bf16 a[172:175], v[224:227], v[196:199], a[172:175]
    s_waitcnt lgkmcnt(4)
    v_exp_f32 v241, v135
    v_mfma_f32_16x16x32_bf16 a[176:179], v[228:231], v[184:187], a[176:179]
    ds_read_b64_tr_b16 v[224:225], v247 offset:448
    v_add_f32 v236, v236, v240
    v_mfma_f32_16x16x32_bf16 a[180:183], v[228:231], v[188:191], a[180:183]
    ds_read_b64_tr_b16 v[226:227], v247 offset:8896
    v_add_f32 v236, v236, v241
    v_mfma_f32_16x16x32_bf16 a[184:187], v[228:231], v[192:195], a[184:187]
    v_cvt_pk_bf16_f32 v179, v240, v241
    v_mfma_f32_16x16x32_bf16 a[188:191], v[228:231], v[196:199], a[188:191]
    s_waitcnt lgkmcnt(4)
    v_exp_f32 v242, v140
    v_mfma_f32_16x16x32_bf16 a[192:195], v[216:219], v[184:187], a[192:195]
    ds_read_b64_tr_b16 v[228:229], v247 offset:480
    v_mfma_f32_16x16x32_bf16 a[196:199], v[216:219], v[188:191], a[196:199]
    ds_read_b64_tr_b16 v[230:231], v247 offset:8928
    v_mfma_f32_16x16x32_bf16 a[200:203], v[216:219], v[192:195], a[200:203]
    v_exp_f32 v243, v141
    v_mfma_f32_16x16x32_bf16 a[204:207], v[216:219], v[196:199], a[204:207]
    s_waitcnt lgkmcnt(4)
    v_add_f32 v237, v237, v242
    v_add_f32 v237, v237, v243
    v_mfma_f32_16x16x32_bf16 a[208:211], v[220:223], v[184:187], a[208:211]
    v_add_u32 v247, 0x8400, v247
    v_cvt_pk_bf16_f32 v182, v242, v243
    v_mfma_f32_16x16x32_bf16 a[212:215], v[220:223], v[188:191], a[212:215]
    v_exp_f32 v244, v142
    v_mfma_f32_16x16x32_bf16 a[216:219], v[220:223], v[192:195], a[216:219]
    v_exp_f32 v245, v143
    v_mfma_f32_16x16x32_bf16 a[220:223], v[220:223], v[196:199], a[220:223]
    s_waitcnt lgkmcnt(2)
    v_add_f32 v237, v237, v244
    v_add_f32 v237, v237, v245
    v_mfma_f32_16x16x32_bf16 a[224:227], v[224:227], v[184:187], a[224:227]
    ds_read_b128 v[216:219], v246 offset:0
    v_cvt_pk_bf16_f32 v183, v244, v245
    v_mfma_f32_16x16x32_bf16 a[228:231], v[224:227], v[188:191], a[228:231]
    ds_read_b128 v[220:223], v246 offset:64
    v_mfma_f32_16x16x32_bf16 a[232:235], v[224:227], v[192:195], a[232:235]
    v_max_f32 v249, v236, v237
    v_mfma_f32_16x16x32_bf16 a[236:239], v[224:227], v[196:199], a[236:239]
    s_waitcnt lgkmcnt(2)
    v_cmp_lt_f32 vcc, s37, v249
    v_mfma_f32_16x16x32_bf16 a[240:243], v[228:231], v[184:187], a[240:243]
    v_mfma_f32_16x16x32_bf16 a[244:247], v[228:231], v[188:191], a[244:247]
    v_mfma_f32_16x16x32_bf16 a[248:251], v[228:231], v[192:195], a[248:251]
    v_mfma_f32_16x16x32_bf16 a[252:255], v[228:231], v[196:199], a[252:255]
    s_waitcnt lgkmcnt(0)
    s_cbranch_vccnz S_R2_P29
R2_P29:
    v_mfma_f32_16x16x32_bf16 v[128:131], v[216:219], v[0:3], v[200:203]
    ds_read_b128 v[224:227], v246 offset:128
    v_add_f32 v232, v232, v236
    v_mfma_f32_16x16x32_bf16 v[128:131], v[220:223], v[16:19], v[128:131]
    ds_read_b128 v[228:231], v246 offset:192
    v_add_f32 v233, v233, v237
    v_mfma_f32_16x16x32_bf16 v[136:139], v[216:219], v[4:7], v[204:207]
    v_exp_f32 v238, v144
    v_mfma_f32_16x16x32_bf16 v[136:139], v[220:223], v[20:23], v[136:139]
    v_exp_f32 v239, v145
    v_mfma_f32_16x16x32_bf16 v[160:163], v[216:219], v[8:11], v[208:211]
    v_add_f32 v236, v238, v239
    v_cvt_pk_bf16_f32 v192, v238, v239
    v_mfma_f32_16x16x32_bf16 v[160:163], v[220:223], v[24:27], v[160:163]
    v_mfma_f32_16x16x32_bf16 v[168:171], v[216:219], v[12:15], v[212:215]
    v_mfma_f32_16x16x32_bf16 v[168:171], v[220:223], v[28:31], v[168:171]
    s_waitcnt lgkmcnt(0)
    v_mfma_f32_16x16x32_bf16 v[128:131], v[224:227], v[32:35], v[128:131]
    ds_read_b128 v[216:219], v246 offset:256
    v_mfma_f32_16x16x32_bf16 v[128:131], v[228:231], v[48:51], v[128:131]
    s_mov_b32 s41, 0x1c000
    s_add_u32 m0, s33, 118272
    ds_read_b128 v[220:223], v246 offset:320
    v_mfma_f32_16x16x32_bf16 v[136:139], v[224:227], v[36:39], v[136:139]
    buffer_load_dwordx4 v252, s[24:27], s41 offen offset:0  lds
    v_mfma_f32_16x16x32_bf16 v[136:139], v[228:231], v[52:55], v[136:139]
    v_exp_f32 v240, v146
    v_mfma_f32_16x16x32_bf16 v[160:163], v[224:227], v[40:43], v[160:163]
    v_exp_f32 v241, v147
    v_mfma_f32_16x16x32_bf16 v[160:163], v[228:231], v[56:59], v[160:163]
    v_add_f32 v236, v236, v240
    v_add_f32 v236, v236, v241
    v_mfma_f32_16x16x32_bf16 v[168:171], v[224:227], v[44:47], v[168:171]
    v_cvt_pk_bf16_f32 v193, v240, v241
    v_mfma_f32_16x16x32_bf16 v[168:171], v[228:231], v[60:63], v[168:171]
    s_waitcnt lgkmcnt(0)
    v_exp_f32 v242, v152
    v_mfma_f32_16x16x32_bf16 v[128:131], v[216:219], v[64:67], v[128:131]
    ds_read_b128 v[224:227], v246 offset:384
    v_mfma_f32_16x16x32_bf16 v[128:131], v[220:223], v[80:83], v[128:131]
    ds_read_b128 v[228:231], v246 offset:448
    v_mfma_f32_16x16x32_bf16 v[136:139], v[216:219], v[68:71], v[136:139]
    v_exp_f32 v243, v153
    v_mfma_f32_16x16x32_bf16 v[136:139], v[220:223], v[84:87], v[136:139]
    v_add_f32 v237, v242, v243
    v_cvt_pk_bf16_f32 v196, v242, v243
    v_mfma_f32_16x16x32_bf16 v[160:163], v[216:219], v[72:75], v[160:163]
    s_add_u32 m0, s33, 118432
    v_mfma_f32_16x16x32_bf16 v[160:163], v[220:223], v[88:91], v[160:163]
    buffer_load_dwordx4 v252, s[24:27], s41 offen offset:896  lds
    v_mfma_f32_16x16x32_bf16 v[168:171], v[216:219], v[76:79], v[168:171]
    v_exp_f32 v244, v154
    v_mfma_f32_16x16x32_bf16 v[168:171], v[220:223], v[92:95], v[168:171]
    s_waitcnt lgkmcnt(0)
    v_exp_f32 v245, v155
    v_mfma_f32_16x16x32_bf16 v[128:131], v[224:227], v[96:99], v[128:131]
    ds_read_b128 v[216:219], v246 offset:8448
    v_add_f32 v237, v237, v244
    v_mfma_f32_16x16x32_bf16 v[128:131], v[228:231], v[112:115], v[128:131]
    ds_read_b128 v[220:223], v246 offset:8512
    v_add_f32 v237, v237, v245
    v_mfma_f32_16x16x32_bf16 v[136:139], v[224:227], v[100:103], v[136:139]
    v_cvt_pk_bf16_f32 v197, v244, v245
    v_mfma_f32_16x16x32_bf16 v[136:139], v[228:231], v[116:119], v[136:139]
    v_mfma_f32_16x16x32_bf16 v[160:163], v[224:227], v[104:107], v[160:163]
    v_exp_f32 v238, v148
    v_mfma_f32_16x16x32_bf16 v[160:163], v[228:231], v[120:123], v[160:163]
    v_exp_f32 v239, v149
    v_mfma_f32_16x16x32_bf16 v[168:171], v[224:227], v[108:111], v[168:171]
    v_add_f32 v236, v236, v238
    v_add_f32 v236, v236, v239
    v_mfma_f32_16x16x32_bf16 v[168:171], v[228:231], v[124:127], v[168:171]
    s_waitcnt lgkmcnt(0)
    v_cvt_pk_bf16_f32 v194, v238, v239
    v_mfma_f32_16x16x32_bf16 v[132:135], v[216:219], v[0:3], v[200:203]
    ds_read_b128 v[224:227], v246 offset:8576
    v_mfma_f32_16x16x32_bf16 v[132:135], v[220:223], v[16:19], v[132:135]
    s_add_u32 m0, s33, 118592
    ds_read_b128 v[228:231], v246 offset:8640
    v_mfma_f32_16x16x32_bf16 v[140:143], v[216:219], v[4:7], v[204:207]
    buffer_load_dwordx4 v252, s[24:27], s41 offen offset:1792  lds
    v_mfma_f32_16x16x32_bf16 v[140:143], v[220:223], v[20:23], v[140:143]
    v_exp_f32 v240, v150
    v_mfma_f32_16x16x32_bf16 v[164:167], v[216:219], v[8:11], v[208:211]
    v_exp_f32 v241, v151
    v_mfma_f32_16x16x32_bf16 v[164:167], v[220:223], v[24:27], v[164:167]
    v_add_f32 v236, v236, v240
    v_add_f32 v236, v236, v241
    v_mfma_f32_16x16x32_bf16 v[172:175], v[216:219], v[12:15], v[212:215]
    v_cvt_pk_bf16_f32 v195, v240, v241
    v_mfma_f32_16x16x32_bf16 v[172:175], v[220:223], v[28:31], v[172:175]
    s_waitcnt lgkmcnt(0)
    v_mfma_f32_16x16x32_bf16 v[132:135], v[224:227], v[32:35], v[132:135]
    ds_read_b128 v[216:219], v246 offset:8704
    v_mfma_f32_16x16x32_bf16 v[132:135], v[228:231], v[48:51], v[132:135]
    ds_read_b128 v[220:223], v246 offset:8768
    v_mfma_f32_16x16x32_bf16 v[140:143], v[224:227], v[36:39], v[140:143]
    v_exp_f32 v242, v156
    v_mfma_f32_16x16x32_bf16 v[140:143], v[228:231], v[52:55], v[140:143]
    v_exp_f32 v243, v157
    v_mfma_f32_16x16x32_bf16 v[164:167], v[224:227], v[40:43], v[164:167]
    s_add_u32 m0, s33, 118752
    v_add_f32 v237, v237, v242
    v_add_f32 v237, v237, v243
    v_mfma_f32_16x16x32_bf16 v[164:167], v[228:231], v[56:59], v[164:167]
    buffer_load_dwordx4 v252, s[24:27], s41 offen offset:2688  lds
    v_mfma_f32_16x16x32_bf16 v[172:175], v[224:227], v[44:47], v[172:175]
    v_cvt_pk_bf16_f32 v198, v242, v243
    v_mfma_f32_16x16x32_bf16 v[172:175], v[228:231], v[60:63], v[172:175]
    s_waitcnt lgkmcnt(0)
    v_exp_f32 v244, v158
    v_mfma_f32_16x16x32_bf16 v[132:135], v[216:219], v[64:67], v[132:135]
    ds_read_b128 v[224:227], v246 offset:8832
    v_mfma_f32_16x16x32_bf16 v[132:135], v[220:223], v[80:83], v[132:135]
    ds_read_b128 v[228:231], v246 offset:8896
    v_mfma_f32_16x16x32_bf16 v[140:143], v[216:219], v[68:71], v[140:143]
    v_exp_f32 v245, v159
    v_mfma_f32_16x16x32_bf16 v[140:143], v[220:223], v[84:87], v[140:143]
    v_add_f32 v237, v237, v244
    v_add_f32 v237, v237, v245
    v_mfma_f32_16x16x32_bf16 v[164:167], v[216:219], v[72:75], v[164:167]
    v_cvt_pk_bf16_f32 v199, v244, v245
    v_mfma_f32_16x16x32_bf16 v[164:167], v[220:223], v[88:91], v[164:167]
    v_mfma_f32_16x16x32_bf16 v[172:175], v[216:219], v[76:79], v[172:175]
    v_mfma_f32_16x16x32_bf16 v[172:175], v[220:223], v[92:95], v[172:175]
    s_waitcnt lgkmcnt(0)
    v_mfma_f32_16x16x32_bf16 v[132:135], v[224:227], v[96:99], v[132:135]
    ds_read_b64_tr_b16 v[216:217], v247 offset:0
    v_mfma_f32_16x16x32_bf16 v[132:135], v[228:231], v[112:115], v[132:135]
    ds_read_b64_tr_b16 v[218:219], v247 offset:8448
    v_mfma_f32_16x16x32_bf16 v[140:143], v[224:227], v[100:103], v[140:143]
    ds_read_b64_tr_b16 v[220:221], v247 offset:32
    v_max_f32 v249, v236, v237
    v_mfma_f32_16x16x32_bf16 v[140:143], v[228:231], v[116:119], v[140:143]
    ds_read_b64_tr_b16 v[222:223], v247 offset:8480
    v_cmp_lt_f32 vcc, s37, v249
    v_mfma_f32_16x16x32_bf16 v[164:167], v[224:227], v[104:107], v[164:167]
    v_mfma_f32_16x16x32_bf16 v[164:167], v[228:231], v[120:123], v[164:167]
    v_mfma_f32_16x16x32_bf16 v[172:175], v[224:227], v[108:111], v[172:175]
    v_mfma_f32_16x16x32_bf16 v[172:175], v[228:231], v[124:127], v[172:175]
    s_waitcnt lgkmcnt(2)
    s_cbranch_vccnz S_R1_P30
R1_P30:
    s_waitcnt vmcnt(8)
    s_barrier
    v_mfma_f32_16x16x32_bf16 a[0:3], v[216:219], v[176:179], a[0:3]
    ds_read_b64_tr_b16 v[224:225], v247 offset:64
    v_add_f32 v234, v234, v236
    v_mfma_f32_16x16x32_bf16 a[4:7], v[216:219], v[180:183], a[4:7]
    ds_read_b64_tr_b16 v[226:227], v247 offset:8512
    v_add_f32 v235, v235, v237
    v_mfma_f32_16x16x32_bf16 a[8:11], v[216:219], v[192:195], a[8:11]
    ds_read_b64_tr_b16 v[228:229], v247 offset:96
    v_mfma_f32_16x16x32_bf16 a[12:15], v[216:219], v[196:199], a[12:15]
    s_waitcnt lgkmcnt(3)
    ds_read_b64_tr_b16 v[230:231], v247 offset:8544
    v_mfma_f32_16x16x32_bf16 a[16:19], v[220:223], v[176:179], a[16:19]
    ds_read_b64_tr_b16 v[216:217], v247 offset:128
    v_mfma_f32_16x16x32_bf16 a[20:23], v[220:223], v[180:183], a[20:23]
    s_mov_b32 s41, 0x80
    s_add_u32 m0, s33, 0
    ds_read_b64_tr_b16 v[218:219], v247 offset:8576
    v_mfma_f32_16x16x32_bf16 a[24:27], v[220:223], v[192:195], a[24:27]
    buffer_load_dwordx4 v252, s[24:27], s41 offen offset:0  lds
    v_mfma_f32_16x16x32_bf16 a[28:31], v[220:223], v[196:199], a[28:31]
    s_waitcnt lgkmcnt(4)
    v_exp_f32 v238, v128
    v_mfma_f32_16x16x32_bf16 a[32:35], v[224:227], v[176:179], a[32:35]
    ds_read_b64_tr_b16 v[220:221], v247 offset:160
    v_mfma_f32_16x16x32_bf16 a[36:39], v[224:227], v[180:183], a[36:39]
    ds_read_b64_tr_b16 v[222:223], v247 offset:8608
    v_mfma_f32_16x16x32_bf16 a[40:43], v[224:227], v[192:195], a[40:43]
    v_exp_f32 v239, v129
    v_mfma_f32_16x16x32_bf16 a[44:47], v[224:227], v[196:199], a[44:47]
    s_waitcnt lgkmcnt(4)
    v_add_f32 v236, v238, v239
    v_cvt_pk_bf16_f32 v184, v238, v239
    v_mfma_f32_16x16x32_bf16 a[48:51], v[228:231], v[176:179], a[48:51]
    ds_read_b64_tr_b16 v[224:225], v247 offset:192
    v_mfma_f32_16x16x32_bf16 a[52:55], v[228:231], v[180:183], a[52:55]
    ds_read_b64_tr_b16 v[226:227], v247 offset:8640
    v_mfma_f32_16x16x32_bf16 a[56:59], v[228:231], v[192:195], a[56:59]
    v_exp_f32 v240, v130
    v_mfma_f32_16x16x32_bf16 a[60:63], v[228:231], v[196:199], a[60:63]
    s_waitcnt lgkmcnt(4)
    v_exp_f32 v241, v131
    v_mfma_f32_16x16x32_bf16 a[64:67], v[216:219], v[176:179], a[64:67]
    ds_read_b64_tr_b16 v[228:229], v247 offset:224
    v_add_f32 v236, v236, v240
    v_mfma_f32_16x16x32_bf16 a[68:71], v[216:219], v[180:183], a[68:71]
    s_add_u32 m0, s33, 160
    ds_read_b64_tr_b16 v[230:231], v247 offset:8672
    v_add_f32 v236, v236, v241
    v_mfma_f32_16x16x32_bf16 a[72:75], v[216:219], v[192:195], a[72:75]
    buffer_load_dwordx4 v252, s[24:27], s41 offen offset:896  lds
    v_mfma_f32_16x16x32_bf16 a[76:79], v[216:219], v[196:199], a[76:79]
    s_waitcnt lgkmcnt(4)
    v_cvt_pk_bf16_f32 v185, v240, v241
    v_mfma_f32_16x16x32_bf16 a[80:83], v[220:223], v[176:179], a[80:83]
    ds_read_b64_tr_b16 v[216:217], v247 offset:256
    v_mfma_f32_16x16x32_bf16 a[84:87], v[220:223], v[180:183], a[84:87]
    ds_read_b64_tr_b16 v[218:219], v247 offset:8704
    v_mfma_f32_16x16x32_bf16 a[88:91], v[220:223], v[192:195], a[88:91]
    v_exp_f32 v242, v136
    v_mfma_f32_16x16x32_bf16 a[92:95], v[220:223], v[196:199], a[92:95]
    s_waitcnt lgkmcnt(4)
    v_exp_f32 v243, v137
    v_mfma_f32_16x16x32_bf16 a[96:99], v[224:227], v[176:179], a[96:99]
    ds_read_b64_tr_b16 v[220:221], v247 offset:288
    v_add_f32 v237, v242, v243
    v_mfma_f32_16x16x32_bf16 a[100:103], v[224:227], v[180:183], a[100:103]
    ds_read_b64_tr_b16 v[222:223], v247 offset:8736
    v_cvt_pk_bf16_f32 v188, v242, v243
    v_mfma_f32_16x16x32_bf16 a[104:107], v[224:227], v[192:195], a[104:107]
    v_exp_f32 v244, v138
    v_mfma_f32_16x16x32_bf16 a[108:111], v[224:227], v[196:199], a[108:111]
    s_waitcnt lgkmcnt(4)
    v_exp_f32 v245, v139
    v_mfma_f32_16x16x32_bf16 a[112:115], v[228:231], v[176:179], a[112:115]
    ds_read_b64_tr_b16 v[224:225], v247 offset:320
    v_add_f32 v237, v237, v244
    v_mfma_f32_16x16x32_bf16 a[116:119], v[228:231], v[180:183], a[116:119]
    s_add_u32 m0, s33, 320
    ds_read_b64_tr_b16 v[226:227], v247 offset:8768
    v_add_f32 v237, v237, v245
    v_mfma_f32_16x16x32_bf16 a[120:123], v[228:231], v[192:195], a[120:123]
    buffer_load_dwordx4 v252, s[24:27], s41 offen offset:1792  lds
    v_mfma_f32_16x16x32_bf16 a[124:127], v[228:231], v[196:199], a[124:127]
    s_waitcnt lgkmcnt(4)
    v_cvt_pk_bf16_f32 v189, v244, v245
    v_mfma_f32_16x16x32_bf16 a[128:131], v[216:219], v[176:179], a[128:131]
    ds_read_b64_tr_b16 v[228:229], v247 offset:352
    v_mfma_f32_16x16x32_bf16 a[132:135], v[216:219], v[180:183], a[132:135]
    ds_read_b64_tr_b16 v[230:231], v247 offset:8800
    v_mfma_f32_16x16x32_bf16 a[136:139], v[216:219], v[192:195], a[136:139]
    v_exp_f32 v238, v132
    v_mfma_f32_16x16x32_bf16 a[140:143], v[216:219], v[196:199], a[140:143]
    s_waitcnt lgkmcnt(4)
    v_exp_f32 v239, v133
    v_mfma_f32_16x16x32_bf16 a[144:147], v[220:223], v[176:179], a[144:147]
    ds_read_b64_tr_b16 v[216:217], v247 offset:384
    v_add_f32 v236, v236, v238
    v_mfma_f32_16x16x32_bf16 a[148:151], v[220:223], v[180:183], a[148:151]
    ds_read_b64_tr_b16 v[218:219], v247 offset:8832
    v_add_f32 v236, v236, v239
    v_mfma_f32_16x16x32_bf16 a[152:155], v[220:223], v[192:195], a[152:155]
    v_cvt_pk_bf16_f32 v186, v238, v239
    v_mfma_f32_16x16x32_bf16 a[156:159], v[220:223], v[196:199], a[156:159]
    s_waitcnt lgkmcnt(4)
    v_exp_f32 v240, v134
    v_mfma_f32_16x16x32_bf16 a[160:163], v[224:227], v[176:179], a[160:163]
    ds_read_b64_tr_b16 v[220:221], v247 offset:416
    v_mfma_f32_16x16x32_bf16 a[164:167], v[224:227], v[180:183], a[164:167]
    s_add_u32 m0, s33, 480
    ds_read_b64_tr_b16 v[222:223], v247 offset:8864
    v_mfma_f32_16x16x32_bf16 a[168:171], v[224:227], v[192:195], a[168:171]
    buffer_load_dwordx4 v252, s[24:27], s41 offen offset:2688  lds
    v_mfma_f32_16x16x32_bf16 a[172:175], v[224:227], v[196:199], a[172:175]
    s_waitcnt lgkmcnt(4)
    v_exp_f32 v241, v135
    v_mfma_f32_16x16x32_bf16 a[176:179], v[228:231], v[176:179], a[176:179]
    ds_read_b64_tr_b16 v[224:225], v247 offset:448
    v_add_f32 v236, v236, v240
    v_mfma_f32_16x16x32_bf16 a[180:183], v[228:231], v[180:183], a[180:183]
    ds_read_b64_tr_b16 v[226:227], v247 offset:8896
    v_add_f32 v236, v236, v241
    v_mfma_f32_16x16x32_bf16 a[184:187], v[228:231], v[192:195], a[184:187]
    v_cvt_pk_bf16_f32 v187, v240, v241
    v_mfma_f32_16x16x32_bf16 a[188:191], v[228:231], v[196:199], a[188:191]
    s_waitcnt lgkmcnt(4)
    v_exp_f32 v242, v140
    v_mfma_f32_16x16x32_bf16 a[192:195], v[216:219], v[176:179], a[192:195]
    ds_read_b64_tr_b16 v[228:229], v247 offset:480
    v_mfma_f32_16x16x32_bf16 a[196:199], v[216:219], v[180:183], a[196:199]
    ds_read_b64_tr_b16 v[230:231], v247 offset:8928
    v_mfma_f32_16x16x32_bf16 a[200:203], v[216:219], v[192:195], a[200:203]
    v_exp_f32 v243, v141
    v_mfma_f32_16x16x32_bf16 a[204:207], v[216:219], v[196:199], a[204:207]
    s_waitcnt lgkmcnt(4)
    v_add_f32 v237, v237, v242
    v_add_f32 v237, v237, v243
    v_mfma_f32_16x16x32_bf16 a[208:211], v[220:223], v[176:179], a[208:211]
    v_add_u32 v247, 0x8400, v247
    v_cvt_pk_bf16_f32 v190, v242, v243
    v_mfma_f32_16x16x32_bf16 a[212:215], v[220:223], v[180:183], a[212:215]
    v_exp_f32 v244, v142
    v_mfma_f32_16x16x32_bf16 a[216:219], v[220:223], v[192:195], a[216:219]
    v_exp_f32 v245, v143
    v_mfma_f32_16x16x32_bf16 a[220:223], v[220:223], v[196:199], a[220:223]
    s_waitcnt lgkmcnt(2)
    v_add_f32 v237, v237, v244
    v_add_f32 v237, v237, v245
    v_mfma_f32_16x16x32_bf16 a[224:227], v[224:227], v[176:179], a[224:227]
    v_cvt_pk_bf16_f32 v191, v244, v245
    v_mfma_f32_16x16x32_bf16 a[228:231], v[224:227], v[180:183], a[228:231]
    v_mfma_f32_16x16x32_bf16 a[232:235], v[224:227], v[192:195], a[232:235]
    v_max_f32 v249, v236, v237
    v_mfma_f32_16x16x32_bf16 a[236:239], v[224:227], v[196:199], a[236:239]
    s_waitcnt lgkmcnt(0)
    v_cmp_lt_f32 vcc, s37, v249
    v_mfma_f32_16x16x32_bf16 a[240:243], v[228:231], v[176:179], a[240:243]
    v_mfma_f32_16x16x32_bf16 a[244:247], v[228:231], v[180:183], a[244:247]
    v_mfma_f32_16x16x32_bf16 a[248:251], v[228:231], v[192:195], a[248:251]
    v_mfma_f32_16x16x32_bf16 a[252:255], v[228:231], v[196:199], a[252:255]
    s_cbranch_vccnz S_R2_P30
R2_P30:
    v_add_f32 v232, v232, v236
    v_add_f32 v233, v233, v237
    s_mov_b32 s41, 0x1c080
    s_add_u32 m0, s33, 16896
    s_nop 0
    buffer_load_dwordx4 v252, s[24:27], s41 offen offset:0  lds
    s_add_u32 m0, s33, 17056
    s_nop 0
    buffer_load_dwordx4 v252, s[24:27], s41 offen offset:896  lds
    s_add_u32 m0, s33, 17216
    s_nop 0
    buffer_load_dwordx4 v252, s[24:27], s41 offen offset:1792  lds
    s_add_u32 m0, s33, 17376
    s_nop 0
    buffer_load_dwordx4 v252, s[24:27], s41 offen offset:2688  lds
    ds_read_b64_tr_b16 v[216:217], v247 offset:0
    ds_read_b64_tr_b16 v[218:219], v247 offset:8448
    ds_read_b64_tr_b16 v[220:221], v247 offset:32
    ds_read_b64_tr_b16 v[222:223], v247 offset:8480
    v_exp_f32 v238, v160
    v_exp_f32 v239, v161
    s_nop 0
    v_add_f32 v236, v238, v239
    v_cvt_pk_bf16_f32 v192, v238, v239
    v_exp_f32 v240, v162
    v_exp_f32 v241, v163
    s_nop 0
    v_add_f32 v236, v236, v240
    v_add_f32 v236, v236, v241
    v_cvt_pk_bf16_f32 v193, v240, v241
    v_exp_f32 v242, v168
    v_exp_f32 v243, v169
    s_nop 0
    v_add_f32 v237, v242, v243
    v_cvt_pk_bf16_f32 v196, v242, v243
    v_exp_f32 v244, v170
    v_exp_f32 v245, v171
    s_nop 0
    v_add_f32 v237, v237, v244
    v_add_f32 v237, v237, v245
    v_cvt_pk_bf16_f32 v197, v244, v245
    v_exp_f32 v238, v164
    v_exp_f32 v239, v165
    s_nop 0
    v_add_f32 v236, v236, v238
    v_add_f32 v236, v236, v239
    v_cvt_pk_bf16_f32 v194, v238, v239
    v_exp_f32 v240, v166
    v_exp_f32 v241, v167
    s_nop 0
    v_add_f32 v236, v236, v240
    v_add_f32 v236, v236, v241
    v_cvt_pk_bf16_f32 v195, v240, v241
    v_exp_f32 v242, v172
    v_exp_f32 v243, v173
    s_nop 0
    v_add_f32 v237, v237, v242
    v_add_f32 v237, v237, v243
    v_cvt_pk_bf16_f32 v198, v242, v243
    v_exp_f32 v244, v174
    v_exp_f32 v245, v175
    s_nop 0
    v_add_f32 v237, v237, v244
    v_add_f32 v237, v237, v245
    v_cvt_pk_bf16_f32 v199, v244, v245
    v_max_f32 v249, v236, v237
    v_cmp_lt_f32 vcc, s37, v249
    s_waitcnt lgkmcnt(2)
    s_cbranch_vccnz S_R1_P31
R1_P31:
    s_waitcnt vmcnt(12)
    s_barrier
    v_mfma_f32_16x16x32_bf16 a[0:3], v[216:219], v[184:187], a[0:3]
    ds_read_b64_tr_b16 v[224:225], v247 offset:64
    v_add_f32 v234, v234, v236
    v_mfma_f32_16x16x32_bf16 a[4:7], v[216:219], v[188:191], a[4:7]
    ds_read_b64_tr_b16 v[226:227], v247 offset:8512
    v_add_f32 v235, v235, v237
    v_mfma_f32_16x16x32_bf16 a[8:11], v[216:219], v[192:195], a[8:11]
    ds_read_b64_tr_b16 v[228:229], v247 offset:96
    v_mfma_f32_16x16x32_bf16 a[12:15], v[216:219], v[196:199], a[12:15]
    s_waitcnt lgkmcnt(3)
    ds_read_b64_tr_b16 v[230:231], v247 offset:8544
    v_mfma_f32_16x16x32_bf16 a[16:19], v[220:223], v[184:187], a[16:19]
    ds_read_b64_tr_b16 v[216:217], v247 offset:128
    v_mfma_f32_16x16x32_bf16 a[20:23], v[220:223], v[188:191], a[20:23]
    s_mov_b32 s41, 0x100
    s_add_u32 m0, s33, 33792
    ds_read_b64_tr_b16 v[218:219], v247 offset:8576
    v_mfma_f32_16x16x32_bf16 a[24:27], v[220:223], v[192:195], a[24:27]
    buffer_load_dwordx4 v252, s[24:27], s41 offen offset:0  lds
    v_mfma_f32_16x16x32_bf16 a[28:31], v[220:223], v[196:199], a[28:31]
    s_waitcnt lgkmcnt(4)
    v_mfma_f32_16x16x32_bf16 a[32:35], v[224:227], v[184:187], a[32:35]
    ds_read_b64_tr_b16 v[220:221], v247 offset:160
    v_mfma_f32_16x16x32_bf16 a[36:39], v[224:227], v[188:191], a[36:39]
    ds_read_b64_tr_b16 v[222:223], v247 offset:8608
    v_mfma_f32_16x16x32_bf16 a[40:43], v[224:227], v[192:195], a[40:43]
    v_mfma_f32_16x16x32_bf16 a[44:47], v[224:227], v[196:199], a[44:47]
    s_waitcnt lgkmcnt(4)
    v_mfma_f32_16x16x32_bf16 a[48:51], v[228:231], v[184:187], a[48:51]
    ds_read_b64_tr_b16 v[224:225], v247 offset:192
    v_mfma_f32_16x16x32_bf16 a[52:55], v[228:231], v[188:191], a[52:55]
    ds_read_b64_tr_b16 v[226:227], v247 offset:8640
    v_mfma_f32_16x16x32_bf16 a[56:59], v[228:231], v[192:195], a[56:59]
    v_mfma_f32_16x16x32_bf16 a[60:63], v[228:231], v[196:199], a[60:63]
    s_waitcnt lgkmcnt(4)
    v_mfma_f32_16x16x32_bf16 a[64:67], v[216:219], v[184:187], a[64:67]
    ds_read_b64_tr_b16 v[228:229], v247 offset:224
    v_mfma_f32_16x16x32_bf16 a[68:71], v[216:219], v[188:191], a[68:71]
    s_add_u32 m0, s33, 33952
    ds_read_b64_tr_b16 v[230:231], v247 offset:8672
    v_mfma_f32_16x16x32_bf16 a[72:75], v[216:219], v[192:195], a[72:75]
    buffer_load_dwordx4 v252, s[24:27], s41 offen offset:896  lds
    v_mfma_f32_16x16x32_bf16 a[76:79], v[216:219], v[196:199], a[76:79]
    s_waitcnt lgkmcnt(4)
    v_mfma_f32_16x16x32_bf16 a[80:83], v[220:223], v[184:187], a[80:83]
    ds_read_b64_tr_b16 v[216:217], v247 offset:256
    v_mfma_f32_16x16x32_bf16 a[84:87], v[220:223], v[188:191], a[84:87]
    ds_read_b64_tr_b16 v[218:219], v247 offset:8704
    v_mfma_f32_16x16x32_bf16 a[88:91], v[220:223], v[192:195], a[88:91]
    v_mfma_f32_16x16x32_bf16 a[92:95], v[220:223], v[196:199], a[92:95]
    s_waitcnt lgkmcnt(4)
    v_mfma_f32_16x16x32_bf16 a[96:99], v[224:227], v[184:187], a[96:99]
    ds_read_b64_tr_b16 v[220:221], v247 offset:288
    v_mfma_f32_16x16x32_bf16 a[100:103], v[224:227], v[188:191], a[100:103]
    ds_read_b64_tr_b16 v[222:223], v247 offset:8736
    v_mfma_f32_16x16x32_bf16 a[104:107], v[224:227], v[192:195], a[104:107]
    v_mfma_f32_16x16x32_bf16 a[108:111], v[224:227], v[196:199], a[108:111]
    s_waitcnt lgkmcnt(4)
    v_mfma_f32_16x16x32_bf16 a[112:115], v[228:231], v[184:187], a[112:115]
    ds_read_b64_tr_b16 v[224:225], v247 offset:320
    v_mfma_f32_16x16x32_bf16 a[116:119], v[228:231], v[188:191], a[116:119]
    s_add_u32 m0, s33, 34112
    ds_read_b64_tr_b16 v[226:227], v247 offset:8768
    v_mfma_f32_16x16x32_bf16 a[120:123], v[228:231], v[192:195], a[120:123]
    buffer_load_dwordx4 v252, s[24:27], s41 offen offset:1792  lds
    v_mfma_f32_16x16x32_bf16 a[124:127], v[228:231], v[196:199], a[124:127]
    s_waitcnt lgkmcnt(4)
    v_mfma_f32_16x16x32_bf16 a[128:131], v[216:219], v[184:187], a[128:131]
    ds_read_b64_tr_b16 v[228:229], v247 offset:352
    v_mfma_f32_16x16x32_bf16 a[132:135], v[216:219], v[188:191], a[132:135]
    ds_read_b64_tr_b16 v[230:231], v247 offset:8800
    v_mfma_f32_16x16x32_bf16 a[136:139], v[216:219], v[192:195], a[136:139]
    v_mfma_f32_16x16x32_bf16 a[140:143], v[216:219], v[196:199], a[140:143]
    s_waitcnt lgkmcnt(4)
    v_mfma_f32_16x16x32_bf16 a[144:147], v[220:223], v[184:187], a[144:147]
    ds_read_b64_tr_b16 v[216:217], v247 offset:384
    v_mfma_f32_16x16x32_bf16 a[148:151], v[220:223], v[188:191], a[148:151]
    ds_read_b64_tr_b16 v[218:219], v247 offset:8832
    v_mfma_f32_16x16x32_bf16 a[152:155], v[220:223], v[192:195], a[152:155]
    v_mfma_f32_16x16x32_bf16 a[156:159], v[220:223], v[196:199], a[156:159]
    s_waitcnt lgkmcnt(4)
    v_mfma_f32_16x16x32_bf16 a[160:163], v[224:227], v[184:187], a[160:163]
    ds_read_b64_tr_b16 v[220:221], v247 offset:416
    v_mfma_f32_16x16x32_bf16 a[164:167], v[224:227], v[188:191], a[164:167]
    s_add_u32 m0, s33, 34272
    ds_read_b64_tr_b16 v[222:223], v247 offset:8864
    v_mfma_f32_16x16x32_bf16 a[168:171], v[224:227], v[192:195], a[168:171]
    buffer_load_dwordx4 v252, s[24:27], s41 offen offset:2688  lds
    v_mfma_f32_16x16x32_bf16 a[172:175], v[224:227], v[196:199], a[172:175]
    s_waitcnt lgkmcnt(4)
    v_mfma_f32_16x16x32_bf16 a[176:179], v[228:231], v[184:187], a[176:179]
    ds_read_b64_tr_b16 v[224:225], v247 offset:448
    v_mfma_f32_16x16x32_bf16 a[180:183], v[228:231], v[188:191], a[180:183]
    s_mov_b32 s41, 0x1c100
    s_add_u32 m0, s33, 50688
    ds_read_b64_tr_b16 v[226:227], v247 offset:8896
    v_mfma_f32_16x16x32_bf16 a[184:187], v[228:231], v[192:195], a[184:187]
    buffer_load_dwordx4 v252, s[24:27], s41 offen offset:0  lds
    v_mfma_f32_16x16x32_bf16 a[188:191], v[228:231], v[196:199], a[188:191]
    s_waitcnt lgkmcnt(4)
    v_mfma_f32_16x16x32_bf16 a[192:195], v[216:219], v[184:187], a[192:195]
    ds_read_b64_tr_b16 v[228:229], v247 offset:480
    v_mfma_f32_16x16x32_bf16 a[196:199], v[216:219], v[188:191], a[196:199]
    s_add_u32 m0, s33, 50848
    ds_read_b64_tr_b16 v[230:231], v247 offset:8928
    v_mfma_f32_16x16x32_bf16 a[200:203], v[216:219], v[192:195], a[200:203]
    buffer_load_dwordx4 v252, s[24:27], s41 offen offset:896  lds
    v_mfma_f32_16x16x32_bf16 a[204:207], v[216:219], v[196:199], a[204:207]
    s_waitcnt lgkmcnt(4)
    v_mfma_f32_16x16x32_bf16 a[208:211], v[220:223], v[184:187], a[208:211]
    v_mfma_f32_16x16x32_bf16 a[212:215], v[220:223], v[188:191], a[212:215]
    s_add_u32 m0, s33, 51008
    v_mfma_f32_16x16x32_bf16 a[216:219], v[220:223], v[192:195], a[216:219]
    buffer_load_dwordx4 v252, s[24:27], s41 offen offset:1792  lds
    v_mfma_f32_16x16x32_bf16 a[220:223], v[220:223], v[196:199], a[220:223]
    s_waitcnt lgkmcnt(2)
    v_mfma_f32_16x16x32_bf16 a[224:227], v[224:227], v[184:187], a[224:227]
    v_mfma_f32_16x16x32_bf16 a[228:231], v[224:227], v[188:191], a[228:231]
    s_add_u32 m0, s33, 51168
    v_mfma_f32_16x16x32_bf16 a[232:235], v[224:227], v[192:195], a[232:235]
    buffer_load_dwordx4 v252, s[24:27], s41 offen offset:2688  lds
    v_mfma_f32_16x16x32_bf16 a[236:239], v[224:227], v[196:199], a[236:239]
    s_waitcnt lgkmcnt(0)
    v_mfma_f32_16x16x32_bf16 a[240:243], v[228:231], v[184:187], a[240:243]
    v_mfma_f32_16x16x32_bf16 a[244:247], v[228:231], v[188:191], a[244:247]
    v_mfma_f32_16x16x32_bf16 a[248:251], v[228:231], v[192:195], a[248:251]
    v_mfma_f32_16x16x32_bf16 a[252:255], v[228:231], v[196:199], a[252:255]
    buffer_load_dwordx4 v[176:179], off, s[48:51], 0 sc1
    v_mul_u32_u24 v180, 896, v250
    v_lshlrev_b32 v181, 7, v250
    s_add_u32 s6, s32, 3
    s_lshl_b32 s6, s6, 7
    s_lshl_b32 s7, s32, 18
    s_lshl_b32 s5, s46, 14
    s_add_u32 s7, s7, s5
    s_add_u32 s5, s7, 0x0
    buffer_load_dword v182, v181, s[28:31], s5 offen
    s_add_u32 s5, s7, 0x2000
    buffer_load_dword v183, v181, s[28:31], s5 offen
    s_bfe_u32 s5, s64, 0x10007
    s_mul_i32 s5, s5, 114688
    s_add_u32 s6, s6, s5
    s_add_u32 s5, s6, 0x0
    buffer_load_dword v184, v180, s[24:27], s5 offen
    s_add_u32 s5, s6, 0xe000
    buffer_load_dword v185, v180, s[24:27], s5 offen
    v_mov_b32 v238, v232
    v_mov_b32 v239, v233
    v_mov_b32 v240, v234
    v_mov_b32 v241, v235
    v_permlane16_swap_b32 v232, v238
    v_permlane16_swap_b32 v233, v239
    v_permlane16_swap_b32 v234, v240
    v_permlane16_swap_b32 v235, v241
    s_nop 0
    v_add_f32 v232, v232, v238
    v_add_f32 v233, v233, v239
    v_add_f32 v234, v234, v240
    v_add_f32 v235, v235, v241
    v_mov_b32 v238, v232
    v_mov_b32 v239, v233
    v_mov_b32 v240, v234
    v_mov_b32 v241, v235
    v_permlane32_swap_b32 v232, v238
    v_permlane32_swap_b32 v233, v239
    v_permlane32_swap_b32 v234, v240
    v_permlane32_swap_b32 v235, v241
    s_nop 0
    v_add_f32 v232, v232, v238
    v_add_f32 v233, v233, v239
    v_add_f32 v234, v234, v240
    v_add_f32 v235, v235, v241
    v_rcp_f32 v232, v232
    v_rcp_f32 v233, v233
    v_rcp_f32 v234, v234
    v_rcp_f32 v235, v235
    v_add_u32 v254, 0x18c00, v251
    s_nop 4
    v_accvgpr_read_b32 v238, a0
    v_accvgpr_read_b32 v239, a1
    v_mul_f32 v238, v232, v238
    v_mul_f32 v239, v232, v239
    v_cvt_pk_bf16_f32 v0, v238, v239
    v_accvgpr_read_b32 v240, a2
    v_accvgpr_read_b32 v241, a3
    v_mul_f32 v240, v232, v240
    v_mul_f32 v241, v232, v241
    v_cvt_pk_bf16_f32 v1, v240, v241
    v_accvgpr_read_b32 v242, a16
    v_accvgpr_read_b32 v243, a17
    v_mul_f32 v242, v232, v242
    v_mul_f32 v243, v232, v243
    v_cvt_pk_bf16_f32 v2, v242, v243
    v_accvgpr_read_b32 v244, a18
    v_accvgpr_read_b32 v245, a19
    v_mul_f32 v244, v232, v244
    v_mul_f32 v245, v232, v245
    v_cvt_pk_bf16_f32 v3, v244, v245
    v_accvgpr_read_b32 v238, a4
    v_accvgpr_read_b32 v239, a5
    v_mul_f32 v238, v233, v238
    v_mul_f32 v239, v233, v239
    v_cvt_pk_bf16_f32 v4, v238, v239
    v_accvgpr_read_b32 v240, a6
    v_accvgpr_read_b32 v241, a7
    v_mul_f32 v240, v233, v240
    v_mul_f32 v241, v233, v241
    v_cvt_pk_bf16_f32 v5, v240, v241
    v_accvgpr_read_b32 v242, a20
    v_accvgpr_read_b32 v243, a21
    v_mul_f32 v242, v233, v242
    v_mul_f32 v243, v233, v243
    v_cvt_pk_bf16_f32 v6, v242, v243
    v_accvgpr_read_b32 v244, a22
    v_accvgpr_read_b32 v245, a23
    v_mul_f32 v244, v233, v244
    v_mul_f32 v245, v233, v245
    v_cvt_pk_bf16_f32 v7, v244, v245
    v_accvgpr_read_b32 v238, a8
    v_accvgpr_read_b32 v239, a9
    v_mul_f32 v238, v234, v238
    v_mul_f32 v239, v234, v239
    v_cvt_pk_bf16_f32 v8, v238, v239
    v_accvgpr_read_b32 v240, a10
    v_accvgpr_read_b32 v241, a11
    v_mul_f32 v240, v234, v240
    v_mul_f32 v241, v234, v241
    v_cvt_pk_bf16_f32 v9, v240, v241
    v_accvgpr_read_b32 v242, a24
    v_accvgpr_read_b32 v243, a25
    v_mul_f32 v242, v234, v242
    v_mul_f32 v243, v234, v243
    v_cvt_pk_bf16_f32 v10, v242, v243
    v_accvgpr_read_b32 v244, a26
    v_accvgpr_read_b32 v245, a27
    v_mul_f32 v244, v234, v244
    v_mul_f32 v245, v234, v245
    v_cvt_pk_bf16_f32 v11, v244, v245
    v_accvgpr_read_b32 v238, a12
    v_accvgpr_read_b32 v239, a13
    v_mul_f32 v238, v235, v238
    v_mul_f32 v239, v235, v239
    v_cvt_pk_bf16_f32 v12, v238, v239
    v_accvgpr_read_b32 v240, a14
    v_accvgpr_read_b32 v241, a15
    v_mul_f32 v240, v235, v240
    v_mul_f32 v241, v235, v241
    v_cvt_pk_bf16_f32 v13, v240, v241
    v_accvgpr_read_b32 v242, a28
    v_accvgpr_read_b32 v243, a29
    v_mul_f32 v242, v235, v242
    v_mul_f32 v243, v235, v243
    v_cvt_pk_bf16_f32 v14, v242, v243
    v_accvgpr_read_b32 v244, a30
    v_accvgpr_read_b32 v245, a31
    v_mul_f32 v244, v235, v244
    v_mul_f32 v245, v235, v245
    v_cvt_pk_bf16_f32 v15, v244, v245
    v_accvgpr_read_b32 v238, a32
    v_accvgpr_read_b32 v239, a33
    v_mul_f32 v238, v232, v238
    v_mul_f32 v239, v232, v239
    v_cvt_pk_bf16_f32 v16, v238, v239
    v_accvgpr_read_b32 v240, a34
    v_accvgpr_read_b32 v241, a35
    v_mul_f32 v240, v232, v240
    v_mul_f32 v241, v232, v241
    v_cvt_pk_bf16_f32 v17, v240, v241
    v_accvgpr_read_b32 v242, a48
    v_accvgpr_read_b32 v243, a49
    v_mul_f32 v242, v232, v242
    v_mul_f32 v243, v232, v243
    v_cvt_pk_bf16_f32 v18, v242, v243
    v_accvgpr_read_b32 v244, a50
    v_accvgpr_read_b32 v245, a51
    v_mul_f32 v244, v232, v244
    v_mul_f32 v245, v232, v245
    v_cvt_pk_bf16_f32 v19, v244, v245
    v_accvgpr_read_b32 v238, a36
    v_accvgpr_read_b32 v239, a37
    v_mul_f32 v238, v233, v238
    v_mul_f32 v239, v233, v239
    v_cvt_pk_bf16_f32 v20, v238, v239
    v_accvgpr_read_b32 v240, a38
    v_accvgpr_read_b32 v241, a39
    v_mul_f32 v240, v233, v240
    v_mul_f32 v241, v233, v241
    v_cvt_pk_bf16_f32 v21, v240, v241
    v_accvgpr_read_b32 v242, a52
    v_accvgpr_read_b32 v243, a53
    v_mul_f32 v242, v233, v242
    v_mul_f32 v243, v233, v243
    v_cvt_pk_bf16_f32 v22, v242, v243
    v_accvgpr_read_b32 v244, a54
    v_accvgpr_read_b32 v245, a55
    v_mul_f32 v244, v233, v244
    v_mul_f32 v245, v233, v245
    v_cvt_pk_bf16_f32 v23, v244, v245
    v_accvgpr_read_b32 v238, a40
    v_accvgpr_read_b32 v239, a41
    v_mul_f32 v238, v234, v238
    v_mul_f32 v239, v234, v239
    v_cvt_pk_bf16_f32 v24, v238, v239
    v_accvgpr_read_b32 v240, a42
    v_accvgpr_read_b32 v241, a43
    v_mul_f32 v240, v234, v240
    v_mul_f32 v241, v234, v241
    v_cvt_pk_bf16_f32 v25, v240, v241
    v_accvgpr_read_b32 v242, a56
    v_accvgpr_read_b32 v243, a57
    v_mul_f32 v242, v234, v242
    v_mul_f32 v243, v234, v243
    v_cvt_pk_bf16_f32 v26, v242, v243
    v_accvgpr_read_b32 v244, a58
    v_accvgpr_read_b32 v245, a59
    v_mul_f32 v244, v234, v244
    v_mul_f32 v245, v234, v245
    v_cvt_pk_bf16_f32 v27, v244, v245
    v_accvgpr_read_b32 v238, a44
    v_accvgpr_read_b32 v239, a45
    v_mul_f32 v238, v235, v238
    v_mul_f32 v239, v235, v239
    v_cvt_pk_bf16_f32 v28, v238, v239
    v_accvgpr_read_b32 v240, a46
    v_accvgpr_read_b32 v241, a47
    v_mul_f32 v240, v235, v240
    v_mul_f32 v241, v235, v241
    v_cvt_pk_bf16_f32 v29, v240, v241
    v_accvgpr_read_b32 v242, a60
    v_accvgpr_read_b32 v243, a61
    v_mul_f32 v242, v235, v242
    v_mul_f32 v243, v235, v243
    v_cvt_pk_bf16_f32 v30, v242, v243
    v_accvgpr_read_b32 v244, a62
    v_accvgpr_read_b32 v245, a63
    v_mul_f32 v244, v235, v244
    v_mul_f32 v245, v235, v245
    v_cvt_pk_bf16_f32 v31, v244, v245
    v_accvgpr_read_b32 v238, a64
    v_accvgpr_read_b32 v239, a65
    v_mul_f32 v238, v232, v238
    v_mul_f32 v239, v232, v239
    v_cvt_pk_bf16_f32 v32, v238, v239
    v_accvgpr_read_b32 v240, a66
    v_accvgpr_read_b32 v241, a67
    v_mul_f32 v240, v232, v240
    v_mul_f32 v241, v232, v241
    v_cvt_pk_bf16_f32 v33, v240, v241
    v_accvgpr_read_b32 v242, a80
    v_accvgpr_read_b32 v243, a81
    v_mul_f32 v242, v232, v242
    v_mul_f32 v243, v232, v243
    v_cvt_pk_bf16_f32 v34, v242, v243
    v_accvgpr_read_b32 v244, a82
    v_accvgpr_read_b32 v245, a83
    v_mul_f32 v244, v232, v244
    v_mul_f32 v245, v232, v245
    v_cvt_pk_bf16_f32 v35, v244, v245
    v_accvgpr_read_b32 v238, a68
    v_accvgpr_read_b32 v239, a69
    v_mul_f32 v238, v233, v238
    v_mul_f32 v239, v233, v239
    v_cvt_pk_bf16_f32 v36, v238, v239
    v_accvgpr_read_b32 v240, a70
    v_accvgpr_read_b32 v241, a71
    v_mul_f32 v240, v233, v240
    v_mul_f32 v241, v233, v241
    v_cvt_pk_bf16_f32 v37, v240, v241
    v_accvgpr_read_b32 v242, a84
    v_accvgpr_read_b32 v243, a85
    v_mul_f32 v242, v233, v242
    v_mul_f32 v243, v233, v243
    v_cvt_pk_bf16_f32 v38, v242, v243
    v_accvgpr_read_b32 v244, a86
    v_accvgpr_read_b32 v245, a87
    v_mul_f32 v244, v233, v244
    v_mul_f32 v245, v233, v245
    v_cvt_pk_bf16_f32 v39, v244, v245
    v_accvgpr_read_b32 v238, a72
    v_accvgpr_read_b32 v239, a73
    v_mul_f32 v238, v234, v238
    v_mul_f32 v239, v234, v239
    v_cvt_pk_bf16_f32 v40, v238, v239
    v_accvgpr_read_b32 v240, a74
    v_accvgpr_read_b32 v241, a75
    v_mul_f32 v240, v234, v240
    v_mul_f32 v241, v234, v241
    v_cvt_pk_bf16_f32 v41, v240, v241
    v_accvgpr_read_b32 v242, a88
    v_accvgpr_read_b32 v243, a89
    v_mul_f32 v242, v234, v242
    v_mul_f32 v243, v234, v243
    v_cvt_pk_bf16_f32 v42, v242, v243
    v_accvgpr_read_b32 v244, a90
    v_accvgpr_read_b32 v245, a91
    v_mul_f32 v244, v234, v244
    v_mul_f32 v245, v234, v245
    v_cvt_pk_bf16_f32 v43, v244, v245
    v_accvgpr_read_b32 v238, a76
    v_accvgpr_read_b32 v239, a77
    v_mul_f32 v238, v235, v238
    v_mul_f32 v239, v235, v239
    v_cvt_pk_bf16_f32 v44, v238, v239
    v_accvgpr_read_b32 v240, a78
    v_accvgpr_read_b32 v241, a79
    v_mul_f32 v240, v235, v240
    v_mul_f32 v241, v235, v241
    v_cvt_pk_bf16_f32 v45, v240, v241
    v_accvgpr_read_b32 v242, a92
    v_accvgpr_read_b32 v243, a93
    v_mul_f32 v242, v235, v242
    v_mul_f32 v243, v235, v243
    v_cvt_pk_bf16_f32 v46, v242, v243
    v_accvgpr_read_b32 v244, a94
    v_accvgpr_read_b32 v245, a95
    v_mul_f32 v244, v235, v244
    v_mul_f32 v245, v235, v245
    v_cvt_pk_bf16_f32 v47, v244, v245
    ds_read_b64_tr_b16 v[128:129], v254 offset:0
    ds_read_b64_tr_b16 v[130:131], v254 offset:256
    ds_read_b64_tr_b16 v[132:133], v254 offset:512
    ds_read_b64_tr_b16 v[134:135], v254 offset:768
    ds_read_b64_tr_b16 v[136:137], v254 offset:8448
    ds_read_b64_tr_b16 v[138:139], v254 offset:8704
    ds_read_b64_tr_b16 v[140:141], v254 offset:8960
    ds_read_b64_tr_b16 v[142:143], v254 offset:9216
    v_accvgpr_read_b32 v238, a96
    v_accvgpr_read_b32 v239, a97
    v_mul_f32 v238, v232, v238
    v_mul_f32 v239, v232, v239
    v_cvt_pk_bf16_f32 v48, v238, v239
    v_accvgpr_read_b32 v240, a98
    v_accvgpr_read_b32 v241, a99
    v_mul_f32 v240, v232, v240
    v_mul_f32 v241, v232, v241
    v_cvt_pk_bf16_f32 v49, v240, v241
    v_accvgpr_read_b32 v242, a112
    v_accvgpr_read_b32 v243, a113
    v_mul_f32 v242, v232, v242
    v_mul_f32 v243, v232, v243
    v_cvt_pk_bf16_f32 v50, v242, v243
    v_accvgpr_read_b32 v244, a114
    v_accvgpr_read_b32 v245, a115
    v_mul_f32 v244, v232, v244
    v_mul_f32 v245, v232, v245
    v_cvt_pk_bf16_f32 v51, v244, v245
    v_accvgpr_read_b32 v238, a100
    v_accvgpr_read_b32 v239, a101
    v_mul_f32 v238, v233, v238
    v_mul_f32 v239, v233, v239
    v_cvt_pk_bf16_f32 v52, v238, v239
    v_accvgpr_read_b32 v240, a102
    v_accvgpr_read_b32 v241, a103
    v_mul_f32 v240, v233, v240
    v_mul_f32 v241, v233, v241
    v_cvt_pk_bf16_f32 v53, v240, v241
    v_accvgpr_read_b32 v242, a116
    v_accvgpr_read_b32 v243, a117
    v_mul_f32 v242, v233, v242
    v_mul_f32 v243, v233, v243
    v_cvt_pk_bf16_f32 v54, v242, v243
    v_accvgpr_read_b32 v244, a118
    v_accvgpr_read_b32 v245, a119
    v_mul_f32 v244, v233, v244
    v_mul_f32 v245, v233, v245
    v_cvt_pk_bf16_f32 v55, v244, v245
    v_accvgpr_read_b32 v238, a104
    v_accvgpr_read_b32 v239, a105
    v_mul_f32 v238, v234, v238
    v_mul_f32 v239, v234, v239
    v_cvt_pk_bf16_f32 v56, v238, v239
    v_accvgpr_read_b32 v240, a106
    v_accvgpr_read_b32 v241, a107
    v_mul_f32 v240, v234, v240
    v_mul_f32 v241, v234, v241
    v_cvt_pk_bf16_f32 v57, v240, v241
    v_accvgpr_read_b32 v242, a120
    v_accvgpr_read_b32 v243, a121
    v_mul_f32 v242, v234, v242
    v_mul_f32 v243, v234, v243
    v_cvt_pk_bf16_f32 v58, v242, v243
    v_accvgpr_read_b32 v244, a122
    v_accvgpr_read_b32 v245, a123
    v_mul_f32 v244, v234, v244
    v_mul_f32 v245, v234, v245
    v_cvt_pk_bf16_f32 v59, v244, v245
    v_accvgpr_read_b32 v238, a108
    v_accvgpr_read_b32 v239, a109
    v_mul_f32 v238, v235, v238
    v_mul_f32 v239, v235, v239
    v_cvt_pk_bf16_f32 v60, v238, v239
    v_accvgpr_read_b32 v240, a110
    v_accvgpr_read_b32 v241, a111
    v_mul_f32 v240, v235, v240
    v_mul_f32 v241, v235, v241
    v_cvt_pk_bf16_f32 v61, v240, v241
    v_accvgpr_read_b32 v242, a124
    v_accvgpr_read_b32 v243, a125
    v_mul_f32 v242, v235, v242
    v_mul_f32 v243, v235, v243
    v_cvt_pk_bf16_f32 v62, v242, v243
    v_accvgpr_read_b32 v244, a126
    v_accvgpr_read_b32 v245, a127
    v_mul_f32 v244, v235, v244
    v_mul_f32 v245, v235, v245
    v_cvt_pk_bf16_f32 v63, v244, v245
    s_waitcnt lgkmcnt(0)
    v_mfma_f32_16x16x32_bf16 a[0:3], v[128:131], v[0:3], 0
    ds_read_b64_tr_b16 v[144:145], v254 offset:32
    ds_read_b64_tr_b16 v[146:147], v254 offset:288
    ds_read_b64_tr_b16 v[148:149], v254 offset:544
    ds_read_b64_tr_b16 v[150:151], v254 offset:800
    ds_read_b64_tr_b16 v[152:153], v254 offset:8480
    ds_read_b64_tr_b16 v[154:155], v254 offset:8736
    ds_read_b64_tr_b16 v[156:157], v254 offset:8992
    ds_read_b64_tr_b16 v[158:159], v254 offset:9248
    v_accvgpr_read_b32 v238, a128
    v_accvgpr_read_b32 v239, a129
    v_mul_f32 v238, v232, v238
    v_mul_f32 v239, v232, v239
    v_cvt_pk_bf16_f32 v64, v238, v239
    v_mfma_f32_16x16x32_bf16 a[0:3], v[132:135], v[16:19], a[0:3]
    v_accvgpr_read_b32 v240, a130
    v_accvgpr_read_b32 v241, a131
    v_mul_f32 v240, v232, v240
    v_mul_f32 v241, v232, v241
    v_cvt_pk_bf16_f32 v65, v240, v241
    v_mfma_f32_16x16x32_bf16 a[0:3], v[136:139], v[32:35], a[0:3]
    v_accvgpr_read_b32 v242, a144
    v_accvgpr_read_b32 v243, a145
    v_mul_f32 v242, v232, v242
    v_mul_f32 v243, v232, v243
    v_cvt_pk_bf16_f32 v66, v242, v243
    v_mfma_f32_16x16x32_bf16 a[0:3], v[140:143], v[48:51], a[0:3]
    v_accvgpr_read_b32 v244, a146
    v_accvgpr_read_b32 v245, a147
    v_mul_f32 v244, v232, v244
    v_mul_f32 v245, v232, v245
    v_cvt_pk_bf16_f32 v67, v244, v245
    v_mfma_f32_16x16x32_bf16 a[4:7], v[128:131], v[4:7], 0
    v_accvgpr_read_b32 v238, a132
    v_accvgpr_read_b32 v239, a133
    v_mul_f32 v238, v233, v238
    v_mul_f32 v239, v233, v239
    v_cvt_pk_bf16_f32 v68, v238, v239
    v_mfma_f32_16x16x32_bf16 a[4:7], v[132:135], v[20:23], a[4:7]
    v_accvgpr_read_b32 v240, a134
    v_accvgpr_read_b32 v241, a135
    v_mul_f32 v240, v233, v240
    v_mul_f32 v241, v233, v241
    v_cvt_pk_bf16_f32 v69, v240, v241
    v_mfma_f32_16x16x32_bf16 a[4:7], v[136:139], v[36:39], a[4:7]
    v_accvgpr_read_b32 v242, a148
    v_accvgpr_read_b32 v243, a149
    v_mul_f32 v242, v233, v242
    v_mul_f32 v243, v233, v243
    v_cvt_pk_bf16_f32 v70, v242, v243
    v_mfma_f32_16x16x32_bf16 a[4:7], v[140:143], v[52:55], a[4:7]
    v_accvgpr_read_b32 v244, a150
    v_accvgpr_read_b32 v245, a151
    v_mul_f32 v244, v233, v244
    v_mul_f32 v245, v233, v245
    v_cvt_pk_bf16_f32 v71, v244, v245
    v_mfma_f32_16x16x32_bf16 a[8:11], v[128:131], v[8:11], 0
    v_accvgpr_read_b32 v238, a136
    v_accvgpr_read_b32 v239, a137
    v_mul_f32 v238, v234, v238
    v_mul_f32 v239, v234, v239
    v_cvt_pk_bf16_f32 v72, v238, v239
    v_mfma_f32_16x16x32_bf16 a[8:11], v[132:135], v[24:27], a[8:11]
    v_accvgpr_read_b32 v240, a138
    v_accvgpr_read_b32 v241, a139
    v_mul_f32 v240, v234, v240
    v_mul_f32 v241, v234, v241
    v_cvt_pk_bf16_f32 v73, v240, v241
    v_mfma_f32_16x16x32_bf16 a[8:11], v[136:139], v[40:43], a[8:11]
    v_accvgpr_read_b32 v242, a152
    v_accvgpr_read_b32 v243, a153
    v_mul_f32 v242, v234, v242
    v_mul_f32 v243, v234, v243
    v_cvt_pk_bf16_f32 v74, v242, v243
    v_mfma_f32_16x16x32_bf16 a[8:11], v[140:143], v[56:59], a[8:11]
    v_accvgpr_read_b32 v244, a154
    v_accvgpr_read_b32 v245, a155
    v_mul_f32 v244, v234, v244
    v_mul_f32 v245, v234, v245
    v_cvt_pk_bf16_f32 v75, v244, v245
    v_mfma_f32_16x16x32_bf16 a[12:15], v[128:131], v[12:15], 0
    v_accvgpr_read_b32 v238, a140
    v_accvgpr_read_b32 v239, a141
    v_mul_f32 v238, v235, v238
    v_mul_f32 v239, v235, v239
    v_cvt_pk_bf16_f32 v76, v238, v239
    v_mfma_f32_16x16x32_bf16 a[12:15], v[132:135], v[28:31], a[12:15]
    v_accvgpr_read_b32 v240, a142
    v_accvgpr_read_b32 v241, a143
    v_mul_f32 v240, v235, v240
    v_mul_f32 v241, v235, v241
    v_cvt_pk_bf16_f32 v77, v240, v241
    v_mfma_f32_16x16x32_bf16 a[12:15], v[136:139], v[44:47], a[12:15]
    v_accvgpr_read_b32 v242, a156
    v_accvgpr_read_b32 v243, a157
    v_mul_f32 v242, v235, v242
    v_mul_f32 v243, v235, v243
    v_cvt_pk_bf16_f32 v78, v242, v243
    v_mfma_f32_16x16x32_bf16 a[12:15], v[140:143], v[60:63], a[12:15]
    v_accvgpr_read_b32 v244, a158
    v_accvgpr_read_b32 v245, a159
    v_mul_f32 v244, v235, v244
    v_mul_f32 v245, v235, v245
    v_cvt_pk_bf16_f32 v79, v244, v245
    s_waitcnt lgkmcnt(0)
    v_mfma_f32_16x16x32_bf16 a[16:19], v[144:147], v[0:3], 0
    ds_read_b64_tr_b16 v[128:129], v254 offset:64
    ds_read_b64_tr_b16 v[130:131], v254 offset:320
    ds_read_b64_tr_b16 v[132:133], v254 offset:576
    ds_read_b64_tr_b16 v[134:135], v254 offset:832
    ds_read_b64_tr_b16 v[136:137], v254 offset:8512
    ds_read_b64_tr_b16 v[138:139], v254 offset:8768
    ds_read_b64_tr_b16 v[140:141], v254 offset:9024
    ds_read_b64_tr_b16 v[142:143], v254 offset:9280
    v_accvgpr_read_b32 v238, a160
    v_accvgpr_read_b32 v239, a161
    v_mul_f32 v238, v232, v238
    v_mul_f32 v239, v232, v239
    v_cvt_pk_bf16_f32 v80, v238, v239
    v_mfma_f32_16x16x32_bf16 a[16:19], v[148:151], v[16:19], a[16:19]
    v_accvgpr_read_b32 v240, a162
    v_accvgpr_read_b32 v241, a163
    v_mul_f32 v240, v232, v240
    v_mul_f32 v241, v232, v241
    v_cvt_pk_bf16_f32 v81, v240, v241
    v_mfma_f32_16x16x32_bf16 a[16:19], v[152:155], v[32:35], a[16:19]
    v_accvgpr_read_b32 v242, a176
    v_accvgpr_read_b32 v243, a177
    v_mul_f32 v242, v232, v242
    v_mul_f32 v243, v232, v243
    v_cvt_pk_bf16_f32 v82, v242, v243
    v_mfma_f32_16x16x32_bf16 a[16:19], v[156:159], v[48:51], a[16:19]
    v_accvgpr_read_b32 v244, a178
    v_accvgpr_read_b32 v245, a179
    v_mul_f32 v244, v232, v244
    v_mul_f32 v245, v232, v245
    v_cvt_pk_bf16_f32 v83, v244, v245
    v_mfma_f32_16x16x32_bf16 a[20:23], v[144:147], v[4:7], 0
    v_accvgpr_read_b32 v238, a164
    v_accvgpr_read_b32 v239, a165
    v_mul_f32 v238, v233, v238
    v_mul_f32 v239, v233, v239
    v_cvt_pk_bf16_f32 v84, v238, v239
    v_mfma_f32_16x16x32_bf16 a[20:23], v[148:151], v[20:23], a[20:23]
    v_accvgpr_read_b32 v240, a166
    v_accvgpr_read_b32 v241, a167
    v_mul_f32 v240, v233, v240
    v_mul_f32 v241, v233, v241
    v_cvt_pk_bf16_f32 v85, v240, v241
    v_mfma_f32_16x16x32_bf16 a[20:23], v[152:155], v[36:39], a[20:23]
    v_accvgpr_read_b32 v242, a180
    v_accvgpr_read_b32 v243, a181
    v_mul_f32 v242, v233, v242
    v_mul_f32 v243, v233, v243
    v_cvt_pk_bf16_f32 v86, v242, v243
    v_mfma_f32_16x16x32_bf16 a[20:23], v[156:159], v[52:55], a[20:23]
    v_accvgpr_read_b32 v244, a182
    v_accvgpr_read_b32 v245, a183
    v_mul_f32 v244, v233, v244
    v_mul_f32 v245, v233, v245
    v_cvt_pk_bf16_f32 v87, v244, v245
    v_mfma_f32_16x16x32_bf16 a[24:27], v[144:147], v[8:11], 0
    v_accvgpr_read_b32 v238, a168
    v_accvgpr_read_b32 v239, a169
    v_mul_f32 v238, v234, v238
    v_mul_f32 v239, v234, v239
    v_cvt_pk_bf16_f32 v88, v238, v239
    v_mfma_f32_16x16x32_bf16 a[24:27], v[148:151], v[24:27], a[24:27]
    v_accvgpr_read_b32 v240, a170
    v_accvgpr_read_b32 v241, a171
    v_mul_f32 v240, v234, v240
    v_mul_f32 v241, v234, v241
    v_cvt_pk_bf16_f32 v89, v240, v241
    v_mfma_f32_16x16x32_bf16 a[24:27], v[152:155], v[40:43], a[24:27]
    v_accvgpr_read_b32 v242, a184
    v_accvgpr_read_b32 v243, a185
    v_mul_f32 v242, v234, v242
    v_mul_f32 v243, v234, v243
    v_cvt_pk_bf16_f32 v90, v242, v243
    v_mfma_f32_16x16x32_bf16 a[24:27], v[156:159], v[56:59], a[24:27]
    v_accvgpr_read_b32 v244, a186
    v_accvgpr_read_b32 v245, a187
    v_mul_f32 v244, v234, v244
    v_mul_f32 v245, v234, v245
    v_cvt_pk_bf16_f32 v91, v244, v245
    v_mfma_f32_16x16x32_bf16 a[28:31], v[144:147], v[12:15], 0
    v_accvgpr_read_b32 v238, a172
    v_accvgpr_read_b32 v239, a173
    v_mul_f32 v238, v235, v238
    v_mul_f32 v239, v235, v239
    v_cvt_pk_bf16_f32 v92, v238, v239
    v_mfma_f32_16x16x32_bf16 a[28:31], v[148:151], v[28:31], a[28:31]
    v_accvgpr_read_b32 v240, a174
    v_accvgpr_read_b32 v241, a175
    v_mul_f32 v240, v235, v240
    v_mul_f32 v241, v235, v241
    v_cvt_pk_bf16_f32 v93, v240, v241
    v_mfma_f32_16x16x32_bf16 a[28:31], v[152:155], v[44:47], a[28:31]
    v_accvgpr_read_b32 v242, a188
    v_accvgpr_read_b32 v243, a189
    v_mul_f32 v242, v235, v242
    v_mul_f32 v243, v235, v243
    v_cvt_pk_bf16_f32 v94, v242, v243
    v_mfma_f32_16x16x32_bf16 a[28:31], v[156:159], v[60:63], a[28:31]
    v_accvgpr_read_b32 v244, a190
    v_accvgpr_read_b32 v245, a191
    v_mul_f32 v244, v235, v244
    v_mul_f32 v245, v235, v245
    v_cvt_pk_bf16_f32 v95, v244, v245
    s_waitcnt lgkmcnt(0)
    v_mfma_f32_16x16x32_bf16 a[32:35], v[128:131], v[0:3], 0
    ds_read_b64_tr_b16 v[144:145], v254 offset:96
    ds_read_b64_tr_b16 v[146:147], v254 offset:352
    ds_read_b64_tr_b16 v[148:149], v254 offset:608
    ds_read_b64_tr_b16 v[150:151], v254 offset:864
    ds_read_b64_tr_b16 v[152:153], v254 offset:8544
    ds_read_b64_tr_b16 v[154:155], v254 offset:8800
    ds_read_b64_tr_b16 v[156:157], v254 offset:9056
    ds_read_b64_tr_b16 v[158:159], v254 offset:9312
    v_accvgpr_read_b32 v238, a192
    v_accvgpr_read_b32 v239, a193
    v_mul_f32 v238, v232, v238
    v_mul_f32 v239, v232, v239
    v_cvt_pk_bf16_f32 v96, v238, v239
    v_mfma_f32_16x16x32_bf16 a[32:35], v[132:135], v[16:19], a[32:35]
    v_accvgpr_read_b32 v240, a194
    v_accvgpr_read_b32 v241, a195
    v_mul_f32 v240, v232, v240
    v_mul_f32 v241, v232, v241
    v_cvt_pk_bf16_f32 v97, v240, v241
    v_mfma_f32_16x16x32_bf16 a[32:35], v[136:139], v[32:35], a[32:35]
    v_accvgpr_read_b32 v242, a208
    v_accvgpr_read_b32 v243, a209
    v_mul_f32 v242, v232, v242
    v_mul_f32 v243, v232, v243
    v_cvt_pk_bf16_f32 v98, v242, v243
    v_mfma_f32_16x16x32_bf16 a[32:35], v[140:143], v[48:51], a[32:35]
    v_accvgpr_read_b32 v244, a210
    v_accvgpr_read_b32 v245, a211
    v_mul_f32 v244, v232, v244
    v_mul_f32 v245, v232, v245
    v_cvt_pk_bf16_f32 v99, v244, v245
    v_mfma_f32_16x16x32_bf16 a[36:39], v[128:131], v[4:7], 0
    v_accvgpr_read_b32 v238, a196
    v_accvgpr_read_b32 v239, a197
    v_mul_f32 v238, v233, v238
    v_mul_f32 v239, v233, v239
    v_cvt_pk_bf16_f32 v100, v238, v239
    v_mfma_f32_16x16x32_bf16 a[36:39], v[132:135], v[20:23], a[36:39]
    v_accvgpr_read_b32 v240, a198
    v_accvgpr_read_b32 v241, a199
    v_mul_f32 v240, v233, v240
    v_mul_f32 v241, v233, v241
    v_cvt_pk_bf16_f32 v101, v240, v241
    v_mfma_f32_16x16x32_bf16 a[36:39], v[136:139], v[36:39], a[36:39]
    v_accvgpr_read_b32 v242, a212
    v_accvgpr_read_b32 v243, a213
    v_mul_f32 v242, v233, v242
    v_mul_f32 v243, v233, v243
    v_cvt_pk_bf16_f32 v102, v242, v243
    v_mfma_f32_16x16x32_bf16 a[36:39], v[140:143], v[52:55], a[36:39]
    v_accvgpr_read_b32 v244, a214
    v_accvgpr_read_b32 v245, a215
    v_mul_f32 v244, v233, v244
    v_mul_f32 v245, v233, v245
    v_cvt_pk_bf16_f32 v103, v244, v245
    v_mfma_f32_16x16x32_bf16 a[40:43], v[128:131], v[8:11], 0
    s_waitcnt vmcnt(21)
    s_barrier
    s_mov_b32 s41, 0x180
    s_add_u32 m0, s33, 67584
    s_nop 0
    buffer_load_dwordx4 v252, s[24:27], s41 offen offset:0  lds
    s_add_u32 m0, s33, 67744
    s_nop 0
    buffer_load_dwordx4 v252, s[24:27], s41 offen offset:896  lds
    s_add_u32 m0, s33, 67904
    s_nop 0
    buffer_load_dwordx4 v252, s[24:27], s41 offen offset:1792  lds
    s_add_u32 m0, s33, 68064
    s_nop 0
    buffer_load_dwordx4 v252, s[24:27], s41 offen offset:2688  lds
    v_accvgpr_read_b32 v238, a200
    v_accvgpr_read_b32 v239, a201
    v_mul_f32 v238, v234, v238
    v_mul_f32 v239, v234, v239
    v_cvt_pk_bf16_f32 v104, v238, v239
    v_mfma_f32_16x16x32_bf16 a[40:43], v[132:135], v[24:27], a[40:43]
    v_accvgpr_read_b32 v240, a202
    v_accvgpr_read_b32 v241, a203
    v_mul_f32 v240, v234, v240
    v_mul_f32 v241, v234, v241
    v_cvt_pk_bf16_f32 v105, v240, v241
    v_mfma_f32_16x16x32_bf16 a[40:43], v[136:139], v[40:43], a[40:43]
    v_accvgpr_read_b32 v242, a216
    v_accvgpr_read_b32 v243, a217
    v_mul_f32 v242, v234, v242
    v_mul_f32 v243, v234, v243
    v_cvt_pk_bf16_f32 v106, v242, v243
    v_mfma_f32_16x16x32_bf16 a[40:43], v[140:143], v[56:59], a[40:43]
    v_accvgpr_read_b32 v244, a218
    v_accvgpr_read_b32 v245, a219
    v_mul_f32 v244, v234, v244
    v_mul_f32 v245, v234, v245
    v_cvt_pk_bf16_f32 v107, v244, v245
    v_mfma_f32_16x16x32_bf16 a[44:47], v[128:131], v[12:15], 0
    v_accvgpr_read_b32 v238, a204
    v_accvgpr_read_b32 v239, a205
    v_mul_f32 v238, v235, v238
    v_mul_f32 v239, v235, v239
    v_cvt_pk_bf16_f32 v108, v238, v239
    v_mfma_f32_16x16x32_bf16 a[44:47], v[132:135], v[28:31], a[44:47]
    v_accvgpr_read_b32 v240, a206
    v_accvgpr_read_b32 v241, a207
    v_mul_f32 v240, v235, v240
    v_mul_f32 v241, v235, v241
    v_cvt_pk_bf16_f32 v109, v240, v241
    v_mfma_f32_16x16x32_bf16 a[44:47], v[136:139], v[44:47], a[44:47]
    v_accvgpr_read_b32 v242, a220
    v_accvgpr_read_b32 v243, a221
    v_mul_f32 v242, v235, v242
    v_mul_f32 v243, v235, v243
    v_cvt_pk_bf16_f32 v110, v242, v243
    v_mfma_f32_16x16x32_bf16 a[44:47], v[140:143], v[60:63], a[44:47]
    v_accvgpr_read_b32 v244, a222
    v_accvgpr_read_b32 v245, a223
    v_mul_f32 v244, v235, v244
    v_mul_f32 v245, v235, v245
    v_cvt_pk_bf16_f32 v111, v244, v245
    s_waitcnt lgkmcnt(0)
    v_mfma_f32_16x16x32_bf16 a[48:51], v[144:147], v[0:3], 0
    v_add_u32 v254, 0x1ce00, v251
    ds_read_b64_tr_b16 v[128:129], v254 offset:0
    ds_read_b64_tr_b16 v[130:131], v254 offset:256
    ds_read_b64_tr_b16 v[132:133], v254 offset:512
    ds_read_b64_tr_b16 v[134:135], v254 offset:768
    ds_read_b64_tr_b16 v[136:137], v254 offset:8448
    ds_read_b64_tr_b16 v[138:139], v254 offset:8704
    ds_read_b64_tr_b16 v[140:141], v254 offset:8960
    ds_read_b64_tr_b16 v[142:143], v254 offset:9216
    v_accvgpr_read_b32 v238, a224
    v_accvgpr_read_b32 v239, a225
    v_mul_f32 v238, v232, v238
    v_mul_f32 v239, v232, v239
    v_cvt_pk_bf16_f32 v112, v238, v239
    v_mfma_f32_16x16x32_bf16 a[48:51], v[148:151], v[16:19], a[48:51]
    v_accvgpr_read_b32 v240, a226
    v_accvgpr_read_b32 v241, a227
    v_mul_f32 v240, v232, v240
    v_mul_f32 v241, v232, v241
    v_cvt_pk_bf16_f32 v113, v240, v241
    v_mfma_f32_16x16x32_bf16 a[48:51], v[152:155], v[32:35], a[48:51]
    v_accvgpr_read_b32 v242, a240
    v_accvgpr_read_b32 v243, a241
    v_mul_f32 v242, v232, v242
    v_mul_f32 v243, v232, v243
    v_cvt_pk_bf16_f32 v114, v242, v243
    v_mfma_f32_16x16x32_bf16 a[48:51], v[156:159], v[48:51], a[48:51]
    v_accvgpr_read_b32 v244, a242
    v_accvgpr_read_b32 v245, a243
    v_mul_f32 v244, v232, v244
    v_mul_f32 v245, v232, v245
    v_cvt_pk_bf16_f32 v115, v244, v245
    v_mfma_f32_16x16x32_bf16 a[52:55], v[144:147], v[4:7], 0
    v_accvgpr_read_b32 v238, a228
    v_accvgpr_read_b32 v239, a229
    v_mul_f32 v238, v233, v238
    v_mul_f32 v239, v233, v239
    v_cvt_pk_bf16_f32 v116, v238, v239
    v_mfma_f32_16x16x32_bf16 a[52:55], v[148:151], v[20:23], a[52:55]
    v_accvgpr_read_b32 v240, a230
    v_accvgpr_read_b32 v241, a231
    v_mul_f32 v240, v233, v240
    v_mul_f32 v241, v233, v241
    v_cvt_pk_bf16_f32 v117, v240, v241
    v_mfma_f32_16x16x32_bf16 a[52:55], v[152:155], v[36:39], a[52:55]
    v_accvgpr_read_b32 v242, a244
    v_accvgpr_read_b32 v243, a245
    v_mul_f32 v242, v233, v242
    v_mul_f32 v243, v233, v243
    v_cvt_pk_bf16_f32 v118, v242, v243
    v_mfma_f32_16x16x32_bf16 a[52:55], v[156:159], v[52:55], a[52:55]
    v_accvgpr_read_b32 v244, a246
    v_accvgpr_read_b32 v245, a247
    v_mul_f32 v244, v233, v244
    v_mul_f32 v245, v233, v245
    v_cvt_pk_bf16_f32 v119, v244, v245
    v_mfma_f32_16x16x32_bf16 a[56:59], v[144:147], v[8:11], 0
    v_accvgpr_read_b32 v238, a232
    v_accvgpr_read_b32 v239, a233
    v_mul_f32 v238, v234, v238
    v_mul_f32 v239, v234, v239
    v_cvt_pk_bf16_f32 v120, v238, v239
    v_mfma_f32_16x16x32_bf16 a[56:59], v[148:151], v[24:27], a[56:59]
    v_accvgpr_read_b32 v240, a234
    v_accvgpr_read_b32 v241, a235
    v_mul_f32 v240, v234, v240
    v_mul_f32 v241, v234, v241
    v_cvt_pk_bf16_f32 v121, v240, v241
    v_mfma_f32_16x16x32_bf16 a[56:59], v[152:155], v[40:43], a[56:59]
    v_accvgpr_read_b32 v242, a248
    v_accvgpr_read_b32 v243, a249
    v_mul_f32 v242, v234, v242
    v_mul_f32 v243, v234, v243
    v_cvt_pk_bf16_f32 v122, v242, v243
    v_mfma_f32_16x16x32_bf16 a[56:59], v[156:159], v[56:59], a[56:59]
    v_accvgpr_read_b32 v244, a250
    v_accvgpr_read_b32 v245, a251
    v_mul_f32 v244, v234, v244
    v_mul_f32 v245, v234, v245
    v_cvt_pk_bf16_f32 v123, v244, v245
    v_mfma_f32_16x16x32_bf16 a[60:63], v[144:147], v[12:15], 0
    v_accvgpr_read_b32 v238, a236
    v_accvgpr_read_b32 v239, a237
    v_mul_f32 v238, v235, v238
    v_mul_f32 v239, v235, v239
    v_cvt_pk_bf16_f32 v124, v238, v239
    v_mfma_f32_16x16x32_bf16 a[60:63], v[148:151], v[28:31], a[60:63]
    v_accvgpr_read_b32 v240, a238
    v_accvgpr_read_b32 v241, a239
    v_mul_f32 v240, v235, v240
    v_mul_f32 v241, v235, v241
    v_cvt_pk_bf16_f32 v125, v240, v241
    v_mfma_f32_16x16x32_bf16 a[60:63], v[152:155], v[44:47], a[60:63]
    v_accvgpr_read_b32 v242, a252
    v_accvgpr_read_b32 v243, a253
    v_mul_f32 v242, v235, v242
    v_mul_f32 v243, v235, v243
    v_cvt_pk_bf16_f32 v126, v242, v243
    v_mfma_f32_16x16x32_bf16 a[60:63], v[156:159], v[60:63], a[60:63]
    v_accvgpr_read_b32 v244, a254
    v_accvgpr_read_b32 v245, a255
    v_mul_f32 v244, v235, v244
    v_mul_f32 v245, v235, v245
    v_cvt_pk_bf16_f32 v127, v244, v245
    s_waitcnt vmcnt(8)
M_eval:
    v_readfirstlane_b32 s4, v176
    v_readfirstlane_b32 s5, v177
    v_readfirstlane_b32 s6, v178
    v_readfirstlane_b32 s7, v179
    s_lshl_b32 s2, s45, 4
    s_or_b32 s2, s2, 0x80
    s_mul_i32 s2, s2, 0x01010101
    s_and_b32 s3, s4, s5
    s_and_b32 s3, s3, s6
    s_and_b32 s3, s3, s7
    s_and_b32 s3, s3, 0x80808080
    s_cmp_lg_u32 s3, 0x80808080
    s_cbranch_scc1 M_spin
M_valid:
    s_xor_b32 s4, s4, s2
    s_xor_b32 s5, s5, s2
    s_xor_b32 s6, s6, s2
    s_xor_b32 s7, s7, s2
    s_or_b32 s4, s4, s5
    s_or_b32 s6, s6, s7
    s_or_b32 s4, s4, s6
    s_cmp_lg_u32 s4, 0
    s_cselect_b32 s65, 1, 0
    s_cmp_eq_u32 s65, 0
    s_cselect_b32 s20, 0xc0000, -1
    s_mov_b32 s2, 0x340000
    s_cselect_b32 s23, 0xc0000, s2
    s_mov_b32 s2, 0x40000000
    s_cselect_b32 s14, 0x40000, s2
    s_mov_b32 s15, 0x40000000
    s_mov_b32 s12, -2
    s_mov_b32 s11, -1
    s_mov_b32 s16, 0x40000000
    s_mov_b32 s13, 0
    s_mov_b32 s18, s33
    s_mov_b32 s19, 384
    s_mov_b32 s21, 4
    s_lshr_b32 s2, s46, 2
    s_lshl_b32 s60, 0x11111111, s2
    s_mov_b32 s61, s60
    s_lshl_b32 s2, s32, 4
    s_mov_b32 s62, 0xffff
    s_mov_b32 s63, 0
    s_lshl_b64 s[62:63], s[62:63], s2
    v_and_b32 v238, 15, v250
    v_lshrrev_b32 v239, 4, v250
    v_mul_u32_u24 v243, 1792, v238
    v_lshl_add_u32 v243, v239, 5, v243
    s_lshl_b32 s7, s32, 3
    v_add_u32 v249, s7, v243
    v_and_b32 v240, 1, v238
    v_lshlrev_b32 v240, 4, v240
    v_mov_b32 v243, 0x3f80
    v_lshlrev_b32 v240, v240, v243
    v_lshrrev_b32 v241, 1, v238
    v_mov_b32 v243, 0
    v_cmp_eq_u32 vcc, 0, v241
    s_nop 1
    v_cndmask_b32 v192, v243, v240, vcc
    v_cmp_eq_u32 vcc, 1, v241
    s_nop 1
    v_cndmask_b32 v193, v243, v240, vcc
    v_cmp_eq_u32 vcc, 2, v241
    s_nop 1
    v_cndmask_b32 v194, v243, v240, vcc
    v_cmp_eq_u32 vcc, 3, v241
    s_nop 1
    v_cndmask_b32 v195, v243, v240, vcc
    v_cmp_eq_u32 vcc, 4, v241
    s_nop 1
    v_cndmask_b32 v196, v243, v240, vcc
    v_cmp_eq_u32 vcc, 5, v241
    s_nop 1
    v_cndmask_b32 v197, v243, v240, vcc
    v_cmp_eq_u32 vcc, 6, v241
    s_nop 1
    v_cndmask_b32 v198, v243, v240, vcc
    v_cmp_eq_u32 vcc, 7, v241
    s_nop 1
    v_cndmask_b32 v199, v243, v240, vcc
    s_cmp_lg_u32 s65, 0
    s_cbranch_scc1 F_entry
    s_mov_b32 s14, 0xc0000
    s_mov_b32 s15, 0x40000000
    s_mov_b32 s22, 0x40000000
    s_mov_b32 s10, 0
    s_or_b32 s62, s62, s60
    s_or_b32 s63, s63, s61
    v_lshlrev_b32 v202, 2, v250
    s_waitcnt vmcnt(0) lgkmcnt(0)
    s_barrier
NO_loop:
    v_mfma_f32_16x16x32_bf16 a[0:3], v[128:131], v[64:67], a[0:3]
    s_add_u32 s40, s22, 0x20000
    s_mov_b32 s12, s10
    buffer_load_dwordx4 v[240:243], v255, s[28:31], s40 offen sc1
    ds_read_b64_tr_b16 v[144:145], v254 offset:32
    v_mfma_f32_16x16x32_bf16 a[0:3], v[132:135], v[80:83], a[0:3]
    s_add_u32 s40, s22, 0x30000
    buffer_load_dwordx4 v[244:247], v255, s[28:31], s40 offen sc1
    ds_read_b64_tr_b16 v[146:147], v254 offset:288
    v_mfma_f32_16x16x32_bf16 a[0:3], v[136:139], v[96:99], a[0:3]
    s_add_u32 s10, s10, 1
    ds_read_b64_tr_b16 v[148:149], v254 offset:544
    buffer_store_dwordx4 v[160:163], v253, s[28:31], s14 offen offset:0
    v_mfma_f32_16x16x32_bf16 a[0:3], v[140:143], v[112:115], a[0:3]
    s_add_u32 s16, s16, 128
    ds_read_b64_tr_b16 v[150:151], v254 offset:800
    v_accvgpr_read_b32 v176, a104
    v_mfma_f32_16x16x32_bf16 a[4:7], v[128:131], v[68:71], a[4:7]
    s_mov_b32 s22, s15
    ds_read_b64_tr_b16 v[152:153], v254 offset:8480
    buffer_store_dwordx4 v[164:167], v253, s[28:31], s14 offen offset:1024
    v_mfma_f32_16x16x32_bf16 a[4:7], v[132:135], v[84:87], a[4:7]
    ds_read_b64_tr_b16 v[154:155], v254 offset:8736
    v_accvgpr_read_b32 v177, a105
    v_mfma_f32_16x16x32_bf16 a[4:7], v[136:139], v[100:103], a[4:7]
    ds_read_b64_tr_b16 v[156:157], v254 offset:8992
    v_accvgpr_read_b32 v178, a106
    v_mfma_f32_16x16x32_bf16 a[4:7], v[140:143], v[116:119], a[4:7]
    ds_read_b64_tr_b16 v[158:159], v254 offset:9248
    v_accvgpr_read_b32 v179, a107
    v_mfma_f32_16x16x32_bf16 a[8:11], v[128:131], v[72:75], a[8:11]
    v_cvt_pk_bf16_f32 v168, v176, v177
    v_cvt_pk_bf16_f32 v169, v178, v179
    v_mfma_f32_16x16x32_bf16 a[8:11], v[132:135], v[88:91], a[8:11]
    v_accvgpr_read_b32 v180, a120
    v_accvgpr_read_b32 v181, a121
    v_mfma_f32_16x16x32_bf16 a[8:11], v[136:139], v[104:107], a[8:11]
    v_accvgpr_read_b32 v182, a122
    v_accvgpr_read_b32 v183, a123
    v_mfma_f32_16x16x32_bf16 a[8:11], v[140:143], v[120:123], a[8:11]
    v_cvt_pk_bf16_f32 v170, v180, v181
    v_cvt_pk_bf16_f32 v171, v182, v183
    v_mfma_f32_16x16x32_bf16 a[12:15], v[128:131], v[76:79], a[12:15]
    buffer_store_dwordx4 v[168:171], v253, s[28:31], s14 offen offset:2048
    v_mov_b32 v200, s10
    v_mfma_f32_16x16x32_bf16 a[12:15], v[132:135], v[92:95], a[12:15]
    v_accvgpr_read_b32 v176, a108
    v_accvgpr_read_b32 v177, a109
    v_mfma_f32_16x16x32_bf16 a[12:15], v[136:139], v[108:111], a[12:15]
    v_accvgpr_read_b32 v178, a110
    v_accvgpr_read_b32 v179, a111
    v_mfma_f32_16x16x32_bf16 a[12:15], v[140:143], v[124:127], a[12:15]
    s_waitcnt lgkmcnt(0)
    v_cvt_pk_bf16_f32 v172, v176, v177
    v_cvt_pk_bf16_f32 v173, v178, v179
    v_mfma_f32_16x16x32_bf16 a[16:19], v[144:147], v[64:67], a[16:19]
    ds_read_b64_tr_b16 v[128:129], v254 offset:64
    v_accvgpr_read_b32 v180, a124
    v_mfma_f32_16x16x32_bf16 a[16:19], v[148:151], v[80:83], a[16:19]
    ds_read_b64_tr_b16 v[130:131], v254 offset:320
    v_accvgpr_read_b32 v181, a125
    v_mfma_f32_16x16x32_bf16 a[16:19], v[152:155], v[96:99], a[16:19]
    ds_read_b64_tr_b16 v[132:133], v254 offset:576
    v_accvgpr_read_b32 v182, a126
    v_mfma_f32_16x16x32_bf16 a[16:19], v[156:159], v[112:115], a[16:19]
    ds_read_b64_tr_b16 v[134:135], v254 offset:832
    v_accvgpr_read_b32 v183, a127
    v_mfma_f32_16x16x32_bf16 a[20:23], v[144:147], v[68:71], a[20:23]
    ds_read_b64_tr_b16 v[136:137], v254 offset:8512
    v_cvt_pk_bf16_f32 v174, v180, v181
    v_mfma_f32_16x16x32_bf16 a[20:23], v[148:151], v[84:87], a[20:23]
    ds_read_b64_tr_b16 v[138:139], v254 offset:8768
    v_cvt_pk_bf16_f32 v175, v182, v183
    v_mfma_f32_16x16x32_bf16 a[20:23], v[152:155], v[100:103], a[20:23]
    ds_read_b64_tr_b16 v[140:141], v254 offset:9024
    buffer_store_dwordx4 v[172:175], v253, s[28:31], s14 offen offset:3072
    v_mfma_f32_16x16x32_bf16 a[20:23], v[156:159], v[116:119], a[20:23]
    s_cmp_eq_u32 s12, 4
    s_cselect_b32 s16, 0, s16
    ds_read_b64_tr_b16 v[142:143], v254 offset:9280
    v_mfma_f32_16x16x32_bf16 a[24:27], v[144:147], v[72:75], a[24:27]
    s_mov_b32 s15, s14
    v_mfma_f32_16x16x32_bf16 a[24:27], v[148:151], v[88:91], a[24:27]
    s_add_u32 s14, s14, 0x40000
    v_mfma_f32_16x16x32_bf16 a[24:27], v[152:155], v[104:107], a[24:27]
    s_and_b32 s14, s14, 0xfffff
    v_mfma_f32_16x16x32_bf16 a[24:27], v[156:159], v[120:123], a[24:27]
    v_mfma_f32_16x16x32_bf16 a[28:31], v[144:147], v[76:79], a[28:31]
    v_mfma_f32_16x16x32_bf16 a[28:31], v[148:151], v[92:95], a[28:31]
    v_mfma_f32_16x16x32_bf16 a[28:31], v[152:155], v[108:111], a[28:31]
    v_mfma_f32_16x16x32_bf16 a[28:31], v[156:159], v[124:127], a[28:31]
    s_waitcnt lgkmcnt(0)
    v_mfma_f32_16x16x32_bf16 a[32:35], v[128:131], v[64:67], a[32:35]
    ds_read_b64_tr_b16 v[144:145], v254 offset:96
    v_mfma_f32_16x16x32_bf16 a[32:35], v[132:135], v[80:83], a[32:35]
    ds_read_b64_tr_b16 v[146:147], v254 offset:352
    v_mfma_f32_16x16x32_bf16 a[32:35], v[136:139], v[96:99], a[32:35]
    ds_read_b64_tr_b16 v[148:149], v254 offset:608
    v_accvgpr_read_b32 v176, a0
    v_mfma_f32_16x16x32_bf16 a[32:35], v[140:143], v[112:115], a[32:35]
    ds_read_b64_tr_b16 v[150:151], v254 offset:864
    v_accvgpr_read_b32 v177, a1
    v_mfma_f32_16x16x32_bf16 a[36:39], v[128:131], v[68:71], a[36:39]
    ds_read_b64_tr_b16 v[152:153], v254 offset:8544
    v_accvgpr_read_b32 v178, a2
    v_mfma_f32_16x16x32_bf16 a[36:39], v[132:135], v[84:87], a[36:39]
    ds_read_b64_tr_b16 v[154:155], v254 offset:8800
    v_accvgpr_read_b32 v179, a3
    v_mfma_f32_16x16x32_bf16 a[36:39], v[136:139], v[100:103], a[36:39]
    ds_read_b64_tr_b16 v[156:157], v254 offset:9056
    buffer_load_dword v212, v202, s[52:55], 0 offen sc1
    v_mfma_f32_16x16x32_bf16 a[36:39], v[140:143], v[116:119], a[36:39]
    ds_read_b64_tr_b16 v[158:159], v254 offset:9312
    v_cvt_pk_bf16_f32 v160, v176, v177
    v_mfma_f32_16x16x32_bf16 a[40:43], v[128:131], v[72:75], a[40:43]
    v_cvt_pk_bf16_f32 v161, v178, v179
    s_waitcnt vmcnt(14)
    s_barrier
    v_mfma_f32_16x16x32_bf16 a[40:43], v[132:135], v[88:91], a[40:43]
    s_add_u32 s41, s19, 0x1c000
    s_add_u32 m0, s18, 84480
    v_accvgpr_read_b32 v180, a16
    v_mfma_f32_16x16x32_bf16 a[40:43], v[136:139], v[104:107], a[40:43]
    buffer_load_dwordx4 v252, s[24:27], s41 offen offset:0  lds
    v_accvgpr_read_b32 v181, a17
    v_mfma_f32_16x16x32_bf16 a[40:43], v[140:143], v[120:123], a[40:43]
    s_waitcnt vmcnt(6)
    s_add_u32 m0, s18, 84640
    v_accvgpr_read_b32 v182, a18
    v_mfma_f32_16x16x32_bf16 v[204:207], v[196:199], v[232:235], v[204:207]
    buffer_load_dwordx4 v252, s[24:27], s41 offen offset:896  lds
    v_accvgpr_read_b32 v183, a19
    v_mfma_f32_16x16x32_bf16 v[204:207], v[196:199], v[236:239], v[204:207]
    s_add_u32 m0, s18, 84800
    v_cvt_pk_bf16_f32 v162, v180, v181
    v_cvt_pk_bf16_f32 v163, v182, v183
    v_mfma_f32_16x16x32_bf16 v[204:207], v[196:199], v[240:243], v[204:207]
    buffer_load_dwordx4 v252, s[24:27], s41 offen offset:1792  lds
    v_accvgpr_read_b32 v176, a4
    v_mfma_f32_16x16x32_bf16 v[204:207], v[196:199], v[244:247], v[204:207]
    s_add_u32 m0, s18, 84960
    v_accvgpr_read_b32 v177, a5
    v_accvgpr_read_b32 v178, a6
    v_mfma_f32_16x16x32_bf16 a[44:47], v[128:131], v[76:79], a[44:47]
    s_add_u32 s17, s13, 0
    buffer_load_dwordx4 v252, s[24:27], s41 offen offset:2688  lds
    v_accvgpr_read_b32 v179, a7
    v_mfma_f32_16x16x32_bf16 a[44:47], v[132:135], v[92:95], a[44:47]
    v_cvt_pk_bf16_f32 v164, v176, v177
    v_cvt_pk_bf16_f32 v165, v178, v179
    v_mfma_f32_16x16x32_bf16 a[44:47], v[136:139], v[108:111], a[44:47]
    v_accvgpr_read_b32 v180, a20
    v_accvgpr_read_b32 v181, a21
    v_mfma_f32_16x16x32_bf16 a[44:47], v[140:143], v[124:127], a[44:47]
    s_waitcnt lgkmcnt(0)
    v_add_u32 v254, s17, v251
    v_accvgpr_read_b32 v182, a22
    v_mfma_f32_16x16x32_bf16 a[48:51], v[144:147], v[64:67], a[48:51]
    ds_read_b64_tr_b16 v[128:129], v254 offset:0
    v_accvgpr_read_b32 v183, a23
    v_mfma_f32_16x16x32_bf16 a[48:51], v[148:151], v[80:83], a[48:51]
    s_add_u32 s19, s19, 128
    ds_read_b64_tr_b16 v[130:131], v254 offset:256
    v_cvt_pk_bf16_f32 v166, v180, v181
    v_mfma_f32_16x16x32_bf16 a[48:51], v[152:155], v[96:99], a[48:51]
    ds_read_b64_tr_b16 v[132:133], v254 offset:512
    v_cvt_pk_bf16_f32 v167, v182, v183
    v_mfma_f32_16x16x32_bf16 a[48:51], v[156:159], v[112:115], a[48:51]
    s_waitcnt vmcnt(5)
    ds_read_b64_tr_b16 v[134:135], v254 offset:768
    buffer_store_dword v200, off, s[52:55], s47
    v_mfma_f32_16x16x32_bf16 a[52:55], v[144:147], v[68:71], a[52:55]
    ds_read_b64_tr_b16 v[136:137], v254 offset:8448
    v_cvt_pk_bf16_f32 v188, v204, v205
    v_mfma_f32_16x16x32_bf16 a[52:55], v[148:151], v[84:87], a[52:55]
    ds_read_b64_tr_b16 v[138:139], v254 offset:8704
    v_cvt_pk_bf16_f32 v189, v206, v207
    v_mfma_f32_16x16x32_bf16 a[52:55], v[152:155], v[100:103], a[52:55]
    ds_read_b64_tr_b16 v[140:141], v254 offset:8960
    buffer_store_dwordx2 v[188:189], v249, s[56:59], s16 offen
    v_mfma_f32_16x16x32_bf16 a[52:55], v[156:159], v[116:119], a[52:55]
    s_cmp_eq_u32 s19, 896
    s_cselect_b32 s19, 0x40000000, s19
    ds_read_b64_tr_b16 v[142:143], v254 offset:9216
    v_mfma_f32_16x16x32_bf16 a[56:59], v[144:147], v[72:75], a[56:59]
    v_mfma_f32_16x16x32_bf16 a[56:59], v[148:151], v[88:91], a[56:59]
    v_mfma_f32_16x16x32_bf16 a[56:59], v[152:155], v[104:107], a[56:59]
    v_mfma_f32_16x16x32_bf16 a[56:59], v[156:159], v[120:123], a[56:59]
    v_mfma_f32_16x16x32_bf16 a[60:63], v[144:147], v[76:79], a[60:63]
    s_waitcnt vmcnt(6)
    v_cmp_gt_i32 vcc, s12, v212
    v_mfma_f32_16x16x32_bf16 a[60:63], v[148:151], v[92:95], a[60:63]
    s_and_b64 vcc, vcc, s[62:63]
    s_cbranch_vccnz NPb_spin
NPb_ok:
    v_mfma_f32_16x16x32_bf16 a[60:63], v[152:155], v[108:111], a[60:63]
    s_add_u32 s40, s22, 0x0
    buffer_load_dwordx4 v[216:219], v255, s[28:31], s40 offen sc1
    v_mfma_f32_16x16x32_bf16 a[60:63], v[156:159], v[124:127], a[60:63]
    s_waitcnt lgkmcnt(0)
    s_add_u32 s40, s22, 0x10000
    buffer_load_dwordx4 v[220:223], v255, s[28:31], s40 offen sc1
    s_sub_u32 s21, s21, 1
    s_cmp_eq_u32 s21, 0
    s_cbranch_scc1 NO_exit
    v_mfma_f32_16x16x32_bf16 a[64:67], v[128:131], v[0:3], 0
    s_add_u32 s40, s22, 0x20000
    s_mov_b32 s12, s10
    buffer_load_dwordx4 v[224:227], v255, s[28:31], s40 offen sc1
    ds_read_b64_tr_b16 v[144:145], v254 offset:32
    v_mfma_f32_16x16x32_bf16 a[64:67], v[132:135], v[16:19], a[64:67]
    s_add_u32 s40, s22, 0x30000
    buffer_load_dwordx4 v[228:231], v255, s[28:31], s40 offen sc1
    ds_read_b64_tr_b16 v[146:147], v254 offset:288
    v_mfma_f32_16x16x32_bf16 a[64:67], v[136:139], v[32:35], a[64:67]
    s_add_u32 s10, s10, 1
    ds_read_b64_tr_b16 v[148:149], v254 offset:544
    buffer_store_dwordx4 v[160:163], v253, s[28:31], s14 offen offset:0
    v_mfma_f32_16x16x32_bf16 a[64:67], v[140:143], v[48:51], a[64:67]
    ds_read_b64_tr_b16 v[150:151], v254 offset:800
    v_accvgpr_read_b32 v176, a8
    v_mfma_f32_16x16x32_bf16 a[68:71], v[128:131], v[4:7], 0
    s_mov_b32 s22, s15
    ds_read_b64_tr_b16 v[152:153], v254 offset:8480
    buffer_store_dwordx4 v[164:167], v253, s[28:31], s14 offen offset:1024
    v_mfma_f32_16x16x32_bf16 a[68:71], v[132:135], v[20:23], a[68:71]
    ds_read_b64_tr_b16 v[154:155], v254 offset:8736
    v_accvgpr_read_b32 v177, a9
    v_mfma_f32_16x16x32_bf16 a[68:71], v[136:139], v[36:39], a[68:71]
    ds_read_b64_tr_b16 v[156:157], v254 offset:8992
    v_accvgpr_read_b32 v178, a10
    v_mfma_f32_16x16x32_bf16 a[68:71], v[140:143], v[52:55], a[68:71]
    ds_read_b64_tr_b16 v[158:159], v254 offset:9248
    v_accvgpr_read_b32 v179, a11
    v_mfma_f32_16x16x32_bf16 a[72:75], v[128:131], v[8:11], 0
    v_cvt_pk_bf16_f32 v168, v176, v177
    v_cvt_pk_bf16_f32 v169, v178, v179
    v_mfma_f32_16x16x32_bf16 a[72:75], v[132:135], v[24:27], a[72:75]
    v_accvgpr_read_b32 v180, a24
    v_accvgpr_read_b32 v181, a25
    v_mfma_f32_16x16x32_bf16 a[72:75], v[136:139], v[40:43], a[72:75]
    v_accvgpr_read_b32 v182, a26
    v_accvgpr_read_b32 v183, a27
    v_mfma_f32_16x16x32_bf16 a[72:75], v[140:143], v[56:59], a[72:75]
    v_cvt_pk_bf16_f32 v170, v180, v181
    v_cvt_pk_bf16_f32 v171, v182, v183
    v_mfma_f32_16x16x32_bf16 a[76:79], v[128:131], v[12:15], 0
    buffer_store_dwordx4 v[168:171], v253, s[28:31], s14 offen offset:2048
    v_mov_b32 v200, s10
    v_mfma_f32_16x16x32_bf16 a[76:79], v[132:135], v[28:31], a[76:79]
    v_accvgpr_read_b32 v176, a12
    v_accvgpr_read_b32 v177, a13
    v_mfma_f32_16x16x32_bf16 a[76:79], v[136:139], v[44:47], a[76:79]
    v_accvgpr_read_b32 v178, a14
    v_accvgpr_read_b32 v179, a15
    v_mfma_f32_16x16x32_bf16 a[76:79], v[140:143], v[60:63], a[76:79]
    s_waitcnt lgkmcnt(0)
    v_cvt_pk_bf16_f32 v172, v176, v177
    v_cvt_pk_bf16_f32 v173, v178, v179
    v_mfma_f32_16x16x32_bf16 a[80:83], v[144:147], v[0:3], 0
    ds_read_b64_tr_b16 v[128:129], v254 offset:64
    v_accvgpr_read_b32 v180, a28
    v_mfma_f32_16x16x32_bf16 a[80:83], v[148:151], v[16:19], a[80:83]
    ds_read_b64_tr_b16 v[130:131], v254 offset:320
    v_accvgpr_read_b32 v181, a29
    v_mfma_f32_16x16x32_bf16 a[80:83], v[152:155], v[32:35], a[80:83]
    ds_read_b64_tr_b16 v[132:133], v254 offset:576
    v_accvgpr_read_b32 v182, a30
    v_mfma_f32_16x16x32_bf16 a[80:83], v[156:159], v[48:51], a[80:83]
    ds_read_b64_tr_b16 v[134:135], v254 offset:832
    v_accvgpr_read_b32 v183, a31
    v_mfma_f32_16x16x32_bf16 a[84:87], v[144:147], v[4:7], 0
    ds_read_b64_tr_b16 v[136:137], v254 offset:8512
    v_cvt_pk_bf16_f32 v174, v180, v181
    v_mfma_f32_16x16x32_bf16 a[84:87], v[148:151], v[20:23], a[84:87]
    ds_read_b64_tr_b16 v[138:139], v254 offset:8768
    v_cvt_pk_bf16_f32 v175, v182, v183
    v_mfma_f32_16x16x32_bf16 a[84:87], v[152:155], v[36:39], a[84:87]
    ds_read_b64_tr_b16 v[140:141], v254 offset:9024
    buffer_store_dwordx4 v[172:175], v253, s[28:31], s14 offen offset:3072
    v_mfma_f32_16x16x32_bf16 a[84:87], v[156:159], v[52:55], a[84:87]
    s_mov_b32 s15, s14
    ds_read_b64_tr_b16 v[142:143], v254 offset:9280
    v_mfma_f32_16x16x32_bf16 a[88:91], v[144:147], v[8:11], 0
    s_add_u32 s14, s14, 0x40000
    v_mfma_f32_16x16x32_bf16 a[88:91], v[148:151], v[24:27], a[88:91]
    s_and_b32 s14, s14, 0xfffff
    v_mfma_f32_16x16x32_bf16 a[88:91], v[152:155], v[40:43], a[88:91]
    v_mfma_f32_16x16x32_bf16 a[88:91], v[156:159], v[56:59], a[88:91]
    v_mfma_f32_16x16x32_bf16 a[92:95], v[144:147], v[12:15], 0
    v_mfma_f32_16x16x32_bf16 a[92:95], v[148:151], v[28:31], a[92:95]
    v_mfma_f32_16x16x32_bf16 a[92:95], v[152:155], v[44:47], a[92:95]
    v_mfma_f32_16x16x32_bf16 a[92:95], v[156:159], v[60:63], a[92:95]
    s_waitcnt lgkmcnt(0)
    v_mfma_f32_16x16x32_bf16 a[96:99], v[128:131], v[0:3], 0
    ds_read_b64_tr_b16 v[144:145], v254 offset:96
    v_mfma_f32_16x16x32_bf16 a[96:99], v[132:135], v[16:19], a[96:99]
    ds_read_b64_tr_b16 v[146:147], v254 offset:352
    v_mfma_f32_16x16x32_bf16 a[96:99], v[136:139], v[32:35], a[96:99]
    ds_read_b64_tr_b16 v[148:149], v254 offset:608
    v_accvgpr_read_b32 v176, a32
    v_mfma_f32_16x16x32_bf16 a[96:99], v[140:143], v[48:51], a[96:99]
    ds_read_b64_tr_b16 v[150:151], v254 offset:864
    v_accvgpr_read_b32 v177, a33
    v_mfma_f32_16x16x32_bf16 a[100:103], v[128:131], v[4:7], 0
    ds_read_b64_tr_b16 v[152:153], v254 offset:8544
    v_accvgpr_read_b32 v178, a34
    v_mfma_f32_16x16x32_bf16 a[100:103], v[132:135], v[20:23], a[100:103]
    ds_read_b64_tr_b16 v[154:155], v254 offset:8800
    v_accvgpr_read_b32 v179, a35
    v_mfma_f32_16x16x32_bf16 a[100:103], v[136:139], v[36:39], a[100:103]
    ds_read_b64_tr_b16 v[156:157], v254 offset:9056
    buffer_load_dword v212, v202, s[52:55], 0 offen sc1
    v_mfma_f32_16x16x32_bf16 a[100:103], v[140:143], v[52:55], a[100:103]
    ds_read_b64_tr_b16 v[158:159], v254 offset:9312
    v_cvt_pk_bf16_f32 v160, v176, v177
    v_mfma_f32_16x16x32_bf16 a[104:107], v[128:131], v[8:11], 0
    v_cvt_pk_bf16_f32 v161, v178, v179
    s_waitcnt vmcnt(15)
    s_barrier
    v_mfma_f32_16x16x32_bf16 a[104:107], v[132:135], v[24:27], a[104:107]
    s_add_u32 s41, s19, 0x0
    s_add_u32 m0, s18, 101376
    v_accvgpr_read_b32 v180, a48
    v_mfma_f32_16x16x32_bf16 a[104:107], v[136:139], v[40:43], a[104:107]
    buffer_load_dwordx4 v252, s[24:27], s41 offen offset:0  lds
    v_accvgpr_read_b32 v181, a49
    v_mfma_f32_16x16x32_bf16 a[104:107], v[140:143], v[56:59], a[104:107]
    s_waitcnt vmcnt(6)
    s_add_u32 m0, s18, 101536
    v_accvgpr_read_b32 v182, a50
    v_mfma_f32_16x16x32_bf16 v[208:211], v[192:195], v[216:219], 0
    buffer_load_dwordx4 v252, s[24:27], s41 offen offset:896  lds
    v_accvgpr_read_b32 v183, a51
    v_mfma_f32_16x16x32_bf16 v[208:211], v[192:195], v[220:223], v[208:211]
    s_add_u32 m0, s18, 101696
    v_cvt_pk_bf16_f32 v162, v180, v181
    v_cvt_pk_bf16_f32 v163, v182, v183
    v_mfma_f32_16x16x32_bf16 v[208:211], v[192:195], v[224:227], v[208:211]
    buffer_load_dwordx4 v252, s[24:27], s41 offen offset:1792  lds
    v_accvgpr_read_b32 v176, a36
    v_mfma_f32_16x16x32_bf16 v[208:211], v[192:195], v[228:231], v[208:211]
    s_add_u32 m0, s18, 101856
    v_accvgpr_read_b32 v177, a37
    v_accvgpr_read_b32 v178, a38
    v_mfma_f32_16x16x32_bf16 a[108:111], v[128:131], v[12:15], 0
    s_add_u32 s17, s13, 16896
    buffer_load_dwordx4 v252, s[24:27], s41 offen offset:2688  lds
    v_accvgpr_read_b32 v179, a39
    v_mfma_f32_16x16x32_bf16 a[108:111], v[132:135], v[28:31], a[108:111]
    v_cvt_pk_bf16_f32 v164, v176, v177
    v_cvt_pk_bf16_f32 v165, v178, v179
    v_mfma_f32_16x16x32_bf16 a[108:111], v[136:139], v[44:47], a[108:111]
    v_accvgpr_read_b32 v180, a52
    v_accvgpr_read_b32 v181, a53
    v_mfma_f32_16x16x32_bf16 a[108:111], v[140:143], v[60:63], a[108:111]
    s_waitcnt lgkmcnt(0)
    v_add_u32 v254, s17, v251
    v_accvgpr_read_b32 v182, a54
    v_mfma_f32_16x16x32_bf16 a[112:115], v[144:147], v[0:3], 0
    ds_read_b64_tr_b16 v[128:129], v254 offset:0
    v_accvgpr_read_b32 v183, a55
    v_mfma_f32_16x16x32_bf16 a[112:115], v[148:151], v[16:19], a[112:115]
    ds_read_b64_tr_b16 v[130:131], v254 offset:256
    v_cvt_pk_bf16_f32 v166, v180, v181
    v_mfma_f32_16x16x32_bf16 a[112:115], v[152:155], v[32:35], a[112:115]
    ds_read_b64_tr_b16 v[132:133], v254 offset:512
    v_cvt_pk_bf16_f32 v167, v182, v183
    v_mfma_f32_16x16x32_bf16 a[112:115], v[156:159], v[48:51], a[112:115]
    s_waitcnt vmcnt(5)
    ds_read_b64_tr_b16 v[134:135], v254 offset:768
    buffer_store_dword v200, off, s[52:55], s47
    v_mfma_f32_16x16x32_bf16 a[116:119], v[144:147], v[4:7], 0
    ds_read_b64_tr_b16 v[136:137], v254 offset:8448
    v_mfma_f32_16x16x32_bf16 a[116:119], v[148:151], v[20:23], a[116:119]
    ds_read_b64_tr_b16 v[138:139], v254 offset:8704
    v_mfma_f32_16x16x32_bf16 a[116:119], v[152:155], v[36:39], a[116:119]
    ds_read_b64_tr_b16 v[140:141], v254 offset:8960
    v_mfma_f32_16x16x32_bf16 a[116:119], v[156:159], v[52:55], a[116:119]
    ds_read_b64_tr_b16 v[142:143], v254 offset:9216
    v_mfma_f32_16x16x32_bf16 a[120:123], v[144:147], v[8:11], 0
    v_mfma_f32_16x16x32_bf16 a[120:123], v[148:151], v[24:27], a[120:123]
    v_mfma_f32_16x16x32_bf16 a[120:123], v[152:155], v[40:43], a[120:123]
    v_mfma_f32_16x16x32_bf16 a[120:123], v[156:159], v[56:59], a[120:123]
    v_mfma_f32_16x16x32_bf16 a[124:127], v[144:147], v[12:15], 0
    s_waitcnt vmcnt(5)
    v_cmp_gt_i32 vcc, s12, v212
    v_mfma_f32_16x16x32_bf16 a[124:127], v[148:151], v[28:31], a[124:127]
    s_and_b64 vcc, vcc, s[62:63]
    s_cbranch_vccnz NPc_spin
NPc_ok:
    v_mfma_f32_16x16x32_bf16 a[124:127], v[152:155], v[44:47], a[124:127]
    s_add_u32 s40, s22, 0x0
    buffer_load_dwordx4 v[232:235], v255, s[28:31], s40 offen sc1
    v_mfma_f32_16x16x32_bf16 a[124:127], v[156:159], v[60:63], a[124:127]
    s_waitcnt lgkmcnt(0)
    s_add_u32 s40, s22, 0x10000
    buffer_load_dwordx4 v[236:239], v255, s[28:31], s40 offen sc1
    v_mfma_f32_16x16x32_bf16 a[64:67], v[128:131], v[64:67], a[64:67]
    s_add_u32 s40, s22, 0x20000
    s_mov_b32 s12, s10
    buffer_load_dwordx4 v[240:243], v255, s[28:31], s40 offen sc1
    ds_read_b64_tr_b16 v[144:145], v254 offset:32
    v_mfma_f32_16x16x32_bf16 a[64:67], v[132:135], v[80:83], a[64:67]
    s_add_u32 s40, s22, 0x30000
    buffer_load_dwordx4 v[244:247], v255, s[28:31], s40 offen sc1
    ds_read_b64_tr_b16 v[146:147], v254 offset:288
    v_mfma_f32_16x16x32_bf16 a[64:67], v[136:139], v[96:99], a[64:67]
    s_add_u32 s10, s10, 1
    ds_read_b64_tr_b16 v[148:149], v254 offset:544
    buffer_store_dwordx4 v[160:163], v253, s[28:31], s14 offen offset:0
    v_mfma_f32_16x16x32_bf16 a[64:67], v[140:143], v[112:115], a[64:67]
    s_add_u32 s16, s16, 128
    ds_read_b64_tr_b16 v[150:151], v254 offset:800
    v_accvgpr_read_b32 v176, a40
    v_mfma_f32_16x16x32_bf16 a[68:71], v[128:131], v[68:71], a[68:71]
    s_mov_b32 s22, s15
    ds_read_b64_tr_b16 v[152:153], v254 offset:8480
    buffer_store_dwordx4 v[164:167], v253, s[28:31], s14 offen offset:1024
    v_mfma_f32_16x16x32_bf16 a[68:71], v[132:135], v[84:87], a[68:71]
    ds_read_b64_tr_b16 v[154:155], v254 offset:8736
    v_accvgpr_read_b32 v177, a41
    v_mfma_f32_16x16x32_bf16 a[68:71], v[136:139], v[100:103], a[68:71]
    ds_read_b64_tr_b16 v[156:157], v254 offset:8992
    v_accvgpr_read_b32 v178, a42
    v_mfma_f32_16x16x32_bf16 a[68:71], v[140:143], v[116:119], a[68:71]
    ds_read_b64_tr_b16 v[158:159], v254 offset:9248
    v_accvgpr_read_b32 v179, a43
    v_mfma_f32_16x16x32_bf16 a[72:75], v[128:131], v[72:75], a[72:75]
    v_cvt_pk_bf16_f32 v168, v176, v177
    v_cvt_pk_bf16_f32 v169, v178, v179
    v_mfma_f32_16x16x32_bf16 a[72:75], v[132:135], v[88:91], a[72:75]
    v_accvgpr_read_b32 v180, a56
    v_accvgpr_read_b32 v181, a57
    v_mfma_f32_16x16x32_bf16 a[72:75], v[136:139], v[104:107], a[72:75]
    v_accvgpr_read_b32 v182, a58
    v_accvgpr_read_b32 v183, a59
    v_mfma_f32_16x16x32_bf16 a[72:75], v[140:143], v[120:123], a[72:75]
    v_cvt_pk_bf16_f32 v170, v180, v181
    v_cvt_pk_bf16_f32 v171, v182, v183
    v_mfma_f32_16x16x32_bf16 a[76:79], v[128:131], v[76:79], a[76:79]
    buffer_store_dwordx4 v[168:171], v253, s[28:31], s14 offen offset:2048
    v_mov_b32 v200, s10
    v_mfma_f32_16x16x32_bf16 a[76:79], v[132:135], v[92:95], a[76:79]
    v_accvgpr_read_b32 v176, a44
    v_accvgpr_read_b32 v177, a45
    v_mfma_f32_16x16x32_bf16 a[76:79], v[136:139], v[108:111], a[76:79]
    v_accvgpr_read_b32 v178, a46
    v_accvgpr_read_b32 v179, a47
    v_mfma_f32_16x16x32_bf16 a[76:79], v[140:143], v[124:127], a[76:79]
    s_waitcnt lgkmcnt(0)
    v_cvt_pk_bf16_f32 v172, v176, v177
    v_cvt_pk_bf16_f32 v173, v178, v179
    v_mfma_f32_16x16x32_bf16 a[80:83], v[144:147], v[64:67], a[80:83]
    ds_read_b64_tr_b16 v[128:129], v254 offset:64
    v_accvgpr_read_b32 v180, a60
    v_mfma_f32_16x16x32_bf16 a[80:83], v[148:151], v[80:83], a[80:83]
    ds_read_b64_tr_b16 v[130:131], v254 offset:320
    v_accvgpr_read_b32 v181, a61
    v_mfma_f32_16x16x32_bf16 a[80:83], v[152:155], v[96:99], a[80:83]
    ds_read_b64_tr_b16 v[132:133], v254 offset:576
    v_accvgpr_read_b32 v182, a62
    v_mfma_f32_16x16x32_bf16 a[80:83], v[156:159], v[112:115], a[80:83]
    ds_read_b64_tr_b16 v[134:135], v254 offset:832
    v_accvgpr_read_b32 v183, a63
    v_mfma_f32_16x16x32_bf16 a[84:87], v[144:147], v[68:71], a[84:87]
    ds_read_b64_tr_b16 v[136:137], v254 offset:8512
    v_cvt_pk_bf16_f32 v174, v180, v181
    v_mfma_f32_16x16x32_bf16 a[84:87], v[148:151], v[84:87], a[84:87]
    ds_read_b64_tr_b16 v[138:139], v254 offset:8768
    v_cvt_pk_bf16_f32 v175, v182, v183
    v_mfma_f32_16x16x32_bf16 a[84:87], v[152:155], v[100:103], a[84:87]
    ds_read_b64_tr_b16 v[140:141], v254 offset:9024
    buffer_store_dwordx4 v[172:175], v253, s[28:31], s14 offen offset:3072
    v_mfma_f32_16x16x32_bf16 a[84:87], v[156:159], v[116:119], a[84:87]
    s_cmp_eq_u32 s12, 4
    s_cselect_b32 s16, 0, s16
    ds_read_b64_tr_b16 v[142:143], v254 offset:9280
    v_mfma_f32_16x16x32_bf16 a[88:91], v[144:147], v[72:75], a[88:91]
    s_mov_b32 s15, s14
    v_mfma_f32_16x16x32_bf16 a[88:91], v[148:151], v[88:91], a[88:91]
    s_add_u32 s14, s14, 0x40000
    v_mfma_f32_16x16x32_bf16 a[88:91], v[152:155], v[104:107], a[88:91]
    s_and_b32 s14, s14, 0xfffff
    v_mfma_f32_16x16x32_bf16 a[88:91], v[156:159], v[120:123], a[88:91]
    v_mfma_f32_16x16x32_bf16 a[92:95], v[144:147], v[76:79], a[92:95]
    v_mfma_f32_16x16x32_bf16 a[92:95], v[148:151], v[92:95], a[92:95]
    v_mfma_f32_16x16x32_bf16 a[92:95], v[152:155], v[108:111], a[92:95]
    v_mfma_f32_16x16x32_bf16 a[92:95], v[156:159], v[124:127], a[92:95]
    s_waitcnt lgkmcnt(0)
    v_mfma_f32_16x16x32_bf16 a[96:99], v[128:131], v[64:67], a[96:99]
    ds_read_b64_tr_b16 v[144:145], v254 offset:96
    v_mfma_f32_16x16x32_bf16 a[96:99], v[132:135], v[80:83], a[96:99]
    ds_read_b64_tr_b16 v[146:147], v254 offset:352
    v_mfma_f32_16x16x32_bf16 a[96:99], v[136:139], v[96:99], a[96:99]
    ds_read_b64_tr_b16 v[148:149], v254 offset:608
    v_accvgpr_read_b32 v176, a64
    v_mfma_f32_16x16x32_bf16 a[96:99], v[140:143], v[112:115], a[96:99]
    ds_read_b64_tr_b16 v[150:151], v254 offset:864
    v_accvgpr_read_b32 v177, a65
    v_mfma_f32_16x16x32_bf16 a[100:103], v[128:131], v[68:71], a[100:103]
    ds_read_b64_tr_b16 v[152:153], v254 offset:8544
    v_accvgpr_read_b32 v178, a66
    v_mfma_f32_16x16x32_bf16 a[100:103], v[132:135], v[84:87], a[100:103]
    ds_read_b64_tr_b16 v[154:155], v254 offset:8800
    v_accvgpr_read_b32 v179, a67
    v_mfma_f32_16x16x32_bf16 a[100:103], v[136:139], v[100:103], a[100:103]
    ds_read_b64_tr_b16 v[156:157], v254 offset:9056
    buffer_load_dword v212, v202, s[52:55], 0 offen sc1
    v_mfma_f32_16x16x32_bf16 a[100:103], v[140:143], v[116:119], a[100:103]
    ds_read_b64_tr_b16 v[158:159], v254 offset:9312
    v_cvt_pk_bf16_f32 v160, v176, v177
    v_mfma_f32_16x16x32_bf16 a[104:107], v[128:131], v[72:75], a[104:107]
    v_cvt_pk_bf16_f32 v161, v178, v179
    s_waitcnt vmcnt(14)
    s_barrier
    v_mfma_f32_16x16x32_bf16 a[104:107], v[132:135], v[88:91], a[104:107]
    s_add_u32 s41, s19, 0x1c000
    s_add_u32 m0, s18, 118272
    v_accvgpr_read_b32 v180, a80
    v_mfma_f32_16x16x32_bf16 a[104:107], v[136:139], v[104:107], a[104:107]
    buffer_load_dwordx4 v252, s[24:27], s41 offen offset:0  lds
    v_accvgpr_read_b32 v181, a81
    v_mfma_f32_16x16x32_bf16 a[104:107], v[140:143], v[120:123], a[104:107]
    s_waitcnt vmcnt(6)
    s_add_u32 m0, s18, 118432
    v_accvgpr_read_b32 v182, a82
    v_mfma_f32_16x16x32_bf16 v[208:211], v[196:199], v[232:235], v[208:211]
    buffer_load_dwordx4 v252, s[24:27], s41 offen offset:896  lds
    v_accvgpr_read_b32 v183, a83
    v_mfma_f32_16x16x32_bf16 v[208:211], v[196:199], v[236:239], v[208:211]
    s_add_u32 m0, s18, 118592
    v_cvt_pk_bf16_f32 v162, v180, v181
    v_cvt_pk_bf16_f32 v163, v182, v183
    v_mfma_f32_16x16x32_bf16 v[208:211], v[196:199], v[240:243], v[208:211]
    buffer_load_dwordx4 v252, s[24:27], s41 offen offset:1792  lds
    v_accvgpr_read_b32 v176, a68
    v_mfma_f32_16x16x32_bf16 v[208:211], v[196:199], v[244:247], v[208:211]
    s_add_u32 m0, s18, 118752
    v_accvgpr_read_b32 v177, a69
    v_accvgpr_read_b32 v178, a70
    v_mfma_f32_16x16x32_bf16 a[108:111], v[128:131], v[76:79], a[108:111]
    s_add_u32 s17, s13, 33792
    buffer_load_dwordx4 v252, s[24:27], s41 offen offset:2688  lds
    v_accvgpr_read_b32 v179, a71
    v_mfma_f32_16x16x32_bf16 a[108:111], v[132:135], v[92:95], a[108:111]
    v_cvt_pk_bf16_f32 v164, v176, v177
    v_cvt_pk_bf16_f32 v165, v178, v179
    v_mfma_f32_16x16x32_bf16 a[108:111], v[136:139], v[108:111], a[108:111]
    v_accvgpr_read_b32 v180, a84
    v_accvgpr_read_b32 v181, a85
    v_mfma_f32_16x16x32_bf16 a[108:111], v[140:143], v[124:127], a[108:111]
    s_waitcnt lgkmcnt(0)
    v_add_u32 v254, s17, v251
    v_accvgpr_read_b32 v182, a86
    v_mfma_f32_16x16x32_bf16 a[112:115], v[144:147], v[64:67], a[112:115]
    ds_read_b64_tr_b16 v[128:129], v254 offset:0
    v_accvgpr_read_b32 v183, a87
    v_mfma_f32_16x16x32_bf16 a[112:115], v[148:151], v[80:83], a[112:115]
    s_add_u32 s19, s19, 128
    ds_read_b64_tr_b16 v[130:131], v254 offset:256
    v_cvt_pk_bf16_f32 v166, v180, v181
    v_mfma_f32_16x16x32_bf16 a[112:115], v[152:155], v[96:99], a[112:115]
    s_xor_b32 s13, s13, 67584
    ds_read_b64_tr_b16 v[132:133], v254 offset:512
    v_cvt_pk_bf16_f32 v167, v182, v183
    v_mfma_f32_16x16x32_bf16 a[112:115], v[156:159], v[112:115], a[112:115]
    s_waitcnt vmcnt(5)
    ds_read_b64_tr_b16 v[134:135], v254 offset:768
    buffer_store_dword v200, off, s[52:55], s47
    v_mfma_f32_16x16x32_bf16 a[116:119], v[144:147], v[68:71], a[116:119]
    s_sub_u32 s18, s33, s13
    ds_read_b64_tr_b16 v[136:137], v254 offset:8448
    v_cvt_pk_bf16_f32 v190, v208, v209
    v_mfma_f32_16x16x32_bf16 a[116:119], v[148:151], v[84:87], a[116:119]
    ds_read_b64_tr_b16 v[138:139], v254 offset:8704
    v_cvt_pk_bf16_f32 v191, v210, v211
    v_mfma_f32_16x16x32_bf16 a[116:119], v[152:155], v[100:103], a[116:119]
    ds_read_b64_tr_b16 v[140:141], v254 offset:8960
    buffer_store_dwordx2 v[190:191], v249, s[56:59], s16 offen
    v_mfma_f32_16x16x32_bf16 a[116:119], v[156:159], v[116:119], a[116:119]
    s_cmp_eq_u32 s19, 896
    s_cselect_b32 s19, 0x40000000, s19
    ds_read_b64_tr_b16 v[142:143], v254 offset:9216
    v_mfma_f32_16x16x32_bf16 a[120:123], v[144:147], v[72:75], a[120:123]
    v_mfma_f32_16x16x32_bf16 a[120:123], v[148:151], v[88:91], a[120:123]
    v_mfma_f32_16x16x32_bf16 a[120:123], v[152:155], v[104:107], a[120:123]
    v_mfma_f32_16x16x32_bf16 a[120:123], v[156:159], v[120:123], a[120:123]
    v_mfma_f32_16x16x32_bf16 a[124:127], v[144:147], v[76:79], a[124:127]
    s_waitcnt vmcnt(6)
    v_cmp_gt_i32 vcc, s12, v212
    v_mfma_f32_16x16x32_bf16 a[124:127], v[148:151], v[92:95], a[124:127]
    s_and_b64 vcc, vcc, s[62:63]
    s_cbranch_vccnz NPd_spin
NPd_ok:
    v_mfma_f32_16x16x32_bf16 a[124:127], v[152:155], v[108:111], a[124:127]
    s_add_u32 s40, s22, 0x0
    buffer_load_dwordx4 v[216:219], v255, s[28:31], s40 offen sc1
    v_mfma_f32_16x16x32_bf16 a[124:127], v[156:159], v[124:127], a[124:127]
    s_waitcnt lgkmcnt(0)
    s_add_u32 s40, s22, 0x10000
    buffer_load_dwordx4 v[220:223], v255, s[28:31], s40 offen sc1
    v_mfma_f32_16x16x32_bf16 a[0:3], v[128:131], v[0:3], 0
    s_add_u32 s40, s22, 0x20000
    s_mov_b32 s12, s10
    buffer_load_dwordx4 v[224:227], v255, s[28:31], s40 offen sc1
    ds_read_b64_tr_b16 v[144:145], v254 offset:32
    v_mfma_f32_16x16x32_bf16 a[0:3], v[132:135], v[16:19], a[0:3]
    s_add_u32 s40, s22, 0x30000
    buffer_load_dwordx4 v[228:231], v255, s[28:31], s40 offen sc1
    ds_read_b64_tr_b16 v[146:147], v254 offset:288
    v_mfma_f32_16x16x32_bf16 a[0:3], v[136:139], v[32:35], a[0:3]
    s_add_u32 s10, s10, 1
    ds_read_b64_tr_b16 v[148:149], v254 offset:544
    buffer_store_dwordx4 v[160:163], v253, s[28:31], s14 offen offset:0
    v_mfma_f32_16x16x32_bf16 a[0:3], v[140:143], v[48:51], a[0:3]
    ds_read_b64_tr_b16 v[150:151], v254 offset:800
    v_accvgpr_read_b32 v176, a72
    v_mfma_f32_16x16x32_bf16 a[4:7], v[128:131], v[4:7], 0
    s_mov_b32 s22, s15
    ds_read_b64_tr_b16 v[152:153], v254 offset:8480
    buffer_store_dwordx4 v[164:167], v253, s[28:31], s14 offen offset:1024
    v_mfma_f32_16x16x32_bf16 a[4:7], v[132:135], v[20:23], a[4:7]
    ds_read_b64_tr_b16 v[154:155], v254 offset:8736
    v_accvgpr_read_b32 v177, a73
    v_mfma_f32_16x16x32_bf16 a[4:7], v[136:139], v[36:39], a[4:7]
    ds_read_b64_tr_b16 v[156:157], v254 offset:8992
    v_accvgpr_read_b32 v178, a74
    v_mfma_f32_16x16x32_bf16 a[4:7], v[140:143], v[52:55], a[4:7]
    ds_read_b64_tr_b16 v[158:159], v254 offset:9248
    v_accvgpr_read_b32 v179, a75
    v_mfma_f32_16x16x32_bf16 a[8:11], v[128:131], v[8:11], 0
    v_cvt_pk_bf16_f32 v168, v176, v177
    v_cvt_pk_bf16_f32 v169, v178, v179
    v_mfma_f32_16x16x32_bf16 a[8:11], v[132:135], v[24:27], a[8:11]
    v_accvgpr_read_b32 v180, a88
    v_accvgpr_read_b32 v181, a89
    v_mfma_f32_16x16x32_bf16 a[8:11], v[136:139], v[40:43], a[8:11]
    v_accvgpr_read_b32 v182, a90
    v_accvgpr_read_b32 v183, a91
    v_mfma_f32_16x16x32_bf16 a[8:11], v[140:143], v[56:59], a[8:11]
    v_cvt_pk_bf16_f32 v170, v180, v181
    v_cvt_pk_bf16_f32 v171, v182, v183
    v_mfma_f32_16x16x32_bf16 a[12:15], v[128:131], v[12:15], 0
    buffer_store_dwordx4 v[168:171], v253, s[28:31], s14 offen offset:2048
    v_mov_b32 v200, s10
    v_mfma_f32_16x16x32_bf16 a[12:15], v[132:135], v[28:31], a[12:15]
    v_accvgpr_read_b32 v176, a76
    v_accvgpr_read_b32 v177, a77
    v_mfma_f32_16x16x32_bf16 a[12:15], v[136:139], v[44:47], a[12:15]
    v_accvgpr_read_b32 v178, a78
    v_accvgpr_read_b32 v179, a79
    v_mfma_f32_16x16x32_bf16 a[12:15], v[140:143], v[60:63], a[12:15]
    s_waitcnt lgkmcnt(0)
    v_cvt_pk_bf16_f32 v172, v176, v177
    v_cvt_pk_bf16_f32 v173, v178, v179
    v_mfma_f32_16x16x32_bf16 a[16:19], v[144:147], v[0:3], 0
    ds_read_b64_tr_b16 v[128:129], v254 offset:64
    v_accvgpr_read_b32 v180, a92
    v_mfma_f32_16x16x32_bf16 a[16:19], v[148:151], v[16:19], a[16:19]
    ds_read_b64_tr_b16 v[130:131], v254 offset:320
    v_accvgpr_read_b32 v181, a93
    v_mfma_f32_16x16x32_bf16 a[16:19], v[152:155], v[32:35], a[16:19]
    ds_read_b64_tr_b16 v[132:133], v254 offset:576
    v_accvgpr_read_b32 v182, a94
    v_mfma_f32_16x16x32_bf16 a[16:19], v[156:159], v[48:51], a[16:19]
    ds_read_b64_tr_b16 v[134:135], v254 offset:832
    v_accvgpr_read_b32 v183, a95
    v_mfma_f32_16x16x32_bf16 a[20:23], v[144:147], v[4:7], 0
    ds_read_b64_tr_b16 v[136:137], v254 offset:8512
    v_cvt_pk_bf16_f32 v174, v180, v181
    v_mfma_f32_16x16x32_bf16 a[20:23], v[148:151], v[20:23], a[20:23]
    ds_read_b64_tr_b16 v[138:139], v254 offset:8768
    v_cvt_pk_bf16_f32 v175, v182, v183
    v_mfma_f32_16x16x32_bf16 a[20:23], v[152:155], v[36:39], a[20:23]
    ds_read_b64_tr_b16 v[140:141], v254 offset:9024
    buffer_store_dwordx4 v[172:175], v253, s[28:31], s14 offen offset:3072
    v_mfma_f32_16x16x32_bf16 a[20:23], v[156:159], v[52:55], a[20:23]
    s_mov_b32 s15, s14
    ds_read_b64_tr_b16 v[142:143], v254 offset:9280
    v_mfma_f32_16x16x32_bf16 a[24:27], v[144:147], v[8:11], 0
    s_add_u32 s14, s14, 0x40000
    v_mfma_f32_16x16x32_bf16 a[24:27], v[148:151], v[24:27], a[24:27]
    s_and_b32 s14, s14, 0xfffff
    v_mfma_f32_16x16x32_bf16 a[24:27], v[152:155], v[40:43], a[24:27]
    v_mfma_f32_16x16x32_bf16 a[24:27], v[156:159], v[56:59], a[24:27]
    v_mfma_f32_16x16x32_bf16 a[28:31], v[144:147], v[12:15], 0
    v_mfma_f32_16x16x32_bf16 a[28:31], v[148:151], v[28:31], a[28:31]
    v_mfma_f32_16x16x32_bf16 a[28:31], v[152:155], v[44:47], a[28:31]
    v_mfma_f32_16x16x32_bf16 a[28:31], v[156:159], v[60:63], a[28:31]
    s_waitcnt lgkmcnt(0)
    v_mfma_f32_16x16x32_bf16 a[32:35], v[128:131], v[0:3], 0
    ds_read_b64_tr_b16 v[144:145], v254 offset:96
    v_mfma_f32_16x16x32_bf16 a[32:35], v[132:135], v[16:19], a[32:35]
    ds_read_b64_tr_b16 v[146:147], v254 offset:352
    v_mfma_f32_16x16x32_bf16 a[32:35], v[136:139], v[32:35], a[32:35]
    ds_read_b64_tr_b16 v[148:149], v254 offset:608
    v_accvgpr_read_b32 v176, a96
    v_mfma_f32_16x16x32_bf16 a[32:35], v[140:143], v[48:51], a[32:35]
    ds_read_b64_tr_b16 v[150:151], v254 offset:864
    v_accvgpr_read_b32 v177, a97
    v_mfma_f32_16x16x32_bf16 a[36:39], v[128:131], v[4:7], 0
    ds_read_b64_tr_b16 v[152:153], v254 offset:8544
    v_accvgpr_read_b32 v178, a98
    v_mfma_f32_16x16x32_bf16 a[36:39], v[132:135], v[20:23], a[36:39]
    ds_read_b64_tr_b16 v[154:155], v254 offset:8800
    v_accvgpr_read_b32 v179, a99
    v_mfma_f32_16x16x32_bf16 a[36:39], v[136:139], v[36:39], a[36:39]
    ds_read_b64_tr_b16 v[156:157], v254 offset:9056
    buffer_load_dword v212, v202, s[52:55], 0 offen sc1
    v_mfma_f32_16x16x32_bf16 a[36:39], v[140:143], v[52:55], a[36:39]
    ds_read_b64_tr_b16 v[158:159], v254 offset:9312
    v_cvt_pk_bf16_f32 v160, v176, v177
    v_mfma_f32_16x16x32_bf16 a[40:43], v[128:131], v[8:11], 0
    v_cvt_pk_bf16_f32 v161, v178, v179
    s_waitcnt vmcnt(15)
    s_barrier
    v_mfma_f32_16x16x32_bf16 a[40:43], v[132:135], v[24:27], a[40:43]
    s_add_u32 s41, s19, 0x0
    s_add_u32 m0, s18, 67584
    v_accvgpr_read_b32 v180, a112
    v_mfma_f32_16x16x32_bf16 a[40:43], v[136:139], v[40:43], a[40:43]
    buffer_load_dwordx4 v252, s[24:27], s41 offen offset:0  lds
    v_accvgpr_read_b32 v181, a113
    v_mfma_f32_16x16x32_bf16 a[40:43], v[140:143], v[56:59], a[40:43]
    s_waitcnt vmcnt(6)
    s_add_u32 m0, s18, 67744
    v_accvgpr_read_b32 v182, a114
    v_mfma_f32_16x16x32_bf16 v[204:207], v[192:195], v[216:219], 0
    buffer_load_dwordx4 v252, s[24:27], s41 offen offset:896  lds
    v_accvgpr_read_b32 v183, a115
    v_mfma_f32_16x16x32_bf16 v[204:207], v[192:195], v[220:223], v[204:207]
    s_add_u32 m0, s18, 67904
    v_cvt_pk_bf16_f32 v162, v180, v181
    v_cvt_pk_bf16_f32 v163, v182, v183
    v_mfma_f32_16x16x32_bf16 v[204:207], v[192:195], v[224:227], v[204:207]
    buffer_load_dwordx4 v252, s[24:27], s41 offen offset:1792  lds
    v_accvgpr_read_b32 v176, a100
    v_mfma_f32_16x16x32_bf16 v[204:207], v[192:195], v[228:231], v[204:207]
    s_add_u32 m0, s18, 68064
    v_accvgpr_read_b32 v177, a101
    v_accvgpr_read_b32 v178, a102
    v_mfma_f32_16x16x32_bf16 a[44:47], v[128:131], v[12:15], 0
    s_sub_u32 s17, 118272, s13
    buffer_load_dwordx4 v252, s[24:27], s41 offen offset:2688  lds
    v_accvgpr_read_b32 v179, a103
    v_mfma_f32_16x16x32_bf16 a[44:47], v[132:135], v[28:31], a[44:47]
    v_cvt_pk_bf16_f32 v164, v176, v177
    v_cvt_pk_bf16_f32 v165, v178, v179
    v_mfma_f32_16x16x32_bf16 a[44:47], v[136:139], v[44:47], a[44:47]
    v_accvgpr_read_b32 v180, a116
    v_accvgpr_read_b32 v181, a117
    v_mfma_f32_16x16x32_bf16 a[44:47], v[140:143], v[60:63], a[44:47]
    s_waitcnt lgkmcnt(0)
    v_add_u32 v254, s17, v251
    v_accvgpr_read_b32 v182, a118
    v_mfma_f32_16x16x32_bf16 a[48:51], v[144:147], v[0:3], 0
    ds_read_b64_tr_b16 v[128:129], v254 offset:0
    v_accvgpr_read_b32 v183, a119
    v_mfma_f32_16x16x32_bf16 a[48:51], v[148:151], v[16:19], a[48:51]
    ds_read_b64_tr_b16 v[130:131], v254 offset:256
    v_cvt_pk_bf16_f32 v166, v180, v181
    v_mfma_f32_16x16x32_bf16 a[48:51], v[152:155], v[32:35], a[48:51]
    ds_read_b64_tr_b16 v[132:133], v254 offset:512
    v_cvt_pk_bf16_f32 v167, v182, v183
    v_mfma_f32_16x16x32_bf16 a[48:51], v[156:159], v[48:51], a[48:51]
    s_waitcnt vmcnt(5)
    ds_read_b64_tr_b16 v[134:135], v254 offset:768
    buffer_store_dword v200, off, s[52:55], s47
    v_mfma_f32_16x16x32_bf16 a[52:55], v[144:147], v[4:7], 0
    ds_read_b64_tr_b16 v[136:137], v254 offset:8448
    v_mfma_f32_16x16x32_bf16 a[52:55], v[148:151], v[20:23], a[52:55]
    ds_read_b64_tr_b16 v[138:139], v254 offset:8704
    v_mfma_f32_16x16x32_bf16 a[52:55], v[152:155], v[36:39], a[52:55]
    ds_read_b64_tr_b16 v[140:141], v254 offset:8960
    v_mfma_f32_16x16x32_bf16 a[52:55], v[156:159], v[52:55], a[52:55]
    ds_read_b64_tr_b16 v[142:143], v254 offset:9216
    v_mfma_f32_16x16x32_bf16 a[56:59], v[144:147], v[8:11], 0
    v_mfma_f32_16x16x32_bf16 a[56:59], v[148:151], v[24:27], a[56:59]
    v_mfma_f32_16x16x32_bf16 a[56:59], v[152:155], v[40:43], a[56:59]
    v_mfma_f32_16x16x32_bf16 a[56:59], v[156:159], v[56:59], a[56:59]
    v_mfma_f32_16x16x32_bf16 a[60:63], v[144:147], v[12:15], 0
    s_waitcnt vmcnt(5)
    v_cmp_gt_i32 vcc, s12, v212
    v_mfma_f32_16x16x32_bf16 a[60:63], v[148:151], v[28:31], a[60:63]
    s_and_b64 vcc, vcc, s[62:63]
    s_cbranch_vccnz NPa_spin
NPa_ok:
    v_mfma_f32_16x16x32_bf16 a[60:63], v[152:155], v[44:47], a[60:63]
    s_add_u32 s40, s22, 0x0
    buffer_load_dwordx4 v[232:235], v255, s[28:31], s40 offen sc1
    v_mfma_f32_16x16x32_bf16 a[60:63], v[156:159], v[60:63], a[60:63]
    s_waitcnt lgkmcnt(0)
    s_add_u32 s40, s22, 0x10000
    buffer_load_dwordx4 v[236:239], v255, s[28:31], s40 offen sc1
    s_branch NO_loop
NO_exit:
    s_add_u32 s40, s22, 0x20000
    buffer_load_dwordx4 v[224:227], v255, s[28:31], s40 offen sc1
    s_add_u32 s40, s22, 0x30000
    buffer_load_dwordx4 v[228:231], v255, s[28:31], s40 offen sc1
    s_nop 3
    buffer_load_dword v212, v202, s[52:55], 0 offen sc1
    buffer_store_dwordx4 v[160:163], v253, s[28:31], s14 offen offset:0
    buffer_store_dwordx4 v[164:167], v253, s[28:31], s14 offen offset:1024
    v_accvgpr_read_b32 v176, a8
    v_accvgpr_read_b32 v177, a9
    v_accvgpr_read_b32 v178, a10
    v_accvgpr_read_b32 v179, a11
    v_cvt_pk_bf16_f32 v168, v176, v177
    v_cvt_pk_bf16_f32 v169, v178, v179
    v_accvgpr_read_b32 v180, a24
    v_accvgpr_read_b32 v181, a25
    v_accvgpr_read_b32 v182, a26
    v_accvgpr_read_b32 v183, a27
    v_cvt_pk_bf16_f32 v170, v180, v181
    v_cvt_pk_bf16_f32 v171, v182, v183
    buffer_store_dwordx4 v[168:171], v253, s[28:31], s14 offen offset:2048
    v_accvgpr_read_b32 v176, a12
    v_accvgpr_read_b32 v177, a13
    v_accvgpr_read_b32 v178, a14
    v_accvgpr_read_b32 v179, a15
    v_cvt_pk_bf16_f32 v172, v176, v177
    v_cvt_pk_bf16_f32 v173, v178, v179
    v_accvgpr_read_b32 v180, a28
    v_accvgpr_read_b32 v181, a29
    v_accvgpr_read_b32 v182, a30
    v_accvgpr_read_b32 v183, a31
    v_cvt_pk_bf16_f32 v174, v180, v181
    v_cvt_pk_bf16_f32 v175, v182, v183
    buffer_store_dwordx4 v[172:175], v253, s[28:31], s14 offen offset:3072
    s_waitcnt vmcnt(5)
    v_mfma_f32_16x16x32_bf16 v[208:211], v[192:195], v[216:219], 0
    v_mfma_f32_16x16x32_bf16 v[208:211], v[192:195], v[220:223], v[208:211]
    v_mfma_f32_16x16x32_bf16 v[208:211], v[192:195], v[224:227], v[208:211]
    v_mfma_f32_16x16x32_bf16 v[208:211], v[192:195], v[228:231], v[208:211]
    v_accvgpr_read_b32 v176, a32
    v_accvgpr_read_b32 v177, a33
    v_accvgpr_read_b32 v178, a34
    v_accvgpr_read_b32 v179, a35
    v_cvt_pk_bf16_f32 v160, v176, v177
    v_cvt_pk_bf16_f32 v161, v178, v179
    v_accvgpr_read_b32 v180, a48
    v_accvgpr_read_b32 v181, a49
    v_accvgpr_read_b32 v182, a50
    v_accvgpr_read_b32 v183, a51
    v_cvt_pk_bf16_f32 v162, v180, v181
    v_cvt_pk_bf16_f32 v163, v182, v183
    v_accvgpr_read_b32 v176, a36
    v_accvgpr_read_b32 v177, a37
    v_accvgpr_read_b32 v178, a38
    v_accvgpr_read_b32 v179, a39
    v_cvt_pk_bf16_f32 v164, v176, v177
    v_cvt_pk_bf16_f32 v165, v178, v179
    v_accvgpr_read_b32 v180, a52
    v_accvgpr_read_b32 v181, a53
    v_accvgpr_read_b32 v182, a54
    v_accvgpr_read_b32 v183, a55
    v_cvt_pk_bf16_f32 v166, v180, v181
    v_cvt_pk_bf16_f32 v167, v182, v183
    s_waitcnt vmcnt(4)
    v_cmp_gt_i32 vcc, 13, v212
    s_nop 1
    s_and_b64 vcc, vcc, s[62:63]
    s_cbranch_vccnz NPz_spin
NPz_ok:
    s_add_u32 s43, s14, 0x40000
    s_and_b32 s43, s43, 0xfffff
    s_add_u32 s40, s15, 0x0
    buffer_load_dwordx4 v[232:235], v255, s[28:31], s40 offen sc1
    s_add_u32 s40, s15, 0x10000
    buffer_load_dwordx4 v[236:239], v255, s[28:31], s40 offen sc1
    s_add_u32 s40, s15, 0x20000
    buffer_load_dwordx4 v[240:243], v255, s[28:31], s40 offen sc1
    s_add_u32 s40, s15, 0x30000
    buffer_load_dwordx4 v[244:247], v255, s[28:31], s40 offen sc1
    buffer_store_dwordx4 v[160:163], v253, s[28:31], s43 offen offset:0
    buffer_store_dwordx4 v[164:167], v253, s[28:31], s43 offen offset:1024
    v_accvgpr_read_b32 v176, a40
    v_accvgpr_read_b32 v177, a41
    v_accvgpr_read_b32 v178, a42
    v_accvgpr_read_b32 v179, a43
    v_cvt_pk_bf16_f32 v168, v176, v177
    v_cvt_pk_bf16_f32 v169, v178, v179
    v_accvgpr_read_b32 v180, a56
    v_accvgpr_read_b32 v181, a57
    v_accvgpr_read_b32 v182, a58
    v_accvgpr_read_b32 v183, a59
    v_cvt_pk_bf16_f32 v170, v180, v181
    v_cvt_pk_bf16_f32 v171, v182, v183
    buffer_store_dwordx4 v[168:171], v253, s[28:31], s43 offen offset:2048
    v_accvgpr_read_b32 v176, a44
    v_accvgpr_read_b32 v177, a45
    v_accvgpr_read_b32 v178, a46
    v_accvgpr_read_b32 v179, a47
    v_cvt_pk_bf16_f32 v172, v176, v177
    v_cvt_pk_bf16_f32 v173, v178, v179
    v_accvgpr_read_b32 v180, a60
    v_accvgpr_read_b32 v181, a61
    v_accvgpr_read_b32 v182, a62
    v_accvgpr_read_b32 v183, a63
    v_cvt_pk_bf16_f32 v174, v180, v181
    v_cvt_pk_bf16_f32 v175, v182, v183
    buffer_store_dwordx4 v[172:175], v253, s[28:31], s43 offen offset:3072
    v_mov_b32 v200, 15
    s_waitcnt vmcnt(0)
    buffer_store_dword v200, off, s[52:55], s47
    buffer_load_dword v212, v202, s[52:55], 0 offen sc1
    s_waitcnt vmcnt(2)
    v_mfma_f32_16x16x32_bf16 v[208:211], v[196:199], v[232:235], v[208:211]
    v_mfma_f32_16x16x32_bf16 v[208:211], v[196:199], v[236:239], v[208:211]
    v_mfma_f32_16x16x32_bf16 v[208:211], v[196:199], v[240:243], v[208:211]
    v_mfma_f32_16x16x32_bf16 v[208:211], v[196:199], v[244:247], v[208:211]
    s_waitcnt vmcnt(0)
    v_cmp_gt_i32 vcc, 15, v212
    s_nop 1
    s_and_b64 vcc, vcc, s[62:63]
    s_cbranch_vccnz NPy_spin
NPy_ok:
    s_add_u32 s40, s14, 0x0
    buffer_load_dwordx4 v[216:219], v255, s[28:31], s40 offen sc1
    s_add_u32 s40, s14, 0x10000
    buffer_load_dwordx4 v[220:223], v255, s[28:31], s40 offen sc1
    s_add_u32 s40, s14, 0x20000
    buffer_load_dwordx4 v[224:227], v255, s[28:31], s40 offen sc1
    s_add_u32 s40, s14, 0x30000
    buffer_load_dwordx4 v[228:231], v255, s[28:31], s40 offen sc1
    s_add_u32 s40, s43, 0x0
    buffer_load_dwordx4 v[232:235], v255, s[28:31], s40 offen sc1
    s_add_u32 s40, s43, 0x10000
    buffer_load_dwordx4 v[236:239], v255, s[28:31], s40 offen sc1
    s_add_u32 s40, s43, 0x20000
    buffer_load_dwordx4 v[240:243], v255, s[28:31], s40 offen sc1
    s_add_u32 s40, s43, 0x30000
    buffer_load_dwordx4 v[244:247], v255, s[28:31], s40 offen sc1
    v_cvt_pk_bf16_f32 v190, v208, v209
    v_cvt_pk_bf16_f32 v191, v210, v211
    s_mov_b32 s41, 640
    buffer_store_dwordx2 v[190:191], v249, s[56:59], s41 offen
    s_waitcnt vmcnt(8)
    v_mfma_f32_16x16x32_bf16 v[204:207], v[192:195], v[216:219], 0
    s_waitcnt vmcnt(7)
    v_mfma_f32_16x16x32_bf16 v[204:207], v[192:195], v[220:223], v[204:207]
    s_waitcnt vmcnt(6)
    v_mfma_f32_16x16x32_bf16 v[204:207], v[192:195], v[224:227], v[204:207]
    s_waitcnt vmcnt(5)
    v_mfma_f32_16x16x32_bf16 v[204:207], v[192:195], v[228:231], v[204:207]
    s_waitcnt vmcnt(4)
    v_mfma_f32_16x16x32_bf16 v[204:207], v[196:199], v[232:235], v[204:207]
    s_waitcnt vmcnt(3)
    v_mfma_f32_16x16x32_bf16 v[204:207], v[196:199], v[236:239], v[204:207]
    s_waitcnt vmcnt(2)
    v_mfma_f32_16x16x32_bf16 v[204:207], v[196:199], v[240:243], v[204:207]
    s_waitcnt vmcnt(1)
    v_mfma_f32_16x16x32_bf16 v[204:207], v[196:199], v[244:247], v[204:207]
    s_nop 7
    v_cvt_pk_bf16_f32 v188, v204, v205
    v_cvt_pk_bf16_f32 v189, v206, v207
    s_mov_b32 s41, 768
    buffer_store_dwordx2 v[188:189], v249, s[56:59], s41 offen
L_end:
    s_endpgm
CODE_END:
M_spin:
    s_mov_b32 s36, 0
M_spin_loop:
    s_sleep 2
    buffer_load_dwordx4 v[176:179], off, s[48:51], 0 sc1
    s_waitcnt vmcnt(0)
    v_readfirstlane_b32 s4, v176
    v_readfirstlane_b32 s5, v177
    v_readfirstlane_b32 s6, v178
    v_readfirstlane_b32 s7, v179
    s_and_b32 s3, s4, s5
    s_and_b32 s3, s3, s6
    s_and_b32 s3, s3, s7
    s_and_b32 s3, s3, 0x80808080
    s_cmp_eq_u32 s3, 0x80808080
    s_cbranch_scc1 M_valid
    s_add_u32 s36, s36, 1
    s_cmp_lt_u32 s36, 0x30d40
    s_cbranch_scc1 M_spin_loop
    s_branch M_valid
NPa_spin:
    s_mov_b32 s36, 0
NPa_loop:
    buffer_load_dword v212, v202, s[52:55], 0 offen sc1
    s_waitcnt vmcnt(0)
    v_cmp_gt_i32 vcc, s12, v212
    s_nop 1
    s_and_b64 vcc, vcc, s[62:63]
    s_cbranch_vccz NPa_ok
    s_add_u32 s36, s36, 1
    s_cmp_lt_u32 s36, 0x30d40
    s_cbranch_scc1 NPa_loop
    s_branch NPa_ok
NPb_spin:
    s_mov_b32 s36, 0
NPb_loop:
    buffer_load_dword v212, v202, s[52:55], 0 offen sc1
    s_waitcnt vmcnt(0)
    v_cmp_gt_i32 vcc, s12, v212
    s_nop 1
    s_and_b64 vcc, vcc, s[62:63]
    s_cbranch_vccz NPb_ok
    s_add_u32 s36, s36, 1
    s_cmp_lt_u32 s36, 0x30d40
    s_cbranch_scc1 NPb_loop
    s_branch NPb_ok
NPc_spin:
    s_mov_b32 s36, 0
NPc_loop:
    buffer_load_dword v212, v202, s[52:55], 0 offen sc1
    s_waitcnt vmcnt(0)
    v_cmp_gt_i32 vcc, s12, v212
    s_nop 1
    s_and_b64 vcc, vcc, s[62:63]
    s_cbranch_vccz NPc_ok
    s_add_u32 s36, s36, 1
    s_cmp_lt_u32 s36, 0x30d40
    s_cbranch_scc1 NPc_loop
    s_branch NPc_ok
NPd_spin:
    s_mov_b32 s36, 0
NPd_loop:
    buffer_load_dword v212, v202, s[52:55], 0 offen sc1
    s_waitcnt vmcnt(0)
    v_cmp_gt_i32 vcc, s12, v212
    s_nop 1
    s_and_b64 vcc, vcc, s[62:63]
    s_cbranch_vccz NPd_ok
    s_add_u32 s36, s36, 1
    s_cmp_lt_u32 s36, 0x30d40
    s_cbranch_scc1 NPd_loop
    s_branch NPd_ok
NPz_spin:
    s_mov_b32 s36, 0
NPz_loop:
    buffer_load_dword v212, v202, s[52:55], 0 offen sc1
    s_waitcnt vmcnt(0)
    v_cmp_gt_i32 vcc, 13, v212
    s_nop 1
    s_and_b64 vcc, vcc, s[62:63]
    s_cbranch_vccz NPz_ok
    s_add_u32 s36, s36, 1
    s_cmp_lt_u32 s36, 0x30d40
    s_cbranch_scc1 NPz_loop
    s_branch NPz_ok
NPy_spin:
    s_mov_b32 s36, 0
NPy_loop:
    buffer_load_dword v212, v202, s[52:55], 0 offen sc1
    s_waitcnt vmcnt(0)
    v_cmp_gt_i32 vcc, 15, v212
    s_nop 1
    s_and_b64 vcc, vcc, s[62:63]
    s_cbranch_vccz NPy_ok
    s_add_u32 s36, s36, 1
    s_cmp_lt_u32 s36, 0x30d40
    s_cbranch_scc1 NPy_loop
    s_branch NPy_ok
FPa_spin:
    s_mov_b32 s36, 0
FPa_loop:
    buffer_load_dword v212, v202, s[52:55], 0 offen sc1
    s_waitcnt vmcnt(0)
    v_cmp_gt_i32 vcc, s12, v212
    s_nop 1
    s_and_b64 vcc, vcc, s[62:63]
    s_cbranch_vccz FPa_ok
    s_add_u32 s36, s36, 1
    s_cmp_lt_u32 s36, 0x30d40
    s_cbranch_scc1 FPa_loop
    s_branch FPa_ok
FPb_spin:
    s_mov_b32 s36, 0
FPb_loop:
    buffer_load_dword v212, v202, s[52:55], 0 offen sc1
    s_waitcnt vmcnt(0)
    v_cmp_gt_i32 vcc, s12, v212
    s_nop 1
    s_and_b64 vcc, vcc, s[62:63]
    s_cbranch_vccz FPb_ok
    s_add_u32 s36, s36, 1
    s_cmp_lt_u32 s36, 0x30d40
    s_cbranch_scc1 FPb_loop
    s_branch FPb_ok
FPc_spin:
    s_mov_b32 s36, 0
FPc_loop:
    buffer_load_dword v212, v202, s[52:55], 0 offen sc1
    s_waitcnt vmcnt(0)
    v_cmp_gt_i32 vcc, s12, v212
    s_nop 1
    s_and_b64 vcc, vcc, s[62:63]
    s_cbranch_vccz FPc_ok
    s_add_u32 s36, s36, 1
    s_cmp_lt_u32 s36, 0x30d40
    s_cbranch_scc1 FPc_loop
    s_branch FPc_ok
FPd_spin:
    s_mov_b32 s36, 0
FPd_loop:
    buffer_load_dword v212, v202, s[52:55], 0 offen sc1
    s_waitcnt vmcnt(0)
    v_cmp_gt_i32 vcc, s12, v212
    s_nop 1
    s_and_b64 vcc, vcc, s[62:63]
    s_cbranch_vccz FPd_ok
    s_add_u32 s36, s36, 1
    s_cmp_lt_u32 s36, 0x30d40
    s_cbranch_scc1 FPd_loop
    s_branch FPd_ok
FPz_spin:
    s_mov_b32 s36, 0
FPz_loop:
    buffer_load_dword v212, v202, s[52:55], 0 offen sc1
    s_waitcnt vmcnt(0)
    v_cmp_gt_i32 vcc, 13, v212
    s_nop 1
    s_and_b64 vcc, vcc, s[62:63]
    s_cbranch_vccz FPz_ok
    s_add_u32 s36, s36, 1
    s_cmp_lt_u32 s36, 0x30d40
    s_cbranch_scc1 FPz_loop
    s_branch FPz_ok
FPy_spin:
    s_mov_b32 s36, 0
FPy_loop:
    buffer_load_dword v212, v202, s[52:55], 0 offen sc1
    s_waitcnt vmcnt(0)
    v_cmp_gt_i32 vcc, 15, v212
    s_nop 1
    s_and_b64 vcc, vcc, s[62:63]
    s_cbranch_vccz FPy_ok
    s_add_u32 s36, s36, 1
    s_cmp_lt_u32 s36, 0x30d40
    s_cbranch_scc1 FPy_loop
    s_branch FPy_ok
F_entry:
    s_add_u32 s28, s28, 0x4000000
    s_addc_u32 s29, s29, 0
    s_add_u32 s52, s52, 0x10000
    s_addc_u32 s53, s53, 0
    s_mov_b32 s14, 0x40000000
    s_mov_b32 s15, 0x40000000
    s_mov_b32 s22, 0x40000000
    s_mov_b32 s10, 0
    s_or_b32 s62, s62, s60
    s_or_b32 s63, s63, s61
    v_lshlrev_b32 v202, 2, v250
    s_waitcnt vmcnt(0) lgkmcnt(0)
    s_barrier
FO_loop:
    v_mfma_f32_16x16x32_bf16 a[0:3], v[128:131], v[64:67], a[0:3]
    s_add_u32 s40, s22, 0x20000
    s_mov_b32 s12, s10
    buffer_load_dwordx4 v[240:243], v255, s[28:31], s40 offen sc1
    ds_read_b64_tr_b16 v[144:145], v254 offset:32
    v_mfma_f32_16x16x32_bf16 a[0:3], v[132:135], v[80:83], a[0:3]
    s_add_u32 s40, s22, 0x30000
    buffer_load_dwordx4 v[244:247], v255, s[28:31], s40 offen sc1
    ds_read_b64_tr_b16 v[146:147], v254 offset:288
    v_mfma_f32_16x16x32_bf16 a[0:3], v[136:139], v[96:99], a[0:3]
    s_add_u32 s10, s10, 1
    ds_read_b64_tr_b16 v[148:149], v254 offset:544
    buffer_store_dwordx4 v[160:163], v253, s[28:31], s14 offen offset:0 sc1
    v_mfma_f32_16x16x32_bf16 a[0:3], v[140:143], v[112:115], a[0:3]
    s_add_u32 s16, s16, 128
    ds_read_b64_tr_b16 v[150:151], v254 offset:800
    v_accvgpr_read_b32 v176, a104
    v_mfma_f32_16x16x32_bf16 a[4:7], v[128:131], v[68:71], a[4:7]
    s_mov_b32 s22, s15
    ds_read_b64_tr_b16 v[152:153], v254 offset:8480
    buffer_store_dwordx4 v[164:167], v253, s[28:31], s14 offen offset:1024 sc1
    v_mfma_f32_16x16x32_bf16 a[4:7], v[132:135], v[84:87], a[4:7]
    ds_read_b64_tr_b16 v[154:155], v254 offset:8736
    v_accvgpr_read_b32 v177, a105
    v_mfma_f32_16x16x32_bf16 a[4:7], v[136:139], v[100:103], a[4:7]
    ds_read_b64_tr_b16 v[156:157], v254 offset:8992
    v_accvgpr_read_b32 v178, a106
    v_mfma_f32_16x16x32_bf16 a[4:7], v[140:143], v[116:119], a[4:7]
    ds_read_b64_tr_b16 v[158:159], v254 offset:9248
    v_accvgpr_read_b32 v179, a107
    v_mfma_f32_16x16x32_bf16 a[8:11], v[128:131], v[72:75], a[8:11]
    v_cvt_pk_bf16_f32 v168, v176, v177
    v_cvt_pk_bf16_f32 v169, v178, v179
    v_mfma_f32_16x16x32_bf16 a[8:11], v[132:135], v[88:91], a[8:11]
    v_accvgpr_read_b32 v180, a120
    v_accvgpr_read_b32 v181, a121
    v_mfma_f32_16x16x32_bf16 a[8:11], v[136:139], v[104:107], a[8:11]
    v_accvgpr_read_b32 v182, a122
    v_accvgpr_read_b32 v183, a123
    v_mfma_f32_16x16x32_bf16 a[8:11], v[140:143], v[120:123], a[8:11]
    v_cvt_pk_bf16_f32 v170, v180, v181
    v_cvt_pk_bf16_f32 v171, v182, v183
    v_mfma_f32_16x16x32_bf16 a[12:15], v[128:131], v[76:79], a[12:15]
    buffer_store_dwordx4 v[168:171], v253, s[28:31], s14 offen offset:2048 sc1
    v_mov_b32 v200, s10
    v_mfma_f32_16x16x32_bf16 a[12:15], v[132:135], v[92:95], a[12:15]
    v_accvgpr_read_b32 v176, a108
    v_accvgpr_read_b32 v177, a109
    v_mfma_f32_16x16x32_bf16 a[12:15], v[136:139], v[108:111], a[12:15]
    v_accvgpr_read_b32 v178, a110
    v_accvgpr_read_b32 v179, a111
    v_mfma_f32_16x16x32_bf16 a[12:15], v[140:143], v[124:127], a[12:15]
    s_waitcnt lgkmcnt(0)
    v_cvt_pk_bf16_f32 v172, v176, v177
    v_cvt_pk_bf16_f32 v173, v178, v179
    v_mfma_f32_16x16x32_bf16 a[16:19], v[144:147], v[64:67], a[16:19]
    ds_read_b64_tr_b16 v[128:129], v254 offset:64
    v_accvgpr_read_b32 v180, a124
    v_mfma_f32_16x16x32_bf16 a[16:19], v[148:151], v[80:83], a[16:19]
    ds_read_b64_tr_b16 v[130:131], v254 offset:320
    v_accvgpr_read_b32 v181, a125
    v_mfma_f32_16x16x32_bf16 a[16:19], v[152:155], v[96:99], a[16:19]
    ds_read_b64_tr_b16 v[132:133], v254 offset:576
    v_accvgpr_read_b32 v182, a126
    v_mfma_f32_16x16x32_bf16 a[16:19], v[156:159], v[112:115], a[16:19]
    ds_read_b64_tr_b16 v[134:135], v254 offset:832
    v_accvgpr_read_b32 v183, a127
    v_mfma_f32_16x16x32_bf16 a[20:23], v[144:147], v[68:71], a[20:23]
    ds_read_b64_tr_b16 v[136:137], v254 offset:8512
    v_cvt_pk_bf16_f32 v174, v180, v181
    v_mfma_f32_16x16x32_bf16 a[20:23], v[148:151], v[84:87], a[20:23]
    ds_read_b64_tr_b16 v[138:139], v254 offset:8768
    v_cvt_pk_bf16_f32 v175, v182, v183
    v_mfma_f32_16x16x32_bf16 a[20:23], v[152:155], v[100:103], a[20:23]
    ds_read_b64_tr_b16 v[140:141], v254 offset:9024
    buffer_store_dwordx4 v[172:175], v253, s[28:31], s14 offen offset:3072 sc1
    v_mfma_f32_16x16x32_bf16 a[20:23], v[156:159], v[116:119], a[20:23]
    s_cmp_eq_u32 s12, 4
    s_cselect_b32 s16, 0, s16
    ds_read_b64_tr_b16 v[142:143], v254 offset:9280
    v_mfma_f32_16x16x32_bf16 a[24:27], v[144:147], v[72:75], a[24:27]
    s_mov_b32 s15, s14
    v_mfma_f32_16x16x32_bf16 a[24:27], v[148:151], v[88:91], a[24:27]
    s_add_u32 s14, s14, 0x40000
    v_mfma_f32_16x16x32_bf16 a[24:27], v[152:155], v[104:107], a[24:27]
    s_cmp_eq_u32 s10, 1
    s_cselect_b32 s14, 0, s14
    v_mfma_f32_16x16x32_bf16 a[24:27], v[156:159], v[120:123], a[24:27]
    v_mfma_f32_16x16x32_bf16 a[28:31], v[144:147], v[76:79], a[28:31]
    v_mfma_f32_16x16x32_bf16 a[28:31], v[148:151], v[92:95], a[28:31]
    v_mfma_f32_16x16x32_bf16 a[28:31], v[152:155], v[108:111], a[28:31]
    v_mfma_f32_16x16x32_bf16 a[28:31], v[156:159], v[124:127], a[28:31]
    s_waitcnt lgkmcnt(0)
    v_mfma_f32_16x16x32_bf16 a[32:35], v[128:131], v[64:67], a[32:35]
    ds_read_b64_tr_b16 v[144:145], v254 offset:96
    v_mfma_f32_16x16x32_bf16 a[32:35], v[132:135], v[80:83], a[32:35]
    ds_read_b64_tr_b16 v[146:147], v254 offset:352
    v_mfma_f32_16x16x32_bf16 a[32:35], v[136:139], v[96:99], a[32:35]
    ds_read_b64_tr_b16 v[148:149], v254 offset:608
    v_accvgpr_read_b32 v176, a0
    v_mfma_f32_16x16x32_bf16 a[32:35], v[140:143], v[112:115], a[32:35]
    ds_read_b64_tr_b16 v[150:151], v254 offset:864
    v_accvgpr_read_b32 v177, a1
    v_mfma_f32_16x16x32_bf16 a[36:39], v[128:131], v[68:71], a[36:39]
    ds_read_b64_tr_b16 v[152:153], v254 offset:8544
    v_accvgpr_read_b32 v178, a2
    v_mfma_f32_16x16x32_bf16 a[36:39], v[132:135], v[84:87], a[36:39]
    ds_read_b64_tr_b16 v[154:155], v254 offset:8800
    v_accvgpr_read_b32 v179, a3
    v_mfma_f32_16x16x32_bf16 a[36:39], v[136:139], v[100:103], a[36:39]
    ds_read_b64_tr_b16 v[156:157], v254 offset:9056
    buffer_load_dword v212, v202, s[52:55], 0 offen sc1
    v_mfma_f32_16x16x32_bf16 a[36:39], v[140:143], v[116:119], a[36:39]
    ds_read_b64_tr_b16 v[158:159], v254 offset:9312
    v_cvt_pk_bf16_f32 v160, v176, v177
    v_mfma_f32_16x16x32_bf16 a[40:43], v[128:131], v[72:75], a[40:43]
    v_cvt_pk_bf16_f32 v161, v178, v179
    s_waitcnt vmcnt(14)
    s_barrier
    v_mfma_f32_16x16x32_bf16 a[40:43], v[132:135], v[88:91], a[40:43]
    s_add_u32 s41, s19, 0x1c000
    s_add_u32 m0, s18, 84480
    v_accvgpr_read_b32 v180, a16
    v_mfma_f32_16x16x32_bf16 a[40:43], v[136:139], v[104:107], a[40:43]
    buffer_load_dwordx4 v252, s[24:27], s41 offen offset:0  lds
    v_accvgpr_read_b32 v181, a17
    v_mfma_f32_16x16x32_bf16 a[40:43], v[140:143], v[120:123], a[40:43]
    s_waitcnt vmcnt(6)
    s_add_u32 m0, s18, 84640
    v_accvgpr_read_b32 v182, a18
    v_mfma_f32_16x16x32_bf16 v[204:207], v[196:199], v[232:235], v[204:207]
    buffer_load_dwordx4 v252, s[24:27], s41 offen offset:896  lds
    v_accvgpr_read_b32 v183, a19
    v_mfma_f32_16x16x32_bf16 v[204:207], v[196:199], v[236:239], v[204:207]
    s_add_u32 m0, s18, 84800
    v_cvt_pk_bf16_f32 v162, v180, v181
    v_cvt_pk_bf16_f32 v163, v182, v183
    v_mfma_f32_16x16x32_bf16 v[204:207], v[196:199], v[240:243], v[204:207]
    buffer_load_dwordx4 v252, s[24:27], s41 offen offset:1792  lds
    v_accvgpr_read_b32 v176, a4
    v_mfma_f32_16x16x32_bf16 v[204:207], v[196:199], v[244:247], v[204:207]
    s_add_u32 m0, s18, 84960
    v_accvgpr_read_b32 v177, a5
    v_accvgpr_read_b32 v178, a6
    v_mfma_f32_16x16x32_bf16 a[44:47], v[128:131], v[76:79], a[44:47]
    s_add_u32 s17, s13, 0
    buffer_load_dwordx4 v252, s[24:27], s41 offen offset:2688  lds
    v_accvgpr_read_b32 v179, a7
    v_mfma_f32_16x16x32_bf16 a[44:47], v[132:135], v[92:95], a[44:47]
    v_cvt_pk_bf16_f32 v164, v176, v177
    v_cvt_pk_bf16_f32 v165, v178, v179
    v_mfma_f32_16x16x32_bf16 a[44:47], v[136:139], v[108:111], a[44:47]
    v_accvgpr_read_b32 v180, a20
    v_accvgpr_read_b32 v181, a21
    v_mfma_f32_16x16x32_bf16 a[44:47], v[140:143], v[124:127], a[44:47]
    s_waitcnt lgkmcnt(0)
    v_add_u32 v254, s17, v251
    v_accvgpr_read_b32 v182, a22
    v_mfma_f32_16x16x32_bf16 a[48:51], v[144:147], v[64:67], a[48:51]
    ds_read_b64_tr_b16 v[128:129], v254 offset:0
    v_accvgpr_read_b32 v183, a23
    v_mfma_f32_16x16x32_bf16 a[48:51], v[148:151], v[80:83], a[48:51]
    s_add_u32 s19, s19, 128
    ds_read_b64_tr_b16 v[130:131], v254 offset:256
    v_cvt_pk_bf16_f32 v166, v180, v181
    v_mfma_f32_16x16x32_bf16 a[48:51], v[152:155], v[96:99], a[48:51]
    ds_read_b64_tr_b16 v[132:133], v254 offset:512
    v_cvt_pk_bf16_f32 v167, v182, v183
    v_mfma_f32_16x16x32_bf16 a[48:51], v[156:159], v[112:115], a[48:51]
    s_waitcnt vmcnt(5)
    ds_read_b64_tr_b16 v[134:135], v254 offset:768
    buffer_store_dword v200, off, s[52:55], s47 sc1
    v_mfma_f32_16x16x32_bf16 a[52:55], v[144:147], v[68:71], a[52:55]
    ds_read_b64_tr_b16 v[136:137], v254 offset:8448
    v_cvt_pk_bf16_f32 v188, v204, v205
    v_mfma_f32_16x16x32_bf16 a[52:55], v[148:151], v[84:87], a[52:55]
    ds_read_b64_tr_b16 v[138:139], v254 offset:8704
    v_cvt_pk_bf16_f32 v189, v206, v207
    v_mfma_f32_16x16x32_bf16 a[52:55], v[152:155], v[100:103], a[52:55]
    ds_read_b64_tr_b16 v[140:141], v254 offset:8960
    buffer_store_dwordx2 v[188:189], v249, s[56:59], s16 offen
    v_mfma_f32_16x16x32_bf16 a[52:55], v[156:159], v[116:119], a[52:55]
    s_cmp_eq_u32 s19, 896
    s_cselect_b32 s19, 0x40000000, s19
    ds_read_b64_tr_b16 v[142:143], v254 offset:9216
    v_mfma_f32_16x16x32_bf16 a[56:59], v[144:147], v[72:75], a[56:59]
    v_mfma_f32_16x16x32_bf16 a[56:59], v[148:151], v[88:91], a[56:59]
    v_mfma_f32_16x16x32_bf16 a[56:59], v[152:155], v[104:107], a[56:59]
    v_mfma_f32_16x16x32_bf16 a[56:59], v[156:159], v[120:123], a[56:59]
    v_mfma_f32_16x16x32_bf16 a[60:63], v[144:147], v[76:79], a[60:63]
    s_waitcnt vmcnt(6)
    v_cmp_gt_i32 vcc, s12, v212
    v_mfma_f32_16x16x32_bf16 a[60:63], v[148:151], v[92:95], a[60:63]
    s_and_b64 vcc, vcc, s[62:63]
    s_cbranch_vccnz FPb_spin
FPb_ok:
    v_mfma_f32_16x16x32_bf16 a[60:63], v[152:155], v[108:111], a[60:63]
    s_add_u32 s40, s22, 0x0
    buffer_load_dwordx4 v[216:219], v255, s[28:31], s40 offen sc1
    v_mfma_f32_16x16x32_bf16 a[60:63], v[156:159], v[124:127], a[60:63]
    s_waitcnt lgkmcnt(0)
    s_add_u32 s40, s22, 0x10000
    buffer_load_dwordx4 v[220:223], v255, s[28:31], s40 offen sc1
    s_sub_u32 s21, s21, 1
    s_cmp_eq_u32 s21, 0
    s_cbranch_scc1 FO_exit
    v_mfma_f32_16x16x32_bf16 a[64:67], v[128:131], v[0:3], 0
    s_add_u32 s40, s22, 0x20000
    s_mov_b32 s12, s10
    buffer_load_dwordx4 v[224:227], v255, s[28:31], s40 offen sc1
    ds_read_b64_tr_b16 v[144:145], v254 offset:32
    v_mfma_f32_16x16x32_bf16 a[64:67], v[132:135], v[16:19], a[64:67]
    s_add_u32 s40, s22, 0x30000
    buffer_load_dwordx4 v[228:231], v255, s[28:31], s40 offen sc1
    ds_read_b64_tr_b16 v[146:147], v254 offset:288
    v_mfma_f32_16x16x32_bf16 a[64:67], v[136:139], v[32:35], a[64:67]
    s_add_u32 s10, s10, 1
    ds_read_b64_tr_b16 v[148:149], v254 offset:544
    buffer_store_dwordx4 v[160:163], v253, s[28:31], s14 offen offset:0 sc1
    v_mfma_f32_16x16x32_bf16 a[64:67], v[140:143], v[48:51], a[64:67]
    ds_read_b64_tr_b16 v[150:151], v254 offset:800
    v_accvgpr_read_b32 v176, a8
    v_mfma_f32_16x16x32_bf16 a[68:71], v[128:131], v[4:7], 0
    s_mov_b32 s22, s15
    ds_read_b64_tr_b16 v[152:153], v254 offset:8480
    buffer_store_dwordx4 v[164:167], v253, s[28:31], s14 offen offset:1024 sc1
    v_mfma_f32_16x16x32_bf16 a[68:71], v[132:135], v[20:23], a[68:71]
    ds_read_b64_tr_b16 v[154:155], v254 offset:8736
    v_accvgpr_read_b32 v177, a9
    v_mfma_f32_16x16x32_bf16 a[68:71], v[136:139], v[36:39], a[68:71]
    ds_read_b64_tr_b16 v[156:157], v254 offset:8992
    v_accvgpr_read_b32 v178, a10
    v_mfma_f32_16x16x32_bf16 a[68:71], v[140:143], v[52:55], a[68:71]
    ds_read_b64_tr_b16 v[158:159], v254 offset:9248
    v_accvgpr_read_b32 v179, a11
    v_mfma_f32_16x16x32_bf16 a[72:75], v[128:131], v[8:11], 0
    v_cvt_pk_bf16_f32 v168, v176, v177
    v_cvt_pk_bf16_f32 v169, v178, v179
    v_mfma_f32_16x16x32_bf16 a[72:75], v[132:135], v[24:27], a[72:75]
    v_accvgpr_read_b32 v180, a24
    v_accvgpr_read_b32 v181, a25
    v_mfma_f32_16x16x32_bf16 a[72:75], v[136:139], v[40:43], a[72:75]
    v_accvgpr_read_b32 v182, a26
    v_accvgpr_read_b32 v183, a27
    v_mfma_f32_16x16x32_bf16 a[72:75], v[140:143], v[56:59], a[72:75]
    v_cvt_pk_bf16_f32 v170, v180, v181
    v_cvt_pk_bf16_f32 v171, v182, v183
    v_mfma_f32_16x16x32_bf16 a[76:79], v[128:131], v[12:15], 0
    buffer_store_dwordx4 v[168:171], v253, s[28:31], s14 offen offset:2048 sc1
    v_mov_b32 v200, s10
    v_mfma_f32_16x16x32_bf16 a[76:79], v[132:135], v[28:31], a[76:79]
    v_accvgpr_read_b32 v176, a12
    v_accvgpr_read_b32 v177, a13
    v_mfma_f32_16x16x32_bf16 a[76:79], v[136:139], v[44:47], a[76:79]
    v_accvgpr_read_b32 v178, a14
    v_accvgpr_read_b32 v179, a15
    v_mfma_f32_16x16x32_bf16 a[76:79], v[140:143], v[60:63], a[76:79]
    s_waitcnt lgkmcnt(0)
    v_cvt_pk_bf16_f32 v172, v176, v177
    v_cvt_pk_bf16_f32 v173, v178, v179
    v_mfma_f32_16x16x32_bf16 a[80:83], v[144:147], v[0:3], 0
    ds_read_b64_tr_b16 v[128:129], v254 offset:64
    v_accvgpr_read_b32 v180, a28
    v_mfma_f32_16x16x32_bf16 a[80:83], v[148:151], v[16:19], a[80:83]
    ds_read_b64_tr_b16 v[130:131], v254 offset:320
    v_accvgpr_read_b32 v181, a29
    v_mfma_f32_16x16x32_bf16 a[80:83], v[152:155], v[32:35], a[80:83]
    ds_read_b64_tr_b16 v[132:133], v254 offset:576
    v_accvgpr_read_b32 v182, a30
    v_mfma_f32_16x16x32_bf16 a[80:83], v[156:159], v[48:51], a[80:83]
    ds_read_b64_tr_b16 v[134:135], v254 offset:832
    v_accvgpr_read_b32 v183, a31
    v_mfma_f32_16x16x32_bf16 a[84:87], v[144:147], v[4:7], 0
    ds_read_b64_tr_b16 v[136:137], v254 offset:8512
    v_cvt_pk_bf16_f32 v174, v180, v181
    v_mfma_f32_16x16x32_bf16 a[84:87], v[148:151], v[20:23], a[84:87]
    ds_read_b64_tr_b16 v[138:139], v254 offset:8768
    v_cvt_pk_bf16_f32 v175, v182, v183
    v_mfma_f32_16x16x32_bf16 a[84:87], v[152:155], v[36:39], a[84:87]
    ds_read_b64_tr_b16 v[140:141], v254 offset:9024
    buffer_store_dwordx4 v[172:175], v253, s[28:31], s14 offen offset:3072 sc1
    v_mfma_f32_16x16x32_bf16 a[84:87], v[156:159], v[52:55], a[84:87]
    s_mov_b32 s15, s14
    ds_read_b64_tr_b16 v[142:143], v254 offset:9280
    v_mfma_f32_16x16x32_bf16 a[88:91], v[144:147], v[8:11], 0
    s_add_u32 s14, s14, 0x40000
    v_mfma_f32_16x16x32_bf16 a[88:91], v[148:151], v[24:27], a[88:91]
    s_cmp_eq_u32 s10, 1
    s_cselect_b32 s14, 0, s14
    v_mfma_f32_16x16x32_bf16 a[88:91], v[152:155], v[40:43], a[88:91]
    v_mfma_f32_16x16x32_bf16 a[88:91], v[156:159], v[56:59], a[88:91]
    v_mfma_f32_16x16x32_bf16 a[92:95], v[144:147], v[12:15], 0
    v_mfma_f32_16x16x32_bf16 a[92:95], v[148:151], v[28:31], a[92:95]
    v_mfma_f32_16x16x32_bf16 a[92:95], v[152:155], v[44:47], a[92:95]
    v_mfma_f32_16x16x32_bf16 a[92:95], v[156:159], v[60:63], a[92:95]
    s_waitcnt lgkmcnt(0)
    v_mfma_f32_16x16x32_bf16 a[96:99], v[128:131], v[0:3], 0
    ds_read_b64_tr_b16 v[144:145], v254 offset:96
    v_mfma_f32_16x16x32_bf16 a[96:99], v[132:135], v[16:19], a[96:99]
    ds_read_b64_tr_b16 v[146:147], v254 offset:352
    v_mfma_f32_16x16x32_bf16 a[96:99], v[136:139], v[32:35], a[96:99]
    ds_read_b64_tr_b16 v[148:149], v254 offset:608
    v_accvgpr_read_b32 v176, a32
    v_mfma_f32_16x16x32_bf16 a[96:99], v[140:143], v[48:51], a[96:99]
    ds_read_b64_tr_b16 v[150:151], v254 offset:864
    v_accvgpr_read_b32 v177, a33
    v_mfma_f32_16x16x32_bf16 a[100:103], v[128:131], v[4:7], 0
    ds_read_b64_tr_b16 v[152:153], v254 offset:8544
    v_accvgpr_read_b32 v178, a34
    v_mfma_f32_16x16x32_bf16 a[100:103], v[132:135], v[20:23], a[100:103]
    ds_read_b64_tr_b16 v[154:155], v254 offset:8800
    v_accvgpr_read_b32 v179, a35
    v_mfma_f32_16x16x32_bf16 a[100:103], v[136:139], v[36:39], a[100:103]
    ds_read_b64_tr_b16 v[156:157], v254 offset:9056
    buffer_load_dword v212, v202, s[52:55], 0 offen sc1
    v_mfma_f32_16x16x32_bf16 a[100:103], v[140:143], v[52:55], a[100:103]
    ds_read_b64_tr_b16 v[158:159], v254 offset:9312
    v_cvt_pk_bf16_f32 v160, v176, v177
    v_mfma_f32_16x16x32_bf16 a[104:107], v[128:131], v[8:11], 0
    v_cvt_pk_bf16_f32 v161, v178, v179
    s_waitcnt vmcnt(15)
    s_barrier
    v_mfma_f32_16x16x32_bf16 a[104:107], v[132:135], v[24:27], a[104:107]
    s_add_u32 s41, s19, 0x0
    s_add_u32 m0, s18, 101376
    v_accvgpr_read_b32 v180, a48
    v_mfma_f32_16x16x32_bf16 a[104:107], v[136:139], v[40:43], a[104:107]
    buffer_load_dwordx4 v252, s[24:27], s41 offen offset:0  lds
    v_accvgpr_read_b32 v181, a49
    v_mfma_f32_16x16x32_bf16 a[104:107], v[140:143], v[56:59], a[104:107]
    s_waitcnt vmcnt(6)
    s_add_u32 m0, s18, 101536
    v_accvgpr_read_b32 v182, a50
    v_mfma_f32_16x16x32_bf16 v[208:211], v[192:195], v[216:219], 0
    buffer_load_dwordx4 v252, s[24:27], s41 offen offset:896  lds
    v_accvgpr_read_b32 v183, a51
    v_mfma_f32_16x16x32_bf16 v[208:211], v[192:195], v[220:223], v[208:211]
    s_add_u32 m0, s18, 101696
    v_cvt_pk_bf16_f32 v162, v180, v181
    v_cvt_pk_bf16_f32 v163, v182, v183
    v_mfma_f32_16x16x32_bf16 v[208:211], v[192:195], v[224:227], v[208:211]
    buffer_load_dwordx4 v252, s[24:27], s41 offen offset:1792  lds
    v_accvgpr_read_b32 v176, a36
    v_mfma_f32_16x16x32_bf16 v[208:211], v[192:195], v[228:231], v[208:211]
    s_add_u32 m0, s18, 101856
    v_accvgpr_read_b32 v177, a37
    v_accvgpr_read_b32 v178, a38
    v_mfma_f32_16x16x32_bf16 a[108:111], v[128:131], v[12:15], 0
    s_add_u32 s17, s13, 16896
    buffer_load_dwordx4 v252, s[24:27], s41 offen offset:2688  lds
    v_accvgpr_read_b32 v179, a39
    v_mfma_f32_16x16x32_bf16 a[108:111], v[132:135], v[28:31], a[108:111]
    v_cvt_pk_bf16_f32 v164, v176, v177
    v_cvt_pk_bf16_f32 v165, v178, v179
    v_mfma_f32_16x16x32_bf16 a[108:111], v[136:139], v[44:47], a[108:111]
    v_accvgpr_read_b32 v180, a52
    v_accvgpr_read_b32 v181, a53
    v_mfma_f32_16x16x32_bf16 a[108:111], v[140:143], v[60:63], a[108:111]
    s_waitcnt lgkmcnt(0)
    v_add_u32 v254, s17, v251
    v_accvgpr_read_b32 v182, a54
    v_mfma_f32_16x16x32_bf16 a[112:115], v[144:147], v[0:3], 0
    ds_read_b64_tr_b16 v[128:129], v254 offset:0
    v_accvgpr_read_b32 v183, a55
    v_mfma_f32_16x16x32_bf16 a[112:115], v[148:151], v[16:19], a[112:115]
    ds_read_b64_tr_b16 v[130:131], v254 offset:256
    v_cvt_pk_bf16_f32 v166, v180, v181
    v_mfma_f32_16x16x32_bf16 a[112:115], v[152:155], v[32:35], a[112:115]
    ds_read_b64_tr_b16 v[132:133], v254 offset:512
    v_cvt_pk_bf16_f32 v167, v182, v183
    v_mfma_f32_16x16x32_bf16 a[112:115], v[156:159], v[48:51], a[112:115]
    s_waitcnt vmcnt(5)
    ds_read_b64_tr_b16 v[134:135], v254 offset:768
    buffer_store_dword v200, off, s[52:55], s47 sc1
    v_mfma_f32_16x16x32_bf16 a[116:119], v[144:147], v[4:7], 0
    ds_read_b64_tr_b16 v[136:137], v254 offset:8448
    v_mfma_f32_16x16x32_bf16 a[116:119], v[148:151], v[20:23], a[116:119]
    ds_read_b64_tr_b16 v[138:139], v254 offset:8704
    v_mfma_f32_16x16x32_bf16 a[116:119], v[152:155], v[36:39], a[116:119]
    ds_read_b64_tr_b16 v[140:141], v254 offset:8960
    v_mfma_f32_16x16x32_bf16 a[116:119], v[156:159], v[52:55], a[116:119]
    ds_read_b64_tr_b16 v[142:143], v254 offset:9216
    v_mfma_f32_16x16x32_bf16 a[120:123], v[144:147], v[8:11], 0
    v_mfma_f32_16x16x32_bf16 a[120:123], v[148:151], v[24:27], a[120:123]
    v_mfma_f32_16x16x32_bf16 a[120:123], v[152:155], v[40:43], a[120:123]
    v_mfma_f32_16x16x32_bf16 a[120:123], v[156:159], v[56:59], a[120:123]
    v_mfma_f32_16x16x32_bf16 a[124:127], v[144:147], v[12:15], 0
    s_waitcnt vmcnt(5)
    v_cmp_gt_i32 vcc, s12, v212
    v_mfma_f32_16x16x32_bf16 a[124:127], v[148:151], v[28:31], a[124:127]
    s_and_b64 vcc, vcc, s[62:63]
    s_cbranch_vccnz FPc_spin
FPc_ok:
    v_mfma_f32_16x16x32_bf16 a[124:127], v[152:155], v[44:47], a[124:127]
    s_add_u32 s40, s22, 0x0
    buffer_load_dwordx4 v[232:235], v255, s[28:31], s40 offen sc1
    v_mfma_f32_16x16x32_bf16 a[124:127], v[156:159], v[60:63], a[124:127]
    s_waitcnt lgkmcnt(0)
    s_add_u32 s40, s22, 0x10000
    buffer_load_dwordx4 v[236:239], v255, s[28:31], s40 offen sc1
    v_mfma_f32_16x16x32_bf16 a[64:67], v[128:131], v[64:67], a[64:67]
    s_add_u32 s40, s22, 0x20000
    s_mov_b32 s12, s10
    buffer_load_dwordx4 v[240:243], v255, s[28:31], s40 offen sc1
    ds_read_b64_tr_b16 v[144:145], v254 offset:32
    v_mfma_f32_16x16x32_bf16 a[64:67], v[132:135], v[80:83], a[64:67]
    s_add_u32 s40, s22, 0x30000
    buffer_load_dwordx4 v[244:247], v255, s[28:31], s40 offen sc1
    ds_read_b64_tr_b16 v[146:147], v254 offset:288
    v_mfma_f32_16x16x32_bf16 a[64:67], v[136:139], v[96:99], a[64:67]
    s_add_u32 s10, s10, 1
    ds_read_b64_tr_b16 v[148:149], v254 offset:544
    buffer_store_dwordx4 v[160:163], v253, s[28:31], s14 offen offset:0 sc1
    v_mfma_f32_16x16x32_bf16 a[64:67], v[140:143], v[112:115], a[64:67]
    s_add_u32 s16, s16, 128
    ds_read_b64_tr_b16 v[150:151], v254 offset:800
    v_accvgpr_read_b32 v176, a40
    v_mfma_f32_16x16x32_bf16 a[68:71], v[128:131], v[68:71], a[68:71]
    s_mov_b32 s22, s15
    ds_read_b64_tr_b16 v[152:153], v254 offset:8480
    buffer_store_dwordx4 v[164:167], v253, s[28:31], s14 offen offset:1024 sc1
    v_mfma_f32_16x16x32_bf16 a[68:71], v[132:135], v[84:87], a[68:71]
    ds_read_b64_tr_b16 v[154:155], v254 offset:8736
    v_accvgpr_read_b32 v177, a41
    v_mfma_f32_16x16x32_bf16 a[68:71], v[136:139], v[100:103], a[68:71]
    ds_read_b64_tr_b16 v[156:157], v254 offset:8992
    v_accvgpr_read_b32 v178, a42
    v_mfma_f32_16x16x32_bf16 a[68:71], v[140:143], v[116:119], a[68:71]
    ds_read_b64_tr_b16 v[158:159], v254 offset:9248
    v_accvgpr_read_b32 v179, a43
    v_mfma_f32_16x16x32_bf16 a[72:75], v[128:131], v[72:75], a[72:75]
    v_cvt_pk_bf16_f32 v168, v176, v177
    v_cvt_pk_bf16_f32 v169, v178, v179
    v_mfma_f32_16x16x32_bf16 a[72:75], v[132:135], v[88:91], a[72:75]
    v_accvgpr_read_b32 v180, a56
    v_accvgpr_read_b32 v181, a57
    v_mfma_f32_16x16x32_bf16 a[72:75], v[136:139], v[104:107], a[72:75]
    v_accvgpr_read_b32 v182, a58
    v_accvgpr_read_b32 v183, a59
    v_mfma_f32_16x16x32_bf16 a[72:75], v[140:143], v[120:123], a[72:75]
    v_cvt_pk_bf16_f32 v170, v180, v181
    v_cvt_pk_bf16_f32 v171, v182, v183
    v_mfma_f32_16x16x32_bf16 a[76:79], v[128:131], v[76:79], a[76:79]
    buffer_store_dwordx4 v[168:171], v253, s[28:31], s14 offen offset:2048 sc1
    v_mov_b32 v200, s10
    v_mfma_f32_16x16x32_bf16 a[76:79], v[132:135], v[92:95], a[76:79]
    v_accvgpr_read_b32 v176, a44
    v_accvgpr_read_b32 v177, a45
    v_mfma_f32_16x16x32_bf16 a[76:79], v[136:139], v[108:111], a[76:79]
    v_accvgpr_read_b32 v178, a46
    v_accvgpr_read_b32 v179, a47
    v_mfma_f32_16x16x32_bf16 a[76:79], v[140:143], v[124:127], a[76:79]
    s_waitcnt lgkmcnt(0)
    v_cvt_pk_bf16_f32 v172, v176, v177
    v_cvt_pk_bf16_f32 v173, v178, v179
    v_mfma_f32_16x16x32_bf16 a[80:83], v[144:147], v[64:67], a[80:83]
    ds_read_b64_tr_b16 v[128:129], v254 offset:64
    v_accvgpr_read_b32 v180, a60
    v_mfma_f32_16x16x32_bf16 a[80:83], v[148:151], v[80:83], a[80:83]
    ds_read_b64_tr_b16 v[130:131], v254 offset:320
    v_accvgpr_read_b32 v181, a61
    v_mfma_f32_16x16x32_bf16 a[80:83], v[152:155], v[96:99], a[80:83]
    ds_read_b64_tr_b16 v[132:133], v254 offset:576
    v_accvgpr_read_b32 v182, a62
    v_mfma_f32_16x16x32_bf16 a[80:83], v[156:159], v[112:115], a[80:83]
    ds_read_b64_tr_b16 v[134:135], v254 offset:832
    v_accvgpr_read_b32 v183, a63
    v_mfma_f32_16x16x32_bf16 a[84:87], v[144:147], v[68:71], a[84:87]
    ds_read_b64_tr_b16 v[136:137], v254 offset:8512
    v_cvt_pk_bf16_f32 v174, v180, v181
    v_mfma_f32_16x16x32_bf16 a[84:87], v[148:151], v[84:87], a[84:87]
    ds_read_b64_tr_b16 v[138:139], v254 offset:8768
    v_cvt_pk_bf16_f32 v175, v182, v183
    v_mfma_f32_16x16x32_bf16 a[84:87], v[152:155], v[100:103], a[84:87]
    ds_read_b64_tr_b16 v[140:141], v254 offset:9024
    buffer_store_dwordx4 v[172:175], v253, s[28:31], s14 offen offset:3072 sc1
    v_mfma_f32_16x16x32_bf16 a[84:87], v[156:159], v[116:119], a[84:87]
    s_cmp_eq_u32 s12, 4
    s_cselect_b32 s16, 0, s16
    ds_read_b64_tr_b16 v[142:143], v254 offset:9280
    v_mfma_f32_16x16x32_bf16 a[88:91], v[144:147], v[72:75], a[88:91]
    s_mov_b32 s15, s14
    v_mfma_f32_16x16x32_bf16 a[88:91], v[148:151], v[88:91], a[88:91]
    s_add_u32 s14, s14, 0x40000
    v_mfma_f32_16x16x32_bf16 a[88:91], v[152:155], v[104:107], a[88:91]
    s_cmp_eq_u32 s10, 1
    s_cselect_b32 s14, 0, s14
    v_mfma_f32_16x16x32_bf16 a[88:91], v[156:159], v[120:123], a[88:91]
    v_mfma_f32_16x16x32_bf16 a[92:95], v[144:147], v[76:79], a[92:95]
    v_mfma_f32_16x16x32_bf16 a[92:95], v[148:151], v[92:95], a[92:95]
    v_mfma_f32_16x16x32_bf16 a[92:95], v[152:155], v[108:111], a[92:95]
    v_mfma_f32_16x16x32_bf16 a[92:95], v[156:159], v[124:127], a[92:95]
    s_waitcnt lgkmcnt(0)
    v_mfma_f32_16x16x32_bf16 a[96:99], v[128:131], v[64:67], a[96:99]
    ds_read_b64_tr_b16 v[144:145], v254 offset:96
    v_mfma_f32_16x16x32_bf16 a[96:99], v[132:135], v[80:83], a[96:99]
    ds_read_b64_tr_b16 v[146:147], v254 offset:352
    v_mfma_f32_16x16x32_bf16 a[96:99], v[136:139], v[96:99], a[96:99]
    ds_read_b64_tr_b16 v[148:149], v254 offset:608
    v_accvgpr_read_b32 v176, a64
    v_mfma_f32_16x16x32_bf16 a[96:99], v[140:143], v[112:115], a[96:99]
    ds_read_b64_tr_b16 v[150:151], v254 offset:864
    v_accvgpr_read_b32 v177, a65
    v_mfma_f32_16x16x32_bf16 a[100:103], v[128:131], v[68:71], a[100:103]
    ds_read_b64_tr_b16 v[152:153], v254 offset:8544
    v_accvgpr_read_b32 v178, a66
    v_mfma_f32_16x16x32_bf16 a[100:103], v[132:135], v[84:87], a[100:103]
    ds_read_b64_tr_b16 v[154:155], v254 offset:8800
    v_accvgpr_read_b32 v179, a67
    v_mfma_f32_16x16x32_bf16 a[100:103], v[136:139], v[100:103], a[100:103]
    ds_read_b64_tr_b16 v[156:157], v254 offset:9056
    buffer_load_dword v212, v202, s[52:55], 0 offen sc1
    v_mfma_f32_16x16x32_bf16 a[100:103], v[140:143], v[116:119], a[100:103]
    ds_read_b64_tr_b16 v[158:159], v254 offset:9312
    v_cvt_pk_bf16_f32 v160, v176, v177
    v_mfma_f32_16x16x32_bf16 a[104:107], v[128:131], v[72:75], a[104:107]
    v_cvt_pk_bf16_f32 v161, v178, v179
    s_waitcnt vmcnt(14)
    s_barrier
    v_mfma_f32_16x16x32_bf16 a[104:107], v[132:135], v[88:91], a[104:107]
    s_add_u32 s41, s19, 0x1c000
    s_add_u32 m0, s18, 118272
    v_accvgpr_read_b32 v180, a80
    v_mfma_f32_16x16x32_bf16 a[104:107], v[136:139], v[104:107], a[104:107]
    buffer_load_dwordx4 v252, s[24:27], s41 offen offset:0  lds
    v_accvgpr_read_b32 v181, a81
    v_mfma_f32_16x16x32_bf16 a[104:107], v[140:143], v[120:123], a[104:107]
    s_waitcnt vmcnt(6)
    s_add_u32 m0, s18, 118432
    v_accvgpr_read_b32 v182, a82
    v_mfma_f32_16x16x32_bf16 v[208:211], v[196:199], v[232:235], v[208:211]
    buffer_load_dwordx4 v252, s[24:27], s41 offen offset:896  lds
    v_accvgpr_read_b32 v183, a83
    v_mfma_f32_16x16x32_bf16 v[208:211], v[196:199], v[236:239], v[208:211]
    s_add_u32 m0, s18, 118592
    v_cvt_pk_bf16_f32 v162, v180, v181
    v_cvt_pk_bf16_f32 v163, v182, v183
    v_mfma_f32_16x16x32_bf16 v[208:211], v[196:199], v[240:243], v[208:211]
    buffer_load_dwordx4 v252, s[24:27], s41 offen offset:1792  lds
    v_accvgpr_read_b32 v176, a68
    v_mfma_f32_16x16x32_bf16 v[208:211], v[196:199], v[244:247], v[208:211]
    s_add_u32 m0, s18, 118752
    v_accvgpr_read_b32 v177, a69
    v_accvgpr_read_b32 v178, a70
    v_mfma_f32_16x16x32_bf16 a[108:111], v[128:131], v[76:79], a[108:111]
    s_add_u32 s17, s13, 33792
    buffer_load_dwordx4 v252, s[24:27], s41 offen offset:2688  lds
    v_accvgpr_read_b32 v179, a71
    v_mfma_f32_16x16x32_bf16 a[108:111], v[132:135], v[92:95], a[108:111]
    v_cvt_pk_bf16_f32 v164, v176, v177
    v_cvt_pk_bf16_f32 v165, v178, v179
    v_mfma_f32_16x16x32_bf16 a[108:111], v[136:139], v[108:111], a[108:111]
    v_accvgpr_read_b32 v180, a84
    v_accvgpr_read_b32 v181, a85
    v_mfma_f32_16x16x32_bf16 a[108:111], v[140:143], v[124:127], a[108:111]
    s_waitcnt lgkmcnt(0)
    v_add_u32 v254, s17, v251
    v_accvgpr_read_b32 v182, a86
    v_mfma_f32_16x16x32_bf16 a[112:115], v[144:147], v[64:67], a[112:115]
    ds_read_b64_tr_b16 v[128:129], v254 offset:0
    v_accvgpr_read_b32 v183, a87
    v_mfma_f32_16x16x32_bf16 a[112:115], v[148:151], v[80:83], a[112:115]
    s_add_u32 s19, s19, 128
    ds_read_b64_tr_b16 v[130:131], v254 offset:256
    v_cvt_pk_bf16_f32 v166, v180, v181
    v_mfma_f32_16x16x32_bf16 a[112:115], v[152:155], v[96:99], a[112:115]
    s_xor_b32 s13, s13, 67584
    ds_read_b64_tr_b16 v[132:133], v254 offset:512
    v_cvt_pk_bf16_f32 v167, v182, v183
    v_mfma_f32_16x16x32_bf16 a[112:115], v[156:159], v[112:115], a[112:115]
    s_waitcnt vmcnt(5)
    ds_read_b64_tr_b16 v[134:135], v254 offset:768
    buffer_store_dword v200, off, s[52:55], s47 sc1
    v_mfma_f32_16x16x32_bf16 a[116:119], v[144:147], v[68:71], a[116:119]
    s_sub_u32 s18, s33, s13
    ds_read_b64_tr_b16 v[136:137], v254 offset:8448
    v_cvt_pk_bf16_f32 v190, v208, v209
    v_mfma_f32_16x16x32_bf16 a[116:119], v[148:151], v[84:87], a[116:119]
    ds_read_b64_tr_b16 v[138:139], v254 offset:8704
    v_cvt_pk_bf16_f32 v191, v210, v211
    v_mfma_f32_16x16x32_bf16 a[116:119], v[152:155], v[100:103], a[116:119]
    ds_read_b64_tr_b16 v[140:141], v254 offset:8960
    buffer_store_dwordx2 v[190:191], v249, s[56:59], s16 offen
    v_mfma_f32_16x16x32_bf16 a[116:119], v[156:159], v[116:119], a[116:119]
    s_cmp_eq_u32 s19, 896
    s_cselect_b32 s19, 0x40000000, s19
    ds_read_b64_tr_b16 v[142:143], v254 offset:9216
    v_mfma_f32_16x16x32_bf16 a[120:123], v[144:147], v[72:75], a[120:123]
    v_mfma_f32_16x16x32_bf16 a[120:123], v[148:151], v[88:91], a[120:123]
    v_mfma_f32_16x16x32_bf16 a[120:123], v[152:155], v[104:107], a[120:123]
    v_mfma_f32_16x16x32_bf16 a[120:123], v[156:159], v[120:123], a[120:123]
    v_mfma_f32_16x16x32_bf16 a[124:127], v[144:147], v[76:79], a[124:127]
    s_waitcnt vmcnt(6)
    v_cmp_gt_i32 vcc, s12, v212
    v_mfma_f32_16x16x32_bf16 a[124:127], v[148:151], v[92:95], a[124:127]
    s_and_b64 vcc, vcc, s[62:63]
    s_cbranch_vccnz FPd_spin
FPd_ok:
    v_mfma_f32_16x16x32_bf16 a[124:127], v[152:155], v[108:111], a[124:127]
    s_add_u32 s40, s22, 0x0
    buffer_load_dwordx4 v[216:219], v255, s[28:31], s40 offen sc1
    v_mfma_f32_16x16x32_bf16 a[124:127], v[156:159], v[124:127], a[124:127]
    s_waitcnt lgkmcnt(0)
    s_add_u32 s40, s22, 0x10000
    buffer_load_dwordx4 v[220:223], v255, s[28:31], s40 offen sc1
    v_mfma_f32_16x16x32_bf16 a[0:3], v[128:131], v[0:3], 0
    s_add_u32 s40, s22, 0x20000
    s_mov_b32 s12, s10
    buffer_load_dwordx4 v[224:227], v255, s[28:31], s40 offen sc1
    ds_read_b64_tr_b16 v[144:145], v254 offset:32
    v_mfma_f32_16x16x32_bf16 a[0:3], v[132:135], v[16:19], a[0:3]
    s_add_u32 s40, s22, 0x30000
    buffer_load_dwordx4 v[228:231], v255, s[28:31], s40 offen sc1
    ds_read_b64_tr_b16 v[146:147], v254 offset:288
    v_mfma_f32_16x16x32_bf16 a[0:3], v[136:139], v[32:35], a[0:3]
    s_add_u32 s10, s10, 1
    ds_read_b64_tr_b16 v[148:149], v254 offset:544
    buffer_store_dwordx4 v[160:163], v253, s[28:31], s14 offen offset:0 sc1
    v_mfma_f32_16x16x32_bf16 a[0:3], v[140:143], v[48:51], a[0:3]
    ds_read_b64_tr_b16 v[150:151], v254 offset:800
    v_accvgpr_read_b32 v176, a72
    v_mfma_f32_16x16x32_bf16 a[4:7], v[128:131], v[4:7], 0
    s_mov_b32 s22, s15
    ds_read_b64_tr_b16 v[152:153], v254 offset:8480
    buffer_store_dwordx4 v[164:167], v253, s[28:31], s14 offen offset:1024 sc1
    v_mfma_f32_16x16x32_bf16 a[4:7], v[132:135], v[20:23], a[4:7]
    ds_read_b64_tr_b16 v[154:155], v254 offset:8736
    v_accvgpr_read_b32 v177, a73
    v_mfma_f32_16x16x32_bf16 a[4:7], v[136:139], v[36:39], a[4:7]
    ds_read_b64_tr_b16 v[156:157], v254 offset:8992
    v_accvgpr_read_b32 v178, a74
    v_mfma_f32_16x16x32_bf16 a[4:7], v[140:143], v[52:55], a[4:7]
    ds_read_b64_tr_b16 v[158:159], v254 offset:9248
    v_accvgpr_read_b32 v179, a75
    v_mfma_f32_16x16x32_bf16 a[8:11], v[128:131], v[8:11], 0
    v_cvt_pk_bf16_f32 v168, v176, v177
    v_cvt_pk_bf16_f32 v169, v178, v179
    v_mfma_f32_16x16x32_bf16 a[8:11], v[132:135], v[24:27], a[8:11]
    v_accvgpr_read_b32 v180, a88
    v_accvgpr_read_b32 v181, a89
    v_mfma_f32_16x16x32_bf16 a[8:11], v[136:139], v[40:43], a[8:11]
    v_accvgpr_read_b32 v182, a90
    v_accvgpr_read_b32 v183, a91
    v_mfma_f32_16x16x32_bf16 a[8:11], v[140:143], v[56:59], a[8:11]
    v_cvt_pk_bf16_f32 v170, v180, v181
    v_cvt_pk_bf16_f32 v171, v182, v183
    v_mfma_f32_16x16x32_bf16 a[12:15], v[128:131], v[12:15], 0
    buffer_store_dwordx4 v[168:171], v253, s[28:31], s14 offen offset:2048 sc1
    v_mov_b32 v200, s10
    v_mfma_f32_16x16x32_bf16 a[12:15], v[132:135], v[28:31], a[12:15]
    v_accvgpr_read_b32 v176, a76
    v_accvgpr_read_b32 v177, a77
    v_mfma_f32_16x16x32_bf16 a[12:15], v[136:139], v[44:47], a[12:15]
    v_accvgpr_read_b32 v178, a78
    v_accvgpr_read_b32 v179, a79
    v_mfma_f32_16x16x32_bf16 a[12:15], v[140:143], v[60:63], a[12:15]
    s_waitcnt lgkmcnt(0)
    v_cvt_pk_bf16_f32 v172, v176, v177
    v_cvt_pk_bf16_f32 v173, v178, v179
    v_mfma_f32_16x16x32_bf16 a[16:19], v[144:147], v[0:3], 0
    ds_read_b64_tr_b16 v[128:129], v254 offset:64
    v_accvgpr_read_b32 v180, a92
    v_mfma_f32_16x16x32_bf16 a[16:19], v[148:151], v[16:19], a[16:19]
    ds_read_b64_tr_b16 v[130:131], v254 offset:320
    v_accvgpr_read_b32 v181, a93
    v_mfma_f32_16x16x32_bf16 a[16:19], v[152:155], v[32:35], a[16:19]
    ds_read_b64_tr_b16 v[132:133], v254 offset:576
    v_accvgpr_read_b32 v182, a94
    v_mfma_f32_16x16x32_bf16 a[16:19], v[156:159], v[48:51], a[16:19]
    ds_read_b64_tr_b16 v[134:135], v254 offset:832
    v_accvgpr_read_b32 v183, a95
    v_mfma_f32_16x16x32_bf16 a[20:23], v[144:147], v[4:7], 0
    ds_read_b64_tr_b16 v[136:137], v254 offset:8512
    v_cvt_pk_bf16_f32 v174, v180, v181
    v_mfma_f32_16x16x32_bf16 a[20:23], v[148:151], v[20:23], a[20:23]
    ds_read_b64_tr_b16 v[138:139], v254 offset:8768
    v_cvt_pk_bf16_f32 v175, v182, v183
    v_mfma_f32_16x16x32_bf16 a[20:23], v[152:155], v[36:39], a[20:23]
    ds_read_b64_tr_b16 v[140:141], v254 offset:9024
    buffer_store_dwordx4 v[172:175], v253, s[28:31], s14 offen offset:3072 sc1
    v_mfma_f32_16x16x32_bf16 a[20:23], v[156:159], v[52:55], a[20:23]
    s_mov_b32 s15, s14
    ds_read_b64_tr_b16 v[142:143], v254 offset:9280
    v_mfma_f32_16x16x32_bf16 a[24:27], v[144:147], v[8:11], 0
    s_add_u32 s14, s14, 0x40000
    v_mfma_f32_16x16x32_bf16 a[24:27], v[148:151], v[24:27], a[24:27]
    s_cmp_eq_u32 s10, 1
    s_cselect_b32 s14, 0, s14
    v_mfma_f32_16x16x32_bf16 a[24:27], v[152:155], v[40:43], a[24:27]
    v_mfma_f32_16x16x32_bf16 a[24:27], v[156:159], v[56:59], a[24:27]
    v_mfma_f32_16x16x32_bf16 a[28:31], v[144:147], v[12:15], 0
    v_mfma_f32_16x16x32_bf16 a[28:31], v[148:151], v[28:31], a[28:31]
    v_mfma_f32_16x16x32_bf16 a[28:31], v[152:155], v[44:47], a[28:31]
    v_mfma_f32_16x16x32_bf16 a[28:31], v[156:159], v[60:63], a[28:31]
    s_waitcnt lgkmcnt(0)
    v_mfma_f32_16x16x32_bf16 a[32:35], v[128:131], v[0:3], 0
    ds_read_b64_tr_b16 v[144:145], v254 offset:96
    v_mfma_f32_16x16x32_bf16 a[32:35], v[132:135], v[16:19], a[32:35]
    ds_read_b64_tr_b16 v[146:147], v254 offset:352
    v_mfma_f32_16x16x32_bf16 a[32:35], v[136:139], v[32:35], a[32:35]
    ds_read_b64_tr_b16 v[148:149], v254 offset:608
    v_accvgpr_read_b32 v176, a96
    v_mfma_f32_16x16x32_bf16 a[32:35], v[140:143], v[48:51], a[32:35]
    ds_read_b64_tr_b16 v[150:151], v254 offset:864
    v_accvgpr_read_b32 v177, a97
    v_mfma_f32_16x16x32_bf16 a[36:39], v[128:131], v[4:7], 0
    ds_read_b64_tr_b16 v[152:153], v254 offset:8544
    v_accvgpr_read_b32 v178, a98
    v_mfma_f32_16x16x32_bf16 a[36:39], v[132:135], v[20:23], a[36:39]
    ds_read_b64_tr_b16 v[154:155], v254 offset:8800
    v_accvgpr_read_b32 v179, a99
    v_mfma_f32_16x16x32_bf16 a[36:39], v[136:139], v[36:39], a[36:39]
    ds_read_b64_tr_b16 v[156:157], v254 offset:9056
    buffer_load_dword v212, v202, s[52:55], 0 offen sc1
    v_mfma_f32_16x16x32_bf16 a[36:39], v[140:143], v[52:55], a[36:39]
    ds_read_b64_tr_b16 v[158:159], v254 offset:9312
    v_cvt_pk_bf16_f32 v160, v176, v177
    v_mfma_f32_16x16x32_bf16 a[40:43], v[128:131], v[8:11], 0
    v_cvt_pk_bf16_f32 v161, v178, v179
    s_waitcnt vmcnt(15)
    s_barrier
    v_mfma_f32_16x16x32_bf16 a[40:43], v[132:135], v[24:27], a[40:43]
    s_add_u32 s41, s19, 0x0
    s_add_u32 m0, s18, 67584
    v_accvgpr_read_b32 v180, a112
    v_mfma_f32_16x16x32_bf16 a[40:43], v[136:139], v[40:43], a[40:43]
    buffer_load_dwordx4 v252, s[24:27], s41 offen offset:0  lds
    v_accvgpr_read_b32 v181, a113
    v_mfma_f32_16x16x32_bf16 a[40:43], v[140:143], v[56:59], a[40:43]
    s_waitcnt vmcnt(6)
    s_add_u32 m0, s18, 67744
    v_accvgpr_read_b32 v182, a114
    v_mfma_f32_16x16x32_bf16 v[204:207], v[192:195], v[216:219], 0
    buffer_load_dwordx4 v252, s[24:27], s41 offen offset:896  lds
    v_accvgpr_read_b32 v183, a115
    v_mfma_f32_16x16x32_bf16 v[204:207], v[192:195], v[220:223], v[204:207]
    s_add_u32 m0, s18, 67904
    v_cvt_pk_bf16_f32 v162, v180, v181
    v_cvt_pk_bf16_f32 v163, v182, v183
    v_mfma_f32_16x16x32_bf16 v[204:207], v[192:195], v[224:227], v[204:207]
    buffer_load_dwordx4 v252, s[24:27], s41 offen offset:1792  lds
    v_accvgpr_read_b32 v176, a100
    v_mfma_f32_16x16x32_bf16 v[204:207], v[192:195], v[228:231], v[204:207]
    s_add_u32 m0, s18, 68064
    v_accvgpr_read_b32 v177, a101
    v_accvgpr_read_b32 v178, a102
    v_mfma_f32_16x16x32_bf16 a[44:47], v[128:131], v[12:15], 0
    s_sub_u32 s17, 118272, s13
    buffer_load_dwordx4 v252, s[24:27], s41 offen offset:2688  lds
    v_accvgpr_read_b32 v179, a103
    v_mfma_f32_16x16x32_bf16 a[44:47], v[132:135], v[28:31], a[44:47]
    v_cvt_pk_bf16_f32 v164, v176, v177
    v_cvt_pk_bf16_f32 v165, v178, v179
    v_mfma_f32_16x16x32_bf16 a[44:47], v[136:139], v[44:47], a[44:47]
    v_accvgpr_read_b32 v180, a116
    v_accvgpr_read_b32 v181, a117
    v_mfma_f32_16x16x32_bf16 a[44:47], v[140:143], v[60:63], a[44:47]
    s_waitcnt lgkmcnt(0)
    v_add_u32 v254, s17, v251
    v_accvgpr_read_b32 v182, a118
    v_mfma_f32_16x16x32_bf16 a[48:51], v[144:147], v[0:3], 0
    ds_read_b64_tr_b16 v[128:129], v254 offset:0
    v_accvgpr_read_b32 v183, a119
    v_mfma_f32_16x16x32_bf16 a[48:51], v[148:151], v[16:19], a[48:51]
    ds_read_b64_tr_b16 v[130:131], v254 offset:256
    v_cvt_pk_bf16_f32 v166, v180, v181
    v_mfma_f32_16x16x32_bf16 a[48:51], v[152:155], v[32:35], a[48:51]
    ds_read_b64_tr_b16 v[132:133], v254 offset:512
    v_cvt_pk_bf16_f32 v167, v182, v183
    v_mfma_f32_16x16x32_bf16 a[48:51], v[156:159], v[48:51], a[48:51]
    s_waitcnt vmcnt(5)
    ds_read_b64_tr_b16 v[134:135], v254 offset:768
    buffer_store_dword v200, off, s[52:55], s47 sc1
    v_mfma_f32_16x16x32_bf16 a[52:55], v[144:147], v[4:7], 0
    ds_read_b64_tr_b16 v[136:137], v254 offset:8448
    v_mfma_f32_16x16x32_bf16 a[52:55], v[148:151], v[20:23], a[52:55]
    ds_read_b64_tr_b16 v[138:139], v254 offset:8704
    v_mfma_f32_16x16x32_bf16 a[52:55], v[152:155], v[36:39], a[52:55]
    ds_read_b64_tr_b16 v[140:141], v254 offset:8960
    v_mfma_f32_16x16x32_bf16 a[52:55], v[156:159], v[52:55], a[52:55]
    ds_read_b64_tr_b16 v[142:143], v254 offset:9216
    v_mfma_f32_16x16x32_bf16 a[56:59], v[144:147], v[8:11], 0
    v_mfma_f32_16x16x32_bf16 a[56:59], v[148:151], v[24:27], a[56:59]
    v_mfma_f32_16x16x32_bf16 a[56:59], v[152:155], v[40:43], a[56:59]
    v_mfma_f32_16x16x32_bf16 a[56:59], v[156:159], v[56:59], a[56:59]
    v_mfma_f32_16x16x32_bf16 a[60:63], v[144:147], v[12:15], 0
    s_waitcnt vmcnt(5)
    v_cmp_gt_i32 vcc, s12, v212
    v_mfma_f32_16x16x32_bf16 a[60:63], v[148:151], v[28:31], a[60:63]
    s_and_b64 vcc, vcc, s[62:63]
    s_cbranch_vccnz FPa_spin
FPa_ok:
    v_mfma_f32_16x16x32_bf16 a[60:63], v[152:155], v[44:47], a[60:63]
    s_add_u32 s40, s22, 0x0
    buffer_load_dwordx4 v[232:235], v255, s[28:31], s40 offen sc1
    v_mfma_f32_16x16x32_bf16 a[60:63], v[156:159], v[60:63], a[60:63]
    s_waitcnt lgkmcnt(0)
    s_add_u32 s40, s22, 0x10000
    buffer_load_dwordx4 v[236:239], v255, s[28:31], s40 offen sc1
    s_branch FO_loop
FO_exit:
    s_add_u32 s40, s22, 0x20000
    buffer_load_dwordx4 v[224:227], v255, s[28:31], s40 offen sc1
    s_add_u32 s40, s22, 0x30000
    buffer_load_dwordx4 v[228:231], v255, s[28:31], s40 offen sc1
    s_nop 3
    buffer_load_dword v212, v202, s[52:55], 0 offen sc1
    buffer_store_dwordx4 v[160:163], v253, s[28:31], s14 offen offset:0 sc1
    buffer_store_dwordx4 v[164:167], v253, s[28:31], s14 offen offset:1024 sc1
    v_accvgpr_read_b32 v176, a8
    v_accvgpr_read_b32 v177, a9
    v_accvgpr_read_b32 v178, a10
    v_accvgpr_read_b32 v179, a11
    v_cvt_pk_bf16_f32 v168, v176, v177
    v_cvt_pk_bf16_f32 v169, v178, v179
    v_accvgpr_read_b32 v180, a24
    v_accvgpr_read_b32 v181, a25
    v_accvgpr_read_b32 v182, a26
    v_accvgpr_read_b32 v183, a27
    v_cvt_pk_bf16_f32 v170, v180, v181
    v_cvt_pk_bf16_f32 v171, v182, v183
    buffer_store_dwordx4 v[168:171], v253, s[28:31], s14 offen offset:2048 sc1
    v_accvgpr_read_b32 v176, a12
    v_accvgpr_read_b32 v177, a13
    v_accvgpr_read_b32 v178, a14
    v_accvgpr_read_b32 v179, a15
    v_cvt_pk_bf16_f32 v172, v176, v177
    v_cvt_pk_bf16_f32 v173, v178, v179
    v_accvgpr_read_b32 v180, a28
    v_accvgpr_read_b32 v181, a29
    v_accvgpr_read_b32 v182, a30
    v_accvgpr_read_b32 v183, a31
    v_cvt_pk_bf16_f32 v174, v180, v181
    v_cvt_pk_bf16_f32 v175, v182, v183
    buffer_store_dwordx4 v[172:175], v253, s[28:31], s14 offen offset:3072 sc1
    s_waitcnt vmcnt(5)
    v_mfma_f32_16x16x32_bf16 v[208:211], v[192:195], v[216:219], 0
    v_mfma_f32_16x16x32_bf16 v[208:211], v[192:195], v[220:223], v[208:211]
    v_mfma_f32_16x16x32_bf16 v[208:211], v[192:195], v[224:227], v[208:211]
    v_mfma_f32_16x16x32_bf16 v[208:211], v[192:195], v[228:231], v[208:211]
    v_accvgpr_read_b32 v176, a32
    v_accvgpr_read_b32 v177, a33
    v_accvgpr_read_b32 v178, a34
    v_accvgpr_read_b32 v179, a35
    v_cvt_pk_bf16_f32 v160, v176, v177
    v_cvt_pk_bf16_f32 v161, v178, v179
    v_accvgpr_read_b32 v180, a48
    v_accvgpr_read_b32 v181, a49
    v_accvgpr_read_b32 v182, a50
    v_accvgpr_read_b32 v183, a51
    v_cvt_pk_bf16_f32 v162, v180, v181
    v_cvt_pk_bf16_f32 v163, v182, v183
    v_accvgpr_read_b32 v176, a36
    v_accvgpr_read_b32 v177, a37
    v_accvgpr_read_b32 v178, a38
    v_accvgpr_read_b32 v179, a39
    v_cvt_pk_bf16_f32 v164, v176, v177
    v_cvt_pk_bf16_f32 v165, v178, v179
    v_accvgpr_read_b32 v180, a52
    v_accvgpr_read_b32 v181, a53
    v_accvgpr_read_b32 v182, a54
    v_accvgpr_read_b32 v183, a55
    v_cvt_pk_bf16_f32 v166, v180, v181
    v_cvt_pk_bf16_f32 v167, v182, v183
    s_waitcnt vmcnt(4)
    v_cmp_gt_i32 vcc, 13, v212
    s_nop 1
    s_and_b64 vcc, vcc, s[62:63]
    s_cbranch_vccnz FPz_spin
FPz_ok:
    s_add_u32 s43, s14, 0x40000
    s_add_u32 s40, s15, 0x0
    buffer_load_dwordx4 v[232:235], v255, s[28:31], s40 offen sc1
    s_add_u32 s40, s15, 0x10000
    buffer_load_dwordx4 v[236:239], v255, s[28:31], s40 offen sc1
    s_add_u32 s40, s15, 0x20000
    buffer_load_dwordx4 v[240:243], v255, s[28:31], s40 offen sc1
    s_add_u32 s40, s15, 0x30000
    buffer_load_dwordx4 v[244:247], v255, s[28:31], s40 offen sc1
    buffer_store_dwordx4 v[160:163], v253, s[28:31], s43 offen offset:0 sc1
    buffer_store_dwordx4 v[164:167], v253, s[28:31], s43 offen offset:1024 sc1
    v_accvgpr_read_b32 v176, a40
    v_accvgpr_read_b32 v177, a41
    v_accvgpr_read_b32 v178, a42
    v_accvgpr_read_b32 v179, a43
    v_cvt_pk_bf16_f32 v168, v176, v177
    v_cvt_pk_bf16_f32 v169, v178, v179
    v_accvgpr_read_b32 v180, a56
    v_accvgpr_read_b32 v181, a57
    v_accvgpr_read_b32 v182, a58
    v_accvgpr_read_b32 v183, a59
    v_cvt_pk_bf16_f32 v170, v180, v181
    v_cvt_pk_bf16_f32 v171, v182, v183
    buffer_store_dwordx4 v[168:171], v253, s[28:31], s43 offen offset:2048 sc1
    v_accvgpr_read_b32 v176, a44
    v_accvgpr_read_b32 v177, a45
    v_accvgpr_read_b32 v178, a46
    v_accvgpr_read_b32 v179, a47
    v_cvt_pk_bf16_f32 v172, v176, v177
    v_cvt_pk_bf16_f32 v173, v178, v179
    v_accvgpr_read_b32 v180, a60
    v_accvgpr_read_b32 v181, a61
    v_accvgpr_read_b32 v182, a62
    v_accvgpr_read_b32 v183, a63
    v_cvt_pk_bf16_f32 v174, v180, v181
    v_cvt_pk_bf16_f32 v175, v182, v183
    buffer_store_dwordx4 v[172:175], v253, s[28:31], s43 offen offset:3072 sc1
    v_mov_b32 v200, 15
    s_waitcnt vmcnt(0)
    buffer_store_dword v200, off, s[52:55], s47 sc1
    buffer_load_dword v212, v202, s[52:55], 0 offen sc1
    s_waitcnt vmcnt(2)
    v_mfma_f32_16x16x32_bf16 v[208:211], v[196:199], v[232:235], v[208:211]
    v_mfma_f32_16x16x32_bf16 v[208:211], v[196:199], v[236:239], v[208:211]
    v_mfma_f32_16x16x32_bf16 v[208:211], v[196:199], v[240:243], v[208:211]
    v_mfma_f32_16x16x32_bf16 v[208:211], v[196:199], v[244:247], v[208:211]
    s_waitcnt vmcnt(0)
    v_cmp_gt_i32 vcc, 15, v212
    s_nop 1
    s_and_b64 vcc, vcc, s[62:63]
    s_cbranch_vccnz FPy_spin
FPy_ok:
    s_add_u32 s40, s14, 0x0
    buffer_load_dwordx4 v[216:219], v255, s[28:31], s40 offen sc1
    s_add_u32 s40, s14, 0x10000
    buffer_load_dwordx4 v[220:223], v255, s[28:31], s40 offen sc1
    s_add_u32 s40, s14, 0x20000
    buffer_load_dwordx4 v[224:227], v255, s[28:31], s40 offen sc1
    s_add_u32 s40, s14, 0x30000
    buffer_load_dwordx4 v[228:231], v255, s[28:31], s40 offen sc1
    s_add_u32 s40, s43, 0x0
    buffer_load_dwordx4 v[232:235], v255, s[28:31], s40 offen sc1
    s_add_u32 s40, s43, 0x10000
    buffer_load_dwordx4 v[236:239], v255, s[28:31], s40 offen sc1
    s_add_u32 s40, s43, 0x20000
    buffer_load_dwordx4 v[240:243], v255, s[28:31], s40 offen sc1
    s_add_u32 s40, s43, 0x30000
    buffer_load_dwordx4 v[244:247], v255, s[28:31], s40 offen sc1
    v_cvt_pk_bf16_f32 v190, v208, v209
    v_cvt_pk_bf16_f32 v191, v210, v211
    s_mov_b32 s41, 640
    buffer_store_dwordx2 v[190:191], v249, s[56:59], s41 offen
    s_waitcnt vmcnt(8)
    v_mfma_f32_16x16x32_bf16 v[204:207], v[192:195], v[216:219], 0
    s_waitcnt vmcnt(7)
    v_mfma_f32_16x16x32_bf16 v[204:207], v[192:195], v[220:223], v[204:207]
    s_waitcnt vmcnt(6)
    v_mfma_f32_16x16x32_bf16 v[204:207], v[192:195], v[224:227], v[204:207]
    s_waitcnt vmcnt(5)
    v_mfma_f32_16x16x32_bf16 v[204:207], v[192:195], v[228:231], v[204:207]
    s_waitcnt vmcnt(4)
    v_mfma_f32_16x16x32_bf16 v[204:207], v[196:199], v[232:235], v[204:207]
    s_waitcnt vmcnt(3)
    v_mfma_f32_16x16x32_bf16 v[204:207], v[196:199], v[236:239], v[204:207]
    s_waitcnt vmcnt(2)
    v_mfma_f32_16x16x32_bf16 v[204:207], v[196:199], v[240:243], v[204:207]
    s_waitcnt vmcnt(1)
    v_mfma_f32_16x16x32_bf16 v[204:207], v[196:199], v[244:247], v[204:207]
    s_nop 7
    v_cvt_pk_bf16_f32 v188, v204, v205
    v_cvt_pk_bf16_f32 v189, v206, v207
    s_mov_b32 s41, 768
    buffer_store_dwordx2 v[188:189], v249, s[56:59], s41 offen
    s_endpgm
S_R1_P0:
    s_mov_b32 s38, 0
    s_branch SUB_p1_0_0
S_R1_L2:
    s_mov_b32 s38, 1
    s_branch SUB_p1_0_0
S_R1_L0:
    s_mov_b32 s38, 2
    s_branch SUB_p1_0_0
S_R1_P30:
    s_mov_b32 s38, 3
    s_branch SUB_p1_0_0
SUB_p1_0_0:
    s_nop 7
    s_nop 7
    v_max3_f32 v238, v144, v145, v146
    v_max3_f32 v238, v238, v147, v148
    v_max3_f32 v238, v238, v149, v150
    v_max_f32 v238, v238, v151
    v_mov_b32 v240, v238
    s_nop 1
    v_permlane16_swap_b32 v238, v240
    s_nop 1
    v_max_f32 v238, v238, v240
    v_mov_b32 v240, v238
    s_nop 1
    v_permlane32_swap_b32 v238, v240
    s_nop 1
    v_max_f32 v238, v238, v240
    v_max_f32 v238, 0, v238
    v_exp_f32_e64 v239, -v238
    s_nop 0
    v_sub_f32 v208, v208, v238
    v_sub_f32 v209, v209, v238
    v_sub_f32 v210, v210, v238
    v_sub_f32 v211, v211, v238
    v_mul_f32 v234, v234, v239
    v_sub_f32 v144, v144, v238
    v_sub_f32 v145, v145, v238
    v_sub_f32 v146, v146, v238
    v_sub_f32 v147, v147, v238
    v_sub_f32 v148, v148, v238
    v_sub_f32 v149, v149, v238
    v_sub_f32 v150, v150, v238
    v_sub_f32 v151, v151, v238
    v_sub_f32 v160, v160, v238
    v_sub_f32 v161, v161, v238
    v_sub_f32 v162, v162, v238
    v_sub_f32 v163, v163, v238
    v_sub_f32 v164, v164, v238
    v_sub_f32 v165, v165, v238
    v_sub_f32 v166, v166, v238
    v_sub_f32 v167, v167, v238
    v_accvgpr_read_b32 v242, a8
    v_accvgpr_read_b32 v243, a9
    v_accvgpr_read_b32 v244, a10
    v_accvgpr_read_b32 v245, a11
    v_mul_f32 v242, v242, v239
    v_mul_f32 v243, v243, v239
    v_mul_f32 v244, v244, v239
    v_mul_f32 v245, v245, v239
    v_accvgpr_write_b32 a8, v242
    v_accvgpr_write_b32 a9, v243
    v_accvgpr_write_b32 a10, v244
    v_accvgpr_write_b32 a11, v245
    v_accvgpr_read_b32 v242, a24
    v_accvgpr_read_b32 v243, a25
    v_accvgpr_read_b32 v244, a26
    v_accvgpr_read_b32 v245, a27
    v_mul_f32 v242, v242, v239
    v_mul_f32 v243, v243, v239
    v_mul_f32 v244, v244, v239
    v_mul_f32 v245, v245, v239
    v_accvgpr_write_b32 a24, v242
    v_accvgpr_write_b32 a25, v243
    v_accvgpr_write_b32 a26, v244
    v_accvgpr_write_b32 a27, v245
    v_accvgpr_read_b32 v242, a40
    v_accvgpr_read_b32 v243, a41
    v_accvgpr_read_b32 v244, a42
    v_accvgpr_read_b32 v245, a43
    v_mul_f32 v242, v242, v239
    v_mul_f32 v243, v243, v239
    v_mul_f32 v244, v244, v239
    v_mul_f32 v245, v245, v239
    v_accvgpr_write_b32 a40, v242
    v_accvgpr_write_b32 a41, v243
    v_accvgpr_write_b32 a42, v244
    v_accvgpr_write_b32 a43, v245
    v_accvgpr_read_b32 v242, a56
    v_accvgpr_read_b32 v243, a57
    v_accvgpr_read_b32 v244, a58
    v_accvgpr_read_b32 v245, a59
    v_mul_f32 v242, v242, v239
    v_mul_f32 v243, v243, v239
    v_mul_f32 v244, v244, v239
    v_mul_f32 v245, v245, v239
    v_accvgpr_write_b32 a56, v242
    v_accvgpr_write_b32 a57, v243
    v_accvgpr_write_b32 a58, v244
    v_accvgpr_write_b32 a59, v245
    v_accvgpr_read_b32 v242, a72
    v_accvgpr_read_b32 v243, a73
    v_accvgpr_read_b32 v244, a74
    v_accvgpr_read_b32 v245, a75
    v_mul_f32 v242, v242, v239
    v_mul_f32 v243, v243, v239
    v_mul_f32 v244, v244, v239
    v_mul_f32 v245, v245, v239
    v_accvgpr_write_b32 a72, v242
    v_accvgpr_write_b32 a73, v243
    v_accvgpr_write_b32 a74, v244
    v_accvgpr_write_b32 a75, v245
    v_accvgpr_read_b32 v242, a88
    v_accvgpr_read_b32 v243, a89
    v_accvgpr_read_b32 v244, a90
    v_accvgpr_read_b32 v245, a91
    v_mul_f32 v242, v242, v239
    v_mul_f32 v243, v243, v239
    v_mul_f32 v244, v244, v239
    v_mul_f32 v245, v245, v239
    v_accvgpr_write_b32 a88, v242
    v_accvgpr_write_b32 a89, v243
    v_accvgpr_write_b32 a90, v244
    v_accvgpr_write_b32 a91, v245
    v_accvgpr_read_b32 v242, a104
    v_accvgpr_read_b32 v243, a105
    v_accvgpr_read_b32 v244, a106
    v_accvgpr_read_b32 v245, a107
    v_mul_f32 v242, v242, v239
    v_mul_f32 v243, v243, v239
    v_mul_f32 v244, v244, v239
    v_mul_f32 v245, v245, v239
    v_accvgpr_write_b32 a104, v242
    v_accvgpr_write_b32 a105, v243
    v_accvgpr_write_b32 a106, v244
    v_accvgpr_write_b32 a107, v245
    v_accvgpr_read_b32 v242, a120
    v_accvgpr_read_b32 v243, a121
    v_accvgpr_read_b32 v244, a122
    v_accvgpr_read_b32 v245, a123
    v_mul_f32 v242, v242, v239
    v_mul_f32 v243, v243, v239
    v_mul_f32 v244, v244, v239
    v_mul_f32 v245, v245, v239
    v_accvgpr_write_b32 a120, v242
    v_accvgpr_write_b32 a121, v243
    v_accvgpr_write_b32 a122, v244
    v_accvgpr_write_b32 a123, v245
    v_accvgpr_read_b32 v242, a136
    v_accvgpr_read_b32 v243, a137
    v_accvgpr_read_b32 v244, a138
    v_accvgpr_read_b32 v245, a139
    v_mul_f32 v242, v242, v239
    v_mul_f32 v243, v243, v239
    v_mul_f32 v244, v244, v239
    v_mul_f32 v245, v245, v239
    v_accvgpr_write_b32 a136, v242
    v_accvgpr_write_b32 a137, v243
    v_accvgpr_write_b32 a138, v244
    v_accvgpr_write_b32 a139, v245
    v_accvgpr_read_b32 v242, a152
    v_accvgpr_read_b32 v243, a153
    v_accvgpr_read_b32 v244, a154
    v_accvgpr_read_b32 v245, a155
    v_mul_f32 v242, v242, v239
    v_mul_f32 v243, v243, v239
    v_mul_f32 v244, v244, v239
    v_mul_f32 v245, v245, v239
    v_accvgpr_write_b32 a152, v242
    v_accvgpr_write_b32 a153, v243
    v_accvgpr_write_b32 a154, v244
    v_accvgpr_write_b32 a155, v245
    v_accvgpr_read_b32 v242, a168
    v_accvgpr_read_b32 v243, a169
    v_accvgpr_read_b32 v244, a170
    v_accvgpr_read_b32 v245, a171
    v_mul_f32 v242, v242, v239
    v_mul_f32 v243, v243, v239
    v_mul_f32 v244, v244, v239
    v_mul_f32 v245, v245, v239
    v_accvgpr_write_b32 a168, v242
    v_accvgpr_write_b32 a169, v243
    v_accvgpr_write_b32 a170, v244
    v_accvgpr_write_b32 a171, v245
    v_accvgpr_read_b32 v242, a184
    v_accvgpr_read_b32 v243, a185
    v_accvgpr_read_b32 v244, a186
    v_accvgpr_read_b32 v245, a187
    v_mul_f32 v242, v242, v239
    v_mul_f32 v243, v243, v239
    v_mul_f32 v244, v244, v239
    v_mul_f32 v245, v245, v239
    v_accvgpr_write_b32 a184, v242
    v_accvgpr_write_b32 a185, v243
    v_accvgpr_write_b32 a186, v244
    v_accvgpr_write_b32 a187, v245
    v_accvgpr_read_b32 v242, a200
    v_accvgpr_read_b32 v243, a201
    v_accvgpr_read_b32 v244, a202
    v_accvgpr_read_b32 v245, a203
    v_mul_f32 v242, v242, v239
    v_mul_f32 v243, v243, v239
    v_mul_f32 v244, v244, v239
    v_mul_f32 v245, v245, v239
    v_accvgpr_write_b32 a200, v242
    v_accvgpr_write_b32 a201, v243
    v_accvgpr_write_b32 a202, v244
    v_accvgpr_write_b32 a203, v245
    v_accvgpr_read_b32 v242, a216
    v_accvgpr_read_b32 v243, a217
    v_accvgpr_read_b32 v244, a218
    v_accvgpr_read_b32 v245, a219
    v_mul_f32 v242, v242, v239
    v_mul_f32 v243, v243, v239
    v_mul_f32 v244, v244, v239
    v_mul_f32 v245, v245, v239
    v_accvgpr_write_b32 a216, v242
    v_accvgpr_write_b32 a217, v243
    v_accvgpr_write_b32 a218, v244
    v_accvgpr_write_b32 a219, v245
    v_accvgpr_read_b32 v242, a232
    v_accvgpr_read_b32 v243, a233
    v_accvgpr_read_b32 v244, a234
    v_accvgpr_read_b32 v245, a235
    v_mul_f32 v242, v242, v239
    v_mul_f32 v243, v243, v239
    v_mul_f32 v244, v244, v239
    v_mul_f32 v245, v245, v239
    v_accvgpr_write_b32 a232, v242
    v_accvgpr_write_b32 a233, v243
    v_accvgpr_write_b32 a234, v244
    v_accvgpr_write_b32 a235, v245
    v_accvgpr_read_b32 v242, a248
    v_accvgpr_read_b32 v243, a249
    v_accvgpr_read_b32 v244, a250
    v_accvgpr_read_b32 v245, a251
    v_mul_f32 v242, v242, v239
    v_mul_f32 v243, v243, v239
    v_mul_f32 v244, v244, v239
    v_mul_f32 v245, v245, v239
    v_accvgpr_write_b32 a248, v242
    v_accvgpr_write_b32 a249, v243
    v_accvgpr_write_b32 a250, v244
    v_accvgpr_write_b32 a251, v245
    v_max3_f32 v238, v152, v153, v154
    v_max3_f32 v238, v238, v155, v156
    v_max3_f32 v238, v238, v157, v158
    v_max_f32 v238, v238, v159
    v_mov_b32 v240, v238
    s_nop 1
    v_permlane16_swap_b32 v238, v240
    s_nop 1
    v_max_f32 v238, v238, v240
    v_mov_b32 v240, v238
    s_nop 1
    v_permlane32_swap_b32 v238, v240
    s_nop 1
    v_max_f32 v238, v238, v240
    v_max_f32 v238, 0, v238
    v_exp_f32_e64 v239, -v238
    s_nop 0
    v_sub_f32 v212, v212, v238
    v_sub_f32 v213, v213, v238
    v_sub_f32 v214, v214, v238
    v_sub_f32 v215, v215, v238
    v_mul_f32 v235, v235, v239
    v_sub_f32 v152, v152, v238
    v_sub_f32 v153, v153, v238
    v_sub_f32 v154, v154, v238
    v_sub_f32 v155, v155, v238
    v_sub_f32 v156, v156, v238
    v_sub_f32 v157, v157, v238
    v_sub_f32 v158, v158, v238
    v_sub_f32 v159, v159, v238
    v_sub_f32 v168, v168, v238
    v_sub_f32 v169, v169, v238
    v_sub_f32 v170, v170, v238
    v_sub_f32 v171, v171, v238
    v_sub_f32 v172, v172, v238
    v_sub_f32 v173, v173, v238
    v_sub_f32 v174, v174, v238
    v_sub_f32 v175, v175, v238
    v_accvgpr_read_b32 v242, a12
    v_accvgpr_read_b32 v243, a13
    v_accvgpr_read_b32 v244, a14
    v_accvgpr_read_b32 v245, a15
    v_mul_f32 v242, v242, v239
    v_mul_f32 v243, v243, v239
    v_mul_f32 v244, v244, v239
    v_mul_f32 v245, v245, v239
    v_accvgpr_write_b32 a12, v242
    v_accvgpr_write_b32 a13, v243
    v_accvgpr_write_b32 a14, v244
    v_accvgpr_write_b32 a15, v245
    v_accvgpr_read_b32 v242, a28
    v_accvgpr_read_b32 v243, a29
    v_accvgpr_read_b32 v244, a30
    v_accvgpr_read_b32 v245, a31
    v_mul_f32 v242, v242, v239
    v_mul_f32 v243, v243, v239
    v_mul_f32 v244, v244, v239
    v_mul_f32 v245, v245, v239
    v_accvgpr_write_b32 a28, v242
    v_accvgpr_write_b32 a29, v243
    v_accvgpr_write_b32 a30, v244
    v_accvgpr_write_b32 a31, v245
    v_accvgpr_read_b32 v242, a44
    v_accvgpr_read_b32 v243, a45
    v_accvgpr_read_b32 v244, a46
    v_accvgpr_read_b32 v245, a47
    v_mul_f32 v242, v242, v239
    v_mul_f32 v243, v243, v239
    v_mul_f32 v244, v244, v239
    v_mul_f32 v245, v245, v239
    v_accvgpr_write_b32 a44, v242
    v_accvgpr_write_b32 a45, v243
    v_accvgpr_write_b32 a46, v244
    v_accvgpr_write_b32 a47, v245
    v_accvgpr_read_b32 v242, a60
    v_accvgpr_read_b32 v243, a61
    v_accvgpr_read_b32 v244, a62
    v_accvgpr_read_b32 v245, a63
    v_mul_f32 v242, v242, v239
    v_mul_f32 v243, v243, v239
    v_mul_f32 v244, v244, v239
    v_mul_f32 v245, v245, v239
    v_accvgpr_write_b32 a60, v242
    v_accvgpr_write_b32 a61, v243
    v_accvgpr_write_b32 a62, v244
    v_accvgpr_write_b32 a63, v245
    v_accvgpr_read_b32 v242, a76
    v_accvgpr_read_b32 v243, a77
    v_accvgpr_read_b32 v244, a78
    v_accvgpr_read_b32 v245, a79
    v_mul_f32 v242, v242, v239
    v_mul_f32 v243, v243, v239
    v_mul_f32 v244, v244, v239
    v_mul_f32 v245, v245, v239
    v_accvgpr_write_b32 a76, v242
    v_accvgpr_write_b32 a77, v243
    v_accvgpr_write_b32 a78, v244
    v_accvgpr_write_b32 a79, v245
    v_accvgpr_read_b32 v242, a92
    v_accvgpr_read_b32 v243, a93
    v_accvgpr_read_b32 v244, a94
    v_accvgpr_read_b32 v245, a95
    v_mul_f32 v242, v242, v239
    v_mul_f32 v243, v243, v239
    v_mul_f32 v244, v244, v239
    v_mul_f32 v245, v245, v239
    v_accvgpr_write_b32 a92, v242
    v_accvgpr_write_b32 a93, v243
    v_accvgpr_write_b32 a94, v244
    v_accvgpr_write_b32 a95, v245
    v_accvgpr_read_b32 v242, a108
    v_accvgpr_read_b32 v243, a109
    v_accvgpr_read_b32 v244, a110
    v_accvgpr_read_b32 v245, a111
    v_mul_f32 v242, v242, v239
    v_mul_f32 v243, v243, v239
    v_mul_f32 v244, v244, v239
    v_mul_f32 v245, v245, v239
    v_accvgpr_write_b32 a108, v242
    v_accvgpr_write_b32 a109, v243
    v_accvgpr_write_b32 a110, v244
    v_accvgpr_write_b32 a111, v245
    v_accvgpr_read_b32 v242, a124
    v_accvgpr_read_b32 v243, a125
    v_accvgpr_read_b32 v244, a126
    v_accvgpr_read_b32 v245, a127
    v_mul_f32 v242, v242, v239
    v_mul_f32 v243, v243, v239
    v_mul_f32 v244, v244, v239
    v_mul_f32 v245, v245, v239
    v_accvgpr_write_b32 a124, v242
    v_accvgpr_write_b32 a125, v243
    v_accvgpr_write_b32 a126, v244
    v_accvgpr_write_b32 a127, v245
    v_accvgpr_read_b32 v242, a140
    v_accvgpr_read_b32 v243, a141
    v_accvgpr_read_b32 v244, a142
    v_accvgpr_read_b32 v245, a143
    v_mul_f32 v242, v242, v239
    v_mul_f32 v243, v243, v239
    v_mul_f32 v244, v244, v239
    v_mul_f32 v245, v245, v239
    v_accvgpr_write_b32 a140, v242
    v_accvgpr_write_b32 a141, v243
    v_accvgpr_write_b32 a142, v244
    v_accvgpr_write_b32 a143, v245
    v_accvgpr_read_b32 v242, a156
    v_accvgpr_read_b32 v243, a157
    v_accvgpr_read_b32 v244, a158
    v_accvgpr_read_b32 v245, a159
    v_mul_f32 v242, v242, v239
    v_mul_f32 v243, v243, v239
    v_mul_f32 v244, v244, v239
    v_mul_f32 v245, v245, v239
    v_accvgpr_write_b32 a156, v242
    v_accvgpr_write_b32 a157, v243
    v_accvgpr_write_b32 a158, v244
    v_accvgpr_write_b32 a159, v245
    v_accvgpr_read_b32 v242, a172
    v_accvgpr_read_b32 v243, a173
    v_accvgpr_read_b32 v244, a174
    v_accvgpr_read_b32 v245, a175
    v_mul_f32 v242, v242, v239
    v_mul_f32 v243, v243, v239
    v_mul_f32 v244, v244, v239
    v_mul_f32 v245, v245, v239
    v_accvgpr_write_b32 a172, v242
    v_accvgpr_write_b32 a173, v243
    v_accvgpr_write_b32 a174, v244
    v_accvgpr_write_b32 a175, v245
    v_accvgpr_read_b32 v242, a188
    v_accvgpr_read_b32 v243, a189
    v_accvgpr_read_b32 v244, a190
    v_accvgpr_read_b32 v245, a191
    v_mul_f32 v242, v242, v239
    v_mul_f32 v243, v243, v239
    v_mul_f32 v244, v244, v239
    v_mul_f32 v245, v245, v239
    v_accvgpr_write_b32 a188, v242
    v_accvgpr_write_b32 a189, v243
    v_accvgpr_write_b32 a190, v244
    v_accvgpr_write_b32 a191, v245
    v_accvgpr_read_b32 v242, a204
    v_accvgpr_read_b32 v243, a205
    v_accvgpr_read_b32 v244, a206
    v_accvgpr_read_b32 v245, a207
    v_mul_f32 v242, v242, v239
    v_mul_f32 v243, v243, v239
    v_mul_f32 v244, v244, v239
    v_mul_f32 v245, v245, v239
    v_accvgpr_write_b32 a204, v242
    v_accvgpr_write_b32 a205, v243
    v_accvgpr_write_b32 a206, v244
    v_accvgpr_write_b32 a207, v245
    v_accvgpr_read_b32 v242, a220
    v_accvgpr_read_b32 v243, a221
    v_accvgpr_read_b32 v244, a222
    v_accvgpr_read_b32 v245, a223
    v_mul_f32 v242, v242, v239
    v_mul_f32 v243, v243, v239
    v_mul_f32 v244, v244, v239
    v_mul_f32 v245, v245, v239
    v_accvgpr_write_b32 a220, v242
    v_accvgpr_write_b32 a221, v243
    v_accvgpr_write_b32 a222, v244
    v_accvgpr_write_b32 a223, v245
    v_accvgpr_read_b32 v242, a236
    v_accvgpr_read_b32 v243, a237
    v_accvgpr_read_b32 v244, a238
    v_accvgpr_read_b32 v245, a239
    v_mul_f32 v242, v242, v239
    v_mul_f32 v243, v243, v239
    v_mul_f32 v244, v244, v239
    v_mul_f32 v245, v245, v239
    v_accvgpr_write_b32 a236, v242
    v_accvgpr_write_b32 a237, v243
    v_accvgpr_write_b32 a238, v244
    v_accvgpr_write_b32 a239, v245
    v_accvgpr_read_b32 v242, a252
    v_accvgpr_read_b32 v243, a253
    v_accvgpr_read_b32 v244, a254
    v_accvgpr_read_b32 v245, a255
    v_mul_f32 v242, v242, v239
    v_mul_f32 v243, v243, v239
    v_mul_f32 v244, v244, v239
    v_mul_f32 v245, v245, v239
    v_accvgpr_write_b32 a252, v242
    v_accvgpr_write_b32 a253, v243
    v_accvgpr_write_b32 a254, v244
    v_accvgpr_write_b32 a255, v245
    v_exp_f32 v238, v144
    v_exp_f32 v239, v145
    s_nop 0
    v_add_f32 v236, v238, v239
    v_cvt_pk_bf16_f32 v192, v238, v239
    v_exp_f32 v240, v146
    v_exp_f32 v241, v147
    s_nop 0
    v_add_f32 v236, v236, v240
    v_add_f32 v236, v236, v241
    v_cvt_pk_bf16_f32 v193, v240, v241
    v_exp_f32 v242, v152
    v_exp_f32 v243, v153
    s_nop 0
    v_add_f32 v237, v242, v243
    v_cvt_pk_bf16_f32 v196, v242, v243
    v_exp_f32 v244, v154
    v_exp_f32 v245, v155
    s_nop 0
    v_add_f32 v237, v237, v244
    v_add_f32 v237, v237, v245
    v_cvt_pk_bf16_f32 v197, v244, v245
    v_exp_f32 v238, v148
    v_exp_f32 v239, v149
    s_nop 0
    v_add_f32 v236, v236, v238
    v_add_f32 v236, v236, v239
    v_cvt_pk_bf16_f32 v194, v238, v239
    v_exp_f32 v240, v150
    v_exp_f32 v241, v151
    s_nop 0
    v_add_f32 v236, v236, v240
    v_add_f32 v236, v236, v241
    v_cvt_pk_bf16_f32 v195, v240, v241
    v_exp_f32 v242, v156
    v_exp_f32 v243, v157
    s_nop 0
    v_add_f32 v237, v237, v242
    v_add_f32 v237, v237, v243
    v_cvt_pk_bf16_f32 v198, v242, v243
    v_exp_f32 v244, v158
    v_exp_f32 v245, v159
    s_nop 0
    v_add_f32 v237, v237, v244
    v_add_f32 v237, v237, v245
    v_cvt_pk_bf16_f32 v199, v244, v245
    s_nop 3
    s_cmp_eq_u32 s38, 0
    s_cbranch_scc1 R1_P0
    s_cmp_eq_u32 s38, 1
    s_cbranch_scc1 R1_L2
    s_cmp_eq_u32 s38, 2
    s_cbranch_scc1 R1_L0
    s_branch R1_P30
S_R2_P0:
    s_mov_b32 s38, 0
    s_branch SUB_p2_0_0
S_R2_L2:
    s_mov_b32 s38, 1
    s_branch SUB_p2_0_0
S_R2_L0:
    s_mov_b32 s38, 2
    s_branch SUB_p2_0_0
S_R2_P30:
    s_mov_b32 s38, 3
    s_branch SUB_p2_0_0
SUB_p2_0_0:
    s_nop 7
    s_nop 7
    v_max3_f32 v238, v128, v129, v130
    v_max3_f32 v238, v238, v131, v132
    v_max3_f32 v238, v238, v133, v134
    v_max_f32 v238, v238, v135
    v_mov_b32 v240, v238
    s_nop 1
    v_permlane16_swap_b32 v238, v240
    s_nop 1
    v_max_f32 v238, v238, v240
    v_mov_b32 v240, v238
    s_nop 1
    v_permlane32_swap_b32 v238, v240
    s_nop 1
    v_max_f32 v238, v238, v240
    v_max_f32 v238, 0, v238
    v_exp_f32_e64 v239, -v238
    s_nop 0
    v_sub_f32 v200, v200, v238
    v_sub_f32 v201, v201, v238
    v_sub_f32 v202, v202, v238
    v_sub_f32 v203, v203, v238
    v_mul_f32 v232, v232, v239
    v_sub_f32 v128, v128, v238
    v_sub_f32 v129, v129, v238
    v_sub_f32 v130, v130, v238
    v_sub_f32 v131, v131, v238
    v_sub_f32 v132, v132, v238
    v_sub_f32 v133, v133, v238
    v_sub_f32 v134, v134, v238
    v_sub_f32 v135, v135, v238
    v_accvgpr_read_b32 v242, a0
    v_accvgpr_read_b32 v243, a1
    v_accvgpr_read_b32 v244, a2
    v_accvgpr_read_b32 v245, a3
    v_mul_f32 v242, v242, v239
    v_mul_f32 v243, v243, v239
    v_mul_f32 v244, v244, v239
    v_mul_f32 v245, v245, v239
    v_accvgpr_write_b32 a0, v242
    v_accvgpr_write_b32 a1, v243
    v_accvgpr_write_b32 a2, v244
    v_accvgpr_write_b32 a3, v245
    v_accvgpr_read_b32 v242, a16
    v_accvgpr_read_b32 v243, a17
    v_accvgpr_read_b32 v244, a18
    v_accvgpr_read_b32 v245, a19
    v_mul_f32 v242, v242, v239
    v_mul_f32 v243, v243, v239
    v_mul_f32 v244, v244, v239
    v_mul_f32 v245, v245, v239
    v_accvgpr_write_b32 a16, v242
    v_accvgpr_write_b32 a17, v243
    v_accvgpr_write_b32 a18, v244
    v_accvgpr_write_b32 a19, v245
    v_accvgpr_read_b32 v242, a32
    v_accvgpr_read_b32 v243, a33
    v_accvgpr_read_b32 v244, a34
    v_accvgpr_read_b32 v245, a35
    v_mul_f32 v242, v242, v239
    v_mul_f32 v243, v243, v239
    v_mul_f32 v244, v244, v239
    v_mul_f32 v245, v245, v239
    v_accvgpr_write_b32 a32, v242
    v_accvgpr_write_b32 a33, v243
    v_accvgpr_write_b32 a34, v244
    v_accvgpr_write_b32 a35, v245
    v_accvgpr_read_b32 v242, a48
    v_accvgpr_read_b32 v243, a49
    v_accvgpr_read_b32 v244, a50
    v_accvgpr_read_b32 v245, a51
    v_mul_f32 v242, v242, v239
    v_mul_f32 v243, v243, v239
    v_mul_f32 v244, v244, v239
    v_mul_f32 v245, v245, v239
    v_accvgpr_write_b32 a48, v242
    v_accvgpr_write_b32 a49, v243
    v_accvgpr_write_b32 a50, v244
    v_accvgpr_write_b32 a51, v245
    v_accvgpr_read_b32 v242, a64
    v_accvgpr_read_b32 v243, a65
    v_accvgpr_read_b32 v244, a66
    v_accvgpr_read_b32 v245, a67
    v_mul_f32 v242, v242, v239
    v_mul_f32 v243, v243, v239
    v_mul_f32 v244, v244, v239
    v_mul_f32 v245, v245, v239
    v_accvgpr_write_b32 a64, v242
    v_accvgpr_write_b32 a65, v243
    v_accvgpr_write_b32 a66, v244
    v_accvgpr_write_b32 a67, v245
    v_accvgpr_read_b32 v242, a80
    v_accvgpr_read_b32 v243, a81
    v_accvgpr_read_b32 v244, a82
    v_accvgpr_read_b32 v245, a83
    v_mul_f32 v242, v242, v239
    v_mul_f32 v243, v243, v239
    v_mul_f32 v244, v244, v239
    v_mul_f32 v245, v245, v239
    v_accvgpr_write_b32 a80, v242
    v_accvgpr_write_b32 a81, v243
    v_accvgpr_write_b32 a82, v244
    v_accvgpr_write_b32 a83, v245
    v_accvgpr_read_b32 v242, a96
    v_accvgpr_read_b32 v243, a97
    v_accvgpr_read_b32 v244, a98
    v_accvgpr_read_b32 v245, a99
    v_mul_f32 v242, v242, v239
    v_mul_f32 v243, v243, v239
    v_mul_f32 v244, v244, v239
    v_mul_f32 v245, v245, v239
    v_accvgpr_write_b32 a96, v242
    v_accvgpr_write_b32 a97, v243
    v_accvgpr_write_b32 a98, v244
    v_accvgpr_write_b32 a99, v245
    v_accvgpr_read_b32 v242, a112
    v_accvgpr_read_b32 v243, a113
    v_accvgpr_read_b32 v244, a114
    v_accvgpr_read_b32 v245, a115
    v_mul_f32 v242, v242, v239
    v_mul_f32 v243, v243, v239
    v_mul_f32 v244, v244, v239
    v_mul_f32 v245, v245, v239
    v_accvgpr_write_b32 a112, v242
    v_accvgpr_write_b32 a113, v243
    v_accvgpr_write_b32 a114, v244
    v_accvgpr_write_b32 a115, v245
    v_accvgpr_read_b32 v242, a128
    v_accvgpr_read_b32 v243, a129
    v_accvgpr_read_b32 v244, a130
    v_accvgpr_read_b32 v245, a131
    v_mul_f32 v242, v242, v239
    v_mul_f32 v243, v243, v239
    v_mul_f32 v244, v244, v239
    v_mul_f32 v245, v245, v239
    v_accvgpr_write_b32 a128, v242
    v_accvgpr_write_b32 a129, v243
    v_accvgpr_write_b32 a130, v244
    v_accvgpr_write_b32 a131, v245
    v_accvgpr_read_b32 v242, a144
    v_accvgpr_read_b32 v243, a145
    v_accvgpr_read_b32 v244, a146
    v_accvgpr_read_b32 v245, a147
    v_mul_f32 v242, v242, v239
    v_mul_f32 v243, v243, v239
    v_mul_f32 v244, v244, v239
    v_mul_f32 v245, v245, v239
    v_accvgpr_write_b32 a144, v242
    v_accvgpr_write_b32 a145, v243
    v_accvgpr_write_b32 a146, v244
    v_accvgpr_write_b32 a147, v245
    v_accvgpr_read_b32 v242, a160
    v_accvgpr_read_b32 v243, a161
    v_accvgpr_read_b32 v244, a162
    v_accvgpr_read_b32 v245, a163
    v_mul_f32 v242, v242, v239
    v_mul_f32 v243, v243, v239
    v_mul_f32 v244, v244, v239
    v_mul_f32 v245, v245, v239
    v_accvgpr_write_b32 a160, v242
    v_accvgpr_write_b32 a161, v243
    v_accvgpr_write_b32 a162, v244
    v_accvgpr_write_b32 a163, v245
    v_accvgpr_read_b32 v242, a176
    v_accvgpr_read_b32 v243, a177
    v_accvgpr_read_b32 v244, a178
    v_accvgpr_read_b32 v245, a179
    v_mul_f32 v242, v242, v239
    v_mul_f32 v243, v243, v239
    v_mul_f32 v244, v244, v239
    v_mul_f32 v245, v245, v239
    v_accvgpr_write_b32 a176, v242
    v_accvgpr_write_b32 a177, v243
    v_accvgpr_write_b32 a178, v244
    v_accvgpr_write_b32 a179, v245
    v_accvgpr_read_b32 v242, a192
    v_accvgpr_read_b32 v243, a193
    v_accvgpr_read_b32 v244, a194
    v_accvgpr_read_b32 v245, a195
    v_mul_f32 v242, v242, v239
    v_mul_f32 v243, v243, v239
    v_mul_f32 v244, v244, v239
    v_mul_f32 v245, v245, v239
    v_accvgpr_write_b32 a192, v242
    v_accvgpr_write_b32 a193, v243
    v_accvgpr_write_b32 a194, v244
    v_accvgpr_write_b32 a195, v245
    v_accvgpr_read_b32 v242, a208
    v_accvgpr_read_b32 v243, a209
    v_accvgpr_read_b32 v244, a210
    v_accvgpr_read_b32 v245, a211
    v_mul_f32 v242, v242, v239
    v_mul_f32 v243, v243, v239
    v_mul_f32 v244, v244, v239
    v_mul_f32 v245, v245, v239
    v_accvgpr_write_b32 a208, v242
    v_accvgpr_write_b32 a209, v243
    v_accvgpr_write_b32 a210, v244
    v_accvgpr_write_b32 a211, v245
    v_accvgpr_read_b32 v242, a224
    v_accvgpr_read_b32 v243, a225
    v_accvgpr_read_b32 v244, a226
    v_accvgpr_read_b32 v245, a227
    v_mul_f32 v242, v242, v239
    v_mul_f32 v243, v243, v239
    v_mul_f32 v244, v244, v239
    v_mul_f32 v245, v245, v239
    v_accvgpr_write_b32 a224, v242
    v_accvgpr_write_b32 a225, v243
    v_accvgpr_write_b32 a226, v244
    v_accvgpr_write_b32 a227, v245
    v_accvgpr_read_b32 v242, a240
    v_accvgpr_read_b32 v243, a241
    v_accvgpr_read_b32 v244, a242
    v_accvgpr_read_b32 v245, a243
    v_mul_f32 v242, v242, v239
    v_mul_f32 v243, v243, v239
    v_mul_f32 v244, v244, v239
    v_mul_f32 v245, v245, v239
    v_accvgpr_write_b32 a240, v242
    v_accvgpr_write_b32 a241, v243
    v_accvgpr_write_b32 a242, v244
    v_accvgpr_write_b32 a243, v245
    v_max3_f32 v238, v136, v137, v138
    v_max3_f32 v238, v238, v139, v140
    v_max3_f32 v238, v238, v141, v142
    v_max_f32 v238, v238, v143
    v_mov_b32 v240, v238
    s_nop 1
    v_permlane16_swap_b32 v238, v240
    s_nop 1
    v_max_f32 v238, v238, v240
    v_mov_b32 v240, v238
    s_nop 1
    v_permlane32_swap_b32 v238, v240
    s_nop 1
    v_max_f32 v238, v238, v240
    v_max_f32 v238, 0, v238
    v_exp_f32_e64 v239, -v238
    s_nop 0
    v_sub_f32 v204, v204, v238
    v_sub_f32 v205, v205, v238
    v_sub_f32 v206, v206, v238
    v_sub_f32 v207, v207, v238
    v_mul_f32 v233, v233, v239
    v_sub_f32 v136, v136, v238
    v_sub_f32 v137, v137, v238
    v_sub_f32 v138, v138, v238
    v_sub_f32 v139, v139, v238
    v_sub_f32 v140, v140, v238
    v_sub_f32 v141, v141, v238
    v_sub_f32 v142, v142, v238
    v_sub_f32 v143, v143, v238
    v_accvgpr_read_b32 v242, a4
    v_accvgpr_read_b32 v243, a5
    v_accvgpr_read_b32 v244, a6
    v_accvgpr_read_b32 v245, a7
    v_mul_f32 v242, v242, v239
    v_mul_f32 v243, v243, v239
    v_mul_f32 v244, v244, v239
    v_mul_f32 v245, v245, v239
    v_accvgpr_write_b32 a4, v242
    v_accvgpr_write_b32 a5, v243
    v_accvgpr_write_b32 a6, v244
    v_accvgpr_write_b32 a7, v245
    v_accvgpr_read_b32 v242, a20
    v_accvgpr_read_b32 v243, a21
    v_accvgpr_read_b32 v244, a22
    v_accvgpr_read_b32 v245, a23
    v_mul_f32 v242, v242, v239
    v_mul_f32 v243, v243, v239
    v_mul_f32 v244, v244, v239
    v_mul_f32 v245, v245, v239
    v_accvgpr_write_b32 a20, v242
    v_accvgpr_write_b32 a21, v243
    v_accvgpr_write_b32 a22, v244
    v_accvgpr_write_b32 a23, v245
    v_accvgpr_read_b32 v242, a36
    v_accvgpr_read_b32 v243, a37
    v_accvgpr_read_b32 v244, a38
    v_accvgpr_read_b32 v245, a39
    v_mul_f32 v242, v242, v239
    v_mul_f32 v243, v243, v239
    v_mul_f32 v244, v244, v239
    v_mul_f32 v245, v245, v239
    v_accvgpr_write_b32 a36, v242
    v_accvgpr_write_b32 a37, v243
    v_accvgpr_write_b32 a38, v244
    v_accvgpr_write_b32 a39, v245
    v_accvgpr_read_b32 v242, a52
    v_accvgpr_read_b32 v243, a53
    v_accvgpr_read_b32 v244, a54
    v_accvgpr_read_b32 v245, a55
    v_mul_f32 v242, v242, v239
    v_mul_f32 v243, v243, v239
    v_mul_f32 v244, v244, v239
    v_mul_f32 v245, v245, v239
    v_accvgpr_write_b32 a52, v242
    v_accvgpr_write_b32 a53, v243
    v_accvgpr_write_b32 a54, v244
    v_accvgpr_write_b32 a55, v245
    v_accvgpr_read_b32 v242, a68
    v_accvgpr_read_b32 v243, a69
    v_accvgpr_read_b32 v244, a70
    v_accvgpr_read_b32 v245, a71
    v_mul_f32 v242, v242, v239
    v_mul_f32 v243, v243, v239
    v_mul_f32 v244, v244, v239
    v_mul_f32 v245, v245, v239
    v_accvgpr_write_b32 a68, v242
    v_accvgpr_write_b32 a69, v243
    v_accvgpr_write_b32 a70, v244
    v_accvgpr_write_b32 a71, v245
    v_accvgpr_read_b32 v242, a84
    v_accvgpr_read_b32 v243, a85
    v_accvgpr_read_b32 v244, a86
    v_accvgpr_read_b32 v245, a87
    v_mul_f32 v242, v242, v239
    v_mul_f32 v243, v243, v239
    v_mul_f32 v244, v244, v239
    v_mul_f32 v245, v245, v239
    v_accvgpr_write_b32 a84, v242
    v_accvgpr_write_b32 a85, v243
    v_accvgpr_write_b32 a86, v244
    v_accvgpr_write_b32 a87, v245
    v_accvgpr_read_b32 v242, a100
    v_accvgpr_read_b32 v243, a101
    v_accvgpr_read_b32 v244, a102
    v_accvgpr_read_b32 v245, a103
    v_mul_f32 v242, v242, v239
    v_mul_f32 v243, v243, v239
    v_mul_f32 v244, v244, v239
    v_mul_f32 v245, v245, v239
    v_accvgpr_write_b32 a100, v242
    v_accvgpr_write_b32 a101, v243
    v_accvgpr_write_b32 a102, v244
    v_accvgpr_write_b32 a103, v245
    v_accvgpr_read_b32 v242, a116
    v_accvgpr_read_b32 v243, a117
    v_accvgpr_read_b32 v244, a118
    v_accvgpr_read_b32 v245, a119
    v_mul_f32 v242, v242, v239
    v_mul_f32 v243, v243, v239
    v_mul_f32 v244, v244, v239
    v_mul_f32 v245, v245, v239
    v_accvgpr_write_b32 a116, v242
    v_accvgpr_write_b32 a117, v243
    v_accvgpr_write_b32 a118, v244
    v_accvgpr_write_b32 a119, v245
    v_accvgpr_read_b32 v242, a132
    v_accvgpr_read_b32 v243, a133
    v_accvgpr_read_b32 v244, a134
    v_accvgpr_read_b32 v245, a135
    v_mul_f32 v242, v242, v239
    v_mul_f32 v243, v243, v239
    v_mul_f32 v244, v244, v239
    v_mul_f32 v245, v245, v239
    v_accvgpr_write_b32 a132, v242
    v_accvgpr_write_b32 a133, v243
    v_accvgpr_write_b32 a134, v244
    v_accvgpr_write_b32 a135, v245
    v_accvgpr_read_b32 v242, a148
    v_accvgpr_read_b32 v243, a149
    v_accvgpr_read_b32 v244, a150
    v_accvgpr_read_b32 v245, a151
    v_mul_f32 v242, v242, v239
    v_mul_f32 v243, v243, v239
    v_mul_f32 v244, v244, v239
    v_mul_f32 v245, v245, v239
    v_accvgpr_write_b32 a148, v242
    v_accvgpr_write_b32 a149, v243
    v_accvgpr_write_b32 a150, v244
    v_accvgpr_write_b32 a151, v245
    v_accvgpr_read_b32 v242, a164
    v_accvgpr_read_b32 v243, a165
    v_accvgpr_read_b32 v244, a166
    v_accvgpr_read_b32 v245, a167
    v_mul_f32 v242, v242, v239
    v_mul_f32 v243, v243, v239
    v_mul_f32 v244, v244, v239
    v_mul_f32 v245, v245, v239
    v_accvgpr_write_b32 a164, v242
    v_accvgpr_write_b32 a165, v243
    v_accvgpr_write_b32 a166, v244
    v_accvgpr_write_b32 a167, v245
    v_accvgpr_read_b32 v242, a180
    v_accvgpr_read_b32 v243, a181
    v_accvgpr_read_b32 v244, a182
    v_accvgpr_read_b32 v245, a183
    v_mul_f32 v242, v242, v239
    v_mul_f32 v243, v243, v239
    v_mul_f32 v244, v244, v239
    v_mul_f32 v245, v245, v239
    v_accvgpr_write_b32 a180, v242
    v_accvgpr_write_b32 a181, v243
    v_accvgpr_write_b32 a182, v244
    v_accvgpr_write_b32 a183, v245
    v_accvgpr_read_b32 v242, a196
    v_accvgpr_read_b32 v243, a197
    v_accvgpr_read_b32 v244, a198
    v_accvgpr_read_b32 v245, a199
    v_mul_f32 v242, v242, v239
    v_mul_f32 v243, v243, v239
    v_mul_f32 v244, v244, v239
    v_mul_f32 v245, v245, v239
    v_accvgpr_write_b32 a196, v242
    v_accvgpr_write_b32 a197, v243
    v_accvgpr_write_b32 a198, v244
    v_accvgpr_write_b32 a199, v245
    v_accvgpr_read_b32 v242, a212
    v_accvgpr_read_b32 v243, a213
    v_accvgpr_read_b32 v244, a214
    v_accvgpr_read_b32 v245, a215
    v_mul_f32 v242, v242, v239
    v_mul_f32 v243, v243, v239
    v_mul_f32 v244, v244, v239
    v_mul_f32 v245, v245, v239
    v_accvgpr_write_b32 a212, v242
    v_accvgpr_write_b32 a213, v243
    v_accvgpr_write_b32 a214, v244
    v_accvgpr_write_b32 a215, v245
    v_accvgpr_read_b32 v242, a228
    v_accvgpr_read_b32 v243, a229
    v_accvgpr_read_b32 v244, a230
    v_accvgpr_read_b32 v245, a231
    v_mul_f32 v242, v242, v239
    v_mul_f32 v243, v243, v239
    v_mul_f32 v244, v244, v239
    v_mul_f32 v245, v245, v239
    v_accvgpr_write_b32 a228, v242
    v_accvgpr_write_b32 a229, v243
    v_accvgpr_write_b32 a230, v244
    v_accvgpr_write_b32 a231, v245
    v_accvgpr_read_b32 v242, a244
    v_accvgpr_read_b32 v243, a245
    v_accvgpr_read_b32 v244, a246
    v_accvgpr_read_b32 v245, a247
    v_mul_f32 v242, v242, v239
    v_mul_f32 v243, v243, v239
    v_mul_f32 v244, v244, v239
    v_mul_f32 v245, v245, v239
    v_accvgpr_write_b32 a244, v242
    v_accvgpr_write_b32 a245, v243
    v_accvgpr_write_b32 a246, v244
    v_accvgpr_write_b32 a247, v245
    v_exp_f32 v238, v128
    v_exp_f32 v239, v129
    s_nop 0
    v_add_f32 v236, v238, v239
    v_cvt_pk_bf16_f32 v184, v238, v239
    v_exp_f32 v240, v130
    v_exp_f32 v241, v131
    s_nop 0
    v_add_f32 v236, v236, v240
    v_add_f32 v236, v236, v241
    v_cvt_pk_bf16_f32 v185, v240, v241
    v_exp_f32 v242, v136
    v_exp_f32 v243, v137
    s_nop 0
    v_add_f32 v237, v242, v243
    v_cvt_pk_bf16_f32 v188, v242, v243
    v_exp_f32 v244, v138
    v_exp_f32 v245, v139
    s_nop 0
    v_add_f32 v237, v237, v244
    v_add_f32 v237, v237, v245
    v_cvt_pk_bf16_f32 v189, v244, v245
    v_exp_f32 v238, v132
    v_exp_f32 v239, v133
    s_nop 0
    v_add_f32 v236, v236, v238
    v_add_f32 v236, v236, v239
    v_cvt_pk_bf16_f32 v186, v238, v239
    v_exp_f32 v240, v134
    v_exp_f32 v241, v135
    s_nop 0
    v_add_f32 v236, v236, v240
    v_add_f32 v236, v236, v241
    v_cvt_pk_bf16_f32 v187, v240, v241
    v_exp_f32 v242, v140
    v_exp_f32 v243, v141
    s_nop 0
    v_add_f32 v237, v237, v242
    v_add_f32 v237, v237, v243
    v_cvt_pk_bf16_f32 v190, v242, v243
    v_exp_f32 v244, v142
    v_exp_f32 v245, v143
    s_nop 0
    v_add_f32 v237, v237, v244
    v_add_f32 v237, v237, v245
    v_cvt_pk_bf16_f32 v191, v244, v245
    s_nop 3
    s_cmp_eq_u32 s38, 0
    s_cbranch_scc1 R2_P0
    s_cmp_eq_u32 s38, 1
    s_cbranch_scc1 R2_L2
    s_cmp_eq_u32 s38, 2
    s_cbranch_scc1 R2_L0
    s_branch R2_P30
S_R1_L1:
    s_mov_b32 s38, 0
    s_branch SUB_p1_1_0
S_R1_L3:
    s_mov_b32 s38, 1
    s_branch SUB_p1_1_0
S_R1_P29:
    s_mov_b32 s38, 2
    s_branch SUB_p1_1_0
SUB_p1_1_0:
    s_nop 7
    s_nop 7
    v_max3_f32 v238, v160, v161, v162
    v_max3_f32 v238, v238, v163, v164
    v_max3_f32 v238, v238, v165, v166
    v_max_f32 v238, v238, v167
    v_mov_b32 v240, v238
    s_nop 1
    v_permlane16_swap_b32 v238, v240
    s_nop 1
    v_max_f32 v238, v238, v240
    v_mov_b32 v240, v238
    s_nop 1
    v_permlane32_swap_b32 v238, v240
    s_nop 1
    v_max_f32 v238, v238, v240
    v_max_f32 v238, 0, v238
    v_exp_f32_e64 v239, -v238
    s_nop 0
    v_sub_f32 v208, v208, v238
    v_sub_f32 v209, v209, v238
    v_sub_f32 v210, v210, v238
    v_sub_f32 v211, v211, v238
    v_mul_f32 v234, v234, v239
    v_sub_f32 v160, v160, v238
    v_sub_f32 v161, v161, v238
    v_sub_f32 v162, v162, v238
    v_sub_f32 v163, v163, v238
    v_sub_f32 v164, v164, v238
    v_sub_f32 v165, v165, v238
    v_sub_f32 v166, v166, v238
    v_sub_f32 v167, v167, v238
    v_sub_f32 v144, v144, v238
    v_sub_f32 v145, v145, v238
    v_sub_f32 v146, v146, v238
    v_sub_f32 v147, v147, v238
    v_sub_f32 v148, v148, v238
    v_sub_f32 v149, v149, v238
    v_sub_f32 v150, v150, v238
    v_sub_f32 v151, v151, v238
    v_accvgpr_read_b32 v242, a8
    v_accvgpr_read_b32 v243, a9
    v_accvgpr_read_b32 v244, a10
    v_accvgpr_read_b32 v245, a11
    v_mul_f32 v242, v242, v239
    v_mul_f32 v243, v243, v239
    v_mul_f32 v244, v244, v239
    v_mul_f32 v245, v245, v239
    v_accvgpr_write_b32 a8, v242
    v_accvgpr_write_b32 a9, v243
    v_accvgpr_write_b32 a10, v244
    v_accvgpr_write_b32 a11, v245
    v_accvgpr_read_b32 v242, a24
    v_accvgpr_read_b32 v243, a25
    v_accvgpr_read_b32 v244, a26
    v_accvgpr_read_b32 v245, a27
    v_mul_f32 v242, v242, v239
    v_mul_f32 v243, v243, v239
    v_mul_f32 v244, v244, v239
    v_mul_f32 v245, v245, v239
    v_accvgpr_write_b32 a24, v242
    v_accvgpr_write_b32 a25, v243
    v_accvgpr_write_b32 a26, v244
    v_accvgpr_write_b32 a27, v245
    v_accvgpr_read_b32 v242, a40
    v_accvgpr_read_b32 v243, a41
    v_accvgpr_read_b32 v244, a42
    v_accvgpr_read_b32 v245, a43
    v_mul_f32 v242, v242, v239
    v_mul_f32 v243, v243, v239
    v_mul_f32 v244, v244, v239
    v_mul_f32 v245, v245, v239
    v_accvgpr_write_b32 a40, v242
    v_accvgpr_write_b32 a41, v243
    v_accvgpr_write_b32 a42, v244
    v_accvgpr_write_b32 a43, v245
    v_accvgpr_read_b32 v242, a56
    v_accvgpr_read_b32 v243, a57
    v_accvgpr_read_b32 v244, a58
    v_accvgpr_read_b32 v245, a59
    v_mul_f32 v242, v242, v239
    v_mul_f32 v243, v243, v239
    v_mul_f32 v244, v244, v239
    v_mul_f32 v245, v245, v239
    v_accvgpr_write_b32 a56, v242
    v_accvgpr_write_b32 a57, v243
    v_accvgpr_write_b32 a58, v244
    v_accvgpr_write_b32 a59, v245
    v_accvgpr_read_b32 v242, a72
    v_accvgpr_read_b32 v243, a73
    v_accvgpr_read_b32 v244, a74
    v_accvgpr_read_b32 v245, a75
    v_mul_f32 v242, v242, v239
    v_mul_f32 v243, v243, v239
    v_mul_f32 v244, v244, v239
    v_mul_f32 v245, v245, v239
    v_accvgpr_write_b32 a72, v242
    v_accvgpr_write_b32 a73, v243
    v_accvgpr_write_b32 a74, v244
    v_accvgpr_write_b32 a75, v245
    v_accvgpr_read_b32 v242, a88
    v_accvgpr_read_b32 v243, a89
    v_accvgpr_read_b32 v244, a90
    v_accvgpr_read_b32 v245, a91
    v_mul_f32 v242, v242, v239
    v_mul_f32 v243, v243, v239
    v_mul_f32 v244, v244, v239
    v_mul_f32 v245, v245, v239
    v_accvgpr_write_b32 a88, v242
    v_accvgpr_write_b32 a89, v243
    v_accvgpr_write_b32 a90, v244
    v_accvgpr_write_b32 a91, v245
    v_accvgpr_read_b32 v242, a104
    v_accvgpr_read_b32 v243, a105
    v_accvgpr_read_b32 v244, a106
    v_accvgpr_read_b32 v245, a107
    v_mul_f32 v242, v242, v239
    v_mul_f32 v243, v243, v239
    v_mul_f32 v244, v244, v239
    v_mul_f32 v245, v245, v239
    v_accvgpr_write_b32 a104, v242
    v_accvgpr_write_b32 a105, v243
    v_accvgpr_write_b32 a106, v244
    v_accvgpr_write_b32 a107, v245
    v_accvgpr_read_b32 v242, a120
    v_accvgpr_read_b32 v243, a121
    v_accvgpr_read_b32 v244, a122
    v_accvgpr_read_b32 v245, a123
    v_mul_f32 v242, v242, v239
    v_mul_f32 v243, v243, v239
    v_mul_f32 v244, v244, v239
    v_mul_f32 v245, v245, v239
    v_accvgpr_write_b32 a120, v242
    v_accvgpr_write_b32 a121, v243
    v_accvgpr_write_b32 a122, v244
    v_accvgpr_write_b32 a123, v245
    v_accvgpr_read_b32 v242, a136
    v_accvgpr_read_b32 v243, a137
    v_accvgpr_read_b32 v244, a138
    v_accvgpr_read_b32 v245, a139
    v_mul_f32 v242, v242, v239
    v_mul_f32 v243, v243, v239
    v_mul_f32 v244, v244, v239
    v_mul_f32 v245, v245, v239
    v_accvgpr_write_b32 a136, v242
    v_accvgpr_write_b32 a137, v243
    v_accvgpr_write_b32 a138, v244
    v_accvgpr_write_b32 a139, v245
    v_accvgpr_read_b32 v242, a152
    v_accvgpr_read_b32 v243, a153
    v_accvgpr_read_b32 v244, a154
    v_accvgpr_read_b32 v245, a155
    v_mul_f32 v242, v242, v239
    v_mul_f32 v243, v243, v239
    v_mul_f32 v244, v244, v239
    v_mul_f32 v245, v245, v239
    v_accvgpr_write_b32 a152, v242
    v_accvgpr_write_b32 a153, v243
    v_accvgpr_write_b32 a154, v244
    v_accvgpr_write_b32 a155, v245
    v_accvgpr_read_b32 v242, a168
    v_accvgpr_read_b32 v243, a169
    v_accvgpr_read_b32 v244, a170
    v_accvgpr_read_b32 v245, a171
    v_mul_f32 v242, v242, v239
    v_mul_f32 v243, v243, v239
    v_mul_f32 v244, v244, v239
    v_mul_f32 v245, v245, v239
    v_accvgpr_write_b32 a168, v242
    v_accvgpr_write_b32 a169, v243
    v_accvgpr_write_b32 a170, v244
    v_accvgpr_write_b32 a171, v245
    v_accvgpr_read_b32 v242, a184
    v_accvgpr_read_b32 v243, a185
    v_accvgpr_read_b32 v244, a186
    v_accvgpr_read_b32 v245, a187
    v_mul_f32 v242, v242, v239
    v_mul_f32 v243, v243, v239
    v_mul_f32 v244, v244, v239
    v_mul_f32 v245, v245, v239
    v_accvgpr_write_b32 a184, v242
    v_accvgpr_write_b32 a185, v243
    v_accvgpr_write_b32 a186, v244
    v_accvgpr_write_b32 a187, v245
    v_accvgpr_read_b32 v242, a200
    v_accvgpr_read_b32 v243, a201
    v_accvgpr_read_b32 v244, a202
    v_accvgpr_read_b32 v245, a203
    v_mul_f32 v242, v242, v239
    v_mul_f32 v243, v243, v239
    v_mul_f32 v244, v244, v239
    v_mul_f32 v245, v245, v239
    v_accvgpr_write_b32 a200, v242
    v_accvgpr_write_b32 a201, v243
    v_accvgpr_write_b32 a202, v244
    v_accvgpr_write_b32 a203, v245
    v_accvgpr_read_b32 v242, a216
    v_accvgpr_read_b32 v243, a217
    v_accvgpr_read_b32 v244, a218
    v_accvgpr_read_b32 v245, a219
    v_mul_f32 v242, v242, v239
    v_mul_f32 v243, v243, v239
    v_mul_f32 v244, v244, v239
    v_mul_f32 v245, v245, v239
    v_accvgpr_write_b32 a216, v242
    v_accvgpr_write_b32 a217, v243
    v_accvgpr_write_b32 a218, v244
    v_accvgpr_write_b32 a219, v245
    v_accvgpr_read_b32 v242, a232
    v_accvgpr_read_b32 v243, a233
    v_accvgpr_read_b32 v244, a234
    v_accvgpr_read_b32 v245, a235
    v_mul_f32 v242, v242, v239
    v_mul_f32 v243, v243, v239
    v_mul_f32 v244, v244, v239
    v_mul_f32 v245, v245, v239
    v_accvgpr_write_b32 a232, v242
    v_accvgpr_write_b32 a233, v243
    v_accvgpr_write_b32 a234, v244
    v_accvgpr_write_b32 a235, v245
    v_accvgpr_read_b32 v242, a248
    v_accvgpr_read_b32 v243, a249
    v_accvgpr_read_b32 v244, a250
    v_accvgpr_read_b32 v245, a251
    v_mul_f32 v242, v242, v239
    v_mul_f32 v243, v243, v239
    v_mul_f32 v244, v244, v239
    v_mul_f32 v245, v245, v239
    v_accvgpr_write_b32 a248, v242
    v_accvgpr_write_b32 a249, v243
    v_accvgpr_write_b32 a250, v244
    v_accvgpr_write_b32 a251, v245
    v_max3_f32 v238, v168, v169, v170
    v_max3_f32 v238, v238, v171, v172
    v_max3_f32 v238, v238, v173, v174
    v_max_f32 v238, v238, v175
    v_mov_b32 v240, v238
    s_nop 1
    v_permlane16_swap_b32 v238, v240
    s_nop 1
    v_max_f32 v238, v238, v240
    v_mov_b32 v240, v238
    s_nop 1
    v_permlane32_swap_b32 v238, v240
    s_nop 1
    v_max_f32 v238, v238, v240
    v_max_f32 v238, 0, v238
    v_exp_f32_e64 v239, -v238
    s_nop 0
    v_sub_f32 v212, v212, v238
    v_sub_f32 v213, v213, v238
    v_sub_f32 v214, v214, v238
    v_sub_f32 v215, v215, v238
    v_mul_f32 v235, v235, v239
    v_sub_f32 v168, v168, v238
    v_sub_f32 v169, v169, v238
    v_sub_f32 v170, v170, v238
    v_sub_f32 v171, v171, v238
    v_sub_f32 v172, v172, v238
    v_sub_f32 v173, v173, v238
    v_sub_f32 v174, v174, v238
    v_sub_f32 v175, v175, v238
    v_sub_f32 v152, v152, v238
    v_sub_f32 v153, v153, v238
    v_sub_f32 v154, v154, v238
    v_sub_f32 v155, v155, v238
    v_sub_f32 v156, v156, v238
    v_sub_f32 v157, v157, v238
    v_sub_f32 v158, v158, v238
    v_sub_f32 v159, v159, v238
    v_accvgpr_read_b32 v242, a12
    v_accvgpr_read_b32 v243, a13
    v_accvgpr_read_b32 v244, a14
    v_accvgpr_read_b32 v245, a15
    v_mul_f32 v242, v242, v239
    v_mul_f32 v243, v243, v239
    v_mul_f32 v244, v244, v239
    v_mul_f32 v245, v245, v239
    v_accvgpr_write_b32 a12, v242
    v_accvgpr_write_b32 a13, v243
    v_accvgpr_write_b32 a14, v244
    v_accvgpr_write_b32 a15, v245
    v_accvgpr_read_b32 v242, a28
    v_accvgpr_read_b32 v243, a29
    v_accvgpr_read_b32 v244, a30
    v_accvgpr_read_b32 v245, a31
    v_mul_f32 v242, v242, v239
    v_mul_f32 v243, v243, v239
    v_mul_f32 v244, v244, v239
    v_mul_f32 v245, v245, v239
    v_accvgpr_write_b32 a28, v242
    v_accvgpr_write_b32 a29, v243
    v_accvgpr_write_b32 a30, v244
    v_accvgpr_write_b32 a31, v245
    v_accvgpr_read_b32 v242, a44
    v_accvgpr_read_b32 v243, a45
    v_accvgpr_read_b32 v244, a46
    v_accvgpr_read_b32 v245, a47
    v_mul_f32 v242, v242, v239
    v_mul_f32 v243, v243, v239
    v_mul_f32 v244, v244, v239
    v_mul_f32 v245, v245, v239
    v_accvgpr_write_b32 a44, v242
    v_accvgpr_write_b32 a45, v243
    v_accvgpr_write_b32 a46, v244
    v_accvgpr_write_b32 a47, v245
    v_accvgpr_read_b32 v242, a60
    v_accvgpr_read_b32 v243, a61
    v_accvgpr_read_b32 v244, a62
    v_accvgpr_read_b32 v245, a63
    v_mul_f32 v242, v242, v239
    v_mul_f32 v243, v243, v239
    v_mul_f32 v244, v244, v239
    v_mul_f32 v245, v245, v239
    v_accvgpr_write_b32 a60, v242
    v_accvgpr_write_b32 a61, v243
    v_accvgpr_write_b32 a62, v244
    v_accvgpr_write_b32 a63, v245
    v_accvgpr_read_b32 v242, a76
    v_accvgpr_read_b32 v243, a77
    v_accvgpr_read_b32 v244, a78
    v_accvgpr_read_b32 v245, a79
    v_mul_f32 v242, v242, v239
    v_mul_f32 v243, v243, v239
    v_mul_f32 v244, v244, v239
    v_mul_f32 v245, v245, v239
    v_accvgpr_write_b32 a76, v242
    v_accvgpr_write_b32 a77, v243
    v_accvgpr_write_b32 a78, v244
    v_accvgpr_write_b32 a79, v245
    v_accvgpr_read_b32 v242, a92
    v_accvgpr_read_b32 v243, a93
    v_accvgpr_read_b32 v244, a94
    v_accvgpr_read_b32 v245, a95
    v_mul_f32 v242, v242, v239
    v_mul_f32 v243, v243, v239
    v_mul_f32 v244, v244, v239
    v_mul_f32 v245, v245, v239
    v_accvgpr_write_b32 a92, v242
    v_accvgpr_write_b32 a93, v243
    v_accvgpr_write_b32 a94, v244
    v_accvgpr_write_b32 a95, v245
    v_accvgpr_read_b32 v242, a108
    v_accvgpr_read_b32 v243, a109
    v_accvgpr_read_b32 v244, a110
    v_accvgpr_read_b32 v245, a111
    v_mul_f32 v242, v242, v239
    v_mul_f32 v243, v243, v239
    v_mul_f32 v244, v244, v239
    v_mul_f32 v245, v245, v239
    v_accvgpr_write_b32 a108, v242
    v_accvgpr_write_b32 a109, v243
    v_accvgpr_write_b32 a110, v244
    v_accvgpr_write_b32 a111, v245
    v_accvgpr_read_b32 v242, a124
    v_accvgpr_read_b32 v243, a125
    v_accvgpr_read_b32 v244, a126
    v_accvgpr_read_b32 v245, a127
    v_mul_f32 v242, v242, v239
    v_mul_f32 v243, v243, v239
    v_mul_f32 v244, v244, v239
    v_mul_f32 v245, v245, v239
    v_accvgpr_write_b32 a124, v242
    v_accvgpr_write_b32 a125, v243
    v_accvgpr_write_b32 a126, v244
    v_accvgpr_write_b32 a127, v245
    v_accvgpr_read_b32 v242, a140
    v_accvgpr_read_b32 v243, a141
    v_accvgpr_read_b32 v244, a142
    v_accvgpr_read_b32 v245, a143
    v_mul_f32 v242, v242, v239
    v_mul_f32 v243, v243, v239
    v_mul_f32 v244, v244, v239
    v_mul_f32 v245, v245, v239
    v_accvgpr_write_b32 a140, v242
    v_accvgpr_write_b32 a141, v243
    v_accvgpr_write_b32 a142, v244
    v_accvgpr_write_b32 a143, v245
    v_accvgpr_read_b32 v242, a156
    v_accvgpr_read_b32 v243, a157
    v_accvgpr_read_b32 v244, a158
    v_accvgpr_read_b32 v245, a159
    v_mul_f32 v242, v242, v239
    v_mul_f32 v243, v243, v239
    v_mul_f32 v244, v244, v239
    v_mul_f32 v245, v245, v239
    v_accvgpr_write_b32 a156, v242
    v_accvgpr_write_b32 a157, v243
    v_accvgpr_write_b32 a158, v244
    v_accvgpr_write_b32 a159, v245
    v_accvgpr_read_b32 v242, a172
    v_accvgpr_read_b32 v243, a173
    v_accvgpr_read_b32 v244, a174
    v_accvgpr_read_b32 v245, a175
    v_mul_f32 v242, v242, v239
    v_mul_f32 v243, v243, v239
    v_mul_f32 v244, v244, v239
    v_mul_f32 v245, v245, v239
    v_accvgpr_write_b32 a172, v242
    v_accvgpr_write_b32 a173, v243
    v_accvgpr_write_b32 a174, v244
    v_accvgpr_write_b32 a175, v245
    v_accvgpr_read_b32 v242, a188
    v_accvgpr_read_b32 v243, a189
    v_accvgpr_read_b32 v244, a190
    v_accvgpr_read_b32 v245, a191
    v_mul_f32 v242, v242, v239
    v_mul_f32 v243, v243, v239
    v_mul_f32 v244, v244, v239
    v_mul_f32 v245, v245, v239
    v_accvgpr_write_b32 a188, v242
    v_accvgpr_write_b32 a189, v243
    v_accvgpr_write_b32 a190, v244
    v_accvgpr_write_b32 a191, v245
    v_accvgpr_read_b32 v242, a204
    v_accvgpr_read_b32 v243, a205
    v_accvgpr_read_b32 v244, a206
    v_accvgpr_read_b32 v245, a207
    v_mul_f32 v242, v242, v239
    v_mul_f32 v243, v243, v239
    v_mul_f32 v244, v244, v239
    v_mul_f32 v245, v245, v239
    v_accvgpr_write_b32 a204, v242
    v_accvgpr_write_b32 a205, v243
    v_accvgpr_write_b32 a206, v244
    v_accvgpr_write_b32 a207, v245
    v_accvgpr_read_b32 v242, a220
    v_accvgpr_read_b32 v243, a221
    v_accvgpr_read_b32 v244, a222
    v_accvgpr_read_b32 v245, a223
    v_mul_f32 v242, v242, v239
    v_mul_f32 v243, v243, v239
    v_mul_f32 v244, v244, v239
    v_mul_f32 v245, v245, v239
    v_accvgpr_write_b32 a220, v242
    v_accvgpr_write_b32 a221, v243
    v_accvgpr_write_b32 a222, v244
    v_accvgpr_write_b32 a223, v245
    v_accvgpr_read_b32 v242, a236
    v_accvgpr_read_b32 v243, a237
    v_accvgpr_read_b32 v244, a238
    v_accvgpr_read_b32 v245, a239
    v_mul_f32 v242, v242, v239
    v_mul_f32 v243, v243, v239
    v_mul_f32 v244, v244, v239
    v_mul_f32 v245, v245, v239
    v_accvgpr_write_b32 a236, v242
    v_accvgpr_write_b32 a237, v243
    v_accvgpr_write_b32 a238, v244
    v_accvgpr_write_b32 a239, v245
    v_accvgpr_read_b32 v242, a252
    v_accvgpr_read_b32 v243, a253
    v_accvgpr_read_b32 v244, a254
    v_accvgpr_read_b32 v245, a255
    v_mul_f32 v242, v242, v239
    v_mul_f32 v243, v243, v239
    v_mul_f32 v244, v244, v239
    v_mul_f32 v245, v245, v239
    v_accvgpr_write_b32 a252, v242
    v_accvgpr_write_b32 a253, v243
    v_accvgpr_write_b32 a254, v244
    v_accvgpr_write_b32 a255, v245
    v_exp_f32 v238, v160
    v_exp_f32 v239, v161
    s_nop 0
    v_add_f32 v236, v238, v239
    v_cvt_pk_bf16_f32 v192, v238, v239
    v_exp_f32 v240, v162
    v_exp_f32 v241, v163
    s_nop 0
    v_add_f32 v236, v236, v240
    v_add_f32 v236, v236, v241
    v_cvt_pk_bf16_f32 v193, v240, v241
    v_exp_f32 v242, v168
    v_exp_f32 v243, v169
    s_nop 0
    v_add_f32 v237, v242, v243
    v_cvt_pk_bf16_f32 v196, v242, v243
    v_exp_f32 v244, v170
    v_exp_f32 v245, v171
    s_nop 0
    v_add_f32 v237, v237, v244
    v_add_f32 v237, v237, v245
    v_cvt_pk_bf16_f32 v197, v244, v245
    v_exp_f32 v238, v164
    v_exp_f32 v239, v165
    s_nop 0
    v_add_f32 v236, v236, v238
    v_add_f32 v236, v236, v239
    v_cvt_pk_bf16_f32 v194, v238, v239
    v_exp_f32 v240, v166
    v_exp_f32 v241, v167
    s_nop 0
    v_add_f32 v236, v236, v240
    v_add_f32 v236, v236, v241
    v_cvt_pk_bf16_f32 v195, v240, v241
    v_exp_f32 v242, v172
    v_exp_f32 v243, v173
    s_nop 0
    v_add_f32 v237, v237, v242
    v_add_f32 v237, v237, v243
    v_cvt_pk_bf16_f32 v198, v242, v243
    v_exp_f32 v244, v174
    v_exp_f32 v245, v175
    s_nop 0
    v_add_f32 v237, v237, v244
    v_add_f32 v237, v237, v245
    v_cvt_pk_bf16_f32 v199, v244, v245
    s_nop 3
    s_cmp_eq_u32 s38, 0
    s_cbranch_scc1 R1_L1
    s_cmp_eq_u32 s38, 1
    s_cbranch_scc1 R1_L3
    s_branch R1_P29
S_R2_L1:
    s_mov_b32 s38, 0
    s_branch SUB_p2_1_0
S_R2_L3:
    s_mov_b32 s38, 1
    s_branch SUB_p2_1_0
S_R2_P29:
    s_mov_b32 s38, 2
    s_branch SUB_p2_1_0
SUB_p2_1_0:
    s_nop 7
    s_nop 7
    v_max3_f32 v238, v128, v129, v130
    v_max3_f32 v238, v238, v131, v132
    v_max3_f32 v238, v238, v133, v134
    v_max_f32 v238, v238, v135
    v_mov_b32 v240, v238
    s_nop 1
    v_permlane16_swap_b32 v238, v240
    s_nop 1
    v_max_f32 v238, v238, v240
    v_mov_b32 v240, v238
    s_nop 1
    v_permlane32_swap_b32 v238, v240
    s_nop 1
    v_max_f32 v238, v238, v240
    v_max_f32 v238, 0, v238
    v_exp_f32_e64 v239, -v238
    s_nop 0
    v_sub_f32 v200, v200, v238
    v_sub_f32 v201, v201, v238
    v_sub_f32 v202, v202, v238
    v_sub_f32 v203, v203, v238
    v_mul_f32 v232, v232, v239
    v_sub_f32 v128, v128, v238
    v_sub_f32 v129, v129, v238
    v_sub_f32 v130, v130, v238
    v_sub_f32 v131, v131, v238
    v_sub_f32 v132, v132, v238
    v_sub_f32 v133, v133, v238
    v_sub_f32 v134, v134, v238
    v_sub_f32 v135, v135, v238
    v_accvgpr_read_b32 v242, a0
    v_accvgpr_read_b32 v243, a1
    v_accvgpr_read_b32 v244, a2
    v_accvgpr_read_b32 v245, a3
    v_mul_f32 v242, v242, v239
    v_mul_f32 v243, v243, v239
    v_mul_f32 v244, v244, v239
    v_mul_f32 v245, v245, v239
    v_accvgpr_write_b32 a0, v242
    v_accvgpr_write_b32 a1, v243
    v_accvgpr_write_b32 a2, v244
    v_accvgpr_write_b32 a3, v245
    v_accvgpr_read_b32 v242, a16
    v_accvgpr_read_b32 v243, a17
    v_accvgpr_read_b32 v244, a18
    v_accvgpr_read_b32 v245, a19
    v_mul_f32 v242, v242, v239
    v_mul_f32 v243, v243, v239
    v_mul_f32 v244, v244, v239
    v_mul_f32 v245, v245, v239
    v_accvgpr_write_b32 a16, v242
    v_accvgpr_write_b32 a17, v243
    v_accvgpr_write_b32 a18, v244
    v_accvgpr_write_b32 a19, v245
    v_accvgpr_read_b32 v242, a32
    v_accvgpr_read_b32 v243, a33
    v_accvgpr_read_b32 v244, a34
    v_accvgpr_read_b32 v245, a35
    v_mul_f32 v242, v242, v239
    v_mul_f32 v243, v243, v239
    v_mul_f32 v244, v244, v239
    v_mul_f32 v245, v245, v239
    v_accvgpr_write_b32 a32, v242
    v_accvgpr_write_b32 a33, v243
    v_accvgpr_write_b32 a34, v244
    v_accvgpr_write_b32 a35, v245
    v_accvgpr_read_b32 v242, a48
    v_accvgpr_read_b32 v243, a49
    v_accvgpr_read_b32 v244, a50
    v_accvgpr_read_b32 v245, a51
    v_mul_f32 v242, v242, v239
    v_mul_f32 v243, v243, v239
    v_mul_f32 v244, v244, v239
    v_mul_f32 v245, v245, v239
    v_accvgpr_write_b32 a48, v242
    v_accvgpr_write_b32 a49, v243
    v_accvgpr_write_b32 a50, v244
    v_accvgpr_write_b32 a51, v245
    v_accvgpr_read_b32 v242, a64
    v_accvgpr_read_b32 v243, a65
    v_accvgpr_read_b32 v244, a66
    v_accvgpr_read_b32 v245, a67
    v_mul_f32 v242, v242, v239
    v_mul_f32 v243, v243, v239
    v_mul_f32 v244, v244, v239
    v_mul_f32 v245, v245, v239
    v_accvgpr_write_b32 a64, v242
    v_accvgpr_write_b32 a65, v243
    v_accvgpr_write_b32 a66, v244
    v_accvgpr_write_b32 a67, v245
    v_accvgpr_read_b32 v242, a80
    v_accvgpr_read_b32 v243, a81
    v_accvgpr_read_b32 v244, a82
    v_accvgpr_read_b32 v245, a83
    v_mul_f32 v242, v242, v239
    v_mul_f32 v243, v243, v239
    v_mul_f32 v244, v244, v239
    v_mul_f32 v245, v245, v239
    v_accvgpr_write_b32 a80, v242
    v_accvgpr_write_b32 a81, v243
    v_accvgpr_write_b32 a82, v244
    v_accvgpr_write_b32 a83, v245
    v_accvgpr_read_b32 v242, a96
    v_accvgpr_read_b32 v243, a97
    v_accvgpr_read_b32 v244, a98
    v_accvgpr_read_b32 v245, a99
    v_mul_f32 v242, v242, v239
    v_mul_f32 v243, v243, v239
    v_mul_f32 v244, v244, v239
    v_mul_f32 v245, v245, v239
    v_accvgpr_write_b32 a96, v242
    v_accvgpr_write_b32 a97, v243
    v_accvgpr_write_b32 a98, v244
    v_accvgpr_write_b32 a99, v245
    v_accvgpr_read_b32 v242, a112
    v_accvgpr_read_b32 v243, a113
    v_accvgpr_read_b32 v244, a114
    v_accvgpr_read_b32 v245, a115
    v_mul_f32 v242, v242, v239
    v_mul_f32 v243, v243, v239
    v_mul_f32 v244, v244, v239
    v_mul_f32 v245, v245, v239
    v_accvgpr_write_b32 a112, v242
    v_accvgpr_write_b32 a113, v243
    v_accvgpr_write_b32 a114, v244
    v_accvgpr_write_b32 a115, v245
    v_accvgpr_read_b32 v242, a128
    v_accvgpr_read_b32 v243, a129
    v_accvgpr_read_b32 v244, a130
    v_accvgpr_read_b32 v245, a131
    v_mul_f32 v242, v242, v239
    v_mul_f32 v243, v243, v239
    v_mul_f32 v244, v244, v239
    v_mul_f32 v245, v245, v239
    v_accvgpr_write_b32 a128, v242
    v_accvgpr_write_b32 a129, v243
    v_accvgpr_write_b32 a130, v244
    v_accvgpr_write_b32 a131, v245
    v_accvgpr_read_b32 v242, a144
    v_accvgpr_read_b32 v243, a145
    v_accvgpr_read_b32 v244, a146
    v_accvgpr_read_b32 v245, a147
    v_mul_f32 v242, v242, v239
    v_mul_f32 v243, v243, v239
    v_mul_f32 v244, v244, v239
    v_mul_f32 v245, v245, v239
    v_accvgpr_write_b32 a144, v242
    v_accvgpr_write_b32 a145, v243
    v_accvgpr_write_b32 a146, v244
    v_accvgpr_write_b32 a147, v245
    v_accvgpr_read_b32 v242, a160
    v_accvgpr_read_b32 v243, a161
    v_accvgpr_read_b32 v244, a162
    v_accvgpr_read_b32 v245, a163
    v_mul_f32 v242, v242, v239
    v_mul_f32 v243, v243, v239
    v_mul_f32 v244, v244, v239
    v_mul_f32 v245, v245, v239
    v_accvgpr_write_b32 a160, v242
    v_accvgpr_write_b32 a161, v243
    v_accvgpr_write_b32 a162, v244
    v_accvgpr_write_b32 a163, v245
    v_accvgpr_read_b32 v242, a176
    v_accvgpr_read_b32 v243, a177
    v_accvgpr_read_b32 v244, a178
    v_accvgpr_read_b32 v245, a179
    v_mul_f32 v242, v242, v239
    v_mul_f32 v243, v243, v239
    v_mul_f32 v244, v244, v239
    v_mul_f32 v245, v245, v239
    v_accvgpr_write_b32 a176, v242
    v_accvgpr_write_b32 a177, v243
    v_accvgpr_write_b32 a178, v244
    v_accvgpr_write_b32 a179, v245
    v_accvgpr_read_b32 v242, a192
    v_accvgpr_read_b32 v243, a193
    v_accvgpr_read_b32 v244, a194
    v_accvgpr_read_b32 v245, a195
    v_mul_f32 v242, v242, v239
    v_mul_f32 v243, v243, v239
    v_mul_f32 v244, v244, v239
    v_mul_f32 v245, v245, v239
    v_accvgpr_write_b32 a192, v242
    v_accvgpr_write_b32 a193, v243
    v_accvgpr_write_b32 a194, v244
    v_accvgpr_write_b32 a195, v245
    v_accvgpr_read_b32 v242, a208
    v_accvgpr_read_b32 v243, a209
    v_accvgpr_read_b32 v244, a210
    v_accvgpr_read_b32 v245, a211
    v_mul_f32 v242, v242, v239
    v_mul_f32 v243, v243, v239
    v_mul_f32 v244, v244, v239
    v_mul_f32 v245, v245, v239
    v_accvgpr_write_b32 a208, v242
    v_accvgpr_write_b32 a209, v243
    v_accvgpr_write_b32 a210, v244
    v_accvgpr_write_b32 a211, v245
    v_accvgpr_read_b32 v242, a224
    v_accvgpr_read_b32 v243, a225
    v_accvgpr_read_b32 v244, a226
    v_accvgpr_read_b32 v245, a227
    v_mul_f32 v242, v242, v239
    v_mul_f32 v243, v243, v239
    v_mul_f32 v244, v244, v239
    v_mul_f32 v245, v245, v239
    v_accvgpr_write_b32 a224, v242
    v_accvgpr_write_b32 a225, v243
    v_accvgpr_write_b32 a226, v244
    v_accvgpr_write_b32 a227, v245
    v_accvgpr_read_b32 v242, a240
    v_accvgpr_read_b32 v243, a241
    v_accvgpr_read_b32 v244, a242
    v_accvgpr_read_b32 v245, a243
    v_mul_f32 v242, v242, v239
    v_mul_f32 v243, v243, v239
    v_mul_f32 v244, v244, v239
    v_mul_f32 v245, v245, v239
    v_accvgpr_write_b32 a240, v242
    v_accvgpr_write_b32 a241, v243
    v_accvgpr_write_b32 a242, v244
    v_accvgpr_write_b32 a243, v245
    v_max3_f32 v238, v136, v137, v138
    v_max3_f32 v238, v238, v139, v140
    v_max3_f32 v238, v238, v141, v142
    v_max_f32 v238, v238, v143
    v_mov_b32 v240, v238
    s_nop 1
    v_permlane16_swap_b32 v238, v240
    s_nop 1
    v_max_f32 v238, v238, v240
    v_mov_b32 v240, v238
    s_nop 1
    v_permlane32_swap_b32 v238, v240
    s_nop 1
    v_max_f32 v238, v238, v240
    v_max_f32 v238, 0, v238
    v_exp_f32_e64 v239, -v238
    s_nop 0
    v_sub_f32 v204, v204, v238
    v_sub_f32 v205, v205, v238
    v_sub_f32 v206, v206, v238
    v_sub_f32 v207, v207, v238
    v_mul_f32 v233, v233, v239
    v_sub_f32 v136, v136, v238
    v_sub_f32 v137, v137, v238
    v_sub_f32 v138, v138, v238
    v_sub_f32 v139, v139, v238
    v_sub_f32 v140, v140, v238
    v_sub_f32 v141, v141, v238
    v_sub_f32 v142, v142, v238
    v_sub_f32 v143, v143, v238
    v_accvgpr_read_b32 v242, a4
    v_accvgpr_read_b32 v243, a5
    v_accvgpr_read_b32 v244, a6
    v_accvgpr_read_b32 v245, a7
    v_mul_f32 v242, v242, v239
    v_mul_f32 v243, v243, v239
    v_mul_f32 v244, v244, v239
    v_mul_f32 v245, v245, v239
    v_accvgpr_write_b32 a4, v242
    v_accvgpr_write_b32 a5, v243
    v_accvgpr_write_b32 a6, v244
    v_accvgpr_write_b32 a7, v245
    v_accvgpr_read_b32 v242, a20
    v_accvgpr_read_b32 v243, a21
    v_accvgpr_read_b32 v244, a22
    v_accvgpr_read_b32 v245, a23
    v_mul_f32 v242, v242, v239
    v_mul_f32 v243, v243, v239
    v_mul_f32 v244, v244, v239
    v_mul_f32 v245, v245, v239
    v_accvgpr_write_b32 a20, v242
    v_accvgpr_write_b32 a21, v243
    v_accvgpr_write_b32 a22, v244
    v_accvgpr_write_b32 a23, v245
    v_accvgpr_read_b32 v242, a36
    v_accvgpr_read_b32 v243, a37
    v_accvgpr_read_b32 v244, a38
    v_accvgpr_read_b32 v245, a39
    v_mul_f32 v242, v242, v239
    v_mul_f32 v243, v243, v239
    v_mul_f32 v244, v244, v239
    v_mul_f32 v245, v245, v239
    v_accvgpr_write_b32 a36, v242
    v_accvgpr_write_b32 a37, v243
    v_accvgpr_write_b32 a38, v244
    v_accvgpr_write_b32 a39, v245
    v_accvgpr_read_b32 v242, a52
    v_accvgpr_read_b32 v243, a53
    v_accvgpr_read_b32 v244, a54
    v_accvgpr_read_b32 v245, a55
    v_mul_f32 v242, v242, v239
    v_mul_f32 v243, v243, v239
    v_mul_f32 v244, v244, v239
    v_mul_f32 v245, v245, v239
    v_accvgpr_write_b32 a52, v242
    v_accvgpr_write_b32 a53, v243
    v_accvgpr_write_b32 a54, v244
    v_accvgpr_write_b32 a55, v245
    v_accvgpr_read_b32 v242, a68
    v_accvgpr_read_b32 v243, a69
    v_accvgpr_read_b32 v244, a70
    v_accvgpr_read_b32 v245, a71
    v_mul_f32 v242, v242, v239
    v_mul_f32 v243, v243, v239
    v_mul_f32 v244, v244, v239
    v_mul_f32 v245, v245, v239
    v_accvgpr_write_b32 a68, v242
    v_accvgpr_write_b32 a69, v243
    v_accvgpr_write_b32 a70, v244
    v_accvgpr_write_b32 a71, v245
    v_accvgpr_read_b32 v242, a84
    v_accvgpr_read_b32 v243, a85
    v_accvgpr_read_b32 v244, a86
    v_accvgpr_read_b32 v245, a87
    v_mul_f32 v242, v242, v239
    v_mul_f32 v243, v243, v239
    v_mul_f32 v244, v244, v239
    v_mul_f32 v245, v245, v239
    v_accvgpr_write_b32 a84, v242
    v_accvgpr_write_b32 a85, v243
    v_accvgpr_write_b32 a86, v244
    v_accvgpr_write_b32 a87, v245
    v_accvgpr_read_b32 v242, a100
    v_accvgpr_read_b32 v243, a101
    v_accvgpr_read_b32 v244, a102
    v_accvgpr_read_b32 v245, a103
    v_mul_f32 v242, v242, v239
    v_mul_f32 v243, v243, v239
    v_mul_f32 v244, v244, v239
    v_mul_f32 v245, v245, v239
    v_accvgpr_write_b32 a100, v242
    v_accvgpr_write_b32 a101, v243
    v_accvgpr_write_b32 a102, v244
    v_accvgpr_write_b32 a103, v245
    v_accvgpr_read_b32 v242, a116
    v_accvgpr_read_b32 v243, a117
    v_accvgpr_read_b32 v244, a118
    v_accvgpr_read_b32 v245, a119
    v_mul_f32 v242, v242, v239
    v_mul_f32 v243, v243, v239
    v_mul_f32 v244, v244, v239
    v_mul_f32 v245, v245, v239
    v_accvgpr_write_b32 a116, v242
    v_accvgpr_write_b32 a117, v243
    v_accvgpr_write_b32 a118, v244
    v_accvgpr_write_b32 a119, v245
    v_accvgpr_read_b32 v242, a132
    v_accvgpr_read_b32 v243, a133
    v_accvgpr_read_b32 v244, a134
    v_accvgpr_read_b32 v245, a135
    v_mul_f32 v242, v242, v239
    v_mul_f32 v243, v243, v239
    v_mul_f32 v244, v244, v239
    v_mul_f32 v245, v245, v239
    v_accvgpr_write_b32 a132, v242
    v_accvgpr_write_b32 a133, v243
    v_accvgpr_write_b32 a134, v244
    v_accvgpr_write_b32 a135, v245
    v_accvgpr_read_b32 v242, a148
    v_accvgpr_read_b32 v243, a149
    v_accvgpr_read_b32 v244, a150
    v_accvgpr_read_b32 v245, a151
    v_mul_f32 v242, v242, v239
    v_mul_f32 v243, v243, v239
    v_mul_f32 v244, v244, v239
    v_mul_f32 v245, v245, v239
    v_accvgpr_write_b32 a148, v242
    v_accvgpr_write_b32 a149, v243
    v_accvgpr_write_b32 a150, v244
    v_accvgpr_write_b32 a151, v245
    v_accvgpr_read_b32 v242, a164
    v_accvgpr_read_b32 v243, a165
    v_accvgpr_read_b32 v244, a166
    v_accvgpr_read_b32 v245, a167
    v_mul_f32 v242, v242, v239
    v_mul_f32 v243, v243, v239
    v_mul_f32 v244, v244, v239
    v_mul_f32 v245, v245, v239
    v_accvgpr_write_b32 a164, v242
    v_accvgpr_write_b32 a165, v243
    v_accvgpr_write_b32 a166, v244
    v_accvgpr_write_b32 a167, v245
    v_accvgpr_read_b32 v242, a180
    v_accvgpr_read_b32 v243, a181
    v_accvgpr_read_b32 v244, a182
    v_accvgpr_read_b32 v245, a183
    v_mul_f32 v242, v242, v239
    v_mul_f32 v243, v243, v239
    v_mul_f32 v244, v244, v239
    v_mul_f32 v245, v245, v239
    v_accvgpr_write_b32 a180, v242
    v_accvgpr_write_b32 a181, v243
    v_accvgpr_write_b32 a182, v244
    v_accvgpr_write_b32 a183, v245
    v_accvgpr_read_b32 v242, a196
    v_accvgpr_read_b32 v243, a197
    v_accvgpr_read_b32 v244, a198
    v_accvgpr_read_b32 v245, a199
    v_mul_f32 v242, v242, v239
    v_mul_f32 v243, v243, v239
    v_mul_f32 v244, v244, v239
    v_mul_f32 v245, v245, v239
    v_accvgpr_write_b32 a196, v242
    v_accvgpr_write_b32 a197, v243
    v_accvgpr_write_b32 a198, v244
    v_accvgpr_write_b32 a199, v245
    v_accvgpr_read_b32 v242, a212
    v_accvgpr_read_b32 v243, a213
    v_accvgpr_read_b32 v244, a214
    v_accvgpr_read_b32 v245, a215
    v_mul_f32 v242, v242, v239
    v_mul_f32 v243, v243, v239
    v_mul_f32 v244, v244, v239
    v_mul_f32 v245, v245, v239
    v_accvgpr_write_b32 a212, v242
    v_accvgpr_write_b32 a213, v243
    v_accvgpr_write_b32 a214, v244
    v_accvgpr_write_b32 a215, v245
    v_accvgpr_read_b32 v242, a228
    v_accvgpr_read_b32 v243, a229
    v_accvgpr_read_b32 v244, a230
    v_accvgpr_read_b32 v245, a231
    v_mul_f32 v242, v242, v239
    v_mul_f32 v243, v243, v239
    v_mul_f32 v244, v244, v239
    v_mul_f32 v245, v245, v239
    v_accvgpr_write_b32 a228, v242
    v_accvgpr_write_b32 a229, v243
    v_accvgpr_write_b32 a230, v244
    v_accvgpr_write_b32 a231, v245
    v_accvgpr_read_b32 v242, a244
    v_accvgpr_read_b32 v243, a245
    v_accvgpr_read_b32 v244, a246
    v_accvgpr_read_b32 v245, a247
    v_mul_f32 v242, v242, v239
    v_mul_f32 v243, v243, v239
    v_mul_f32 v244, v244, v239
    v_mul_f32 v245, v245, v239
    v_accvgpr_write_b32 a244, v242
    v_accvgpr_write_b32 a245, v243
    v_accvgpr_write_b32 a246, v244
    v_accvgpr_write_b32 a247, v245
    v_exp_f32 v238, v128
    v_exp_f32 v239, v129
    s_nop 0
    v_add_f32 v236, v238, v239
    v_cvt_pk_bf16_f32 v176, v238, v239
    v_exp_f32 v240, v130
    v_exp_f32 v241, v131
    s_nop 0
    v_add_f32 v236, v236, v240
    v_add_f32 v236, v236, v241
    v_cvt_pk_bf16_f32 v177, v240, v241
    v_exp_f32 v242, v136
    v_exp_f32 v243, v137
    s_nop 0
    v_add_f32 v237, v242, v243
    v_cvt_pk_bf16_f32 v180, v242, v243
    v_exp_f32 v244, v138
    v_exp_f32 v245, v139
    s_nop 0
    v_add_f32 v237, v237, v244
    v_add_f32 v237, v237, v245
    v_cvt_pk_bf16_f32 v181, v244, v245
    v_exp_f32 v238, v132
    v_exp_f32 v239, v133
    s_nop 0
    v_add_f32 v236, v236, v238
    v_add_f32 v236, v236, v239
    v_cvt_pk_bf16_f32 v178, v238, v239
    v_exp_f32 v240, v134
    v_exp_f32 v241, v135
    s_nop 0
    v_add_f32 v236, v236, v240
    v_add_f32 v236, v236, v241
    v_cvt_pk_bf16_f32 v179, v240, v241
    v_exp_f32 v242, v140
    v_exp_f32 v243, v141
    s_nop 0
    v_add_f32 v237, v237, v242
    v_add_f32 v237, v237, v243
    v_cvt_pk_bf16_f32 v182, v242, v243
    v_exp_f32 v244, v142
    v_exp_f32 v245, v143
    s_nop 0
    v_add_f32 v237, v237, v244
    v_add_f32 v237, v237, v245
    v_cvt_pk_bf16_f32 v183, v244, v245
    s_nop 3
    s_cmp_eq_u32 s38, 0
    s_cbranch_scc1 R2_L1
    s_cmp_eq_u32 s38, 1
    s_cbranch_scc1 R2_L3
    s_branch R2_P29
S_R1_P31:
    s_mov_b32 s38, 0
    s_branch SUB_p1_1_1
SUB_p1_1_1:
    s_nop 7
    s_nop 7
    v_max3_f32 v238, v160, v161, v162
    v_max3_f32 v238, v238, v163, v164
    v_max3_f32 v238, v238, v165, v166
    v_max_f32 v238, v238, v167
    v_mov_b32 v240, v238
    s_nop 1
    v_permlane16_swap_b32 v238, v240
    s_nop 1
    v_max_f32 v238, v238, v240
    v_mov_b32 v240, v238
    s_nop 1
    v_permlane32_swap_b32 v238, v240
    s_nop 1
    v_max_f32 v238, v238, v240
    v_max_f32 v238, 0, v238
    v_exp_f32_e64 v239, -v238
    s_nop 0
    v_sub_f32 v208, v208, v238
    v_sub_f32 v209, v209, v238
    v_sub_f32 v210, v210, v238
    v_sub_f32 v211, v211, v238
    v_mul_f32 v234, v234, v239
    v_sub_f32 v160, v160, v238
    v_sub_f32 v161, v161, v238
    v_sub_f32 v162, v162, v238
    v_sub_f32 v163, v163, v238
    v_sub_f32 v164, v164, v238
    v_sub_f32 v165, v165, v238
    v_sub_f32 v166, v166, v238
    v_sub_f32 v167, v167, v238
    v_accvgpr_read_b32 v242, a8
    v_accvgpr_read_b32 v243, a9
    v_accvgpr_read_b32 v244, a10
    v_accvgpr_read_b32 v245, a11
    v_mul_f32 v242, v242, v239
    v_mul_f32 v243, v243, v239
    v_mul_f32 v244, v244, v239
    v_mul_f32 v245, v245, v239
    v_accvgpr_write_b32 a8, v242
    v_accvgpr_write_b32 a9, v243
    v_accvgpr_write_b32 a10, v244
    v_accvgpr_write_b32 a11, v245
    v_accvgpr_read_b32 v242, a24
    v_accvgpr_read_b32 v243, a25
    v_accvgpr_read_b32 v244, a26
    v_accvgpr_read_b32 v245, a27
    v_mul_f32 v242, v242, v239
    v_mul_f32 v243, v243, v239
    v_mul_f32 v244, v244, v239
    v_mul_f32 v245, v245, v239
    v_accvgpr_write_b32 a24, v242
    v_accvgpr_write_b32 a25, v243
    v_accvgpr_write_b32 a26, v244
    v_accvgpr_write_b32 a27, v245
    v_accvgpr_read_b32 v242, a40
    v_accvgpr_read_b32 v243, a41
    v_accvgpr_read_b32 v244, a42
    v_accvgpr_read_b32 v245, a43
    v_mul_f32 v242, v242, v239
    v_mul_f32 v243, v243, v239
    v_mul_f32 v244, v244, v239
    v_mul_f32 v245, v245, v239
    v_accvgpr_write_b32 a40, v242
    v_accvgpr_write_b32 a41, v243
    v_accvgpr_write_b32 a42, v244
    v_accvgpr_write_b32 a43, v245
    v_accvgpr_read_b32 v242, a56
    v_accvgpr_read_b32 v243, a57
    v_accvgpr_read_b32 v244, a58
    v_accvgpr_read_b32 v245, a59
    v_mul_f32 v242, v242, v239
    v_mul_f32 v243, v243, v239
    v_mul_f32 v244, v244, v239
    v_mul_f32 v245, v245, v239
    v_accvgpr_write_b32 a56, v242
    v_accvgpr_write_b32 a57, v243
    v_accvgpr_write_b32 a58, v244
    v_accvgpr_write_b32 a59, v245
    v_accvgpr_read_b32 v242, a72
    v_accvgpr_read_b32 v243, a73
    v_accvgpr_read_b32 v244, a74
    v_accvgpr_read_b32 v245, a75
    v_mul_f32 v242, v242, v239
    v_mul_f32 v243, v243, v239
    v_mul_f32 v244, v244, v239
    v_mul_f32 v245, v245, v239
    v_accvgpr_write_b32 a72, v242
    v_accvgpr_write_b32 a73, v243
    v_accvgpr_write_b32 a74, v244
    v_accvgpr_write_b32 a75, v245
    v_accvgpr_read_b32 v242, a88
    v_accvgpr_read_b32 v243, a89
    v_accvgpr_read_b32 v244, a90
    v_accvgpr_read_b32 v245, a91
    v_mul_f32 v242, v242, v239
    v_mul_f32 v243, v243, v239
    v_mul_f32 v244, v244, v239
    v_mul_f32 v245, v245, v239
    v_accvgpr_write_b32 a88, v242
    v_accvgpr_write_b32 a89, v243
    v_accvgpr_write_b32 a90, v244
    v_accvgpr_write_b32 a91, v245
    v_accvgpr_read_b32 v242, a104
    v_accvgpr_read_b32 v243, a105
    v_accvgpr_read_b32 v244, a106
    v_accvgpr_read_b32 v245, a107
    v_mul_f32 v242, v242, v239
    v_mul_f32 v243, v243, v239
    v_mul_f32 v244, v244, v239
    v_mul_f32 v245, v245, v239
    v_accvgpr_write_b32 a104, v242
    v_accvgpr_write_b32 a105, v243
    v_accvgpr_write_b32 a106, v244
    v_accvgpr_write_b32 a107, v245
    v_accvgpr_read_b32 v242, a120
    v_accvgpr_read_b32 v243, a121
    v_accvgpr_read_b32 v244, a122
    v_accvgpr_read_b32 v245, a123
    v_mul_f32 v242, v242, v239
    v_mul_f32 v243, v243, v239
    v_mul_f32 v244, v244, v239
    v_mul_f32 v245, v245, v239
    v_accvgpr_write_b32 a120, v242
    v_accvgpr_write_b32 a121, v243
    v_accvgpr_write_b32 a122, v244
    v_accvgpr_write_b32 a123, v245
    v_accvgpr_read_b32 v242, a136
    v_accvgpr_read_b32 v243, a137
    v_accvgpr_read_b32 v244, a138
    v_accvgpr_read_b32 v245, a139
    v_mul_f32 v242, v242, v239
    v_mul_f32 v243, v243, v239
    v_mul_f32 v244, v244, v239
    v_mul_f32 v245, v245, v239
    v_accvgpr_write_b32 a136, v242
    v_accvgpr_write_b32 a137, v243
    v_accvgpr_write_b32 a138, v244
    v_accvgpr_write_b32 a139, v245
    v_accvgpr_read_b32 v242, a152
    v_accvgpr_read_b32 v243, a153
    v_accvgpr_read_b32 v244, a154
    v_accvgpr_read_b32 v245, a155
    v_mul_f32 v242, v242, v239
    v_mul_f32 v243, v243, v239
    v_mul_f32 v244, v244, v239
    v_mul_f32 v245, v245, v239
    v_accvgpr_write_b32 a152, v242
    v_accvgpr_write_b32 a153, v243
    v_accvgpr_write_b32 a154, v244
    v_accvgpr_write_b32 a155, v245
    v_accvgpr_read_b32 v242, a168
    v_accvgpr_read_b32 v243, a169
    v_accvgpr_read_b32 v244, a170
    v_accvgpr_read_b32 v245, a171
    v_mul_f32 v242, v242, v239
    v_mul_f32 v243, v243, v239
    v_mul_f32 v244, v244, v239
    v_mul_f32 v245, v245, v239
    v_accvgpr_write_b32 a168, v242
    v_accvgpr_write_b32 a169, v243
    v_accvgpr_write_b32 a170, v244
    v_accvgpr_write_b32 a171, v245
    v_accvgpr_read_b32 v242, a184
    v_accvgpr_read_b32 v243, a185
    v_accvgpr_read_b32 v244, a186
    v_accvgpr_read_b32 v245, a187
    v_mul_f32 v242, v242, v239
    v_mul_f32 v243, v243, v239
    v_mul_f32 v244, v244, v239
    v_mul_f32 v245, v245, v239
    v_accvgpr_write_b32 a184, v242
    v_accvgpr_write_b32 a185, v243
    v_accvgpr_write_b32 a186, v244
    v_accvgpr_write_b32 a187, v245
    v_accvgpr_read_b32 v242, a200
    v_accvgpr_read_b32 v243, a201
    v_accvgpr_read_b32 v244, a202
    v_accvgpr_read_b32 v245, a203
    v_mul_f32 v242, v242, v239
    v_mul_f32 v243, v243, v239
    v_mul_f32 v244, v244, v239
    v_mul_f32 v245, v245, v239
    v_accvgpr_write_b32 a200, v242
    v_accvgpr_write_b32 a201, v243
    v_accvgpr_write_b32 a202, v244
    v_accvgpr_write_b32 a203, v245
    v_accvgpr_read_b32 v242, a216
    v_accvgpr_read_b32 v243, a217
    v_accvgpr_read_b32 v244, a218
    v_accvgpr_read_b32 v245, a219
    v_mul_f32 v242, v242, v239
    v_mul_f32 v243, v243, v239
    v_mul_f32 v244, v244, v239
    v_mul_f32 v245, v245, v239
    v_accvgpr_write_b32 a216, v242
    v_accvgpr_write_b32 a217, v243
    v_accvgpr_write_b32 a218, v244
    v_accvgpr_write_b32 a219, v245
    v_accvgpr_read_b32 v242, a232
    v_accvgpr_read_b32 v243, a233
    v_accvgpr_read_b32 v244, a234
    v_accvgpr_read_b32 v245, a235
    v_mul_f32 v242, v242, v239
    v_mul_f32 v243, v243, v239
    v_mul_f32 v244, v244, v239
    v_mul_f32 v245, v245, v239
    v_accvgpr_write_b32 a232, v242
    v_accvgpr_write_b32 a233, v243
    v_accvgpr_write_b32 a234, v244
    v_accvgpr_write_b32 a235, v245
    v_accvgpr_read_b32 v242, a248
    v_accvgpr_read_b32 v243, a249
    v_accvgpr_read_b32 v244, a250
    v_accvgpr_read_b32 v245, a251
    v_mul_f32 v242, v242, v239
    v_mul_f32 v243, v243, v239
    v_mul_f32 v244, v244, v239
    v_mul_f32 v245, v245, v239
    v_accvgpr_write_b32 a248, v242
    v_accvgpr_write_b32 a249, v243
    v_accvgpr_write_b32 a250, v244
    v_accvgpr_write_b32 a251, v245
    v_max3_f32 v238, v168, v169, v170
    v_max3_f32 v238, v238, v171, v172
    v_max3_f32 v238, v238, v173, v174
    v_max_f32 v238, v238, v175
    v_mov_b32 v240, v238
    s_nop 1
    v_permlane16_swap_b32 v238, v240
    s_nop 1
    v_max_f32 v238, v238, v240
    v_mov_b32 v240, v238
    s_nop 1
    v_permlane32_swap_b32 v238, v240
    s_nop 1
    v_max_f32 v238, v238, v240
    v_max_f32 v238, 0, v238
    v_exp_f32_e64 v239, -v238
    s_nop 0
    v_sub_f32 v212, v212, v238
    v_sub_f32 v213, v213, v238
    v_sub_f32 v214, v214, v238
    v_sub_f32 v215, v215, v238
    v_mul_f32 v235, v235, v239
    v_sub_f32 v168, v168, v238
    v_sub_f32 v169, v169, v238
    v_sub_f32 v170, v170, v238
    v_sub_f32 v171, v171, v238
    v_sub_f32 v172, v172, v238
    v_sub_f32 v173, v173, v238
    v_sub_f32 v174, v174, v238
    v_sub_f32 v175, v175, v238
    v_accvgpr_read_b32 v242, a12
    v_accvgpr_read_b32 v243, a13
    v_accvgpr_read_b32 v244, a14
    v_accvgpr_read_b32 v245, a15
    v_mul_f32 v242, v242, v239
    v_mul_f32 v243, v243, v239
    v_mul_f32 v244, v244, v239
    v_mul_f32 v245, v245, v239
    v_accvgpr_write_b32 a12, v242
    v_accvgpr_write_b32 a13, v243
    v_accvgpr_write_b32 a14, v244
    v_accvgpr_write_b32 a15, v245
    v_accvgpr_read_b32 v242, a28
    v_accvgpr_read_b32 v243, a29
    v_accvgpr_read_b32 v244, a30
    v_accvgpr_read_b32 v245, a31
    v_mul_f32 v242, v242, v239
    v_mul_f32 v243, v243, v239
    v_mul_f32 v244, v244, v239
    v_mul_f32 v245, v245, v239
    v_accvgpr_write_b32 a28, v242
    v_accvgpr_write_b32 a29, v243
    v_accvgpr_write_b32 a30, v244
    v_accvgpr_write_b32 a31, v245
    v_accvgpr_read_b32 v242, a44
    v_accvgpr_read_b32 v243, a45
    v_accvgpr_read_b32 v244, a46
    v_accvgpr_read_b32 v245, a47
    v_mul_f32 v242, v242, v239
    v_mul_f32 v243, v243, v239
    v_mul_f32 v244, v244, v239
    v_mul_f32 v245, v245, v239
    v_accvgpr_write_b32 a44, v242
    v_accvgpr_write_b32 a45, v243
    v_accvgpr_write_b32 a46, v244
    v_accvgpr_write_b32 a47, v245
    v_accvgpr_read_b32 v242, a60
    v_accvgpr_read_b32 v243, a61
    v_accvgpr_read_b32 v244, a62
    v_accvgpr_read_b32 v245, a63
    v_mul_f32 v242, v242, v239
    v_mul_f32 v243, v243, v239
    v_mul_f32 v244, v244, v239
    v_mul_f32 v245, v245, v239
    v_accvgpr_write_b32 a60, v242
    v_accvgpr_write_b32 a61, v243
    v_accvgpr_write_b32 a62, v244
    v_accvgpr_write_b32 a63, v245
    v_accvgpr_read_b32 v242, a76
    v_accvgpr_read_b32 v243, a77
    v_accvgpr_read_b32 v244, a78
    v_accvgpr_read_b32 v245, a79
    v_mul_f32 v242, v242, v239
    v_mul_f32 v243, v243, v239
    v_mul_f32 v244, v244, v239
    v_mul_f32 v245, v245, v239
    v_accvgpr_write_b32 a76, v242
    v_accvgpr_write_b32 a77, v243
    v_accvgpr_write_b32 a78, v244
    v_accvgpr_write_b32 a79, v245
    v_accvgpr_read_b32 v242, a92
    v_accvgpr_read_b32 v243, a93
    v_accvgpr_read_b32 v244, a94
    v_accvgpr_read_b32 v245, a95
    v_mul_f32 v242, v242, v239
    v_mul_f32 v243, v243, v239
    v_mul_f32 v244, v244, v239
    v_mul_f32 v245, v245, v239
    v_accvgpr_write_b32 a92, v242
    v_accvgpr_write_b32 a93, v243
    v_accvgpr_write_b32 a94, v244
    v_accvgpr_write_b32 a95, v245
    v_accvgpr_read_b32 v242, a108
    v_accvgpr_read_b32 v243, a109
    v_accvgpr_read_b32 v244, a110
    v_accvgpr_read_b32 v245, a111
    v_mul_f32 v242, v242, v239
    v_mul_f32 v243, v243, v239
    v_mul_f32 v244, v244, v239
    v_mul_f32 v245, v245, v239
    v_accvgpr_write_b32 a108, v242
    v_accvgpr_write_b32 a109, v243
    v_accvgpr_write_b32 a110, v244
    v_accvgpr_write_b32 a111, v245
    v_accvgpr_read_b32 v242, a124
    v_accvgpr_read_b32 v243, a125
    v_accvgpr_read_b32 v244, a126
    v_accvgpr_read_b32 v245, a127
    v_mul_f32 v242, v242, v239
    v_mul_f32 v243, v243, v239
    v_mul_f32 v244, v244, v239
    v_mul_f32 v245, v245, v239
    v_accvgpr_write_b32 a124, v242
    v_accvgpr_write_b32 a125, v243
    v_accvgpr_write_b32 a126, v244
    v_accvgpr_write_b32 a127, v245
    v_accvgpr_read_b32 v242, a140
    v_accvgpr_read_b32 v243, a141
    v_accvgpr_read_b32 v244, a142
    v_accvgpr_read_b32 v245, a143
    v_mul_f32 v242, v242, v239
    v_mul_f32 v243, v243, v239
    v_mul_f32 v244, v244, v239
    v_mul_f32 v245, v245, v239
    v_accvgpr_write_b32 a140, v242
    v_accvgpr_write_b32 a141, v243
    v_accvgpr_write_b32 a142, v244
    v_accvgpr_write_b32 a143, v245
    v_accvgpr_read_b32 v242, a156
    v_accvgpr_read_b32 v243, a157
    v_accvgpr_read_b32 v244, a158
    v_accvgpr_read_b32 v245, a159
    v_mul_f32 v242, v242, v239
    v_mul_f32 v243, v243, v239
    v_mul_f32 v244, v244, v239
    v_mul_f32 v245, v245, v239
    v_accvgpr_write_b32 a156, v242
    v_accvgpr_write_b32 a157, v243
    v_accvgpr_write_b32 a158, v244
    v_accvgpr_write_b32 a159, v245
    v_accvgpr_read_b32 v242, a172
    v_accvgpr_read_b32 v243, a173
    v_accvgpr_read_b32 v244, a174
    v_accvgpr_read_b32 v245, a175
    v_mul_f32 v242, v242, v239
    v_mul_f32 v243, v243, v239
    v_mul_f32 v244, v244, v239
    v_mul_f32 v245, v245, v239
    v_accvgpr_write_b32 a172, v242
    v_accvgpr_write_b32 a173, v243
    v_accvgpr_write_b32 a174, v244
    v_accvgpr_write_b32 a175, v245
    v_accvgpr_read_b32 v242, a188
    v_accvgpr_read_b32 v243, a189
    v_accvgpr_read_b32 v244, a190
    v_accvgpr_read_b32 v245, a191
    v_mul_f32 v242, v242, v239
    v_mul_f32 v243, v243, v239
    v_mul_f32 v244, v244, v239
    v_mul_f32 v245, v245, v239
    v_accvgpr_write_b32 a188, v242
    v_accvgpr_write_b32 a189, v243
    v_accvgpr_write_b32 a190, v244
    v_accvgpr_write_b32 a191, v245
    v_accvgpr_read_b32 v242, a204
    v_accvgpr_read_b32 v243, a205
    v_accvgpr_read_b32 v244, a206
    v_accvgpr_read_b32 v245, a207
    v_mul_f32 v242, v242, v239
    v_mul_f32 v243, v243, v239
    v_mul_f32 v244, v244, v239
    v_mul_f32 v245, v245, v239
    v_accvgpr_write_b32 a204, v242
    v_accvgpr_write_b32 a205, v243
    v_accvgpr_write_b32 a206, v244
    v_accvgpr_write_b32 a207, v245
    v_accvgpr_read_b32 v242, a220
    v_accvgpr_read_b32 v243, a221
    v_accvgpr_read_b32 v244, a222
    v_accvgpr_read_b32 v245, a223
    v_mul_f32 v242, v242, v239
    v_mul_f32 v243, v243, v239
    v_mul_f32 v244, v244, v239
    v_mul_f32 v245, v245, v239
    v_accvgpr_write_b32 a220, v242
    v_accvgpr_write_b32 a221, v243
    v_accvgpr_write_b32 a222, v244
    v_accvgpr_write_b32 a223, v245
    v_accvgpr_read_b32 v242, a236
    v_accvgpr_read_b32 v243, a237
    v_accvgpr_read_b32 v244, a238
    v_accvgpr_read_b32 v245, a239
    v_mul_f32 v242, v242, v239
    v_mul_f32 v243, v243, v239
    v_mul_f32 v244, v244, v239
    v_mul_f32 v245, v245, v239
    v_accvgpr_write_b32 a236, v242
    v_accvgpr_write_b32 a237, v243
    v_accvgpr_write_b32 a238, v244
    v_accvgpr_write_b32 a239, v245
    v_accvgpr_read_b32 v242, a252
    v_accvgpr_read_b32 v243, a253
    v_accvgpr_read_b32 v244, a254
    v_accvgpr_read_b32 v245, a255
    v_mul_f32 v242, v242, v239
    v_mul_f32 v243, v243, v239
    v_mul_f32 v244, v244, v239
    v_mul_f32 v245, v245, v239
    v_accvgpr_write_b32 a252, v242
    v_accvgpr_write_b32 a253, v243
    v_accvgpr_write_b32 a254, v244
    v_accvgpr_write_b32 a255, v245
    v_exp_f32 v238, v160
    v_exp_f32 v239, v161
    s_nop 0
    v_add_f32 v236, v238, v239
    v_cvt_pk_bf16_f32 v192, v238, v239
    v_exp_f32 v240, v162
    v_exp_f32 v241, v163
    s_nop 0
    v_add_f32 v236, v236, v240
    v_add_f32 v236, v236, v241
    v_cvt_pk_bf16_f32 v193, v240, v241
    v_exp_f32 v242, v168
    v_exp_f32 v243, v169
    s_nop 0
    v_add_f32 v237, v242, v243
    v_cvt_pk_bf16_f32 v196, v242, v243
    v_exp_f32 v244, v170
    v_exp_f32 v245, v171
    s_nop 0
    v_add_f32 v237, v237, v244
    v_add_f32 v237, v237, v245
    v_cvt_pk_bf16_f32 v197, v244, v245
    v_exp_f32 v238, v164
    v_exp_f32 v239, v165
    s_nop 0
    v_add_f32 v236, v236, v238
    v_add_f32 v236, v236, v239
    v_cvt_pk_bf16_f32 v194, v238, v239
    v_exp_f32 v240, v166
    v_exp_f32 v241, v167
    s_nop 0
    v_add_f32 v236, v236, v240
    v_add_f32 v236, v236, v241
    v_cvt_pk_bf16_f32 v195, v240, v241
    v_exp_f32 v242, v172
    v_exp_f32 v243, v173
    s_nop 0
    v_add_f32 v237, v237, v242
    v_add_f32 v237, v237, v243
    v_cvt_pk_bf16_f32 v198, v242, v243
    v_exp_f32 v244, v174
    v_exp_f32 v245, v175
    s_nop 0
    v_add_f32 v237, v237, v244
    v_add_f32 v237, v237, v245
    v_cvt_pk_bf16_f32 v199, v244, v245
    s_nop 3
    s_branch R1_P31
.section .rodata,"a"
.p2align 6
.amdhsa_kernel concat_heads__mha_block_cached__mha_block_cached__near_ridge_kernel
  .amdhsa_next_free_vgpr 512
  .amdhsa_next_free_sgpr 102
  .amdhsa_accum_offset 256
  .amdhsa_group_segment_fixed_size 0
  .amdhsa_kernarg_size 104
  .amdhsa_user_sgpr_count 2
  .amdhsa_user_sgpr_kernarg_segment_ptr 1
  .amdhsa_system_sgpr_workgroup_id_x 1
  .amdhsa_float_denorm_mode_32 3
.end_amdhsa_kernel
```
